```python
import torch

def _softmax(x, axis=-1):
    return torch.softmax(x, dim=axis)

def _gelu(x):
    return torch.nn.functional.gelu(x, approximate='tanh')

def _silu(x):
    return torch.nn.functional.silu(x)

def _sigmoid(x):
    return torch.sigmoid(x)

def _layernorm(x, axis=-1, eps=1e-05):
    m = x.mean(dim=axis, keepdim=True)
    v = x.var(dim=axis, keepdim=True, unbiased=False)
    return (x - m) / torch.sqrt(v + eps)

def _scatter_add(tgt, idx, src, axis=0):
    return tgt.clone().index_add_(axis, idx, src)

def _segment_sum(src, seg, n):
    out = torch.zeros((n,) + src.shape[1:], dtype=src.dtype)
    return out.index_add_(0, seg, src)

def _pad(x, pw):
    flat = tuple((v for pair in reversed(pw) for v in pair))
    return torch.nn.functional.pad(x, flat)
kernel_name = 'gated_mix__linear_attn_block__mixer_gmlp__prompt'

def setup_inputs():

    _w = lambda a: (lambda t: t.to(torch.bfloat16) if t.is_floating_point() else t)(torch.as_tensor(a))

    def _A_setup():
        B, S, D = (1, 2048, 640)
        return {'x': _w((lambda *s: torch.randn(*s, dtype=torch.bfloat16) * 0.05)(B, S, D)), 'wqkv': _w((lambda *s: torch.randn(*s, dtype=torch.bfloat16) * 1.6)(D, 3 * D)), 'wo': _w((lambda *s: torch.randn(*s, dtype=torch.bfloat16) * 0.2)(D, D))}
    _A_in = _A_setup()

    def _B_setup():
        B, S, D, F = (1, 2048, 640, 1728)
        Fh = F // 2
        return {'x': _w((lambda *s: torch.randn(*s, dtype=torch.bfloat16) * 0.05)(B, S, D)), 'w_in': _w((lambda *s: torch.randn(*s, dtype=torch.bfloat16) * 0.4)(D, 2 * Fh)), 'w_sp': _w(0.01 * (lambda *s: torch.randn(*s, dtype=torch.bfloat16) * 0.4)(S, S)), 'b_sp': _w(1.0 + 0.01 * (lambda *s: torch.randn(*s, dtype=torch.bfloat16) * 0.05)(S)), 'w_out': _w((lambda *s: torch.randn(*s, dtype=torch.bfloat16) * 0.05)(Fh, D))}
    _B_in = _B_setup()
    return {'A_x': _A_in['x'], 'A_wqkv': _A_in['wqkv'], 'A_wo': _A_in['wo'], 'B_x': _B_in['x'], 'B_w_in': _B_in['w_in'], 'B_w_sp': _B_in['w_sp'], 'B_b_sp': _B_in['b_sp'], 'B_w_out': _B_in['w_out'], 'gate_w': _w((lambda *s: torch.randn(*s, dtype=torch.bfloat16) * 0.05)(640) * 16.0)}

def reference(A_x, A_wqkv, A_wo, B_x, B_w_in, B_w_sp, B_b_sp, B_w_out, gate_w):

    def _A_ref(x, wqkv, wo):
        B, S, D = x.shape
        H = 32
        Dh = D // H
        qkv = (lambda x, *d: x.permute(*d))((x @ wqkv).reshape(B, S, 3, H, Dh), 2, 0, 3, 1, 4)
        q, k, v = (qkv[0], qkv[1], qkv[2])
        phi = lambda t: torch.where(t > 0, t + 1, torch.exp(t)) + 1e-06
        pq, pk = (phi(q), phi(k))
        kv = torch.einsum('bhsd,bhse->bhde', pk, v)
        z = torch.einsum('bhsd->bhd', pk)
        num = torch.einsum('bhqd,bhde->bhqe', pq, kv)
        den = torch.einsum('bhqd,bhd->bhq', pq, z)[..., None] + 1e-06
        o = num / den
        return (lambda x, *d: x.permute(*d))(o, 0, 2, 1, 3).reshape(B, S, D) @ wo

    def _B_ref(x, w_in, w_sp, b_sp, w_out):
        B, S, D = x.shape
        F = w_in.shape[-1]
        Fh = F // 2
        z = _gelu(torch.einsum('bsd,df->bsf', x, w_in))
        z1 = z[..., :Fh].clone()
        z2 = _layernorm(z[..., Fh:], axis=-1)
        g = torch.einsum('ts,bsf->btf', w_sp, z2) + b_sp[None, :, None]
        return torch.einsum('bsf,fd->bsd', z1 * g, w_out)
    x = A_x
    g = _sigmoid((x * gate_w).sum(-1, keepdims=True))
    a = _A_ref(x, A_wqkv, A_wo)
    b = _B_ref(x, B_w_in, B_w_sp, B_b_sp, B_w_out)
    return g * a + (1 - g) * b
```

```asm
; @launch grid=(256,1,1) block=(256,1,1) lds=163840
.amdgcn_target "amdgcn-amd-amdhsa--gfx950"
.text
.globl gated_mix__linear_attn_block__mixer_gmlp__prompt_kernel
.p2align 8
.type gated_mix__linear_attn_block__mixer_gmlp__prompt_kernel,@function
gated_mix__linear_attn_block__mixer_gmlp__prompt_kernel:
  s_load_dwordx16 s[36:51], s[0:1], 0
  s_load_dwordx8 s[52:59], s[0:1], 64
  s_getpc_b64 s[32:33]
L_pc:
  s_cmp_ge_u32 s2, 256
  s_cbranch_scc1 L_end
  s_lshr_b32 s3, s2, 3
  v_lshrrev_b32 v238, 3, v0
  v_lshl_add_u32 v238, v238, 5, s3
  v_lshlrev_b32 v238, 7, v238
  v_min_u32 v238, L_code_end-L_pc-4, v238
  global_load_dword v237, v238, s[32:33]
  v_lshrrev_b32 v4, 6, v0
  v_and_b32 v1, 63, v0
  s_and_b32 s76, s2, 1
  v_readfirstlane_b32 s60, v4
  s_bfe_u32 s77, s2, 0x20001
  s_and_b32 s75, s3, 15
  s_lshl4_add_u32 s62, s77, s75
  s_and_b32 s78, s62, 7
  s_lshr_b32 s62, s62, 3
  s_lshl3_add_u32 s61, s76, s78
  s_lshl2_add_u32 s68, s61, s60
  v_lshrrev_b32 v8, 3, v1
  v_and_b32 v9, 7, v1
  v_lshrrev_b32 v10, 4, v1
  v_xor_b32 v9, v9, v10
  v_lshlrev_b32 v9, 4, v9
  v_lshl_add_u32 v8, s68, 5, v8
  v_mul_u32_u24 v8, 1280, v8
  v_add_u32 v4, v8, v9
  v_xor_b32 v5, 64, v4
  s_movk_i32 s75, 9216
  v_add_u32 v5, s75, v5
  v_lshl_add_u32 v6, s75, 1, v4
  v_lshl_add_u32 v7, s75, 1, v5
  s_lshl_b32 s81, s60, 14
  s_mov_b32 s34, 0x18856330
  s_mov_b32 s35, 0x63301885
  s_lshl_b32 s75, s2, 2
  s_lshr_b64 s[34:35], s[34:35], s75
  s_and_b32 s80, s34, 15
  s_mov_b32 s34, 0x98890990
  s_mov_b32 s35, 0x98890990
  s_lshr_b32 s67, s3, 3
  s_lshl3_add_u32 s75, s67, s78
  s_lshl_b32 s75, s75, 1
  s_andn2_b32 s75, s75, 3
  s_lshr_b64 s[34:35], s[34:35], s75
  s_and_b32 s34, s34, 15
  s_add_u32 s80, s80, s34
  s_sub_u32 s34, s80, 10
  s_min_u32 s80, s80, s34
  s_lshl_b32 s83, s80, 7
  s_mov_b32 s6, 2621440
  s_mov_b32 s7, 0x20000
  s_mov_b32 m0, s81
  s_lshr_b32 s75, s67, 1
  s_add_u32 s75, s75, s62
  s_cmp_eq_u32 s75, 8
  s_waitcnt lgkmcnt(0)
  s_mov_b64 s[4:5], s[36:37]
  s_cbranch_scc1 L_nox
  buffer_load_dwordx4 v4, s[4:7], s83 offen offset:0 lds
  buffer_load_dwordx4 v5, s[4:7], s83 offen offset:1024 lds
  buffer_load_dwordx4 v6, s[4:7], s83 offen offset:2048 lds
  buffer_load_dwordx4 v7, s[4:7], s83 offen offset:3072 lds
L_nox:
  s_and_b32 s79, s67, 1
  s_and_b32 s78, s3, 7
  s_mov_b32 s11, 0x20000
  s_cmp_lt_u32 s67, 2
  s_cbranch_scc1 L_qkv
  s_cmp_eq_u32 s62, 7
  s_cbranch_scc1 L_misc
  v_lshrrev_b32 v28, 4, v1
  v_and_b32 v29, 15, v1
  v_lshlrev_b32 v30, 1, v28
  v_xor_b32 v29, v29, v30
  v_lshl_add_u32 v28, s60, 4, v28
  v_mul_u32_u24 v28, 3456, v28
  s_lshl_b32 s75, s62, 8
  s_add_u32 s75, s75, 1664
  s_mul_i32 s84, s80, 221184
  s_sub_u32 s84, s84, 221184
  v_add_u32 v28, s75, v28
  v_mov_b32 v31, 1073741824
  v_lshl_add_u32 v12, v29, 4, v28
  v_lshrrev_b32 v30, 2, v29
  v_lshl_add_u32 v30, s62, 2, v30
  v_cmp_eq_u32 vcc, 0, v30
  s_nop 1
  v_cndmask_b32 v245, 0, v31, vcc
  v_cmp_eq_u32 vcc, 27, v30
  v_add_u32 v12, v12, v245
  v_add_u32 v245, 1664, v245
  v_cndmask_b32 v30, 0, v31, vcc
  v_sub_u32 v245, v245, v30
  v_add_u32 v13, 12800, v12
  v_xor_b32 v29, 8, v29
  v_add_u32 v28, 25600, v28
  v_lshl_add_u32 v14, v29, 4, v28
  v_lshrrev_b32 v30, 2, v29
  v_lshl_add_u32 v30, s62, 2, v30
  v_cmp_eq_u32 vcc, 0, v30
  s_nop 1
  v_cndmask_b32 v246, 0, v31, vcc
  v_cmp_eq_u32 vcc, 27, v30
  v_add_u32 v14, v14, v246
  v_add_u32 v246, 1664, v246
  v_cndmask_b32 v30, 0, v31, vcc
  v_sub_u32 v246, v246, v30
  v_add_u32 v15, 12800, v14
  s_lshl_b32 s82, s60, 12
  s_add_u32 s82, s82, 65536
  s_mov_b32 s10, 2211840
  s_mov_b64 s[8:9], s[44:45]
  s_add_u32 m0, s82, 0
  s_add_u32 s84, s84, 221184
  s_sub_u32 s3, s84, 2211840
  s_min_u32 s84, s84, s3
  buffer_load_dwordx4 v12, s[8:11], s84 offen offset:0 lds
  buffer_load_dwordx4 v13, s[8:11], s84 offen offset:1024 lds
  buffer_load_dwordx4 v14, s[8:11], s84 offen offset:2048 lds
  buffer_load_dwordx4 v15, s[8:11], s84 offen offset:3072 lds
  s_and_b32 s76, s2, 1
  s_lshl3_add_u32 s64, s77, s78
  s_lshl2_add_u32 s66, s76, s67
  s_lshl1_add_u32 s65, s76, s79
  s_lshr_b32 s79, s67, 1
  s_lshl1_add_u32 s65, s65, s79
  v_cmp_eq_u32 vcc, 0, v1
  v_mov_b32 v3, 1073741824
  s_nop 0
  v_cndmask_b32_e64 v3, v3, 0, vcc
  s_mov_b64 s[12:13], s[58:59]
  s_mov_b32 s14, 33554432
  s_mov_b32 s15, 0x20000
  s_mov_b64 s[16:17], s[46:47]
  s_mov_b32 s18, 8388608
  s_mov_b32 s19, 0x20000
  s_mov_b64 s[20:21], s[54:55]
  s_mov_b32 s22, 2621440
  s_mov_b32 s23, 0x20000
  s_mov_b64 s[24:25], s[48:49]
  s_mov_b32 s26, 4096
  s_mov_b32 s27, 0x20000
  s_mov_b64 s[28:29], s[52:53]
  s_mov_b32 s30, 1280
  s_mov_b32 s31, 0x20000
  v_mov_b32 v2, 19931136
  buffer_load_dword v2, v2, s[12:15], 0 offen sc1
  v_and_b32 v30, 15, v1
  v_lshrrev_b32 v31, 1, v30
  v_lshrrev_b32 v8, 4, v1
  v_xor_b32 v31, v31, v8
  v_lshlrev_b32 v31, 4, v31
  v_lshl_add_u32 v30, v30, 7, v31
  v_add_u32 v8, s81, v30
  v_xor_b32 v9, 64, v8
  v_bfe_u32 v28, v1, 2, 2
  v_lshrrev_b32 v29, 4, v1
  v_lshl_add_u32 v30, v29, 3, v28
  v_lshlrev_b32 v30, 8, v30
  v_and_b32 v29, 1, v29
  v_lshl_add_u32 v28, v29, 2, v28
  v_lshl_add_u32 v30, v28, 5, v30
  v_and_b32 v28, 3, v1
  v_lshl_add_u32 v30, v28, 3, v30
  v_add_u32 v22, 65536, v30
  v_xor_b32 v23, 32, v22
  v_xor_b32 v24, 64, v22
  v_xor_b32 v25, 96, v22
  v_xor_b32 v26, 128, v22
  v_xor_b32 v27, 160, v22
  v_xor_b32 v28, 192, v22
  v_xor_b32 v29, 224, v22
  s_lshl_b32 s89, s60, 13
  s_add_u32 s89, s89, 131072
  s_lshl_b32 s52, s64, 18
  s_lshl_b32 s53, s60, 10
  s_add_u32 s52, s52, s53
  s_and_b32 s53, s2, 1
  s_mul_i32 s53, s53, 2
  s_and_b32 s54, s67, 1
  s_mul_i32 s54, s54, 1
  s_xor_b32 s53, s53, s54
  s_lshl_b32 s53, s53, 1
  s_lshl_b32 s54, s64, 0
  s_and_b32 s54, s54, 6
  s_xor_b32 s53, s53, s54
  s_lshl_b32 s95, s53, 11
  s_lshl_b32 s53, s53, 7
  s_add_u32 s52, s52, s53
  s_add_u32 s53, s60, 0
  s_and_b32 s53, s53, 3
  s_lshl_b32 s53, s53, 16
  s_add_u32 s70, s52, s53
  s_add_u32 s53, s60, 1
  s_and_b32 s53, s53, 3
  s_lshl_b32 s53, s53, 16
  s_add_u32 s71, s52, s53
  s_add_u32 s53, s60, 2
  s_and_b32 s53, s53, 3
  s_lshl_b32 s53, s53, 16
  s_add_u32 s72, s52, s53
  s_add_u32 s53, s60, 3
  s_and_b32 s53, s53, 3
  s_lshl_b32 s53, s53, 16
  s_add_u32 s73, s52, s53
  s_lshr_b32 s52, s65, 1
  s_and_b32 s53, s65, 1
  s_mul_i32 s52, s52, 14
  s_mul_i32 s54, s53, 6
  s_add_u32 s85, s52, s54
  s_mul_i32 s52, s60, 16384
  s_add_u32 s52, s52, 196608
  s_mul_i32 s36, s85, 65536
  s_add_u32 s36, s36, s52
  s_mov_b32 s52, s85
  s_lshl_b32 s53, s53, 1
  s_add_u32 s53, s53, s85
  s_add_u32 s53, s53, 5
  s_min_u32 s53, s53, 53
  s_add_u32 s38, s52, 2
  s_add_u32 s39, s53, 2
  s_lshr_b32 s38, s38, 3
  s_lshr_b32 s39, s39, 3
  s_sub_u32 s39, s39, s38
  s_lshl_b32 s39, s39, 11
  s_lshl_b32 s38, s38, 11
  s_lshl_b32 s54, s60, 9
  s_add_u32 s38, s38, s54
  s_add_u32 s38, s38, 19988480
  s_lshr_b32 s52, s52, 3
  s_lshr_b32 s53, s53, 3
  s_lshl_b32 s52, s52, 11
  s_lshl_b32 s53, s53, 11
  s_lshl_b32 s42, s64, 2
  s_add_u32 s42, s42, s60
  s_lshr_b32 s54, s42, 3
  s_lshl_b32 s54, s54, 7
  s_add_u32 s52, s52, s54
  s_add_u32 s53, s53, s54
  s_bfe_u32 s54, s42, 0x20001
  s_lshl_b32 s54, s54, 2
  s_add_u32 s54, s54, 20054016
  s_add_u32 s52, s52, s54
  s_add_u32 s53, s53, s54
  v_and_b32 v252, 15, v1
  s_sub_u32 s53, s53, s52
  v_bfe_u32 v254, v1, 4, 1
  v_mul_u32_u24 v254, s53, v254
  v_add_u32 v254, s52, v254
  s_lshl_b32 s52, s42, 4
  v_add_u32 v252, s52, v252
  v_lshlrev_b32 v250, 3, v252
  v_add_u32 v250, 19660800, v250
  v_lshlrev_b32 v252, 1, v252
  buffer_load_ushort v251, v252, s[24:27], 0 offen
  v_lshlrev_b32 v253, 4, v1
  s_lshr_b32 s52, s85, 1
  s_lshl_b32 s52, s52, 10
  v_add_u32 v248, s52, v253
  s_mul_i32 s87, s42, 27648
  s_add_u32 s87, s87, 4194304
  s_mul_i32 s88, s42, 48128
  s_add_u32 s88, s88, 8409088
  s_mul_i32 s52, s66, 5120
  s_add_u32 s52, s52, 16777216
  s_cmp_eq_u32 s60, 3
  s_cselect_b32 s43, 1073741824, 0
  s_mul_i32 s44, s60, 204800
  s_add_u32 s44, s44, s52
  s_mul_i32 s45, s60, 286720
  s_add_u32 m0, s81, 4096
  s_add_u32 s83, s83, 128
  s_sub_u32 s3, s83, 1280
  s_min_u32 s83, s83, s3
  buffer_load_dwordx4 v4, s[4:7], s83 offen offset:0 lds
  s_add_u32 s45, s45, s52
  s_add_u32 s45, s45, 819200
  s_mul_i32 s46, s60, 5120
  s_add_u32 s46, s46, 8388608
  s_lshl_b32 s47, s60, 11
  s_add_u32 s47, s47, 20480
  s_lshr_b32 s48, s64, 1
  s_lshl_b32 s48, s48, 10
  s_and_b32 s52, s64, 1
  s_lshl_b32 s52, s52, 3
  s_add_u32 s48, s48, s52
  s_lshl_b32 s52, s60, 8
  s_add_u32 s48, s48, s52
  s_add_u32 s48, s48, 20185088
  s_lshl_b32 s52, s64, 10
  s_add_u32 s52, s52, 20250624
  s_lshl_b32 s53, s65, 7
  s_lshl_b32 s54, s60, 2
  s_add_u32 s53, s53, s54
  s_add_u32 s49, s52, s53
  s_lshl_b32 s54, s60, 8
  s_add_u32 s55, s52, s54
  s_mul_i32 s54, s67, 1
  s_add_u32 s54, s54, s60
  buffer_load_dwordx4 v5, s[4:7], s83 offen offset:1024 lds
  s_and_b32 s52, s54, 3
  s_lshl_b32 s53, s64, 2
  s_add_u32 s52, s52, s53
  s_mul_i32 s58, s52, 20480
  s_mul_i32 s52, s66, 160
  s_add_u32 s58, s58, s52
  s_and_b32 s52, s64, 7
  s_and_b32 s53, s65, 1
  s_lshl_b32 s53, s53, 3
  s_add_u32 s52, s52, s53
  s_lshl_b32 s52, s52, 1
  s_lshr_b32 s52, 0x0, s52
  s_and_b32 s52, s52, 3
  s_and_b32 s101, s65, 1
  s_add_u32 s101, s101, 3
  s_cmp_eq_u32 s65, 7
  s_cselect_b32 s59, 2, 3
  s_min_u32 s53, s52, s59
  s_lshl_b32 s53, s53, 17
  s_or_b32 s85, s53, s95
  s_add_u32 s52, s52, 1
  s_sub_u32 s53, s52, s101
  s_min_u32 s52, s52, s53
  s_min_u32 s53, s52, s59
  buffer_load_dwordx4 v6, s[4:7], s83 offen offset:2048 lds
  s_lshl_b32 s53, s53, 17
  s_or_b32 s86, s53, s95
  s_add_u32 s52, s52, 1
  s_sub_u32 s53, s52, s101
  s_min_u32 s52, s52, s53
  s_min_u32 s53, s52, s59
  s_lshl_b32 s53, s53, 17
  s_or_b32 s91, s53, s95
  s_add_u32 s52, s52, 1
  s_sub_u32 s53, s52, s101
  s_min_u32 s52, s52, s53
  s_min_u32 s53, s52, s59
  s_lshl_b32 s53, s53, 17
  s_or_b32 s37, s53, s95
  s_add_u32 s52, s52, 1
  s_sub_u32 s53, s52, s101
  s_min_u32 s52, s52, s53
  s_add_u32 s52, s54, 0
  s_and_b32 s52, s52, 3
  s_lshl_b32 s53, s64, 2
  s_add_u32 s52, s52, s53
  s_mul_i32 s52, s52, 48128
  s_add_u32 s40, s52, s46
  s_add_u32 s52, s54, 1
  buffer_load_dwordx4 v7, s[4:7], s83 offen offset:3072 lds
  s_and_b32 s52, s52, 3
  s_lshl_b32 s53, s64, 2
  s_add_u32 s52, s52, s53
  s_mul_i32 s52, s52, 48128
  s_add_u32 s41, s52, s46
  s_add_u32 s52, s54, 2
  s_and_b32 s52, s52, 3
  s_lshl_b32 s53, s64, 2
  s_add_u32 s52, s52, s53
  s_mul_i32 s52, s52, 48128
  s_add_u32 s50, s52, s46
  s_add_u32 s52, s54, 3
  s_and_b32 s52, s52, 3
  s_lshl_b32 s53, s64, 2
  s_add_u32 s52, s52, s53
  s_mul_i32 s52, s52, 48128
  s_add_u32 s51, s52, s46
  v_mov_b32 v16, 0xc0135761
  v_mov_b32 v17, 0xbdd2d3e8
  v_mov_b32 v36, 0
  v_mov_b32 v37, 0
  v_mov_b32 v38, 0
  v_mov_b32 v39, 0
  v_lshlrev_b32 v34, 4, v1
  s_add_u32 m0, s82, 16384
  s_add_u32 s84, s84, 221184
  s_sub_u32 s3, s84, 2211840
  s_min_u32 s84, s84, s3
  buffer_load_dwordx4 v12, s[8:11], s84 offen offset:0 lds
  v_mov_b32 v30, 1073741824
  v_cmp_gt_u32 vcc, 32, v1
  s_nop 1
  v_cndmask_b32 v35, v30, v34, vcc
  v_and_b32 v20, 511, v34
  v_cndmask_b32_e64 v21, 0, 1.0, vcc
  v_and_b32 v30, 15, v1
  v_lshrrev_b32 v31, 4, v1
  v_mul_u32_u24 v30, 136, v30
  v_lshl_add_u32 v30, v31, 3, v30
  v_add_u32 v10, s89, v30
  v_lshrrev_b32 v30, 4, v1
  v_bfe_u32 v31, v1, 2, 2
  v_lshl_add_u32 v30, v30, 3, v31
  v_mul_u32_u24 v30, 136, v30
  v_and_b32 v31, 3, v1
  v_lshl_add_u32 v30, v31, 3, v30
  v_add_u32 v11, s89, v30
  s_mul_i32 s76, s68, 55296
  s_lshl_b32 s75, s62, 12
  s_add_u32 s75, s75, s76
  s_add_u32 s75, s75, 4194304
  v_add_u32 v240, s75, v34
  s_cmp_eq_u32 s62, 6
  s_cselect_b32 s76, 1073741824, 0
  buffer_load_dwordx4 v13, s[8:11], s84 offen offset:1024 lds
  v_add_u32 v241, s76, v240
  s_and_b32 s75, s68, 15
  s_lshl_b32 s75, s75, 10
  s_lshr_b32 s76, s68, 4
  s_mul_i32 s76, s76, 16384
  s_add_u32 s75, s75, s76
  s_mul_i32 s76, s62, 524288
  s_add_u32 s75, s75, s76
  s_add_u32 s75, s75, 65536
  v_add_u32 v33, s75, v34
  s_cmp_eq_u32 s62, 0
  s_cselect_b32 s76, 1073741824, 0
  v_add_u32 v32, s76, v33
  s_lshl_b32 s78, s68, 12
  s_add_u32 s78, s78, 19136512
  s_lshl_b32 s79, s62, 9
  s_add_u32 s79, s79, s78
  s_lshl_b32 s80, s62, 11
  s_lshl_b32 s75, s61, 7
  s_add_u32 s80, s80, s75
  s_lshl_b32 s75, s60, 2
  s_add_u32 s80, s80, s75
  s_add_u32 s90, s80, 20054016
  s_add_u32 s80, s80, 19988480
  buffer_load_dwordx4 v14, s[8:11], s84 offen offset:2048 lds
  v_lshlrev_b32 v242, 4, v1
  v_add_u32 v242, s36, v242
  s_cmp_eq_u32 s65, 7
  s_cselect_b32 s59, 1073741824, 0
  v_bfe_u32 v243, v1, 4, 1
  v_mul_u32_u24 v243, s39, v243
  v_add_u32 v243, s38, v243
  v_and_b32 v244, 3, v1
  v_lshl_add_u32 v243, v244, 2, v243
  v_bfe_u32 v244, v1, 2, 2
  v_lshl_add_u32 v243, v244, 7, v243
  s_lshl_b32 s52, s60, 9
  s_add_u32 s52, s52, 19927040
  v_bfe_u32 v30, v1, 3, 2
  v_lshl_add_u32 v30, v30, 7, s52
  v_cmp_gt_u32 vcc, 32, v1
  s_nop 1
  v_cndmask_b32 v244, v30, v243, vcc
  buffer_load_dwordx4 v15, s[8:11], s84 offen offset:3072 lds
  s_waitcnt vmcnt(10)
  s_barrier
  ds_read_b128 a[0:3], v8 offset:0
  ds_read_b128 a[4:7], v8 offset:2048
  ds_read_b64_tr_b16 v[40:41], v22 offset:0
  ds_read_b64_tr_b16 v[42:43], v22 offset:1024
  ds_read_b128 a[8:11], v9 offset:0
  ds_read_b128 a[12:15], v9 offset:2048
  ds_read_b64_tr_b16 v[44:45], v22 offset:8192
  ds_read_b64_tr_b16 v[46:47], v22 offset:9216
  ds_read_b64_tr_b16 v[48:49], v23 offset:0
  ds_read_b64_tr_b16 v[50:51], v23 offset:1024
  ds_read_b64_tr_b16 v[52:53], v23 offset:8192
  ds_read_b64_tr_b16 v[54:55], v23 offset:9216
  ds_read_b64_tr_b16 v[56:57], v24 offset:0
  ds_read_b64_tr_b16 v[58:59], v24 offset:1024
  s_waitcnt lgkmcnt(6)
  v_mfma_f32_16x16x32_bf16 v[128:131], v[40:43], a[0:3], 0
  v_mfma_f32_16x16x32_bf16 v[128:131], v[44:47], a[8:11], v[128:131]
  ds_read_b64_tr_b16 v[60:61], v24 offset:8192
  ds_read_b64_tr_b16 v[62:63], v24 offset:9216
  s_add_u32 m0, s81, 8192
  v_mfma_f32_16x16x32_bf16 v[132:135], v[44:47], a[12:15], 0
  s_add_u32 s83, s83, 128
  s_sub_u32 s3, s83, 1280
  s_min_u32 s83, s83, s3
  v_mfma_f32_16x16x32_bf16 v[132:135], v[40:43], a[4:7], v[132:135]
  ds_read_b64_tr_b16 v[40:41], v25 offset:0
  ds_read_b64_tr_b16 v[42:43], v25 offset:1024
  s_waitcnt lgkmcnt(6)
  v_mfma_f32_16x16x32_bf16 v[136:139], v[48:51], a[0:3], 0
  buffer_load_dwordx4 v4, s[4:7], s83 offen offset:0 lds
  v_mfma_f32_16x16x32_bf16 v[136:139], v[52:55], a[8:11], v[136:139]
  ds_read_b64_tr_b16 v[44:45], v25 offset:8192
  ds_read_b64_tr_b16 v[46:47], v25 offset:9216
  v_mfma_f32_16x16x32_bf16 v[140:143], v[52:55], a[12:15], 0
  buffer_load_dwordx4 v5, s[4:7], s83 offen offset:1024 lds
  v_mfma_f32_16x16x32_bf16 v[140:143], v[48:51], a[4:7], v[140:143]
  ds_read_b64_tr_b16 v[48:49], v26 offset:0
  s_waitcnt lgkmcnt(5)
  v_mfma_f32_16x16x32_bf16 v[144:147], v[56:59], a[0:3], 0
  ds_read_b64_tr_b16 v[50:51], v26 offset:1024
  v_mfma_f32_16x16x32_bf16 v[144:147], v[60:63], a[8:11], v[144:147]
  ds_read_b64_tr_b16 v[52:53], v26 offset:8192
  ds_read_b64_tr_b16 v[54:55], v26 offset:9216
  v_mfma_f32_16x16x32_bf16 v[148:151], v[60:63], a[12:15], 0
  buffer_load_dwordx4 v6, s[4:7], s83 offen offset:2048 lds
  v_mfma_f32_16x16x32_bf16 v[148:151], v[56:59], a[4:7], v[148:151]
  ds_read_b64_tr_b16 v[56:57], v27 offset:0
  ds_read_b64_tr_b16 v[58:59], v27 offset:1024
  s_waitcnt lgkmcnt(6)
  v_mfma_f32_16x16x32_bf16 v[152:155], v[40:43], a[0:3], 0
  buffer_load_dwordx4 v7, s[4:7], s83 offen offset:3072 lds
  s_add_u32 m0, s82, 32768
  v_mfma_f32_16x16x32_bf16 v[152:155], v[44:47], a[8:11], v[152:155]
  ds_read_b64_tr_b16 v[60:61], v27 offset:8192
  ds_read_b64_tr_b16 v[62:63], v27 offset:9216
  s_add_u32 s84, s84, 221184
  v_mfma_f32_16x16x32_bf16 v[156:159], v[44:47], a[12:15], 0
  s_sub_u32 s3, s84, 2211840
  s_min_u32 s84, s84, s3
  v_mfma_f32_16x16x32_bf16 v[156:159], v[40:43], a[4:7], v[156:159]
  ds_read_b64_tr_b16 v[40:41], v28 offset:0
  ds_read_b64_tr_b16 v[42:43], v28 offset:1024
  s_waitcnt lgkmcnt(6)
  v_mfma_f32_16x16x32_bf16 v[160:163], v[48:51], a[0:3], 0
  buffer_load_dwordx4 v12, s[8:11], s84 offen offset:0 lds
  v_mfma_f32_16x16x32_bf16 v[160:163], v[52:55], a[8:11], v[160:163]
  ds_read_b64_tr_b16 v[44:45], v28 offset:8192
  v_mfma_f32_16x16x32_bf16 v[164:167], v[52:55], a[12:15], 0
  ds_read_b64_tr_b16 v[46:47], v28 offset:9216
  v_mfma_f32_16x16x32_bf16 v[164:167], v[48:51], a[4:7], v[164:167]
  ds_read_b64_tr_b16 v[48:49], v29 offset:0
  ds_read_b64_tr_b16 v[50:51], v29 offset:1024
  s_waitcnt lgkmcnt(6)
  v_mfma_f32_16x16x32_bf16 v[168:171], v[56:59], a[0:3], 0
  buffer_load_dwordx4 v13, s[8:11], s84 offen offset:1024 lds
  v_mfma_f32_16x16x32_bf16 v[168:171], v[60:63], a[8:11], v[168:171]
  ds_read_b64_tr_b16 v[52:53], v29 offset:8192
  v_mfma_f32_16x16x32_bf16 v[172:175], v[60:63], a[12:15], 0
  ds_read_b64_tr_b16 v[54:55], v29 offset:9216
  v_mfma_f32_16x16x32_bf16 v[172:175], v[56:59], a[4:7], v[172:175]
  s_waitcnt vmcnt(6)
  s_barrier
  ds_read_b128 a[16:19], v8 offset:4096
  ds_read_b128 a[20:23], v8 offset:6144
  s_waitcnt lgkmcnt(6)
  v_mfma_f32_16x16x32_bf16 v[176:179], v[40:43], a[0:3], 0
  ds_read_b64_tr_b16 v[56:57], v22 offset:16384
  ds_read_b64_tr_b16 v[58:59], v22 offset:17408
  buffer_load_dwordx4 v14, s[8:11], s84 offen offset:2048 lds
  v_mfma_f32_16x16x32_bf16 v[176:179], v[44:47], a[8:11], v[176:179]
  ds_read_b128 a[24:27], v9 offset:4096
  ds_read_b128 a[28:31], v9 offset:6144
  ds_read_b64_tr_b16 v[60:61], v22 offset:24576
  v_mfma_f32_16x16x32_bf16 v[180:183], v[44:47], a[12:15], 0
  ds_read_b64_tr_b16 v[62:63], v22 offset:25600
  buffer_load_dwordx4 v15, s[8:11], s84 offen offset:3072 lds
  v_mfma_f32_16x16x32_bf16 v[180:183], v[40:43], a[4:7], v[180:183]
  ds_read_b64_tr_b16 v[40:41], v23 offset:16384
  ds_read_b64_tr_b16 v[42:43], v23 offset:17408
  s_waitcnt lgkmcnt(10)
  v_mfma_f32_16x16x32_bf16 v[184:187], v[48:51], a[0:3], 0
  s_add_u32 m0, s81, 12288
  s_add_u32 s83, s83, 128
  s_sub_u32 s3, s83, 1280
  v_mfma_f32_16x16x32_bf16 v[184:187], v[52:55], a[8:11], v[184:187]
  ds_read_b64_tr_b16 v[44:45], v23 offset:24576
  ds_read_b64_tr_b16 v[46:47], v23 offset:25600
  s_min_u32 s83, s83, s3
  v_mfma_f32_16x16x32_bf16 v[188:191], v[52:55], a[12:15], 0
  buffer_load_dwordx4 v4, s[4:7], s83 offen offset:0 lds
  v_mfma_f32_16x16x32_bf16 v[188:191], v[48:51], a[4:7], v[188:191]
  ds_read_b64_tr_b16 v[48:49], v24 offset:16384
  s_waitcnt lgkmcnt(5)
  v_mfma_f32_16x16x32_bf16 v[128:131], v[56:59], a[16:19], v[128:131]
  ds_read_b64_tr_b16 v[50:51], v24 offset:17408
  v_mfma_f32_16x16x32_bf16 v[128:131], v[60:63], a[24:27], v[128:131]
  ds_read_b64_tr_b16 v[52:53], v24 offset:24576
  ds_read_b64_tr_b16 v[54:55], v24 offset:25600
  v_mfma_f32_16x16x32_bf16 v[132:135], v[60:63], a[28:31], v[132:135]
  buffer_load_dwordx4 v5, s[4:7], s83 offen offset:1024 lds
  v_mfma_f32_16x16x32_bf16 v[132:135], v[56:59], a[20:23], v[132:135]
  ds_read_b64_tr_b16 v[56:57], v25 offset:16384
  ds_read_b64_tr_b16 v[58:59], v25 offset:17408
  s_waitcnt lgkmcnt(6)
  v_mfma_f32_16x16x32_bf16 v[136:139], v[40:43], a[16:19], v[136:139]
  buffer_load_dwordx4 v6, s[4:7], s83 offen offset:2048 lds
  v_mfma_f32_16x16x32_bf16 v[136:139], v[44:47], a[24:27], v[136:139]
  ds_read_b64_tr_b16 v[60:61], v25 offset:24576
  v_mfma_f32_16x16x32_bf16 v[140:143], v[44:47], a[28:31], v[140:143]
  ds_read_b64_tr_b16 v[62:63], v25 offset:25600
  v_mfma_f32_16x16x32_bf16 v[140:143], v[40:43], a[20:23], v[140:143]
  ds_read_b64_tr_b16 v[40:41], v26 offset:16384
  ds_read_b64_tr_b16 v[42:43], v26 offset:17408
  s_waitcnt lgkmcnt(6)
  v_mfma_f32_16x16x32_bf16 v[144:147], v[48:51], a[16:19], v[144:147]
  buffer_load_dwordx4 v7, s[4:7], s83 offen offset:3072 lds
  s_add_u32 m0, s82, 49152
  v_mfma_f32_16x16x32_bf16 v[144:147], v[52:55], a[24:27], v[144:147]
  ds_read_b64_tr_b16 v[44:45], v26 offset:24576
  ds_read_b64_tr_b16 v[46:47], v26 offset:25600
  s_add_u32 s84, s84, 221184
  v_mfma_f32_16x16x32_bf16 v[148:151], v[52:55], a[28:31], v[148:151]
  s_sub_u32 s3, s84, 2211840
  s_min_u32 s84, s84, s3
  v_mfma_f32_16x16x32_bf16 v[148:151], v[48:51], a[20:23], v[148:151]
  ds_read_b64_tr_b16 v[48:49], v27 offset:16384
  ds_read_b64_tr_b16 v[50:51], v27 offset:17408
  s_waitcnt lgkmcnt(6)
  v_mfma_f32_16x16x32_bf16 v[152:155], v[56:59], a[16:19], v[152:155]
  buffer_load_dwordx4 v12, s[8:11], s84 offen offset:0 lds
  v_mfma_f32_16x16x32_bf16 v[152:155], v[60:63], a[24:27], v[152:155]
  ds_read_b64_tr_b16 v[52:53], v27 offset:24576
  ds_read_b64_tr_b16 v[54:55], v27 offset:25600
  v_mfma_f32_16x16x32_bf16 v[156:159], v[60:63], a[28:31], v[156:159]
  buffer_load_dwordx4 v13, s[8:11], s84 offen offset:1024 lds
  v_mfma_f32_16x16x32_bf16 v[156:159], v[56:59], a[20:23], v[156:159]
  ds_read_b64_tr_b16 v[56:57], v28 offset:16384
  s_waitcnt lgkmcnt(5)
  v_mfma_f32_16x16x32_bf16 v[160:163], v[40:43], a[16:19], v[160:163]
  ds_read_b64_tr_b16 v[58:59], v28 offset:17408
  v_mfma_f32_16x16x32_bf16 v[160:163], v[44:47], a[24:27], v[160:163]
  ds_read_b64_tr_b16 v[60:61], v28 offset:24576
  ds_read_b64_tr_b16 v[62:63], v28 offset:25600
  v_mfma_f32_16x16x32_bf16 v[164:167], v[44:47], a[28:31], v[164:167]
  buffer_load_dwordx4 v14, s[8:11], s84 offen offset:2048 lds
  v_mfma_f32_16x16x32_bf16 v[164:167], v[40:43], a[20:23], v[164:167]
  ds_read_b64_tr_b16 v[40:41], v29 offset:16384
  s_waitcnt lgkmcnt(5)
  v_mfma_f32_16x16x32_bf16 v[168:171], v[48:51], a[16:19], v[168:171]
  ds_read_b64_tr_b16 v[42:43], v29 offset:17408
  v_mfma_f32_16x16x32_bf16 v[168:171], v[52:55], a[24:27], v[168:171]
  ds_read_b64_tr_b16 v[44:45], v29 offset:24576
  ds_read_b64_tr_b16 v[46:47], v29 offset:25600
  buffer_load_dwordx4 v15, s[8:11], s84 offen offset:3072 lds
  v_mfma_f32_16x16x32_bf16 v[172:175], v[52:55], a[28:31], v[172:175]
  v_add_u32 v2, 2654435761, v2
  s_nop 0
  v_readfirstlane_b32 s63, v2
  v_mfma_f32_16x16x32_bf16 v[172:175], v[48:51], a[20:23], v[172:175]
  s_waitcnt vmcnt(8)
  s_barrier
  ds_read_b128 a[32:35], v8 offset:8192
  s_waitcnt lgkmcnt(5)
  v_mfma_f32_16x16x32_bf16 v[176:179], v[56:59], a[16:19], v[176:179]
  ds_read_b128 a[36:39], v8 offset:10240
  ds_read_b64_tr_b16 v[48:49], v22 offset:32768
  ds_read_b64_tr_b16 v[50:51], v22 offset:33792
  v_mfma_f32_16x16x32_bf16 v[176:179], v[60:63], a[24:27], v[176:179]
  ds_read_b128 a[40:43], v9 offset:8192
  ds_read_b128 a[44:47], v9 offset:10240
  ds_read_b64_tr_b16 v[52:53], v22 offset:40960
  v_mfma_f32_16x16x32_bf16 v[180:183], v[60:63], a[28:31], v[180:183]
  ds_read_b64_tr_b16 v[54:55], v22 offset:41984
  s_add_u32 m0, s81, 0
  s_add_u32 s83, s83, 128
  v_mfma_f32_16x16x32_bf16 v[180:183], v[56:59], a[20:23], v[180:183]
  ds_read_b64_tr_b16 v[56:57], v23 offset:32768
  ds_read_b64_tr_b16 v[58:59], v23 offset:33792
  s_sub_u32 s3, s83, 1280
  s_waitcnt lgkmcnt(10)
  v_mfma_f32_16x16x32_bf16 v[184:187], v[40:43], a[16:19], v[184:187]
  s_min_u32 s83, s83, s3
  buffer_load_dwordx4 v4, s[4:7], s83 offen offset:0 lds
  v_mfma_f32_16x16x32_bf16 v[184:187], v[44:47], a[24:27], v[184:187]
  ds_read_b64_tr_b16 v[60:61], v23 offset:40960
  ds_read_b64_tr_b16 v[62:63], v23 offset:41984
  v_mfma_f32_16x16x32_bf16 v[188:191], v[44:47], a[28:31], v[188:191]
  buffer_load_dwordx4 v5, s[4:7], s83 offen offset:1024 lds
  v_mfma_f32_16x16x32_bf16 v[188:191], v[40:43], a[20:23], v[188:191]
  ds_read_b64_tr_b16 v[40:41], v24 offset:32768
  ds_read_b64_tr_b16 v[42:43], v24 offset:33792
  s_waitcnt lgkmcnt(6)
  v_mfma_f32_16x16x32_bf16 v[128:131], v[48:51], a[32:35], v[128:131]
  buffer_load_dwordx4 v6, s[4:7], s83 offen offset:2048 lds
  v_mfma_f32_16x16x32_bf16 v[128:131], v[52:55], a[40:43], v[128:131]
  ds_read_b64_tr_b16 v[44:45], v24 offset:40960
  v_mfma_f32_16x16x32_bf16 v[132:135], v[52:55], a[44:47], v[132:135]
  ds_read_b64_tr_b16 v[46:47], v24 offset:41984
  v_mfma_f32_16x16x32_bf16 v[132:135], v[48:51], a[36:39], v[132:135]
  ds_read_b64_tr_b16 v[48:49], v25 offset:32768
  ds_read_b64_tr_b16 v[50:51], v25 offset:33792
  s_waitcnt lgkmcnt(6)
  v_mfma_f32_16x16x32_bf16 v[136:139], v[56:59], a[32:35], v[136:139]
  buffer_load_dwordx4 v7, s[4:7], s83 offen offset:3072 lds
  s_add_u32 m0, s82, 0
  v_mfma_f32_16x16x32_bf16 v[136:139], v[60:63], a[40:43], v[136:139]
  ds_read_b64_tr_b16 v[52:53], v25 offset:40960
  ds_read_b64_tr_b16 v[54:55], v25 offset:41984
  s_add_u32 s84, s84, 221184
  v_mfma_f32_16x16x32_bf16 v[140:143], v[60:63], a[44:47], v[140:143]
  s_sub_u32 s3, s84, 2211840
  s_min_u32 s84, s84, s3
  v_mfma_f32_16x16x32_bf16 v[140:143], v[56:59], a[36:39], v[140:143]
  ds_read_b64_tr_b16 v[56:57], v26 offset:32768
  ds_read_b64_tr_b16 v[58:59], v26 offset:33792
  s_waitcnt lgkmcnt(6)
  v_mfma_f32_16x16x32_bf16 v[144:147], v[40:43], a[32:35], v[144:147]
  buffer_load_dwordx4 v12, s[8:11], s84 offen offset:0 lds
  v_mfma_f32_16x16x32_bf16 v[144:147], v[44:47], a[40:43], v[144:147]
  ds_read_b64_tr_b16 v[60:61], v26 offset:40960
  ds_read_b64_tr_b16 v[62:63], v26 offset:41984
  v_mfma_f32_16x16x32_bf16 v[148:151], v[44:47], a[44:47], v[148:151]
  buffer_load_dwordx4 v13, s[8:11], s84 offen offset:1024 lds
  v_mfma_f32_16x16x32_bf16 v[148:151], v[40:43], a[36:39], v[148:151]
  ds_read_b64_tr_b16 v[40:41], v27 offset:32768
  s_waitcnt lgkmcnt(5)
  v_mfma_f32_16x16x32_bf16 v[152:155], v[48:51], a[32:35], v[152:155]
  ds_read_b64_tr_b16 v[42:43], v27 offset:33792
  v_mfma_f32_16x16x32_bf16 v[152:155], v[52:55], a[40:43], v[152:155]
  ds_read_b64_tr_b16 v[44:45], v27 offset:40960
  ds_read_b64_tr_b16 v[46:47], v27 offset:41984
  v_mfma_f32_16x16x32_bf16 v[156:159], v[52:55], a[44:47], v[156:159]
  buffer_load_dwordx4 v14, s[8:11], s84 offen offset:2048 lds
  v_mfma_f32_16x16x32_bf16 v[156:159], v[48:51], a[36:39], v[156:159]
  ds_read_b64_tr_b16 v[48:49], v28 offset:32768
  s_waitcnt lgkmcnt(5)
  v_mfma_f32_16x16x32_bf16 v[160:163], v[56:59], a[32:35], v[160:163]
  ds_read_b64_tr_b16 v[50:51], v28 offset:33792
  v_mfma_f32_16x16x32_bf16 v[160:163], v[60:63], a[40:43], v[160:163]
  ds_read_b64_tr_b16 v[52:53], v28 offset:40960
  ds_read_b64_tr_b16 v[54:55], v28 offset:41984
  buffer_load_dwordx4 v15, s[8:11], s84 offen offset:3072 lds
  v_mfma_f32_16x16x32_bf16 v[164:167], v[60:63], a[44:47], v[164:167]
  s_add_u32 m0, s81, 4096
  s_add_u32 s83, s83, 128
  v_mfma_f32_16x16x32_bf16 v[164:167], v[56:59], a[36:39], v[164:167]
  ds_read_b64_tr_b16 v[56:57], v29 offset:32768
  ds_read_b64_tr_b16 v[58:59], v29 offset:33792
  s_waitcnt lgkmcnt(6)
  v_mfma_f32_16x16x32_bf16 v[168:171], v[40:43], a[32:35], v[168:171]
  s_sub_u32 s3, s83, 1280
  s_min_u32 s83, s83, s3
  v_mfma_f32_16x16x32_bf16 v[168:171], v[44:47], a[40:43], v[168:171]
  ds_read_b64_tr_b16 v[60:61], v29 offset:40960
  ds_read_b64_tr_b16 v[62:63], v29 offset:41984
  v_mfma_f32_16x16x32_bf16 v[172:175], v[44:47], a[44:47], v[172:175]
  buffer_load_dwordx4 v4, s[4:7], s83 offen offset:0 lds
  v_mfma_f32_16x16x32_bf16 v[172:175], v[40:43], a[36:39], v[172:175]
  s_waitcnt vmcnt(9)
  s_barrier
  ds_read_b128 a[48:51], v8 offset:12288
  s_waitcnt lgkmcnt(5)
  v_mfma_f32_16x16x32_bf16 v[176:179], v[48:51], a[32:35], v[176:179]
  ds_read_b128 a[52:55], v8 offset:14336
  ds_read_b64_tr_b16 v[40:41], v22 offset:49152
  ds_read_b64_tr_b16 v[42:43], v22 offset:50176
  v_mfma_f32_16x16x32_bf16 v[176:179], v[52:55], a[40:43], v[176:179]
  ds_read_b128 a[56:59], v9 offset:12288
  ds_read_b128 a[60:63], v9 offset:14336
  ds_read_b64_tr_b16 v[44:45], v22 offset:57344
  v_mfma_f32_16x16x32_bf16 v[180:183], v[52:55], a[44:47], v[180:183]
  ds_read_b64_tr_b16 v[46:47], v22 offset:58368
  buffer_load_dwordx4 v5, s[4:7], s83 offen offset:1024 lds
  v_mfma_f32_16x16x32_bf16 v[180:183], v[48:51], a[36:39], v[180:183]
  ds_read_b64_tr_b16 v[48:49], v23 offset:49152
  ds_read_b64_tr_b16 v[50:51], v23 offset:50176
  s_waitcnt lgkmcnt(10)
  v_mfma_f32_16x16x32_bf16 v[184:187], v[56:59], a[32:35], v[184:187]
  buffer_load_dwordx4 v6, s[4:7], s83 offen offset:2048 lds
  v_mfma_f32_16x16x32_bf16 v[184:187], v[60:63], a[40:43], v[184:187]
  ds_read_b64_tr_b16 v[52:53], v23 offset:57344
  ds_read_b64_tr_b16 v[54:55], v23 offset:58368
  buffer_load_dwordx4 v7, s[4:7], s83 offen offset:3072 lds
  v_mfma_f32_16x16x32_bf16 v[188:191], v[60:63], a[44:47], v[188:191]
  s_add_u32 m0, s82, 16384
  s_add_u32 s84, s84, 221184
  v_mfma_f32_16x16x32_bf16 v[188:191], v[56:59], a[36:39], v[188:191]
  ds_read_b64_tr_b16 v[56:57], v24 offset:49152
  ds_read_b64_tr_b16 v[58:59], v24 offset:50176
  s_waitcnt lgkmcnt(6)
  v_mfma_f32_16x16x32_bf16 v[128:131], v[40:43], a[48:51], v[128:131]
  s_sub_u32 s3, s84, 2211840
  s_min_u32 s84, s84, s3
  v_mfma_f32_16x16x32_bf16 v[128:131], v[44:47], a[56:59], v[128:131]
  ds_read_b64_tr_b16 v[60:61], v24 offset:57344
  ds_read_b64_tr_b16 v[62:63], v24 offset:58368
  v_mfma_f32_16x16x32_bf16 v[132:135], v[44:47], a[60:63], v[132:135]
  buffer_load_dwordx4 v12, s[8:11], s84 offen offset:0 lds
  v_mfma_f32_16x16x32_bf16 v[132:135], v[40:43], a[52:55], v[132:135]
  ds_read_b64_tr_b16 v[40:41], v25 offset:49152
  s_waitcnt lgkmcnt(5)
  v_mfma_f32_16x16x32_bf16 v[136:139], v[48:51], a[48:51], v[136:139]
  ds_read_b64_tr_b16 v[42:43], v25 offset:50176
  v_mfma_f32_16x16x32_bf16 v[136:139], v[52:55], a[56:59], v[136:139]
  ds_read_b64_tr_b16 v[44:45], v25 offset:57344
  ds_read_b64_tr_b16 v[46:47], v25 offset:58368
  v_mfma_f32_16x16x32_bf16 v[140:143], v[52:55], a[60:63], v[140:143]
  buffer_load_dwordx4 v13, s[8:11], s84 offen offset:1024 lds
  v_mfma_f32_16x16x32_bf16 v[140:143], v[48:51], a[52:55], v[140:143]
  ds_read_b64_tr_b16 v[48:49], v26 offset:49152
  ds_read_b64_tr_b16 v[50:51], v26 offset:50176
  s_waitcnt lgkmcnt(6)
  v_mfma_f32_16x16x32_bf16 v[144:147], v[56:59], a[48:51], v[144:147]
  buffer_load_dwordx4 v14, s[8:11], s84 offen offset:2048 lds
  v_mfma_f32_16x16x32_bf16 v[144:147], v[60:63], a[56:59], v[144:147]
  ds_read_b64_tr_b16 v[52:53], v26 offset:57344
  v_mfma_f32_16x16x32_bf16 v[148:151], v[60:63], a[60:63], v[148:151]
  ds_read_b64_tr_b16 v[54:55], v26 offset:58368
  v_mfma_f32_16x16x32_bf16 v[148:151], v[56:59], a[52:55], v[148:151]
  ds_read_b64_tr_b16 v[56:57], v27 offset:49152
  ds_read_b64_tr_b16 v[58:59], v27 offset:50176
  s_waitcnt lgkmcnt(6)
  v_mfma_f32_16x16x32_bf16 v[152:155], v[40:43], a[48:51], v[152:155]
  buffer_load_dwordx4 v15, s[8:11], s84 offen offset:3072 lds
  s_add_u32 m0, s81, 8192
  v_mfma_f32_16x16x32_bf16 v[152:155], v[44:47], a[56:59], v[152:155]
  ds_read_b64_tr_b16 v[60:61], v27 offset:57344
  ds_read_b64_tr_b16 v[62:63], v27 offset:58368
  s_add_u32 s83, s83, 128
  v_mfma_f32_16x16x32_bf16 v[156:159], v[44:47], a[60:63], v[156:159]
  s_sub_u32 s3, s83, 1280
  s_min_u32 s83, s83, s3
  v_mfma_f32_16x16x32_bf16 v[156:159], v[40:43], a[52:55], v[156:159]
  ds_read_b64_tr_b16 v[40:41], v28 offset:49152
  ds_read_b64_tr_b16 v[42:43], v28 offset:50176
  s_waitcnt lgkmcnt(6)
  v_mfma_f32_16x16x32_bf16 v[160:163], v[48:51], a[48:51], v[160:163]
  buffer_load_dwordx4 v4, s[4:7], s83 offen offset:0 lds
  v_mfma_f32_16x16x32_bf16 v[160:163], v[52:55], a[56:59], v[160:163]
  ds_read_b64_tr_b16 v[44:45], v28 offset:57344
  ds_read_b64_tr_b16 v[46:47], v28 offset:58368
  v_mfma_f32_16x16x32_bf16 v[164:167], v[52:55], a[60:63], v[164:167]
  buffer_load_dwordx4 v5, s[4:7], s83 offen offset:1024 lds
  v_mfma_f32_16x16x32_bf16 v[164:167], v[48:51], a[52:55], v[164:167]
  ds_read_b64_tr_b16 v[48:49], v29 offset:49152
  s_waitcnt lgkmcnt(5)
  v_mfma_f32_16x16x32_bf16 v[168:171], v[56:59], a[48:51], v[168:171]
  ds_read_b64_tr_b16 v[50:51], v29 offset:50176
  v_mfma_f32_16x16x32_bf16 v[168:171], v[60:63], a[56:59], v[168:171]
  ds_read_b64_tr_b16 v[52:53], v29 offset:57344
  ds_read_b64_tr_b16 v[54:55], v29 offset:58368
  v_mfma_f32_16x16x32_bf16 v[172:175], v[60:63], a[60:63], v[172:175]
  buffer_load_dwordx4 v6, s[4:7], s83 offen offset:2048 lds
  v_mfma_f32_16x16x32_bf16 v[172:175], v[56:59], a[52:55], v[172:175]
  s_waitcnt vmcnt(11)
  s_barrier
  ds_read_b128 a[64:67], v8 offset:0
  s_waitcnt lgkmcnt(5)
  v_mfma_f32_16x16x32_bf16 v[176:179], v[40:43], a[48:51], v[176:179]
  ds_read_b128 a[68:71], v8 offset:2048
  ds_read_b64_tr_b16 v[56:57], v22 offset:0
  ds_read_b64_tr_b16 v[58:59], v22 offset:1024
  v_mfma_f32_16x16x32_bf16 v[176:179], v[44:47], a[56:59], v[176:179]
  ds_read_b128 a[72:75], v9 offset:0
  ds_read_b128 a[76:79], v9 offset:2048
  ds_read_b64_tr_b16 v[60:61], v22 offset:8192
  v_mfma_f32_16x16x32_bf16 v[180:183], v[44:47], a[60:63], v[180:183]
  ds_read_b64_tr_b16 v[62:63], v22 offset:9216
  buffer_load_dwordx4 v7, s[4:7], s83 offen offset:3072 lds
  v_mfma_f32_16x16x32_bf16 v[180:183], v[40:43], a[52:55], v[180:183]
  ds_read_b64_tr_b16 v[40:41], v23 offset:0
  ds_read_b64_tr_b16 v[42:43], v23 offset:1024
  s_waitcnt lgkmcnt(10)
  v_mfma_f32_16x16x32_bf16 v[184:187], v[48:51], a[48:51], v[184:187]
  s_add_u32 m0, s82, 32768
  s_add_u32 s84, s84, 221184
  s_sub_u32 s3, s84, 2211840
  v_mfma_f32_16x16x32_bf16 v[184:187], v[52:55], a[56:59], v[184:187]
  ds_read_b64_tr_b16 v[44:45], v23 offset:8192
  ds_read_b64_tr_b16 v[46:47], v23 offset:9216
  s_min_u32 s84, s84, s3
  v_mfma_f32_16x16x32_bf16 v[188:191], v[52:55], a[60:63], v[188:191]
  buffer_load_dwordx4 v12, s[8:11], s84 offen offset:0 lds
  v_mfma_f32_16x16x32_bf16 v[188:191], v[48:51], a[52:55], v[188:191]
  ds_read_b64_tr_b16 v[48:49], v24 offset:0
  ds_read_b64_tr_b16 v[50:51], v24 offset:1024
  s_waitcnt lgkmcnt(6)
  v_mfma_f32_16x16x32_bf16 v[128:131], v[56:59], a[64:67], v[128:131]
  buffer_load_dwordx4 v13, s[8:11], s84 offen offset:1024 lds
  v_mfma_f32_16x16x32_bf16 v[128:131], v[60:63], a[72:75], v[128:131]
  ds_read_b64_tr_b16 v[52:53], v24 offset:8192
  ds_read_b64_tr_b16 v[54:55], v24 offset:9216
  v_mfma_f32_16x16x32_bf16 v[132:135], v[60:63], a[76:79], v[132:135]
  buffer_load_dwordx4 v14, s[8:11], s84 offen offset:2048 lds
  v_mfma_f32_16x16x32_bf16 v[132:135], v[56:59], a[68:71], v[132:135]
  ds_read_b64_tr_b16 v[56:57], v25 offset:0
  s_waitcnt lgkmcnt(5)
  v_mfma_f32_16x16x32_bf16 v[136:139], v[40:43], a[64:67], v[136:139]
  ds_read_b64_tr_b16 v[58:59], v25 offset:1024
  v_mfma_f32_16x16x32_bf16 v[136:139], v[44:47], a[72:75], v[136:139]
  ds_read_b64_tr_b16 v[60:61], v25 offset:8192
  ds_read_b64_tr_b16 v[62:63], v25 offset:9216
  buffer_load_dwordx4 v15, s[8:11], s84 offen offset:3072 lds
  v_mfma_f32_16x16x32_bf16 v[140:143], v[44:47], a[76:79], v[140:143]
  s_add_u32 m0, s81, 12288
  s_add_u32 s83, s83, 128
  v_mfma_f32_16x16x32_bf16 v[140:143], v[40:43], a[68:71], v[140:143]
  ds_read_b64_tr_b16 v[40:41], v26 offset:0
  ds_read_b64_tr_b16 v[42:43], v26 offset:1024
  s_waitcnt lgkmcnt(6)
  v_mfma_f32_16x16x32_bf16 v[144:147], v[48:51], a[64:67], v[144:147]
  s_sub_u32 s3, s83, 1280
  s_min_u32 s83, s83, s3
  v_mfma_f32_16x16x32_bf16 v[144:147], v[52:55], a[72:75], v[144:147]
  ds_read_b64_tr_b16 v[44:45], v26 offset:8192
  ds_read_b64_tr_b16 v[46:47], v26 offset:9216
  v_mfma_f32_16x16x32_bf16 v[148:151], v[52:55], a[76:79], v[148:151]
  buffer_load_dwordx4 v4, s[4:7], s83 offen offset:0 lds
  v_mfma_f32_16x16x32_bf16 v[148:151], v[48:51], a[68:71], v[148:151]
  ds_read_b64_tr_b16 v[48:49], v27 offset:0
  ds_read_b64_tr_b16 v[50:51], v27 offset:1024
  s_waitcnt lgkmcnt(6)
  v_mfma_f32_16x16x32_bf16 v[152:155], v[56:59], a[64:67], v[152:155]
  buffer_load_dwordx4 v5, s[4:7], s83 offen offset:1024 lds
  v_mfma_f32_16x16x32_bf16 v[152:155], v[60:63], a[72:75], v[152:155]
  ds_read_b64_tr_b16 v[52:53], v27 offset:8192
  v_mfma_f32_16x16x32_bf16 v[156:159], v[60:63], a[76:79], v[156:159]
  ds_read_b64_tr_b16 v[54:55], v27 offset:9216
  v_mfma_f32_16x16x32_bf16 v[156:159], v[56:59], a[68:71], v[156:159]
  ds_read_b64_tr_b16 v[56:57], v28 offset:0
  ds_read_b64_tr_b16 v[58:59], v28 offset:1024
  s_waitcnt lgkmcnt(6)
  v_mfma_f32_16x16x32_bf16 v[160:163], v[40:43], a[64:67], v[160:163]
  buffer_load_dwordx4 v6, s[4:7], s83 offen offset:2048 lds
  v_mfma_f32_16x16x32_bf16 v[160:163], v[44:47], a[72:75], v[160:163]
  ds_read_b64_tr_b16 v[60:61], v28 offset:8192
  v_mfma_f32_16x16x32_bf16 v[164:167], v[44:47], a[76:79], v[164:167]
  ds_read_b64_tr_b16 v[62:63], v28 offset:9216
  v_mfma_f32_16x16x32_bf16 v[164:167], v[40:43], a[68:71], v[164:167]
  ds_read_b64_tr_b16 v[40:41], v29 offset:0
  ds_read_b64_tr_b16 v[42:43], v29 offset:1024
  s_waitcnt lgkmcnt(6)
  v_mfma_f32_16x16x32_bf16 v[168:171], v[48:51], a[64:67], v[168:171]
  buffer_load_dwordx4 v7, s[4:7], s83 offen offset:3072 lds
  v_mfma_f32_16x16x32_bf16 v[168:171], v[52:55], a[72:75], v[168:171]
  ds_read_b64_tr_b16 v[44:45], v29 offset:8192
  v_mfma_f32_16x16x32_bf16 v[172:175], v[52:55], a[76:79], v[172:175]
  ds_read_b64_tr_b16 v[46:47], v29 offset:9216
  v_mfma_f32_16x16x32_bf16 v[172:175], v[48:51], a[68:71], v[172:175]
  s_waitcnt vmcnt(12)
  s_barrier
  ds_read_b128 a[80:83], v8 offset:4096
  s_waitcnt lgkmcnt(5)
  v_mfma_f32_16x16x32_bf16 v[176:179], v[56:59], a[64:67], v[176:179]
  ds_read_b128 a[84:87], v8 offset:6144
  ds_read_b64_tr_b16 v[48:49], v22 offset:16384
  ds_read_b64_tr_b16 v[50:51], v22 offset:17408
  v_mfma_f32_16x16x32_bf16 v[176:179], v[60:63], a[72:75], v[176:179]
  ds_read_b128 a[88:91], v9 offset:4096
  ds_read_b128 a[92:95], v9 offset:6144
  ds_read_b64_tr_b16 v[52:53], v22 offset:24576
  v_mfma_f32_16x16x32_bf16 v[180:183], v[60:63], a[76:79], v[180:183]
  ds_read_b64_tr_b16 v[54:55], v22 offset:25600
  s_add_u32 m0, s82, 49152
  s_add_u32 s84, s84, 221184
  v_mfma_f32_16x16x32_bf16 v[180:183], v[56:59], a[68:71], v[180:183]
  ds_read_b64_tr_b16 v[56:57], v23 offset:16384
  ds_read_b64_tr_b16 v[58:59], v23 offset:17408
  s_sub_u32 s3, s84, 2211840
  s_waitcnt lgkmcnt(10)
  v_mfma_f32_16x16x32_bf16 v[184:187], v[40:43], a[64:67], v[184:187]
  s_min_u32 s84, s84, s3
  buffer_load_dwordx4 v12, s[8:11], s84 offen offset:0 lds
  v_mfma_f32_16x16x32_bf16 v[184:187], v[44:47], a[72:75], v[184:187]
  ds_read_b64_tr_b16 v[60:61], v23 offset:24576
  ds_read_b64_tr_b16 v[62:63], v23 offset:25600
  v_mfma_f32_16x16x32_bf16 v[188:191], v[44:47], a[76:79], v[188:191]
  buffer_load_dwordx4 v13, s[8:11], s84 offen offset:1024 lds
  v_mfma_f32_16x16x32_bf16 v[188:191], v[40:43], a[68:71], v[188:191]
  ds_read_b64_tr_b16 v[40:41], v24 offset:16384
  ds_read_b64_tr_b16 v[42:43], v24 offset:17408
  s_waitcnt lgkmcnt(6)
  v_mfma_f32_16x16x32_bf16 v[128:131], v[48:51], a[80:83], v[128:131]
  buffer_load_dwordx4 v14, s[8:11], s84 offen offset:2048 lds
  v_mfma_f32_16x16x32_bf16 v[128:131], v[52:55], a[88:91], v[128:131]
  ds_read_b64_tr_b16 v[44:45], v24 offset:24576
  v_mfma_f32_16x16x32_bf16 v[132:135], v[52:55], a[92:95], v[132:135]
  ds_read_b64_tr_b16 v[46:47], v24 offset:25600
  v_mfma_f32_16x16x32_bf16 v[132:135], v[48:51], a[84:87], v[132:135]
  ds_read_b64_tr_b16 v[48:49], v25 offset:16384
  ds_read_b64_tr_b16 v[50:51], v25 offset:17408
  s_waitcnt lgkmcnt(6)
  v_mfma_f32_16x16x32_bf16 v[136:139], v[56:59], a[80:83], v[136:139]
  buffer_load_dwordx4 v15, s[8:11], s84 offen offset:3072 lds
  s_add_u32 m0, s81, 0
  v_mfma_f32_16x16x32_bf16 v[136:139], v[60:63], a[88:91], v[136:139]
  ds_read_b64_tr_b16 v[52:53], v25 offset:24576
  ds_read_b64_tr_b16 v[54:55], v25 offset:25600
  s_add_u32 s83, s83, 128
  v_mfma_f32_16x16x32_bf16 v[140:143], v[60:63], a[92:95], v[140:143]
  s_sub_u32 s3, s83, 1280
  s_min_u32 s83, s83, s3
  v_mfma_f32_16x16x32_bf16 v[140:143], v[56:59], a[84:87], v[140:143]
  ds_read_b64_tr_b16 v[56:57], v26 offset:16384
  ds_read_b64_tr_b16 v[58:59], v26 offset:17408
  s_waitcnt lgkmcnt(6)
  v_mfma_f32_16x16x32_bf16 v[144:147], v[40:43], a[80:83], v[144:147]
  buffer_load_dwordx4 v4, s[4:7], s83 offen offset:0 lds
  v_mfma_f32_16x16x32_bf16 v[144:147], v[44:47], a[88:91], v[144:147]
  ds_read_b64_tr_b16 v[60:61], v26 offset:24576
  ds_read_b64_tr_b16 v[62:63], v26 offset:25600
  v_mfma_f32_16x16x32_bf16 v[148:151], v[44:47], a[92:95], v[148:151]
  buffer_load_dwordx4 v5, s[4:7], s83 offen offset:1024 lds
  v_mfma_f32_16x16x32_bf16 v[148:151], v[40:43], a[84:87], v[148:151]
  ds_read_b64_tr_b16 v[40:41], v27 offset:16384
  s_waitcnt lgkmcnt(5)
  v_mfma_f32_16x16x32_bf16 v[152:155], v[48:51], a[80:83], v[152:155]
  ds_read_b64_tr_b16 v[42:43], v27 offset:17408
  v_mfma_f32_16x16x32_bf16 v[152:155], v[52:55], a[88:91], v[152:155]
  ds_read_b64_tr_b16 v[44:45], v27 offset:24576
  ds_read_b64_tr_b16 v[46:47], v27 offset:25600
  v_mfma_f32_16x16x32_bf16 v[156:159], v[52:55], a[92:95], v[156:159]
  buffer_load_dwordx4 v6, s[4:7], s83 offen offset:2048 lds
  v_mfma_f32_16x16x32_bf16 v[156:159], v[48:51], a[84:87], v[156:159]
  ds_read_b64_tr_b16 v[48:49], v28 offset:16384
  s_waitcnt lgkmcnt(5)
  v_mfma_f32_16x16x32_bf16 v[160:163], v[56:59], a[80:83], v[160:163]
  ds_read_b64_tr_b16 v[50:51], v28 offset:17408
  v_mfma_f32_16x16x32_bf16 v[160:163], v[60:63], a[88:91], v[160:163]
  ds_read_b64_tr_b16 v[52:53], v28 offset:24576
  ds_read_b64_tr_b16 v[54:55], v28 offset:25600
  v_mfma_f32_16x16x32_bf16 v[164:167], v[60:63], a[92:95], v[164:167]
  buffer_load_dwordx4 v7, s[4:7], s83 offen offset:3072 lds
  v_mfma_f32_16x16x32_bf16 v[164:167], v[56:59], a[84:87], v[164:167]
  ds_read_b64_tr_b16 v[56:57], v29 offset:16384
  s_waitcnt lgkmcnt(5)
  v_mfma_f32_16x16x32_bf16 v[168:171], v[40:43], a[80:83], v[168:171]
  ds_read_b64_tr_b16 v[58:59], v29 offset:17408
  v_mfma_f32_16x16x32_bf16 v[168:171], v[44:47], a[88:91], v[168:171]
  ds_read_b64_tr_b16 v[60:61], v29 offset:24576
  v_mfma_f32_16x16x32_bf16 v[172:175], v[44:47], a[92:95], v[172:175]
  ds_read_b64_tr_b16 v[62:63], v29 offset:25600
  v_mfma_f32_16x16x32_bf16 v[172:175], v[40:43], a[84:87], v[172:175]
  s_waitcnt vmcnt(12)
  s_barrier
  ds_read_b128 a[96:99], v8 offset:8192
  s_waitcnt lgkmcnt(5)
  v_mfma_f32_16x16x32_bf16 v[176:179], v[48:51], a[80:83], v[176:179]
  ds_read_b128 a[100:103], v8 offset:10240
  ds_read_b64_tr_b16 v[40:41], v22 offset:32768
  ds_read_b64_tr_b16 v[42:43], v22 offset:33792
  v_mfma_f32_16x16x32_bf16 v[176:179], v[52:55], a[88:91], v[176:179]
  ds_read_b128 a[104:107], v9 offset:8192
  ds_read_b128 a[108:111], v9 offset:10240
  ds_read_b64_tr_b16 v[44:45], v22 offset:40960
  v_mfma_f32_16x16x32_bf16 v[180:183], v[52:55], a[92:95], v[180:183]
  ds_read_b64_tr_b16 v[46:47], v22 offset:41984
  s_add_u32 m0, s82, 0
  s_add_u32 s84, s84, 221184
  v_mfma_f32_16x16x32_bf16 v[180:183], v[48:51], a[84:87], v[180:183]
  ds_read_b64_tr_b16 v[48:49], v23 offset:32768
  ds_read_b64_tr_b16 v[50:51], v23 offset:33792
  s_sub_u32 s3, s84, 2211840
  s_waitcnt lgkmcnt(10)
  v_mfma_f32_16x16x32_bf16 v[184:187], v[56:59], a[80:83], v[184:187]
  s_min_u32 s84, s84, s3
  buffer_load_dwordx4 v12, s[8:11], s84 offen offset:0 lds
  v_mfma_f32_16x16x32_bf16 v[184:187], v[60:63], a[88:91], v[184:187]
  ds_read_b64_tr_b16 v[52:53], v23 offset:40960
  ds_read_b64_tr_b16 v[54:55], v23 offset:41984
  v_mfma_f32_16x16x32_bf16 v[188:191], v[60:63], a[92:95], v[188:191]
  buffer_load_dwordx4 v13, s[8:11], s84 offen offset:1024 lds
  v_mfma_f32_16x16x32_bf16 v[188:191], v[56:59], a[84:87], v[188:191]
  ds_read_b64_tr_b16 v[56:57], v24 offset:32768
  ds_read_b64_tr_b16 v[58:59], v24 offset:33792
  s_waitcnt lgkmcnt(6)
  v_mfma_f32_16x16x32_bf16 v[128:131], v[40:43], a[96:99], v[128:131]
  buffer_load_dwordx4 v14, s[8:11], s84 offen offset:2048 lds
  v_mfma_f32_16x16x32_bf16 v[128:131], v[44:47], a[104:107], v[128:131]
  ds_read_b64_tr_b16 v[60:61], v24 offset:40960
  v_mfma_f32_16x16x32_bf16 v[132:135], v[44:47], a[108:111], v[132:135]
  ds_read_b64_tr_b16 v[62:63], v24 offset:41984
  v_mfma_f32_16x16x32_bf16 v[132:135], v[40:43], a[100:103], v[132:135]
  ds_read_b64_tr_b16 v[40:41], v25 offset:32768
  ds_read_b64_tr_b16 v[42:43], v25 offset:33792
  s_waitcnt lgkmcnt(6)
  v_mfma_f32_16x16x32_bf16 v[136:139], v[48:51], a[96:99], v[136:139]
  buffer_load_dwordx4 v15, s[8:11], s84 offen offset:3072 lds
  s_add_u32 m0, s81, 4096
  v_mfma_f32_16x16x32_bf16 v[136:139], v[52:55], a[104:107], v[136:139]
  ds_read_b64_tr_b16 v[44:45], v25 offset:40960
  ds_read_b64_tr_b16 v[46:47], v25 offset:41984
  s_add_u32 s83, s83, 128
  v_mfma_f32_16x16x32_bf16 v[140:143], v[52:55], a[108:111], v[140:143]
  s_sub_u32 s3, s83, 1280
  s_min_u32 s83, s83, s3
  v_mfma_f32_16x16x32_bf16 v[140:143], v[48:51], a[100:103], v[140:143]
  ds_read_b64_tr_b16 v[48:49], v26 offset:32768
  ds_read_b64_tr_b16 v[50:51], v26 offset:33792
  s_waitcnt lgkmcnt(6)
  v_mfma_f32_16x16x32_bf16 v[144:147], v[56:59], a[96:99], v[144:147]
  buffer_load_dwordx4 v4, s[4:7], s83 offen offset:0 lds
  v_mfma_f32_16x16x32_bf16 v[144:147], v[60:63], a[104:107], v[144:147]
  ds_read_b64_tr_b16 v[52:53], v26 offset:40960
  ds_read_b64_tr_b16 v[54:55], v26 offset:41984
  v_mfma_f32_16x16x32_bf16 v[148:151], v[60:63], a[108:111], v[148:151]
  buffer_load_dwordx4 v5, s[4:7], s83 offen offset:1024 lds
  v_mfma_f32_16x16x32_bf16 v[148:151], v[56:59], a[100:103], v[148:151]
  ds_read_b64_tr_b16 v[56:57], v27 offset:32768
  s_waitcnt lgkmcnt(5)
  v_mfma_f32_16x16x32_bf16 v[152:155], v[40:43], a[96:99], v[152:155]
  ds_read_b64_tr_b16 v[58:59], v27 offset:33792
  v_mfma_f32_16x16x32_bf16 v[152:155], v[44:47], a[104:107], v[152:155]
  ds_read_b64_tr_b16 v[60:61], v27 offset:40960
  ds_read_b64_tr_b16 v[62:63], v27 offset:41984
  v_mfma_f32_16x16x32_bf16 v[156:159], v[44:47], a[108:111], v[156:159]
  buffer_load_dwordx4 v6, s[4:7], s83 offen offset:2048 lds
  v_mfma_f32_16x16x32_bf16 v[156:159], v[40:43], a[100:103], v[156:159]
  ds_read_b64_tr_b16 v[40:41], v28 offset:32768
  s_waitcnt lgkmcnt(5)
  v_mfma_f32_16x16x32_bf16 v[160:163], v[48:51], a[96:99], v[160:163]
  ds_read_b64_tr_b16 v[42:43], v28 offset:33792
  v_mfma_f32_16x16x32_bf16 v[160:163], v[52:55], a[104:107], v[160:163]
  ds_read_b64_tr_b16 v[44:45], v28 offset:40960
  ds_read_b64_tr_b16 v[46:47], v28 offset:41984
  v_mfma_f32_16x16x32_bf16 v[164:167], v[52:55], a[108:111], v[164:167]
  buffer_load_dwordx4 v7, s[4:7], s83 offen offset:3072 lds
  v_mfma_f32_16x16x32_bf16 v[164:167], v[48:51], a[100:103], v[164:167]
  ds_read_b64_tr_b16 v[48:49], v29 offset:32768
  s_waitcnt lgkmcnt(5)
  v_mfma_f32_16x16x32_bf16 v[168:171], v[56:59], a[96:99], v[168:171]
  ds_read_b64_tr_b16 v[50:51], v29 offset:33792
  v_mfma_f32_16x16x32_bf16 v[168:171], v[60:63], a[104:107], v[168:171]
  ds_read_b64_tr_b16 v[52:53], v29 offset:40960
  v_mfma_f32_16x16x32_bf16 v[172:175], v[60:63], a[108:111], v[172:175]
  ds_read_b64_tr_b16 v[54:55], v29 offset:41984
  v_mfma_f32_16x16x32_bf16 v[172:175], v[56:59], a[100:103], v[172:175]
  s_waitcnt vmcnt(12)
  s_barrier
  ds_read_b128 a[112:115], v8 offset:12288
  s_waitcnt lgkmcnt(5)
  v_mfma_f32_16x16x32_bf16 v[176:179], v[40:43], a[96:99], v[176:179]
  ds_read_b128 a[116:119], v8 offset:14336
  ds_read_b64_tr_b16 v[56:57], v22 offset:49152
  ds_read_b64_tr_b16 v[58:59], v22 offset:50176
  v_mfma_f32_16x16x32_bf16 v[176:179], v[44:47], a[104:107], v[176:179]
  ds_read_b128 a[120:123], v9 offset:12288
  ds_read_b128 a[124:127], v9 offset:14336
  ds_read_b64_tr_b16 v[60:61], v22 offset:57344
  v_mfma_f32_16x16x32_bf16 v[180:183], v[44:47], a[108:111], v[180:183]
  ds_read_b64_tr_b16 v[62:63], v22 offset:58368
  s_add_u32 m0, s82, 16384
  s_add_u32 s84, s84, 221184
  v_mfma_f32_16x16x32_bf16 v[180:183], v[40:43], a[100:103], v[180:183]
  ds_read_b64_tr_b16 v[40:41], v23 offset:49152
  ds_read_b64_tr_b16 v[42:43], v23 offset:50176
  s_sub_u32 s3, s84, 2211840
  s_waitcnt lgkmcnt(10)
  v_mfma_f32_16x16x32_bf16 v[184:187], v[48:51], a[96:99], v[184:187]
  s_min_u32 s84, s84, s3
  buffer_load_dwordx4 v12, s[8:11], s84 offen offset:0 lds
  v_mfma_f32_16x16x32_bf16 v[184:187], v[52:55], a[104:107], v[184:187]
  ds_read_b64_tr_b16 v[44:45], v23 offset:57344
  ds_read_b64_tr_b16 v[46:47], v23 offset:58368
  v_mfma_f32_16x16x32_bf16 v[188:191], v[52:55], a[108:111], v[188:191]
  buffer_load_dwordx4 v13, s[8:11], s84 offen offset:1024 lds
  v_mfma_f32_16x16x32_bf16 v[188:191], v[48:51], a[100:103], v[188:191]
  ds_read_b64_tr_b16 v[48:49], v24 offset:49152
  s_waitcnt lgkmcnt(5)
  v_mfma_f32_16x16x32_bf16 v[128:131], v[56:59], a[112:115], v[128:131]
  ds_read_b64_tr_b16 v[50:51], v24 offset:50176
  v_mfma_f32_16x16x32_bf16 v[128:131], v[60:63], a[120:123], v[128:131]
  ds_read_b64_tr_b16 v[52:53], v24 offset:57344
  v_mfma_f32_16x16x32_bf16 v[132:135], v[60:63], a[124:127], v[132:135]
  ds_read_b64_tr_b16 v[54:55], v24 offset:58368
  v_mfma_f32_16x16x32_bf16 v[132:135], v[56:59], a[116:119], v[132:135]
  ds_read_b64_tr_b16 v[56:57], v25 offset:49152
  ds_read_b64_tr_b16 v[58:59], v25 offset:50176
  s_waitcnt lgkmcnt(6)
  v_mfma_f32_16x16x32_bf16 v[136:139], v[40:43], a[112:115], v[136:139]
  buffer_load_dwordx4 v14, s[8:11], s84 offen offset:2048 lds
  v_mfma_f32_16x16x32_bf16 v[136:139], v[44:47], a[120:123], v[136:139]
  ds_read_b64_tr_b16 v[60:61], v25 offset:57344
  v_mfma_f32_16x16x32_bf16 v[140:143], v[44:47], a[124:127], v[140:143]
  ds_read_b64_tr_b16 v[62:63], v25 offset:58368
  v_mfma_f32_16x16x32_bf16 v[140:143], v[40:43], a[116:119], v[140:143]
  ds_read_b64_tr_b16 v[40:41], v26 offset:49152
  s_waitcnt lgkmcnt(5)
  v_mfma_f32_16x16x32_bf16 v[144:147], v[48:51], a[112:115], v[144:147]
  ds_read_b64_tr_b16 v[42:43], v26 offset:50176
  v_mfma_f32_16x16x32_bf16 v[144:147], v[52:55], a[120:123], v[144:147]
  ds_read_b64_tr_b16 v[44:45], v26 offset:57344
  ds_read_b64_tr_b16 v[46:47], v26 offset:58368
  v_mfma_f32_16x16x32_bf16 v[148:151], v[52:55], a[124:127], v[148:151]
  buffer_load_dwordx4 v15, s[8:11], s84 offen offset:3072 lds
  v_mfma_f32_16x16x32_bf16 v[148:151], v[48:51], a[116:119], v[148:151]
  ds_read_b64_tr_b16 v[48:49], v27 offset:49152
  s_waitcnt lgkmcnt(5)
  v_mfma_f32_16x16x32_bf16 v[152:155], v[56:59], a[112:115], v[152:155]
  ds_read_b64_tr_b16 v[50:51], v27 offset:50176
  v_mfma_f32_16x16x32_bf16 v[152:155], v[60:63], a[120:123], v[152:155]
  ds_read_b64_tr_b16 v[52:53], v27 offset:57344
  v_mfma_f32_16x16x32_bf16 v[156:159], v[60:63], a[124:127], v[156:159]
  ds_read_b64_tr_b16 v[54:55], v27 offset:58368
  v_mfma_f32_16x16x32_bf16 v[156:159], v[56:59], a[116:119], v[156:159]
  ds_read_b64_tr_b16 v[56:57], v28 offset:49152
  s_waitcnt lgkmcnt(5)
  v_mfma_f32_16x16x32_bf16 v[160:163], v[40:43], a[112:115], v[160:163]
  ds_read_b64_tr_b16 v[58:59], v28 offset:50176
  v_mfma_f32_16x16x32_bf16 v[160:163], v[44:47], a[120:123], v[160:163]
  ds_read_b64_tr_b16 v[60:61], v28 offset:57344
  v_mfma_f32_16x16x32_bf16 v[164:167], v[44:47], a[124:127], v[164:167]
  ds_read_b64_tr_b16 v[62:63], v28 offset:58368
  v_mfma_f32_16x16x32_bf16 v[164:167], v[40:43], a[116:119], v[164:167]
  ds_read_b64_tr_b16 v[40:41], v29 offset:49152
  s_waitcnt lgkmcnt(5)
  v_mfma_f32_16x16x32_bf16 v[168:171], v[48:51], a[112:115], v[168:171]
  ds_read_b64_tr_b16 v[42:43], v29 offset:50176
  v_mfma_f32_16x16x32_bf16 v[168:171], v[52:55], a[120:123], v[168:171]
  ds_read_b64_tr_b16 v[44:45], v29 offset:57344
  v_mfma_f32_16x16x32_bf16 v[172:175], v[52:55], a[124:127], v[172:175]
  ds_read_b64_tr_b16 v[46:47], v29 offset:58368
  v_mfma_f32_16x16x32_bf16 v[172:175], v[48:51], a[116:119], v[172:175]
  s_waitcnt vmcnt(8)
  s_barrier
  ds_read_b128 a[128:131], v8 offset:0
  s_waitcnt lgkmcnt(5)
  v_mfma_f32_16x16x32_bf16 v[176:179], v[56:59], a[112:115], v[176:179]
  ds_read_b128 a[132:135], v8 offset:2048
  ds_read_b64_tr_b16 v[48:49], v22 offset:0
  ds_read_b64_tr_b16 v[50:51], v22 offset:1024
  v_mfma_f32_16x16x32_bf16 v[176:179], v[60:63], a[120:123], v[176:179]
  ds_read_b128 a[136:139], v9 offset:0
  ds_read_b128 a[140:143], v9 offset:2048
  ds_read_b64_tr_b16 v[52:53], v22 offset:8192
  v_mfma_f32_16x16x32_bf16 v[180:183], v[60:63], a[124:127], v[180:183]
  ds_read_b64_tr_b16 v[54:55], v22 offset:9216
  s_add_u32 m0, s82, 32768
  s_add_u32 s84, s84, 221184
  v_mfma_f32_16x16x32_bf16 v[180:183], v[56:59], a[116:119], v[180:183]
  ds_read_b64_tr_b16 v[56:57], v23 offset:0
  ds_read_b64_tr_b16 v[58:59], v23 offset:1024
  s_sub_u32 s3, s84, 2211840
  s_waitcnt lgkmcnt(10)
  v_mfma_f32_16x16x32_bf16 v[184:187], v[40:43], a[112:115], v[184:187]
  s_min_u32 s84, s84, s3
  v_subrev_u32 v12, v245, v12
  buffer_load_dwordx4 v12, s[8:11], s84 offen offset:0 lds
  v_mfma_f32_16x16x32_bf16 v[184:187], v[44:47], a[120:123], v[184:187]
  ds_read_b64_tr_b16 v[60:61], v23 offset:8192
  ds_read_b64_tr_b16 v[62:63], v23 offset:9216
  v_subrev_u32 v13, v245, v13
  v_mfma_f32_16x16x32_bf16 v[188:191], v[44:47], a[124:127], v[188:191]
  buffer_load_dwordx4 v13, s[8:11], s84 offen offset:1024 lds
  v_subrev_u32 v14, v246, v14
  v_mfma_f32_16x16x32_bf16 v[188:191], v[40:43], a[116:119], v[188:191]
  ds_read_b64_tr_b16 v[40:41], v24 offset:0
  s_waitcnt lgkmcnt(5)
  v_mfma_f32_16x16x32_bf16 v[128:131], v[48:51], a[128:131], v[128:131]
  ds_read_b64_tr_b16 v[42:43], v24 offset:1024
  v_mfma_f32_16x16x32_bf16 v[128:131], v[52:55], a[136:139], v[128:131]
  ds_read_b64_tr_b16 v[44:45], v24 offset:8192
  v_mfma_f32_16x16x32_bf16 v[132:135], v[52:55], a[140:143], v[132:135]
  ds_read_b64_tr_b16 v[46:47], v24 offset:9216
  v_mfma_f32_16x16x32_bf16 v[132:135], v[48:51], a[132:135], v[132:135]
  ds_read_b64_tr_b16 v[48:49], v25 offset:0
  ds_read_b64_tr_b16 v[50:51], v25 offset:1024
  s_waitcnt lgkmcnt(6)
  v_mfma_f32_16x16x32_bf16 v[136:139], v[56:59], a[128:131], v[136:139]
  buffer_load_dwordx4 v14, s[8:11], s84 offen offset:2048 lds
  v_subrev_u32 v15, v246, v15
  v_mfma_f32_16x16x32_bf16 v[136:139], v[60:63], a[136:139], v[136:139]
  ds_read_b64_tr_b16 v[52:53], v25 offset:8192
  v_mfma_f32_16x16x32_bf16 v[140:143], v[60:63], a[140:143], v[140:143]
  ds_read_b64_tr_b16 v[54:55], v25 offset:9216
  v_mfma_f32_16x16x32_bf16 v[140:143], v[56:59], a[132:135], v[140:143]
  ds_read_b64_tr_b16 v[56:57], v26 offset:0
  s_waitcnt lgkmcnt(5)
  v_mfma_f32_16x16x32_bf16 v[144:147], v[40:43], a[128:131], v[144:147]
  ds_read_b64_tr_b16 v[58:59], v26 offset:1024
  v_mfma_f32_16x16x32_bf16 v[144:147], v[44:47], a[136:139], v[144:147]
  ds_read_b64_tr_b16 v[60:61], v26 offset:8192
  ds_read_b64_tr_b16 v[62:63], v26 offset:9216
  v_mfma_f32_16x16x32_bf16 v[148:151], v[44:47], a[140:143], v[148:151]
  buffer_load_dwordx4 v15, s[8:11], s84 offen offset:3072 lds
  v_mfma_f32_16x16x32_bf16 v[148:151], v[40:43], a[132:135], v[148:151]
  ds_read_b64_tr_b16 v[40:41], v27 offset:0
  s_waitcnt lgkmcnt(5)
  v_mfma_f32_16x16x32_bf16 v[152:155], v[48:51], a[128:131], v[152:155]
  ds_read_b64_tr_b16 v[42:43], v27 offset:1024
  v_mfma_f32_16x16x32_bf16 v[152:155], v[52:55], a[136:139], v[152:155]
  ds_read_b64_tr_b16 v[44:45], v27 offset:8192
  v_mfma_f32_16x16x32_bf16 v[156:159], v[52:55], a[140:143], v[156:159]
  ds_read_b64_tr_b16 v[46:47], v27 offset:9216
  v_mfma_f32_16x16x32_bf16 v[156:159], v[48:51], a[132:135], v[156:159]
  ds_read_b64_tr_b16 v[48:49], v28 offset:0
  s_waitcnt lgkmcnt(5)
  v_mfma_f32_16x16x32_bf16 v[160:163], v[56:59], a[128:131], v[160:163]
  ds_read_b64_tr_b16 v[50:51], v28 offset:1024
  v_mfma_f32_16x16x32_bf16 v[160:163], v[60:63], a[136:139], v[160:163]
  ds_read_b64_tr_b16 v[52:53], v28 offset:8192
  v_mfma_f32_16x16x32_bf16 v[164:167], v[60:63], a[140:143], v[164:167]
  ds_read_b64_tr_b16 v[54:55], v28 offset:9216
  v_mfma_f32_16x16x32_bf16 v[164:167], v[56:59], a[132:135], v[164:167]
  ds_read_b64_tr_b16 v[56:57], v29 offset:0
  s_waitcnt lgkmcnt(5)
  v_mfma_f32_16x16x32_bf16 v[168:171], v[40:43], a[128:131], v[168:171]
  ds_read_b64_tr_b16 v[58:59], v29 offset:1024
  v_mfma_f32_16x16x32_bf16 v[168:171], v[44:47], a[136:139], v[168:171]
  ds_read_b64_tr_b16 v[60:61], v29 offset:8192
  v_mfma_f32_16x16x32_bf16 v[172:175], v[44:47], a[140:143], v[172:175]
  ds_read_b64_tr_b16 v[62:63], v29 offset:9216
  v_mfma_f32_16x16x32_bf16 v[172:175], v[40:43], a[132:135], v[172:175]
  s_waitcnt vmcnt(4)
  s_barrier
  ds_read_b128 a[144:147], v8 offset:4096
  s_waitcnt lgkmcnt(5)
  v_mfma_f32_16x16x32_bf16 v[176:179], v[48:51], a[128:131], v[176:179]
  ds_read_b128 a[148:151], v8 offset:6144
  ds_read_b64_tr_b16 v[40:41], v22 offset:16384
  ds_read_b64_tr_b16 v[42:43], v22 offset:17408
  v_mfma_f32_16x16x32_bf16 v[176:179], v[52:55], a[136:139], v[176:179]
  ds_read_b128 a[152:155], v9 offset:4096
  ds_read_b128 a[156:159], v9 offset:6144
  ds_read_b64_tr_b16 v[44:45], v22 offset:24576
  v_mfma_f32_16x16x32_bf16 v[180:183], v[52:55], a[140:143], v[180:183]
  ds_read_b64_tr_b16 v[46:47], v22 offset:25600
  s_add_u32 m0, s82, 49152
  s_add_u32 s84, s84, 221184
  v_mfma_f32_16x16x32_bf16 v[180:183], v[48:51], a[132:135], v[180:183]
  ds_read_b64_tr_b16 v[48:49], v23 offset:16384
  ds_read_b64_tr_b16 v[50:51], v23 offset:17408
  s_sub_u32 s3, s84, 2211840
  s_waitcnt lgkmcnt(10)
  v_mfma_f32_16x16x32_bf16 v[184:187], v[56:59], a[128:131], v[184:187]
  s_min_u32 s84, s84, s3
  buffer_load_dwordx4 v12, s[8:11], s84 offen offset:0 lds
  v_mfma_f32_16x16x32_bf16 v[184:187], v[60:63], a[136:139], v[184:187]
  ds_read_b64_tr_b16 v[52:53], v23 offset:24576
  ds_read_b64_tr_b16 v[54:55], v23 offset:25600
  v_mfma_f32_16x16x32_bf16 v[188:191], v[60:63], a[140:143], v[188:191]
  buffer_load_dwordx4 v13, s[8:11], s84 offen offset:1024 lds
  v_mfma_f32_16x16x32_bf16 v[188:191], v[56:59], a[132:135], v[188:191]
  ds_read_b64_tr_b16 v[56:57], v24 offset:16384
  s_waitcnt lgkmcnt(5)
  v_mfma_f32_16x16x32_bf16 v[128:131], v[40:43], a[144:147], v[128:131]
  ds_read_b64_tr_b16 v[58:59], v24 offset:17408
  v_mfma_f32_16x16x32_bf16 v[128:131], v[44:47], a[152:155], v[128:131]
  ds_read_b64_tr_b16 v[60:61], v24 offset:24576
  v_mfma_f32_16x16x32_bf16 v[132:135], v[44:47], a[156:159], v[132:135]
  ds_read_b64_tr_b16 v[62:63], v24 offset:25600
  v_mfma_f32_16x16x32_bf16 v[132:135], v[40:43], a[148:151], v[132:135]
  ds_read_b64_tr_b16 v[40:41], v25 offset:16384
  ds_read_b64_tr_b16 v[42:43], v25 offset:17408
  s_waitcnt lgkmcnt(6)
  v_mfma_f32_16x16x32_bf16 v[136:139], v[48:51], a[144:147], v[136:139]
  buffer_load_dwordx4 v14, s[8:11], s84 offen offset:2048 lds
  v_mfma_f32_16x16x32_bf16 v[136:139], v[52:55], a[152:155], v[136:139]
  ds_read_b64_tr_b16 v[44:45], v25 offset:24576
  v_mfma_f32_16x16x32_bf16 v[140:143], v[52:55], a[156:159], v[140:143]
  ds_read_b64_tr_b16 v[46:47], v25 offset:25600
  v_mfma_f32_16x16x32_bf16 v[140:143], v[48:51], a[148:151], v[140:143]
  ds_read_b64_tr_b16 v[48:49], v26 offset:16384
  s_waitcnt lgkmcnt(5)
  v_mfma_f32_16x16x32_bf16 v[144:147], v[56:59], a[144:147], v[144:147]
  ds_read_b64_tr_b16 v[50:51], v26 offset:17408
  v_mfma_f32_16x16x32_bf16 v[144:147], v[60:63], a[152:155], v[144:147]
  ds_read_b64_tr_b16 v[52:53], v26 offset:24576
  ds_read_b64_tr_b16 v[54:55], v26 offset:25600
  v_mfma_f32_16x16x32_bf16 v[148:151], v[60:63], a[156:159], v[148:151]
  buffer_load_dwordx4 v15, s[8:11], s84 offen offset:3072 lds
  v_mfma_f32_16x16x32_bf16 v[148:151], v[56:59], a[148:151], v[148:151]
  ds_read_b64_tr_b16 v[56:57], v27 offset:16384
  s_waitcnt lgkmcnt(5)
  v_mfma_f32_16x16x32_bf16 v[152:155], v[40:43], a[144:147], v[152:155]
  ds_read_b64_tr_b16 v[58:59], v27 offset:17408
  v_mfma_f32_16x16x32_bf16 v[152:155], v[44:47], a[152:155], v[152:155]
  ds_read_b64_tr_b16 v[60:61], v27 offset:24576
  v_mfma_f32_16x16x32_bf16 v[156:159], v[44:47], a[156:159], v[156:159]
  ds_read_b64_tr_b16 v[62:63], v27 offset:25600
  v_mfma_f32_16x16x32_bf16 v[156:159], v[40:43], a[148:151], v[156:159]
  ds_read_b64_tr_b16 v[40:41], v28 offset:16384
  s_waitcnt lgkmcnt(5)
  v_mfma_f32_16x16x32_bf16 v[160:163], v[48:51], a[144:147], v[160:163]
  ds_read_b64_tr_b16 v[42:43], v28 offset:17408
  v_mfma_f32_16x16x32_bf16 v[160:163], v[52:55], a[152:155], v[160:163]
  ds_read_b64_tr_b16 v[44:45], v28 offset:24576
  v_mfma_f32_16x16x32_bf16 v[164:167], v[52:55], a[156:159], v[164:167]
  ds_read_b64_tr_b16 v[46:47], v28 offset:25600
  v_mfma_f32_16x16x32_bf16 v[164:167], v[48:51], a[148:151], v[164:167]
  ds_read_b64_tr_b16 v[48:49], v29 offset:16384
  s_waitcnt lgkmcnt(5)
  v_mfma_f32_16x16x32_bf16 v[168:171], v[56:59], a[144:147], v[168:171]
  ds_read_b64_tr_b16 v[50:51], v29 offset:17408
  v_mfma_f32_16x16x32_bf16 v[168:171], v[60:63], a[152:155], v[168:171]
  ds_read_b64_tr_b16 v[52:53], v29 offset:24576
  v_mfma_f32_16x16x32_bf16 v[172:175], v[60:63], a[156:159], v[172:175]
  ds_read_b64_tr_b16 v[54:55], v29 offset:25600
  v_mfma_f32_16x16x32_bf16 v[172:175], v[56:59], a[148:151], v[172:175]
  s_waitcnt vmcnt(4)
  s_barrier
  s_waitcnt lgkmcnt(4)
  v_mfma_f32_16x16x32_bf16 v[176:179], v[40:43], a[144:147], v[176:179]
  ds_read_b64_tr_b16 v[56:57], v22 offset:32768
  ds_read_b64_tr_b16 v[58:59], v22 offset:33792
  s_add_u32 m0, s82, 0
  v_mfma_f32_16x16x32_bf16 v[176:179], v[44:47], a[152:155], v[176:179]
  ds_read_b64_tr_b16 v[60:61], v22 offset:40960
  ds_read_b64_tr_b16 v[62:63], v22 offset:41984
  s_add_u32 s84, s84, 221184
  s_sub_u32 s3, s84, 2211840
  v_mfma_f32_16x16x32_bf16 v[180:183], v[44:47], a[156:159], v[180:183]
  s_min_u32 s84, s84, s3
  buffer_load_dwordx4 v12, s[8:11], s84 offen offset:0 lds
  v_mfma_f32_16x16x32_bf16 v[180:183], v[40:43], a[148:151], v[180:183]
  ds_read_b64_tr_b16 v[40:41], v23 offset:32768
  ds_read_b64_tr_b16 v[42:43], v23 offset:33792
  s_waitcnt lgkmcnt(6)
  v_mfma_f32_16x16x32_bf16 v[184:187], v[48:51], a[144:147], v[184:187]
  buffer_load_dwordx4 v13, s[8:11], s84 offen offset:1024 lds
  v_mfma_f32_16x16x32_bf16 v[184:187], v[52:55], a[152:155], v[184:187]
  ds_read_b64_tr_b16 v[44:45], v23 offset:40960
  v_mfma_f32_16x16x32_bf16 v[188:191], v[52:55], a[156:159], v[188:191]
  ds_read_b64_tr_b16 v[46:47], v23 offset:41984
  v_mfma_f32_16x16x32_bf16 v[188:191], v[48:51], a[148:151], v[188:191]
  ds_read_b64_tr_b16 v[48:49], v24 offset:32768
  ds_read_b64_tr_b16 v[50:51], v24 offset:33792
  v_lshrrev_b32 v18, 3, v0
  v_lshlrev_b32 v18, 8, v18
  v_add_u32 v18, s2, v18
  v_lshlrev_b32 v18, 4, v18
  v_and_b32 v18, 0xffffff80, v18
  v_min_u32 v18, L_code_end-L_pc-4, v18
  global_load_dword v18, v18, s[32:33]
  v_lshrrev_b32 v4, 3, v1
  v_and_b32 v5, 7, v1
  v_lshrrev_b32 v6, 4, v1
  v_xor_b32 v5, v5, v6
  v_lshlrev_b32 v5, 4, v5
  v_lshl_add_u32 v4, v4, 12, v5
  v_xor_b32 v5, 64, v4
  v_add_u32 v5, 31744, v5
  v_and_b32 v30, 15, v1
  v_lshrrev_b32 v31, 1, v30
  v_lshrrev_b32 v6, 4, v1
  v_xor_b32 v31, v31, v6
  v_lshlrev_b32 v31, 4, v31
  v_lshl_add_u32 v30, v30, 7, v31
  v_add_u32 v6, s81, v30
  v_xor_b32 v7, 64, v6
  v_add_u32 v8, s89, v30
  v_xor_b32 v9, 64, v8
  v_mul_f32 v192, v128, v128
  v_mul_f32 v193, v129, v129
  v_mul_f32 v194, v130, v130
  v_mul_f32 v195, v131, v131
  v_fma_f32 v192, v192, v17, v16
  v_fma_f32 v193, v193, v17, v16
  v_fma_f32 v194, v194, v17, v16
  v_fma_f32 v195, v195, v17, v16
  v_mul_f32 v192, v192, v128
  v_mul_f32 v193, v193, v129
  v_mul_f32 v194, v194, v130
  v_mul_f32 v195, v195, v131
  v_exp_f32 v192, v192
  v_exp_f32 v193, v193
  v_exp_f32 v194, v194
  v_exp_f32 v195, v195
  v_add_f32 v192, 1.0, v192
  v_add_f32 v193, 1.0, v193
  v_add_f32 v194, 1.0, v194
  v_add_f32 v195, 1.0, v195
  buffer_load_dwordx4 v14, s[8:11], s84 offen offset:2048 lds
  v_rcp_f32 v192, v192
  v_rcp_f32 v193, v193
  v_rcp_f32 v194, v194
  v_rcp_f32 v195, v195
  v_mul_f32 v128, v128, v192
  v_mul_f32 v129, v129, v193
  v_mul_f32 v130, v130, v194
  v_mul_f32 v131, v131, v195
  v_add_f32 v36, v36, v128
  v_fmac_f32 v38, v128, v128
  v_add_f32 v36, v36, v129
  v_fmac_f32 v38, v129, v129
  v_add_f32 v36, v36, v130
  v_fmac_f32 v38, v130, v130
  v_add_f32 v36, v36, v131
  v_fmac_f32 v38, v131, v131
  v_mul_f32 v192, v132, v132
  v_mul_f32 v193, v133, v133
  v_mul_f32 v194, v134, v134
  v_mul_f32 v195, v135, v135
  buffer_load_dwordx4 v15, s[8:11], s84 offen offset:3072 lds
  v_fma_f32 v192, v192, v17, v16
  v_fma_f32 v193, v193, v17, v16
  v_fma_f32 v194, v194, v17, v16
  v_fma_f32 v195, v195, v17, v16
  v_mul_f32 v192, v192, v132
  v_mul_f32 v193, v193, v133
  v_mul_f32 v194, v194, v134
  v_mul_f32 v195, v195, v135
  v_exp_f32 v192, v192
  v_exp_f32 v193, v193
  v_exp_f32 v194, v194
  v_exp_f32 v195, v195
  v_add_f32 v192, 1.0, v192
  v_add_f32 v193, 1.0, v193
  v_add_f32 v194, 1.0, v194
  v_add_f32 v195, 1.0, v195
  v_rcp_f32 v192, v192
  v_rcp_f32 v193, v193
  s_add_u32 m0, s81, 0
  s_xor_b32 s83, s70, 0
  buffer_load_dwordx4 v4, s[16:19], s83 offen lds
  v_rcp_f32 v194, v194
  v_rcp_f32 v195, v195
  v_mul_f32 v132, v132, v192
  v_mul_f32 v133, v133, v193
  v_mul_f32 v134, v134, v194
  v_mul_f32 v135, v135, v195
  v_add_f32 v37, v37, v132
  v_fmac_f32 v39, v132, v132
  v_add_f32 v37, v37, v133
  v_fmac_f32 v39, v133, v133
  v_add_f32 v37, v37, v134
  v_fmac_f32 v39, v134, v134
  v_add_f32 v37, v37, v135
  v_fmac_f32 v39, v135, v135
  v_mul_f32 v192, v136, v136
  v_mul_f32 v193, v137, v137
  v_mul_f32 v194, v138, v138
  v_mul_f32 v195, v139, v139
  v_fma_f32 v192, v192, v17, v16
  v_fma_f32 v193, v193, v17, v16
  v_fma_f32 v194, v194, v17, v16
  v_fma_f32 v195, v195, v17, v16
  buffer_load_dwordx4 v5, s[16:19], s83 offen offset:1024 lds
  v_mul_f32 v192, v192, v136
  v_mul_f32 v193, v193, v137
  v_mul_f32 v194, v194, v138
  v_mul_f32 v195, v195, v139
  v_exp_f32 v192, v192
  v_exp_f32 v193, v193
  v_exp_f32 v194, v194
  v_exp_f32 v195, v195
  v_add_f32 v192, 1.0, v192
  v_add_f32 v193, 1.0, v193
  v_add_f32 v194, 1.0, v194
  v_add_f32 v195, 1.0, v195
  v_rcp_f32 v192, v192
  v_rcp_f32 v193, v193
  v_rcp_f32 v194, v194
  v_rcp_f32 v195, v195
  s_add_u32 m0, s81, 2048
  s_xor_b32 s83, s71, 0
  buffer_load_dwordx4 v4, s[16:19], s83 offen lds
  v_mul_f32 v136, v136, v192
  v_mul_f32 v137, v137, v193
  v_mul_f32 v138, v138, v194
  v_mul_f32 v139, v139, v195
  v_add_f32 v36, v36, v136
  v_fmac_f32 v38, v136, v136
  v_add_f32 v36, v36, v137
  v_fmac_f32 v38, v137, v137
  v_add_f32 v36, v36, v138
  v_fmac_f32 v38, v138, v138
  v_add_f32 v36, v36, v139
  v_fmac_f32 v38, v139, v139
  v_mul_f32 v192, v140, v140
  v_mul_f32 v193, v141, v141
  v_mul_f32 v194, v142, v142
  v_mul_f32 v195, v143, v143
  v_fma_f32 v192, v192, v17, v16
  v_fma_f32 v193, v193, v17, v16
  v_fma_f32 v194, v194, v17, v16
  v_fma_f32 v195, v195, v17, v16
  v_mul_f32 v192, v192, v140
  v_mul_f32 v193, v193, v141
  v_mul_f32 v194, v194, v142
  v_mul_f32 v195, v195, v143
  buffer_load_dwordx4 v5, s[16:19], s83 offen offset:1024 lds
  v_exp_f32 v192, v192
  v_exp_f32 v193, v193
  v_exp_f32 v194, v194
  v_exp_f32 v195, v195
  v_add_f32 v192, 1.0, v192
  v_add_f32 v193, 1.0, v193
  v_add_f32 v194, 1.0, v194
  v_add_f32 v195, 1.0, v195
  v_rcp_f32 v192, v192
  v_rcp_f32 v193, v193
  v_rcp_f32 v194, v194
  v_rcp_f32 v195, v195
  v_mul_f32 v140, v140, v192
  v_mul_f32 v141, v141, v193
  v_mul_f32 v142, v142, v194
  v_mul_f32 v143, v143, v195
  s_add_u32 m0, s81, 4096
  s_xor_b32 s83, s72, 0
  buffer_load_dwordx4 v4, s[16:19], s83 offen lds
  v_add_f32 v37, v37, v140
  v_fmac_f32 v39, v140, v140
  v_add_f32 v37, v37, v141
  v_fmac_f32 v39, v141, v141
  v_add_f32 v37, v37, v142
  v_fmac_f32 v39, v142, v142
  v_add_f32 v37, v37, v143
  v_fmac_f32 v39, v143, v143
  v_mul_f32 v192, v144, v144
  v_mul_f32 v193, v145, v145
  v_mul_f32 v194, v146, v146
  v_mul_f32 v195, v147, v147
  v_fma_f32 v192, v192, v17, v16
  v_fma_f32 v193, v193, v17, v16
  v_fma_f32 v194, v194, v17, v16
  v_fma_f32 v195, v195, v17, v16
  v_mul_f32 v192, v192, v144
  v_mul_f32 v193, v193, v145
  v_mul_f32 v194, v194, v146
  v_mul_f32 v195, v195, v147
  v_exp_f32 v192, v192
  v_exp_f32 v193, v193
  buffer_load_dwordx4 v5, s[16:19], s83 offen offset:1024 lds
  v_exp_f32 v194, v194
  v_exp_f32 v195, v195
  v_add_f32 v192, 1.0, v192
  v_add_f32 v193, 1.0, v193
  v_add_f32 v194, 1.0, v194
  v_add_f32 v195, 1.0, v195
  v_rcp_f32 v192, v192
  v_rcp_f32 v193, v193
  v_rcp_f32 v194, v194
  v_rcp_f32 v195, v195
  v_mul_f32 v144, v144, v192
  v_mul_f32 v145, v145, v193
  v_mul_f32 v146, v146, v194
  v_mul_f32 v147, v147, v195
  v_add_f32 v36, v36, v144
  v_fmac_f32 v38, v144, v144
  v_add_f32 v36, v36, v145
  v_fmac_f32 v38, v145, v145
  s_add_u32 m0, s81, 6144
  s_xor_b32 s83, s73, 0
  buffer_load_dwordx4 v4, s[16:19], s83 offen lds
  v_add_f32 v36, v36, v146
  v_fmac_f32 v38, v146, v146
  v_add_f32 v36, v36, v147
  v_fmac_f32 v38, v147, v147
  v_mul_f32 v192, v148, v148
  v_mul_f32 v193, v149, v149
  v_mul_f32 v194, v150, v150
  v_mul_f32 v195, v151, v151
  v_fma_f32 v192, v192, v17, v16
  v_fma_f32 v193, v193, v17, v16
  v_fma_f32 v194, v194, v17, v16
  v_fma_f32 v195, v195, v17, v16
  v_mul_f32 v192, v192, v148
  v_mul_f32 v193, v193, v149
  v_mul_f32 v194, v194, v150
  v_mul_f32 v195, v195, v151
  v_exp_f32 v192, v192
  v_exp_f32 v193, v193
  v_exp_f32 v194, v194
  v_exp_f32 v195, v195
  buffer_load_dwordx4 v5, s[16:19], s83 offen offset:1024 lds
  v_add_f32 v192, 1.0, v192
  v_add_f32 v193, 1.0, v193
  v_add_f32 v194, 1.0, v194
  v_add_f32 v195, 1.0, v195
  v_rcp_f32 v192, v192
  v_rcp_f32 v193, v193
  v_rcp_f32 v194, v194
  v_rcp_f32 v195, v195
  v_mul_f32 v148, v148, v192
  v_mul_f32 v149, v149, v193
  v_mul_f32 v150, v150, v194
  v_mul_f32 v151, v151, v195
  v_add_f32 v37, v37, v148
  v_fmac_f32 v39, v148, v148
  v_add_f32 v37, v37, v149
  v_fmac_f32 v39, v149, v149
  v_add_f32 v37, v37, v150
  v_fmac_f32 v39, v150, v150
  v_add_f32 v37, v37, v151
  v_fmac_f32 v39, v151, v151
  s_add_u32 m0, s81, 8192
  s_xor_b32 s83, s70, 128
  buffer_load_dwordx4 v4, s[16:19], s83 offen lds
  v_mul_f32 v192, v152, v152
  v_mul_f32 v193, v153, v153
  v_mul_f32 v194, v154, v154
  v_mul_f32 v195, v155, v155
  v_fma_f32 v192, v192, v17, v16
  v_fma_f32 v193, v193, v17, v16
  v_fma_f32 v194, v194, v17, v16
  v_fma_f32 v195, v195, v17, v16
  v_mul_f32 v192, v192, v152
  v_mul_f32 v193, v193, v153
  v_mul_f32 v194, v194, v154
  v_mul_f32 v195, v195, v155
  v_exp_f32 v192, v192
  v_exp_f32 v193, v193
  v_exp_f32 v194, v194
  v_exp_f32 v195, v195
  v_add_f32 v192, 1.0, v192
  v_add_f32 v193, 1.0, v193
  v_add_f32 v194, 1.0, v194
  v_add_f32 v195, 1.0, v195
  buffer_load_dwordx4 v5, s[16:19], s83 offen offset:1024 lds
  v_rcp_f32 v192, v192
  v_rcp_f32 v193, v193
  v_rcp_f32 v194, v194
  v_rcp_f32 v195, v195
  v_mul_f32 v152, v152, v192
  v_mul_f32 v153, v153, v193
  v_mul_f32 v154, v154, v194
  v_mul_f32 v155, v155, v195
  v_add_f32 v36, v36, v152
  v_fmac_f32 v38, v152, v152
  v_add_f32 v36, v36, v153
  v_fmac_f32 v38, v153, v153
  v_add_f32 v36, v36, v154
  v_fmac_f32 v38, v154, v154
  v_add_f32 v36, v36, v155
  v_fmac_f32 v38, v155, v155
  v_mul_f32 v192, v156, v156
  v_mul_f32 v193, v157, v157
  v_mul_f32 v194, v158, v158
  v_mul_f32 v195, v159, v159
  s_add_u32 m0, s81, 10240
  s_xor_b32 s83, s71, 128
  buffer_load_dwordx4 v4, s[16:19], s83 offen lds
  v_fma_f32 v192, v192, v17, v16
  v_fma_f32 v193, v193, v17, v16
  v_fma_f32 v194, v194, v17, v16
  v_fma_f32 v195, v195, v17, v16
  v_mul_f32 v192, v192, v156
  v_mul_f32 v193, v193, v157
  v_mul_f32 v194, v194, v158
  v_mul_f32 v195, v195, v159
  v_exp_f32 v192, v192
  v_exp_f32 v193, v193
  v_exp_f32 v194, v194
  v_exp_f32 v195, v195
  v_add_f32 v192, 1.0, v192
  v_add_f32 v193, 1.0, v193
  v_add_f32 v194, 1.0, v194
  v_add_f32 v195, 1.0, v195
  v_rcp_f32 v192, v192
  v_rcp_f32 v193, v193
  buffer_load_dwordx4 v5, s[16:19], s83 offen offset:1024 lds
  v_rcp_f32 v194, v194
  v_rcp_f32 v195, v195
  v_mul_f32 v156, v156, v192
  v_mul_f32 v157, v157, v193
  v_mul_f32 v158, v158, v194
  v_mul_f32 v159, v159, v195
  v_add_f32 v37, v37, v156
  v_fmac_f32 v39, v156, v156
  v_add_f32 v37, v37, v157
  v_fmac_f32 v39, v157, v157
  v_add_f32 v37, v37, v158
  v_fmac_f32 v39, v158, v158
  v_add_f32 v37, v37, v159
  v_fmac_f32 v39, v159, v159
  v_mul_f32 v192, v160, v160
  v_mul_f32 v193, v161, v161
  v_mul_f32 v194, v162, v162
  v_mul_f32 v195, v163, v163
  v_fma_f32 v192, v192, v17, v16
  v_fma_f32 v193, v193, v17, v16
  v_fma_f32 v194, v194, v17, v16
  v_fma_f32 v195, v195, v17, v16
  s_add_u32 m0, s81, 12288
  s_xor_b32 s83, s72, 128
  buffer_load_dwordx4 v4, s[16:19], s83 offen lds
  v_mul_f32 v192, v192, v160
  v_mul_f32 v193, v193, v161
  v_mul_f32 v194, v194, v162
  v_mul_f32 v195, v195, v163
  v_exp_f32 v192, v192
  v_exp_f32 v193, v193
  v_exp_f32 v194, v194
  v_exp_f32 v195, v195
  v_add_f32 v192, 1.0, v192
  v_add_f32 v193, 1.0, v193
  v_add_f32 v194, 1.0, v194
  v_add_f32 v195, 1.0, v195
  v_rcp_f32 v192, v192
  v_rcp_f32 v193, v193
  v_rcp_f32 v194, v194
  v_rcp_f32 v195, v195
  buffer_load_dwordx4 v5, s[16:19], s83 offen offset:1024 lds
  v_mul_f32 v160, v160, v192
  v_mul_f32 v161, v161, v193
  v_mul_f32 v162, v162, v194
  v_mul_f32 v163, v163, v195
  v_add_f32 v36, v36, v160
  v_fmac_f32 v38, v160, v160
  v_add_f32 v36, v36, v161
  v_fmac_f32 v38, v161, v161
  v_add_f32 v36, v36, v162
  v_fmac_f32 v38, v162, v162
  v_add_f32 v36, v36, v163
  v_fmac_f32 v38, v163, v163
  v_mul_f32 v192, v164, v164
  v_mul_f32 v193, v165, v165
  v_mul_f32 v194, v166, v166
  v_mul_f32 v195, v167, v167
  v_fma_f32 v192, v192, v17, v16
  v_fma_f32 v193, v193, v17, v16
  v_fma_f32 v194, v194, v17, v16
  v_fma_f32 v195, v195, v17, v16
  v_mul_f32 v192, v192, v164
  v_mul_f32 v193, v193, v165
  v_mul_f32 v194, v194, v166
  v_mul_f32 v195, v195, v167
  s_add_u32 m0, s81, 14336
  s_xor_b32 s83, s73, 128
  buffer_load_dwordx4 v4, s[16:19], s83 offen lds
  v_exp_f32 v192, v192
  v_exp_f32 v193, v193
  v_exp_f32 v194, v194
  v_exp_f32 v195, v195
  v_add_f32 v192, 1.0, v192
  v_add_f32 v193, 1.0, v193
  v_add_f32 v194, 1.0, v194
  v_add_f32 v195, 1.0, v195
  v_rcp_f32 v192, v192
  v_rcp_f32 v193, v193
  v_rcp_f32 v194, v194
  v_rcp_f32 v195, v195
  v_mul_f32 v164, v164, v192
  v_mul_f32 v165, v165, v193
  v_mul_f32 v166, v166, v194
  v_mul_f32 v167, v167, v195
  buffer_load_dwordx4 v5, s[16:19], s83 offen offset:1024 lds
  v_add_f32 v37, v37, v164
  v_fmac_f32 v39, v164, v164
  v_add_f32 v37, v37, v165
  v_fmac_f32 v39, v165, v165
  v_add_f32 v37, v37, v166
  v_fmac_f32 v39, v166, v166
  v_add_f32 v37, v37, v167
  v_fmac_f32 v39, v167, v167
  v_mul_f32 v192, v168, v168
  v_mul_f32 v193, v169, v169
  v_mul_f32 v194, v170, v170
  v_mul_f32 v195, v171, v171
  v_fma_f32 v192, v192, v17, v16
  v_fma_f32 v193, v193, v17, v16
  v_fma_f32 v194, v194, v17, v16
  v_fma_f32 v195, v195, v17, v16
  v_mul_f32 v192, v192, v168
  v_mul_f32 v193, v193, v169
  v_mul_f32 v194, v194, v170
  v_mul_f32 v195, v195, v171
  v_exp_f32 v192, v192
  v_exp_f32 v193, v193
  s_add_u32 m0, s89, 0
  s_xor_b32 s83, s70, 256
  buffer_load_dwordx4 v4, s[16:19], s83 offen lds
  v_exp_f32 v194, v194
  v_exp_f32 v195, v195
  v_add_f32 v192, 1.0, v192
  v_add_f32 v193, 1.0, v193
  v_add_f32 v194, 1.0, v194
  v_add_f32 v195, 1.0, v195
  v_rcp_f32 v192, v192
  v_rcp_f32 v193, v193
  v_rcp_f32 v194, v194
  v_rcp_f32 v195, v195
  v_mul_f32 v168, v168, v192
  v_mul_f32 v169, v169, v193
  v_mul_f32 v170, v170, v194
  v_mul_f32 v171, v171, v195
  v_add_f32 v36, v36, v168
  v_fmac_f32 v38, v168, v168
  v_add_f32 v36, v36, v169
  v_fmac_f32 v38, v169, v169
  buffer_load_dwordx4 v5, s[16:19], s83 offen offset:1024 lds
  v_add_f32 v36, v36, v170
  v_fmac_f32 v38, v170, v170
  v_add_f32 v36, v36, v171
  v_fmac_f32 v38, v171, v171
  v_mul_f32 v192, v172, v172
  v_mul_f32 v193, v173, v173
  v_mul_f32 v194, v174, v174
  v_mul_f32 v195, v175, v175
  v_fma_f32 v192, v192, v17, v16
  v_fma_f32 v193, v193, v17, v16
  v_fma_f32 v194, v194, v17, v16
  v_fma_f32 v195, v195, v17, v16
  v_mul_f32 v192, v192, v172
  v_mul_f32 v193, v193, v173
  v_mul_f32 v194, v194, v174
  v_mul_f32 v195, v195, v175
  v_exp_f32 v192, v192
  v_exp_f32 v193, v193
  v_exp_f32 v194, v194
  v_exp_f32 v195, v195
  s_add_u32 m0, s89, 2048
  s_xor_b32 s83, s71, 256
  buffer_load_dwordx4 v4, s[16:19], s83 offen lds
  v_add_f32 v192, 1.0, v192
  v_add_f32 v193, 1.0, v193
  v_add_f32 v194, 1.0, v194
  v_add_f32 v195, 1.0, v195
  v_rcp_f32 v192, v192
  v_rcp_f32 v193, v193
  v_rcp_f32 v194, v194
  v_rcp_f32 v195, v195
  v_mul_f32 v172, v172, v192
  v_mul_f32 v173, v173, v193
  v_mul_f32 v174, v174, v194
  v_mul_f32 v175, v175, v195
  v_add_f32 v37, v37, v172
  v_fmac_f32 v39, v172, v172
  v_add_f32 v37, v37, v173
  v_fmac_f32 v39, v173, v173
  v_add_f32 v37, v37, v174
  v_fmac_f32 v39, v174, v174
  v_add_f32 v37, v37, v175
  v_fmac_f32 v39, v175, v175
  buffer_load_dwordx4 v5, s[16:19], s83 offen offset:1024 lds
  v_mul_f32 v192, v176, v176
  v_mul_f32 v193, v177, v177
  v_mul_f32 v194, v178, v178
  v_mul_f32 v195, v179, v179
  v_fma_f32 v192, v192, v17, v16
  v_fma_f32 v193, v193, v17, v16
  v_fma_f32 v194, v194, v17, v16
  v_fma_f32 v195, v195, v17, v16
  v_mul_f32 v192, v192, v176
  v_mul_f32 v193, v193, v177
  v_mul_f32 v194, v194, v178
  v_mul_f32 v195, v195, v179
  v_exp_f32 v192, v192
  v_exp_f32 v193, v193
  v_exp_f32 v194, v194
  v_exp_f32 v195, v195
  v_add_f32 v192, 1.0, v192
  v_add_f32 v193, 1.0, v193
  v_add_f32 v194, 1.0, v194
  v_add_f32 v195, 1.0, v195
  s_add_u32 m0, s89, 4096
  s_xor_b32 s83, s72, 256
  buffer_load_dwordx4 v4, s[16:19], s83 offen lds
  v_rcp_f32 v192, v192
  v_rcp_f32 v193, v193
  v_rcp_f32 v194, v194
  v_rcp_f32 v195, v195
  v_mul_f32 v176, v176, v192
  v_mul_f32 v177, v177, v193
  v_mul_f32 v178, v178, v194
  v_mul_f32 v179, v179, v195
  v_add_f32 v36, v36, v176
  v_fmac_f32 v38, v176, v176
  v_add_f32 v36, v36, v177
  v_fmac_f32 v38, v177, v177
  v_add_f32 v36, v36, v178
  v_fmac_f32 v38, v178, v178
  v_add_f32 v36, v36, v179
  v_fmac_f32 v38, v179, v179
  v_mul_f32 v192, v180, v180
  v_mul_f32 v193, v181, v181
  v_mul_f32 v194, v182, v182
  v_mul_f32 v195, v183, v183
  buffer_load_dwordx4 v5, s[16:19], s83 offen offset:1024 lds
  v_fma_f32 v192, v192, v17, v16
  v_fma_f32 v193, v193, v17, v16
  v_fma_f32 v194, v194, v17, v16
  v_fma_f32 v195, v195, v17, v16
  v_mul_f32 v192, v192, v180
  v_mul_f32 v193, v193, v181
  v_mul_f32 v194, v194, v182
  v_mul_f32 v195, v195, v183
  v_exp_f32 v192, v192
  v_exp_f32 v193, v193
  v_exp_f32 v194, v194
  v_exp_f32 v195, v195
  v_add_f32 v192, 1.0, v192
  v_add_f32 v193, 1.0, v193
  v_add_f32 v194, 1.0, v194
  v_add_f32 v195, 1.0, v195
  v_rcp_f32 v192, v192
  v_rcp_f32 v193, v193
  s_add_u32 m0, s89, 6144
  s_xor_b32 s83, s73, 256
  buffer_load_dwordx4 v4, s[16:19], s83 offen lds
  v_rcp_f32 v194, v194
  v_rcp_f32 v195, v195
  v_mul_f32 v180, v180, v192
  v_mul_f32 v181, v181, v193
  v_mul_f32 v182, v182, v194
  v_mul_f32 v183, v183, v195
  v_add_f32 v37, v37, v180
  v_fmac_f32 v39, v180, v180
  v_add_f32 v37, v37, v181
  v_fmac_f32 v39, v181, v181
  v_add_f32 v37, v37, v182
  v_fmac_f32 v39, v182, v182
  v_add_f32 v37, v37, v183
  v_fmac_f32 v39, v183, v183
  v_mul_f32 v192, v184, v184
  v_mul_f32 v193, v185, v185
  v_mul_f32 v194, v186, v186
  v_mul_f32 v195, v187, v187
  v_fma_f32 v192, v192, v17, v16
  v_fma_f32 v193, v193, v17, v16
  v_fma_f32 v194, v194, v17, v16
  v_fma_f32 v195, v195, v17, v16
  buffer_load_dwordx4 v5, s[16:19], s83 offen offset:1024 lds
  v_mul_f32 v192, v192, v184
  v_mul_f32 v193, v193, v185
  v_mul_f32 v194, v194, v186
  v_mul_f32 v195, v195, v187
  v_exp_f32 v192, v192
  v_exp_f32 v193, v193
  v_exp_f32 v194, v194
  v_exp_f32 v195, v195
  v_add_f32 v192, 1.0, v192
  v_add_f32 v193, 1.0, v193
  v_add_f32 v194, 1.0, v194
  v_add_f32 v195, 1.0, v195
  v_rcp_f32 v192, v192
  v_rcp_f32 v193, v193
  v_rcp_f32 v194, v194
  v_rcp_f32 v195, v195
  s_waitcnt vmcnt(16)
  ds_read_b128 a[160:163], v6 offset:0
  ds_read_b128 a[176:179], v7 offset:0
  ds_read_b128 a[164:167], v6 offset:2048
  ds_read_b128 a[180:183], v7 offset:2048
  ds_read_b128 a[168:171], v6 offset:4096
  ds_read_b128 a[184:187], v7 offset:4096
  ds_read_b128 a[172:175], v6 offset:6144
  ds_read_b128 a[188:191], v7 offset:6144
  v_mul_f32 v184, v184, v192
  v_mul_f32 v185, v185, v193
  v_mul_f32 v186, v186, v194
  v_mul_f32 v187, v187, v195
  v_add_f32 v36, v36, v184
  v_fmac_f32 v38, v184, v184
  v_add_f32 v36, v36, v185
  v_fmac_f32 v38, v185, v185
  v_add_f32 v36, v36, v186
  v_fmac_f32 v38, v186, v186
  v_add_f32 v36, v36, v187
  v_fmac_f32 v38, v187, v187
  v_mul_f32 v192, v188, v188
  v_mul_f32 v193, v189, v189
  v_mul_f32 v194, v190, v190
  v_mul_f32 v195, v191, v191
  v_fma_f32 v192, v192, v17, v16
  v_fma_f32 v193, v193, v17, v16
  v_fma_f32 v194, v194, v17, v16
  v_fma_f32 v195, v195, v17, v16
  v_mul_f32 v192, v192, v188
  v_mul_f32 v193, v193, v189
  v_mul_f32 v194, v194, v190
  v_mul_f32 v195, v195, v191
  s_waitcnt lgkmcnt(0)
  s_add_u32 m0, s81, 0
  s_xor_b32 s83, s70, 384
  buffer_load_dwordx4 v4, s[16:19], s83 offen lds
  v_exp_f32 v192, v192
  v_exp_f32 v193, v193
  v_exp_f32 v194, v194
  v_exp_f32 v195, v195
  v_add_f32 v192, 1.0, v192
  v_add_f32 v193, 1.0, v193
  v_add_f32 v194, 1.0, v194
  v_add_f32 v195, 1.0, v195
  v_rcp_f32 v192, v192
  v_rcp_f32 v193, v193
  v_rcp_f32 v194, v194
  v_rcp_f32 v195, v195
  v_mul_f32 v188, v188, v192
  v_mul_f32 v189, v189, v193
  v_mul_f32 v190, v190, v194
  v_mul_f32 v191, v191, v195
  buffer_load_dwordx4 v5, s[16:19], s83 offen offset:1024 lds
  v_add_f32 v37, v37, v188
  v_fmac_f32 v39, v188, v188
  v_add_f32 v37, v37, v189
  v_fmac_f32 v39, v189, v189
  v_add_f32 v37, v37, v190
  v_fmac_f32 v39, v190, v190
  v_add_f32 v37, v37, v191
  v_fmac_f32 v39, v191, v191
  s_nop 0
  v_permlane16_swap_b32 v36, v37
  v_permlane16_swap_b32 v38, v39
  v_add_f32 v36, v36, v37
  v_add_f32 v38, v38, v39
  v_mov_b32 v37, v36
  v_mov_b32 v39, v38
  s_nop 0
  v_permlane32_swap_b32 v36, v37
  v_permlane32_swap_b32 v38, v39
  v_add_f32 v36, v36, v37
  v_add_f32 v38, v38, v39
  v_mov_b32 v37, v2
  v_mov_b32 v39, v2
  buffer_store_dwordx4 v[36:39], v35, s[12:15], s79 offen sc1
  s_add_u32 m0, s81, 2048
  s_xor_b32 s83, s71, 384
  buffer_load_dwordx4 v4, s[16:19], s83 offen lds
  buffer_load_dwordx4 v5, s[16:19], s83 offen offset:1024 lds
  v_mfma_f32_16x16x32_bf16 v[64:67], v[56:59], a[0:3], 0
  v_mfma_f32_16x16x32_bf16 v[64:67], v[60:63], a[8:11], v[64:67]
  ds_read_b64_tr_b16 v[52:53], v24 offset:40960
  v_mfma_f32_16x16x32_bf16 v[68:71], v[60:63], a[12:15], 0
  ds_read_b64_tr_b16 v[54:55], v24 offset:41984
  v_mfma_f32_16x16x32_bf16 v[68:71], v[56:59], a[4:7], v[68:71]
  ds_read_b64_tr_b16 v[56:57], v25 offset:32768
  v_mfma_f32_16x16x32_bf16 v[72:75], v[40:43], a[0:3], 0
  ds_read_b64_tr_b16 v[58:59], v25 offset:33792
  v_mfma_f32_16x16x32_bf16 v[72:75], v[44:47], a[8:11], v[72:75]
  ds_read_b64_tr_b16 v[60:61], v25 offset:40960
  v_mfma_f32_16x16x32_bf16 v[76:79], v[44:47], a[12:15], 0
  ds_read_b64_tr_b16 v[62:63], v25 offset:41984
  v_mfma_f32_16x16x32_bf16 v[76:79], v[40:43], a[4:7], v[76:79]
  ds_read_b64_tr_b16 v[40:41], v26 offset:32768
  s_waitcnt lgkmcnt(5)
  v_mfma_f32_16x16x32_bf16 v[80:83], v[48:51], a[0:3], 0
  ds_read_b64_tr_b16 v[42:43], v26 offset:33792
  v_mfma_f32_16x16x32_bf16 v[80:83], v[52:55], a[8:11], v[80:83]
  ds_read_b64_tr_b16 v[44:45], v26 offset:40960
  v_mfma_f32_16x16x32_bf16 v[84:87], v[52:55], a[12:15], 0
  ds_read_b64_tr_b16 v[46:47], v26 offset:41984
  v_mfma_f32_16x16x32_bf16 v[84:87], v[48:51], a[4:7], v[84:87]
  ds_read_b64_tr_b16 v[48:49], v27 offset:32768
  s_waitcnt lgkmcnt(5)
  v_mfma_f32_16x16x32_bf16 v[88:91], v[56:59], a[0:3], 0
  ds_read_b64_tr_b16 v[50:51], v27 offset:33792
  v_mfma_f32_16x16x32_bf16 v[88:91], v[60:63], a[8:11], v[88:91]
  ds_read_b64_tr_b16 v[52:53], v27 offset:40960
  v_mfma_f32_16x16x32_bf16 v[92:95], v[60:63], a[12:15], 0
  ds_read_b64_tr_b16 v[54:55], v27 offset:41984
  v_mfma_f32_16x16x32_bf16 v[92:95], v[56:59], a[4:7], v[92:95]
  ds_read_b64_tr_b16 v[56:57], v28 offset:32768
  s_waitcnt lgkmcnt(5)
  v_mfma_f32_16x16x32_bf16 v[96:99], v[40:43], a[0:3], 0
  ds_read_b64_tr_b16 v[58:59], v28 offset:33792
  v_mfma_f32_16x16x32_bf16 v[96:99], v[44:47], a[8:11], v[96:99]
  ds_read_b64_tr_b16 v[60:61], v28 offset:40960
  v_mfma_f32_16x16x32_bf16 v[100:103], v[44:47], a[12:15], 0
  ds_read_b64_tr_b16 v[62:63], v28 offset:41984
  v_mfma_f32_16x16x32_bf16 v[100:103], v[40:43], a[4:7], v[100:103]
  ds_read_b64_tr_b16 v[40:41], v29 offset:32768
  s_waitcnt lgkmcnt(5)
  v_mfma_f32_16x16x32_bf16 v[104:107], v[48:51], a[0:3], 0
  ds_read_b64_tr_b16 v[42:43], v29 offset:33792
  v_mfma_f32_16x16x32_bf16 v[104:107], v[52:55], a[8:11], v[104:107]
  ds_read_b64_tr_b16 v[44:45], v29 offset:40960
  v_mfma_f32_16x16x32_bf16 v[108:111], v[52:55], a[12:15], 0
  ds_read_b64_tr_b16 v[46:47], v29 offset:41984
  v_mfma_f32_16x16x32_bf16 v[108:111], v[48:51], a[4:7], v[108:111]
  s_barrier
  s_waitcnt lgkmcnt(4)
  v_mfma_f32_16x16x32_bf16 v[112:115], v[56:59], a[0:3], 0
  ds_read_b64_tr_b16 v[48:49], v22 offset:49152
  ds_read_b64_tr_b16 v[50:51], v22 offset:50176
  s_add_u32 m0, s82, 16384
  v_mfma_f32_16x16x32_bf16 v[112:115], v[60:63], a[8:11], v[112:115]
  ds_read_b64_tr_b16 v[52:53], v22 offset:57344
  ds_read_b64_tr_b16 v[54:55], v22 offset:58368
  s_add_u32 s84, s84, 221184
  s_sub_u32 s3, s84, 2211840
  v_mfma_f32_16x16x32_bf16 v[116:119], v[60:63], a[12:15], 0
  s_min_u32 s84, s84, s3
  buffer_load_dwordx4 v12, s[8:11], s84 offen offset:0 lds
  v_mfma_f32_16x16x32_bf16 v[116:119], v[56:59], a[4:7], v[116:119]
  ds_read_b64_tr_b16 v[56:57], v23 offset:49152
  ds_read_b64_tr_b16 v[58:59], v23 offset:50176
  s_waitcnt lgkmcnt(6)
  v_mfma_f32_16x16x32_bf16 v[120:123], v[40:43], a[0:3], 0
  buffer_load_dwordx4 v13, s[8:11], s84 offen offset:1024 lds
  v_mfma_f32_16x16x32_bf16 v[120:123], v[44:47], a[8:11], v[120:123]
  ds_read_b64_tr_b16 v[60:61], v23 offset:57344
  ds_read_b64_tr_b16 v[62:63], v23 offset:58368
  v_mfma_f32_16x16x32_bf16 v[124:127], v[44:47], a[12:15], 0
  buffer_load_dwordx4 v14, s[8:11], s84 offen offset:2048 lds
  v_mfma_f32_16x16x32_bf16 v[124:127], v[40:43], a[4:7], v[124:127]
  ds_read_b64_tr_b16 v[40:41], v24 offset:49152
  ds_read_b64_tr_b16 v[42:43], v24 offset:50176
  s_waitcnt lgkmcnt(6)
  v_mfma_f32_16x16x32_bf16 v[64:67], v[48:51], a[16:19], v[64:67]
  s_waitcnt vmcnt(8)
  ds_read_b128 a[224:227], v8 offset:0
  v_mfma_f32_16x16x32_bf16 v[64:67], v[52:55], a[24:27], v[64:67]
  ds_read_b64_tr_b16 v[44:45], v24 offset:57344
  ds_read_b64_tr_b16 v[46:47], v24 offset:58368
  buffer_load_dwordx4 v15, s[8:11], s84 offen offset:3072 lds
  v_mfma_f32_16x16x32_bf16 v[68:71], v[52:55], a[28:31], v[68:71]
  s_add_u32 m0, s81, 4096
  s_xor_b32 s83, s72, 384
  v_mfma_f32_16x16x32_bf16 v[68:71], v[48:51], a[20:23], v[68:71]
  ds_read_b64_tr_b16 v[48:49], v25 offset:49152
  ds_read_b64_tr_b16 v[50:51], v25 offset:50176
  s_waitcnt lgkmcnt(7)
  v_mfma_f32_16x16x32_bf16 v[72:75], v[56:59], a[16:19], v[72:75]
  ds_read_b128 a[240:243], v9 offset:0
  v_mfma_f32_16x16x32_bf16 v[72:75], v[60:63], a[24:27], v[72:75]
  ds_read_b64_tr_b16 v[52:53], v25 offset:57344
  ds_read_b64_tr_b16 v[54:55], v25 offset:58368
  v_mfma_f32_16x16x32_bf16 v[76:79], v[60:63], a[28:31], v[76:79]
  buffer_load_dwordx4 v4, s[16:19], s83 offen lds
  v_mfma_f32_16x16x32_bf16 v[76:79], v[56:59], a[20:23], v[76:79]
  ds_read_b64_tr_b16 v[56:57], v26 offset:49152
  ds_read_b64_tr_b16 v[58:59], v26 offset:50176
  s_waitcnt lgkmcnt(7)
  v_mfma_f32_16x16x32_bf16 v[80:83], v[40:43], a[16:19], v[80:83]
  buffer_load_dwordx4 v5, s[16:19], s83 offen offset:1024 lds
  s_add_u32 m0, s81, 6144
  v_mfma_f32_16x16x32_bf16 v[80:83], v[44:47], a[24:27], v[80:83]
  ds_read_b64_tr_b16 v[60:61], v26 offset:57344
  ds_read_b64_tr_b16 v[62:63], v26 offset:58368
  s_xor_b32 s83, s73, 384
  v_mfma_f32_16x16x32_bf16 v[84:87], v[44:47], a[28:31], v[84:87]
  ds_read_b128 a[228:231], v8 offset:2048
  v_mfma_f32_16x16x32_bf16 v[84:87], v[40:43], a[20:23], v[84:87]
  ds_read_b64_tr_b16 v[40:41], v27 offset:49152
  ds_read_b64_tr_b16 v[42:43], v27 offset:50176
  s_waitcnt lgkmcnt(7)
  v_mfma_f32_16x16x32_bf16 v[88:91], v[48:51], a[16:19], v[88:91]
  buffer_load_dwordx4 v4, s[16:19], s83 offen lds
  v_mfma_f32_16x16x32_bf16 v[88:91], v[52:55], a[24:27], v[88:91]
  ds_read_b64_tr_b16 v[44:45], v27 offset:57344
  ds_read_b64_tr_b16 v[46:47], v27 offset:58368
  v_mfma_f32_16x16x32_bf16 v[92:95], v[52:55], a[28:31], v[92:95]
  ds_read_b128 a[244:247], v9 offset:2048
  v_mfma_f32_16x16x32_bf16 v[92:95], v[48:51], a[20:23], v[92:95]
  ds_read_b64_tr_b16 v[48:49], v28 offset:49152
  ds_read_b64_tr_b16 v[50:51], v28 offset:50176
  s_waitcnt lgkmcnt(8)
  v_mfma_f32_16x16x32_bf16 v[96:99], v[56:59], a[16:19], v[96:99]
  buffer_load_dwordx4 v5, s[16:19], s83 offen offset:1024 lds
  v_mfma_f32_16x16x32_bf16 v[96:99], v[60:63], a[24:27], v[96:99]
  ds_read_b64_tr_b16 v[52:53], v28 offset:57344
  ds_read_b64_tr_b16 v[54:55], v28 offset:58368
  v_mfma_f32_16x16x32_bf16 v[100:103], v[60:63], a[28:31], v[100:103]
  ds_read_b128 a[232:235], v8 offset:4096
  v_mfma_f32_16x16x32_bf16 v[100:103], v[56:59], a[20:23], v[100:103]
  ds_read_b64_tr_b16 v[56:57], v29 offset:49152
  ds_read_b64_tr_b16 v[58:59], v29 offset:50176
  s_waitcnt lgkmcnt(8)
  v_mfma_f32_16x16x32_bf16 v[104:107], v[40:43], a[16:19], v[104:107]
  ds_read_b128 a[248:251], v9 offset:4096
  v_mfma_f32_16x16x32_bf16 v[104:107], v[44:47], a[24:27], v[104:107]
  ds_read_b64_tr_b16 v[60:61], v29 offset:57344
  ds_read_b64_tr_b16 v[62:63], v29 offset:58368
  v_mfma_f32_16x16x32_bf16 v[108:111], v[44:47], a[28:31], v[108:111]
  ds_read_b128 a[236:239], v8 offset:6144
  v_mfma_f32_16x16x32_bf16 v[108:111], v[40:43], a[20:23], v[108:111]
  s_barrier
  s_waitcnt lgkmcnt(7)
  v_mfma_f32_16x16x32_bf16 v[112:115], v[48:51], a[16:19], v[112:115]
  ds_read_b64_tr_b16 v[40:41], v22 offset:0
  ds_read_b64_tr_b16 v[42:43], v22 offset:1024
  s_add_u32 m0, s82, 32768
  buffer_load_dwordx4 v[196:199], v34, s[12:15], s78 offen offset:0 sc1
  v_mfma_f32_16x16x32_bf16 v[112:115], v[52:55], a[24:27], v[112:115]
  ds_read_b64_tr_b16 v[44:45], v22 offset:8192
  ds_read_b64_tr_b16 v[46:47], v22 offset:9216
  s_add_u32 s84, s84, 221184
  s_sub_u32 s3, s84, 2211840
  v_mfma_f32_16x16x32_bf16 v[116:119], v[52:55], a[28:31], v[116:119]
  s_min_u32 s84, s84, s3
  buffer_load_dwordx4 v12, s[8:11], s84 offen offset:0 lds
  v_mfma_f32_16x16x32_bf16 v[116:119], v[48:51], a[20:23], v[116:119]
  ds_read_b64_tr_b16 v[48:49], v23 offset:0
  ds_read_b64_tr_b16 v[50:51], v23 offset:1024
  buffer_load_dwordx4 v[200:203], v34, s[12:15], s78 offen offset:1024 sc1
  s_waitcnt lgkmcnt(7)
  v_mfma_f32_16x16x32_bf16 v[120:123], v[56:59], a[16:19], v[120:123]
  buffer_load_dwordx4 v13, s[8:11], s84 offen offset:1024 lds
  v_mfma_f32_16x16x32_bf16 v[120:123], v[60:63], a[24:27], v[120:123]
  ds_read_b64_tr_b16 v[52:53], v23 offset:8192
  ds_read_b64_tr_b16 v[54:55], v23 offset:9216
  buffer_load_dwordx4 v[204:207], v34, s[12:15], s78 offen offset:2048 sc1
  v_mfma_f32_16x16x32_bf16 v[124:127], v[60:63], a[28:31], v[124:127]
  buffer_load_dwordx4 v14, s[8:11], s84 offen offset:2048 lds
  v_mfma_f32_16x16x32_bf16 v[124:127], v[56:59], a[20:23], v[124:127]
  ds_read_b64_tr_b16 v[56:57], v24 offset:0
  ds_read_b64_tr_b16 v[58:59], v24 offset:1024
  buffer_load_dwordx4 v[208:211], v20, s[12:15], s78 offen offset:3072 sc1
  s_waitcnt lgkmcnt(6)
  v_mfma_f32_16x16x32_bf16 v[64:67], v[40:43], a[32:35], v[64:67]
  ds_read_b128 a[252:255], v9 offset:6144
  v_mfma_f32_16x16x32_bf16 v[64:67], v[44:47], a[40:43], v[64:67]
  ds_read_b64_tr_b16 v[60:61], v24 offset:8192
  ds_read_b64_tr_b16 v[62:63], v24 offset:9216
  v_mfma_f32_16x16x32_bf16 v[68:71], v[44:47], a[44:47], v[68:71]
  buffer_load_dwordx4 v15, s[8:11], s84 offen offset:3072 lds
  v_mfma_f32_16x16x32_bf16 v[68:71], v[40:43], a[36:39], v[68:71]
  ds_read_b64_tr_b16 v[40:41], v25 offset:0
  ds_read_b64_tr_b16 v[42:43], v25 offset:1024
  s_waitcnt lgkmcnt(7)
  v_mfma_f32_16x16x32_bf16 v[72:75], v[48:51], a[32:35], v[72:75]
  ds_read_b128 a[192:195], v6 offset:8192
  v_mfma_f32_16x16x32_bf16 v[72:75], v[52:55], a[40:43], v[72:75]
  ds_read_b64_tr_b16 v[44:45], v25 offset:8192
  ds_read_b64_tr_b16 v[46:47], v25 offset:9216
  v_mfma_f32_16x16x32_bf16 v[76:79], v[52:55], a[44:47], v[76:79]
  ds_read_b128 a[208:211], v7 offset:8192
  v_mfma_f32_16x16x32_bf16 v[76:79], v[48:51], a[36:39], v[76:79]
  ds_read_b64_tr_b16 v[48:49], v26 offset:0
  ds_read_b64_tr_b16 v[50:51], v26 offset:1024
  s_waitcnt lgkmcnt(8)
  v_mfma_f32_16x16x32_bf16 v[80:83], v[56:59], a[32:35], v[80:83]
  ds_read_b128 a[196:199], v6 offset:10240
  v_mfma_f32_16x16x32_bf16 v[80:83], v[60:63], a[40:43], v[80:83]
  ds_read_b64_tr_b16 v[52:53], v26 offset:8192
  ds_read_b64_tr_b16 v[54:55], v26 offset:9216
  v_mfma_f32_16x16x32_bf16 v[84:87], v[60:63], a[44:47], v[84:87]
  ds_read_b128 a[212:215], v7 offset:10240
  v_mfma_f32_16x16x32_bf16 v[84:87], v[56:59], a[36:39], v[84:87]
  ds_read_b64_tr_b16 v[56:57], v27 offset:0
  ds_read_b64_tr_b16 v[58:59], v27 offset:1024
  s_waitcnt lgkmcnt(9)
  v_mfma_f32_16x16x32_bf16 v[88:91], v[40:43], a[32:35], v[88:91]
  ds_read_b128 a[200:203], v6 offset:12288
  v_mfma_f32_16x16x32_bf16 v[88:91], v[44:47], a[40:43], v[88:91]
  ds_read_b64_tr_b16 v[60:61], v27 offset:8192
  ds_read_b64_tr_b16 v[62:63], v27 offset:9216
  v_mfma_f32_16x16x32_bf16 v[92:95], v[44:47], a[44:47], v[92:95]
  ds_read_b128 a[216:219], v7 offset:12288
  v_mfma_f32_16x16x32_bf16 v[92:95], v[40:43], a[36:39], v[92:95]
  ds_read_b64_tr_b16 v[40:41], v28 offset:0
  ds_read_b64_tr_b16 v[42:43], v28 offset:1024
  s_waitcnt lgkmcnt(9)
  v_mfma_f32_16x16x32_bf16 v[96:99], v[48:51], a[32:35], v[96:99]
  ds_read_b128 a[204:207], v6 offset:14336
  v_mfma_f32_16x16x32_bf16 v[96:99], v[52:55], a[40:43], v[96:99]
  ds_read_b64_tr_b16 v[44:45], v28 offset:8192
  ds_read_b64_tr_b16 v[46:47], v28 offset:9216
  v_mfma_f32_16x16x32_bf16 v[100:103], v[52:55], a[44:47], v[100:103]
  ds_read_b128 a[220:223], v7 offset:14336
  v_mfma_f32_16x16x32_bf16 v[100:103], v[48:51], a[36:39], v[100:103]
  ds_read_b64_tr_b16 v[48:49], v29 offset:0
  s_waitcnt lgkmcnt(8)
  v_mfma_f32_16x16x32_bf16 v[104:107], v[56:59], a[32:35], v[104:107]
  ds_read_b64_tr_b16 v[50:51], v29 offset:1024
  v_mfma_f32_16x16x32_bf16 v[104:107], v[60:63], a[40:43], v[104:107]
  ds_read_b64_tr_b16 v[52:53], v29 offset:8192
  v_mfma_f32_16x16x32_bf16 v[108:111], v[60:63], a[44:47], v[108:111]
  ds_read_b64_tr_b16 v[54:55], v29 offset:9216
  v_mfma_f32_16x16x32_bf16 v[108:111], v[56:59], a[36:39], v[108:111]
  s_waitcnt vmcnt(12)
  s_barrier
  s_waitcnt lgkmcnt(5)
  v_mfma_f32_16x16x32_bf16 v[112:115], v[40:43], a[32:35], v[112:115]
  ds_read_b64_tr_b16 v[56:57], v22 offset:16384
  ds_read_b64_tr_b16 v[58:59], v22 offset:17408
  s_add_u32 m0, s82, 49152
  v_mfma_f32_16x16x32_bf16 v[112:115], v[44:47], a[40:43], v[112:115]
  ds_read_b64_tr_b16 v[60:61], v22 offset:24576
  ds_read_b64_tr_b16 v[62:63], v22 offset:25600
  s_add_u32 s84, s84, 221184
  s_sub_u32 s3, s84, 2211840
  v_mfma_f32_16x16x32_bf16 v[116:119], v[44:47], a[44:47], v[116:119]
  s_min_u32 s84, s84, s3
  buffer_load_dwordx4 v12, s[8:11], s84 offen offset:0 lds
  v_mfma_f32_16x16x32_bf16 v[116:119], v[40:43], a[36:39], v[116:119]
  ds_read_b64_tr_b16 v[40:41], v23 offset:16384
  ds_read_b64_tr_b16 v[42:43], v23 offset:17408
  s_waitcnt lgkmcnt(6)
  v_mfma_f32_16x16x32_bf16 v[120:123], v[48:51], a[32:35], v[120:123]
  buffer_load_dwordx4 v13, s[8:11], s84 offen offset:1024 lds
  v_mfma_f32_16x16x32_bf16 v[120:123], v[52:55], a[40:43], v[120:123]
  ds_read_b64_tr_b16 v[44:45], v23 offset:24576
  ds_read_b64_tr_b16 v[46:47], v23 offset:25600
  v_mfma_f32_16x16x32_bf16 v[124:127], v[52:55], a[44:47], v[124:127]
  buffer_load_dwordx4 v14, s[8:11], s84 offen offset:2048 lds
  v_mfma_f32_16x16x32_bf16 v[124:127], v[48:51], a[36:39], v[124:127]
  ds_read_b64_tr_b16 v[48:49], v24 offset:16384
  s_waitcnt lgkmcnt(5)
  v_mfma_f32_16x16x32_bf16 v[64:67], v[56:59], a[48:51], v[64:67]
  ds_read_b64_tr_b16 v[50:51], v24 offset:17408
  v_mfma_f32_16x16x32_bf16 v[64:67], v[60:63], a[56:59], v[64:67]
  ds_read_b64_tr_b16 v[52:53], v24 offset:24576
  ds_read_b64_tr_b16 v[54:55], v24 offset:25600
  buffer_load_dwordx4 v15, s[8:11], s84 offen offset:3072 lds
  v_mfma_f32_16x16x32_bf16 v[68:71], v[60:63], a[60:63], v[68:71]
  s_add_u32 m0, s81, 8192
  s_xor_b32 s83, s70, 512
  v_mfma_f32_16x16x32_bf16 v[68:71], v[56:59], a[52:55], v[68:71]
  ds_read_b64_tr_b16 v[56:57], v25 offset:16384
  s_waitcnt lgkmcnt(5)
  v_mfma_f32_16x16x32_bf16 v[72:75], v[40:43], a[48:51], v[72:75]
  ds_read_b64_tr_b16 v[58:59], v25 offset:17408
  v_mfma_f32_16x16x32_bf16 v[72:75], v[44:47], a[56:59], v[72:75]
  ds_read_b64_tr_b16 v[60:61], v25 offset:24576
  ds_read_b64_tr_b16 v[62:63], v25 offset:25600
  v_mfma_f32_16x16x32_bf16 v[76:79], v[44:47], a[60:63], v[76:79]
  buffer_load_dwordx4 v4, s[16:19], s83 offen lds
  v_mfma_f32_16x16x32_bf16 v[76:79], v[40:43], a[52:55], v[76:79]
  ds_read_b64_tr_b16 v[40:41], v26 offset:16384
  ds_read_b64_tr_b16 v[42:43], v26 offset:17408
  s_waitcnt lgkmcnt(6)
  v_mfma_f32_16x16x32_bf16 v[80:83], v[48:51], a[48:51], v[80:83]
  buffer_load_dwordx4 v5, s[16:19], s83 offen offset:1024 lds
  s_add_u32 m0, s81, 10240
  v_mfma_f32_16x16x32_bf16 v[80:83], v[52:55], a[56:59], v[80:83]
  ds_read_b64_tr_b16 v[44:45], v26 offset:24576
  ds_read_b64_tr_b16 v[46:47], v26 offset:25600
  v_mfma_f32_16x16x32_bf16 v[84:87], v[52:55], a[60:63], v[84:87]
  s_xor_b32 s83, s71, 512
  v_mfma_f32_16x16x32_bf16 v[84:87], v[48:51], a[52:55], v[84:87]
  ds_read_b64_tr_b16 v[48:49], v27 offset:16384
  ds_read_b64_tr_b16 v[50:51], v27 offset:17408
  v_mov_b32 v192, 0
  s_waitcnt vmcnt(13)
  v_xor_b32 v193, s63, v197
  v_xor_b32 v194, s63, v199
  s_waitcnt lgkmcnt(6)
  v_mfma_f32_16x16x32_bf16 v[88:91], v[56:59], a[48:51], v[88:91]
  buffer_load_dwordx4 v4, s[16:19], s83 offen lds
  v_or3_b32 v192, v192, v193, v194
  s_waitcnt vmcnt(12)
  v_xor_b32 v193, s63, v201
  v_xor_b32 v194, s63, v203
  v_or3_b32 v192, v192, v193, v194
  s_waitcnt vmcnt(10)
  v_xor_b32 v193, s63, v205
  v_xor_b32 v194, s63, v207
  v_or3_b32 v192, v192, v193, v194
  s_waitcnt vmcnt(8)
  v_xor_b32 v193, s63, v209
  v_xor_b32 v194, s63, v211
  v_or3_b32 v192, v192, v193, v194
  v_cmp_ne_u32 vcc, 0, v192
  s_cbranch_vccnz L_retry2
L_back2:
  v_mfma_f32_16x16x32_bf16 v[88:91], v[60:63], a[56:59], v[88:91]
  ds_read_b64_tr_b16 v[52:53], v27 offset:24576
  v_add_f32 v196, v196, v200
  v_add_f32 v198, v198, v202
  v_add_f32 v196, v196, v204
  v_add_f32 v198, v198, v206
  v_fmac_f32 v196, v208, v21
  v_fmac_f32 v198, v210, v21
  v_mov_b32 v197, v196
  v_mov_b32 v199, v198
  s_nop 0
  v_permlane32_swap_b32 v196, v197
  v_permlane32_swap_b32 v198, v199
  v_add_f32 v196, v196, v197
  v_mfma_f32_16x16x32_bf16 v[92:95], v[60:63], a[60:63], v[92:95]
  ds_read_b64_tr_b16 v[54:55], v27 offset:25600
  v_add_f32 v198, v198, v199
  v_mul_f32 v196, 0x3a97b426, v196
  v_mul_f32 v198, 0x3a97b426, v198
  v_fma_f32 v198, -v196, v196, v198
  v_max_f32 v198, 0, v198
  v_add_f32 v198, 0x3727c5ac, v198
  v_rsq_f32 v198, v198
  s_nop 0
  v_mul_f32 v196, v196, v198
  v_mov_b32 v199, v198
  v_mov_b32 v197, v196
  s_nop 0
  v_permlane16_swap_b32 v198, v199
  v_mfma_f32_16x16x32_bf16 v[92:95], v[56:59], a[52:55], v[92:95]
  ds_read_b64_tr_b16 v[56:57], v28 offset:16384
  ds_read_b64_tr_b16 v[58:59], v28 offset:17408
  v_permlane16_swap_b32 v196, v197
  v_fma_f32 v128, v128, v198, -v196
  v_fma_f32 v129, v129, v198, -v196
  v_fma_f32 v130, v130, v198, -v196
  v_fma_f32 v131, v131, v198, -v196
  v_cvt_pk_bf16_f32 v128, v128, v129
  v_cvt_pk_bf16_f32 v129, v130, v131
  ds_write_b64 v10, v[128:129] offset:0
  s_waitcnt lgkmcnt(7)
  v_mfma_f32_16x16x32_bf16 v[96:99], v[40:43], a[48:51], v[96:99]
  buffer_load_dwordx4 v5, s[16:19], s83 offen offset:1024 lds
  s_add_u32 m0, s81, 12288
  v_fma_f32 v132, v132, v199, -v197
  v_fma_f32 v133, v133, v199, -v197
  v_fma_f32 v134, v134, v199, -v197
  v_fma_f32 v135, v135, v199, -v197
  v_cvt_pk_bf16_f32 v132, v132, v133
  v_cvt_pk_bf16_f32 v133, v134, v135
  ds_write_b64 v10, v[132:133] offset:2176
  v_mfma_f32_16x16x32_bf16 v[96:99], v[44:47], a[56:59], v[96:99]
  ds_read_b64_tr_b16 v[60:61], v28 offset:24576
  ds_read_b64_tr_b16 v[62:63], v28 offset:25600
  s_xor_b32 s83, s72, 512
  v_fma_f32 v136, v136, v198, -v196
  v_fma_f32 v137, v137, v198, -v196
  v_fma_f32 v138, v138, v198, -v196
  v_fma_f32 v139, v139, v198, -v196
  v_cvt_pk_bf16_f32 v136, v136, v137
  v_cvt_pk_bf16_f32 v137, v138, v139
  v_mfma_f32_16x16x32_bf16 v[100:103], v[44:47], a[60:63], v[100:103]
  buffer_load_dwordx4 v4, s[16:19], s83 offen lds
  ds_write_b64 v10, v[136:137] offset:32
  v_fma_f32 v140, v140, v199, -v197
  v_fma_f32 v141, v141, v199, -v197
  v_fma_f32 v142, v142, v199, -v197
  v_fma_f32 v143, v143, v199, -v197
  v_cvt_pk_bf16_f32 v140, v140, v141
  v_cvt_pk_bf16_f32 v141, v142, v143
  v_mfma_f32_16x16x32_bf16 v[100:103], v[40:43], a[52:55], v[100:103]
  ds_read_b64_tr_b16 v[40:41], v29 offset:16384
  ds_write_b64 v10, v[140:141] offset:2208
  ds_read_b64_tr_b16 v[224:225], v11 offset:0
  ds_read_b64_tr_b16 v[226:227], v11 offset:544
  ds_read_b64_tr_b16 v[228:229], v11 offset:32
  ds_read_b64_tr_b16 v[230:231], v11 offset:576
  v_fma_f32 v144, v144, v198, -v196
  v_fma_f32 v145, v145, v198, -v196
  s_waitcnt lgkmcnt(13)
  v_mfma_f32_16x16x32_bf16 v[104:107], v[48:51], a[48:51], v[104:107]
  ds_read_b64_tr_b16 v[42:43], v29 offset:17408
  v_fma_f32 v146, v146, v198, -v196
  v_fma_f32 v147, v147, v198, -v196
  v_cvt_pk_bf16_f32 v144, v144, v145
  v_cvt_pk_bf16_f32 v145, v146, v147
  ds_write_b64 v10, v[144:145] offset:64
  v_fma_f32 v148, v148, v199, -v197
  v_fma_f32 v149, v149, v199, -v197
  v_fma_f32 v150, v150, v199, -v197
  v_mfma_f32_16x16x32_bf16 v[104:107], v[52:55], a[56:59], v[104:107]
  ds_read_b64_tr_b16 v[44:45], v29 offset:24576
  ds_read_b64_tr_b16 v[46:47], v29 offset:25600
  buffer_load_dwordx4 v5, s[16:19], s83 offen offset:1024 lds
  v_fma_f32 v151, v151, v199, -v197
  v_cvt_pk_bf16_f32 v148, v148, v149
  v_cvt_pk_bf16_f32 v149, v150, v151
  ds_write_b64 v10, v[148:149] offset:2240
  s_mov_b32 s75, 0
  v_mfma_f32_16x16x32_bf16 v[108:111], v[52:55], a[60:63], v[108:111]
  s_add_u32 m0, s81, 14336
  s_xor_b32 s83, s73, 512
  s_waitcnt lgkmcnt(7)
  buffer_store_dwordx4 v[224:227], v32, s[12:15], s75 offen sc1
  v_fma_f32 v152, v152, v198, -v196
  v_fma_f32 v153, v153, v198, -v196
  v_fma_f32 v154, v154, v198, -v196
  v_fma_f32 v155, v155, v198, -v196
  v_cvt_pk_bf16_f32 v152, v152, v153
  v_mfma_f32_16x16x32_bf16 v[108:111], v[48:51], a[52:55], v[108:111]
  s_waitcnt vmcnt(11)
  s_barrier
  v_cvt_pk_bf16_f32 v153, v154, v155
  ds_write_b64 v10, v[152:153] offset:96
  v_fma_f32 v156, v156, v199, -v197
  v_fma_f32 v157, v157, v199, -v197
  v_fma_f32 v158, v158, v199, -v197
  v_fma_f32 v159, v159, v199, -v197
  v_mfma_f32_16x16x32_bf16 v[112:115], v[56:59], a[48:51], v[112:115]
  ds_read_b64_tr_b16 v[48:49], v22 offset:32768
  ds_read_b64_tr_b16 v[50:51], v22 offset:33792
  v_cvt_pk_bf16_f32 v156, v156, v157
  v_cvt_pk_bf16_f32 v157, v158, v159
  ds_write_b64 v10, v[156:157] offset:2272
  s_mov_b32 s75, 65536
  s_waitcnt lgkmcnt(9)
  buffer_store_dwordx4 v[228:231], v32, s[12:15], s75 offen sc1
  v_mfma_f32_16x16x32_bf16 v[112:115], v[60:63], a[56:59], v[112:115]
  ds_read_b64_tr_b16 v[52:53], v22 offset:40960
  ds_read_b64_tr_b16 v[54:55], v22 offset:41984
  ds_read_b64_tr_b16 v[232:233], v11 offset:64
  ds_read_b64_tr_b16 v[234:235], v11 offset:608
  ds_read_b64_tr_b16 v[236:237], v11 offset:96
  ds_read_b64_tr_b16 v[238:239], v11 offset:640
  v_fma_f32 v160, v160, v198, -v196
  v_fma_f32 v161, v161, v198, -v196
  v_fma_f32 v162, v162, v198, -v196
  v_fma_f32 v163, v163, v198, -v196
  v_mfma_f32_16x16x32_bf16 v[116:119], v[60:63], a[60:63], v[116:119]
  buffer_load_dwordx4 v4, s[16:19], s83 offen lds
  v_cvt_pk_bf16_f32 v160, v160, v161
  v_cvt_pk_bf16_f32 v161, v162, v163
  ds_write_b64 v10, v[160:161] offset:0
  v_fma_f32 v164, v164, v199, -v197
  v_fma_f32 v165, v165, v199, -v197
  v_fma_f32 v166, v166, v199, -v197
  v_fma_f32 v167, v167, v199, -v197
  v_mfma_f32_16x16x32_bf16 v[116:119], v[56:59], a[52:55], v[116:119]
  ds_read_b64_tr_b16 v[56:57], v23 offset:32768
  ds_read_b64_tr_b16 v[58:59], v23 offset:33792
  v_cvt_pk_bf16_f32 v164, v164, v165
  v_cvt_pk_bf16_f32 v165, v166, v167
  ds_write_b64 v10, v[164:165] offset:2176
  s_mov_b32 s75, 131072
  s_waitcnt lgkmcnt(6)
  buffer_store_dwordx4 v[232:235], v33, s[12:15], s75 offen sc1
  v_mfma_f32_16x16x32_bf16 v[120:123], v[40:43], a[48:51], v[120:123]
  ds_read_b128 a[0:3], v6 offset:0
  v_fma_f32 v168, v168, v198, -v196
  v_fma_f32 v169, v169, v198, -v196
  v_fma_f32 v170, v170, v198, -v196
  v_fma_f32 v171, v171, v198, -v196
  v_cvt_pk_bf16_f32 v168, v168, v169
  v_cvt_pk_bf16_f32 v169, v170, v171
  v_mfma_f32_16x16x32_bf16 v[120:123], v[44:47], a[56:59], v[120:123]
  ds_read_b64_tr_b16 v[60:61], v23 offset:40960
  ds_read_b64_tr_b16 v[62:63], v23 offset:41984
  buffer_load_dwordx4 v5, s[16:19], s83 offen offset:1024 lds
  ds_write_b64 v10, v[168:169] offset:32
  v_fma_f32 v172, v172, v199, -v197
  v_fma_f32 v173, v173, v199, -v197
  v_fma_f32 v174, v174, v199, -v197
  v_fma_f32 v175, v175, v199, -v197
  v_mfma_f32_16x16x32_bf16 v[124:127], v[44:47], a[60:63], v[124:127]
  s_add_u32 m0, s82, 0
  s_add_u32 s84, s84, 221184
  v_cvt_pk_bf16_f32 v172, v172, v173
  v_cvt_pk_bf16_f32 v173, v174, v175
  ds_write_b64 v10, v[172:173] offset:2208
  s_mov_b32 s75, 196608
  s_waitcnt lgkmcnt(9)
  buffer_store_dwordx4 v[236:239], v33, s[12:15], s75 offen sc1
  v_mfma_f32_16x16x32_bf16 v[124:127], v[40:43], a[52:55], v[124:127]
  ds_read_b64_tr_b16 v[40:41], v24 offset:32768
  ds_read_b64_tr_b16 v[42:43], v24 offset:33792
  ds_read_b64_tr_b16 v[200:201], v11 offset:0
  ds_read_b64_tr_b16 v[202:203], v11 offset:544
  ds_read_b64_tr_b16 v[204:205], v11 offset:32
  ds_read_b64_tr_b16 v[206:207], v11 offset:576
  v_fma_f32 v176, v176, v198, -v196
  v_fma_f32 v177, v177, v198, -v196
  v_fma_f32 v178, v178, v198, -v196
  v_mfma_f32_16x16x32_bf16 v[64:67], v[48:51], a[64:67], v[64:67]
  s_sub_u32 s3, s84, 2211840
  s_min_u32 s84, s84, s3
  v_fma_f32 v179, v179, v198, -v196
  v_cvt_pk_bf16_f32 v176, v176, v177
  v_cvt_pk_bf16_f32 v177, v178, v179
  ds_write_b64 v10, v[176:177] offset:64
  v_fma_f32 v180, v180, v199, -v197
  v_fma_f32 v181, v181, v199, -v197
  v_fma_f32 v182, v182, v199, -v197
  v_mfma_f32_16x16x32_bf16 v[64:67], v[52:55], a[72:75], v[64:67]
  ds_read_b64_tr_b16 v[44:45], v24 offset:40960
  ds_read_b64_tr_b16 v[46:47], v24 offset:41984
  v_fma_f32 v183, v183, v199, -v197
  v_cvt_pk_bf16_f32 v180, v180, v181
  v_cvt_pk_bf16_f32 v181, v182, v183
  ds_write_b64 v10, v[180:181] offset:2240
  s_mov_b32 s75, 262144
  s_waitcnt lgkmcnt(6)
  buffer_store_dwordx4 v[200:203], v33, s[12:15], s75 offen sc1
  v_mfma_f32_16x16x32_bf16 v[68:71], v[52:55], a[76:79], v[68:71]
  buffer_load_dwordx4 v12, s[8:11], s84 offen offset:0 lds
  v_fma_f32 v184, v184, v198, -v196
  v_fma_f32 v185, v185, v198, -v196
  v_fma_f32 v186, v186, v198, -v196
  v_fma_f32 v187, v187, v198, -v196
  v_cvt_pk_bf16_f32 v184, v184, v185
  v_cvt_pk_bf16_f32 v185, v186, v187
  v_mfma_f32_16x16x32_bf16 v[68:71], v[48:51], a[68:71], v[68:71]
  ds_read_b64_tr_b16 v[48:49], v25 offset:32768
  ds_read_b64_tr_b16 v[50:51], v25 offset:33792
  ds_write_b64 v10, v[184:185] offset:96
  v_fma_f32 v188, v188, v199, -v197
  v_fma_f32 v189, v189, v199, -v197
  v_fma_f32 v190, v190, v199, -v197
  v_fma_f32 v191, v191, v199, -v197
  v_cvt_pk_bf16_f32 v188, v188, v189
  v_mfma_f32_16x16x32_bf16 v[72:75], v[56:59], a[64:67], v[72:75]
  ds_read_b128 a[16:19], v7 offset:0
  v_cvt_pk_bf16_f32 v189, v190, v191
  ds_write_b64 v10, v[188:189] offset:2272
  s_mov_b32 s75, 327680
  s_waitcnt lgkmcnt(9)
  buffer_store_dwordx4 v[204:207], v33, s[12:15], s75 offen sc1
  v_mfma_f32_16x16x32_bf16 v[72:75], v[60:63], a[72:75], v[72:75]
  ds_read_b64_tr_b16 v[52:53], v25 offset:40960
  ds_read_b64_tr_b16 v[54:55], v25 offset:41984
  ds_read_b64_tr_b16 v[208:209], v11 offset:64
  ds_read_b64_tr_b16 v[210:211], v11 offset:608
  ds_read_b64_tr_b16 v[212:213], v11 offset:96
  ds_read_b64_tr_b16 v[214:215], v11 offset:640
  s_mov_b32 s75, 393216
  s_waitcnt lgkmcnt(2)
  buffer_store_dwordx4 v[208:211], v33, s[12:15], s75 offen sc1
  v_mfma_f32_16x16x32_bf16 v[76:79], v[60:63], a[76:79], v[76:79]
  buffer_load_dwordx4 v13, s[8:11], s84 offen offset:1024 lds
  s_mov_b32 s75, 458752
  s_waitcnt lgkmcnt(0)
  buffer_store_dwordx4 v[212:215], v33, s[12:15], s75 offen sc1
  v_lshrrev_b32 v19, 3, v0
  v_lshlrev_b32 v19, 8, v19
  v_mfma_f32_16x16x32_bf16 v[76:79], v[56:59], a[68:71], v[76:79]
  ds_read_b64_tr_b16 v[56:57], v26 offset:32768
  ds_read_b64_tr_b16 v[58:59], v26 offset:33792
  v_add_u32 v19, s2, v19
  v_lshlrev_b32 v19, 4, v19
  v_and_b32 v19, 0xffffff80, v19
  v_min_u32 v19, L_code_end-L_pc-4, v19
  global_load_dword v19, v19, s[32:33]
  v_mfma_f32_16x16x32_bf16 v[80:83], v[40:43], a[64:67], v[80:83]
  ds_read_b128 a[4:7], v6 offset:2048
  v_mfma_f32_16x16x32_bf16 v[80:83], v[44:47], a[72:75], v[80:83]
  ds_read_b64_tr_b16 v[60:61], v26 offset:40960
  ds_read_b64_tr_b16 v[62:63], v26 offset:41984
  v_mfma_f32_16x16x32_bf16 v[84:87], v[44:47], a[76:79], v[84:87]
  buffer_load_dwordx4 v14, s[8:11], s84 offen offset:2048 lds
  v_mfma_f32_16x16x32_bf16 v[84:87], v[40:43], a[68:71], v[84:87]
  ds_read_b64_tr_b16 v[40:41], v27 offset:32768
  ds_read_b64_tr_b16 v[42:43], v27 offset:33792
  v_mfma_f32_16x16x32_bf16 v[88:91], v[48:51], a[64:67], v[88:91]
  ds_read_b128 a[20:23], v7 offset:2048
  v_mfma_f32_16x16x32_bf16 v[88:91], v[52:55], a[72:75], v[88:91]
  ds_read_b64_tr_b16 v[44:45], v27 offset:40960
  ds_read_b64_tr_b16 v[46:47], v27 offset:41984
  v_mfma_f32_16x16x32_bf16 v[92:95], v[52:55], a[76:79], v[92:95]
  buffer_load_dwordx4 v15, s[8:11], s84 offen offset:3072 lds
  v_mfma_f32_16x16x32_bf16 v[92:95], v[48:51], a[68:71], v[92:95]
  ds_read_b64_tr_b16 v[48:49], v28 offset:32768
  ds_read_b64_tr_b16 v[50:51], v28 offset:33792
  s_waitcnt lgkmcnt(7)
  v_mfma_f32_16x16x32_bf16 v[96:99], v[56:59], a[64:67], v[96:99]
  ds_read_b128 a[8:11], v6 offset:4096
  v_mfma_f32_16x16x32_bf16 v[96:99], v[60:63], a[72:75], v[96:99]
  ds_read_b64_tr_b16 v[52:53], v28 offset:40960
  ds_read_b64_tr_b16 v[54:55], v28 offset:41984
  v_mfma_f32_16x16x32_bf16 v[100:103], v[60:63], a[76:79], v[100:103]
  ds_read_b128 a[24:27], v7 offset:4096
  v_mfma_f32_16x16x32_bf16 v[100:103], v[56:59], a[68:71], v[100:103]
  ds_read_b64_tr_b16 v[56:57], v29 offset:32768
  ds_read_b64_tr_b16 v[58:59], v29 offset:33792
  s_waitcnt lgkmcnt(8)
  v_mfma_f32_16x16x32_bf16 v[104:107], v[40:43], a[64:67], v[104:107]
  ds_read_b128 a[12:15], v6 offset:6144
  v_mfma_f32_16x16x32_bf16 v[104:107], v[44:47], a[72:75], v[104:107]
  ds_read_b64_tr_b16 v[60:61], v29 offset:40960
  ds_read_b64_tr_b16 v[62:63], v29 offset:41984
  v_mfma_f32_16x16x32_bf16 v[108:111], v[44:47], a[76:79], v[108:111]
  ds_read_b128 a[28:31], v7 offset:6144
  v_mfma_f32_16x16x32_bf16 v[108:111], v[40:43], a[68:71], v[108:111]
  s_waitcnt vmcnt(21)
  s_barrier
  s_waitcnt lgkmcnt(7)
  v_mfma_f32_16x16x32_bf16 v[112:115], v[48:51], a[64:67], v[112:115]
  ds_read_b64_tr_b16 v[40:41], v22 offset:49152
  ds_read_b64_tr_b16 v[42:43], v22 offset:50176
  s_add_u32 m0, s82, 16384
  v_mfma_f32_16x16x32_bf16 v[112:115], v[52:55], a[72:75], v[112:115]
  ds_read_b64_tr_b16 v[44:45], v22 offset:57344
  ds_read_b64_tr_b16 v[46:47], v22 offset:58368
  s_add_u32 s84, s84, 221184
  s_sub_u32 s3, s84, 2211840
  v_mfma_f32_16x16x32_bf16 v[116:119], v[52:55], a[76:79], v[116:119]
  s_min_u32 s84, s84, s3
  buffer_load_dwordx4 v12, s[8:11], s84 offen offset:0 lds
  v_mfma_f32_16x16x32_bf16 v[116:119], v[48:51], a[68:71], v[116:119]
  ds_read_b64_tr_b16 v[48:49], v23 offset:49152
  ds_read_b64_tr_b16 v[50:51], v23 offset:50176
  s_waitcnt lgkmcnt(7)
  v_mfma_f32_16x16x32_bf16 v[120:123], v[56:59], a[64:67], v[120:123]
  buffer_load_dwordx4 v13, s[8:11], s84 offen offset:1024 lds
  v_mfma_f32_16x16x32_bf16 v[120:123], v[60:63], a[72:75], v[120:123]
  ds_read_b64_tr_b16 v[52:53], v23 offset:57344
  ds_read_b64_tr_b16 v[54:55], v23 offset:58368
  v_mfma_f32_16x16x32_bf16 v[124:127], v[60:63], a[76:79], v[124:127]
  buffer_load_dwordx4 v14, s[8:11], s84 offen offset:2048 lds
  v_mfma_f32_16x16x32_bf16 v[124:127], v[56:59], a[68:71], v[124:127]
  ds_read_b64_tr_b16 v[56:57], v24 offset:49152
  s_waitcnt lgkmcnt(5)
  v_mfma_f32_16x16x32_bf16 v[64:67], v[40:43], a[80:83], v[64:67]
  ds_read_b64_tr_b16 v[58:59], v24 offset:50176
  v_mfma_f32_16x16x32_bf16 v[64:67], v[44:47], a[88:91], v[64:67]
  ds_read_b64_tr_b16 v[60:61], v24 offset:57344
  ds_read_b64_tr_b16 v[62:63], v24 offset:58368
  buffer_load_dwordx4 v15, s[8:11], s84 offen offset:3072 lds
  v_mfma_f32_16x16x32_bf16 v[68:71], v[44:47], a[92:95], v[68:71]
  s_add_u32 m0, s89, 0
  s_xor_b32 s83, s70, 896
  v_mfma_f32_16x16x32_bf16 v[68:71], v[40:43], a[84:87], v[68:71]
  ds_read_b64_tr_b16 v[40:41], v25 offset:49152
  s_waitcnt lgkmcnt(5)
  v_mfma_f32_16x16x32_bf16 v[72:75], v[48:51], a[80:83], v[72:75]
  ds_read_b64_tr_b16 v[42:43], v25 offset:50176
  v_mfma_f32_16x16x32_bf16 v[72:75], v[52:55], a[88:91], v[72:75]
  ds_read_b64_tr_b16 v[44:45], v25 offset:57344
  ds_read_b64_tr_b16 v[46:47], v25 offset:58368
  v_mfma_f32_16x16x32_bf16 v[76:79], v[52:55], a[92:95], v[76:79]
  buffer_load_dwordx4 v4, s[16:19], s83 offen lds
  v_mfma_f32_16x16x32_bf16 v[76:79], v[48:51], a[84:87], v[76:79]
  ds_read_b64_tr_b16 v[48:49], v26 offset:49152
  ds_read_b64_tr_b16 v[50:51], v26 offset:50176
  s_waitcnt lgkmcnt(6)
  v_mfma_f32_16x16x32_bf16 v[80:83], v[56:59], a[80:83], v[80:83]
  buffer_load_dwordx4 v5, s[16:19], s83 offen offset:1024 lds
  s_add_u32 m0, s89, 2048
  v_mfma_f32_16x16x32_bf16 v[80:83], v[60:63], a[88:91], v[80:83]
  ds_read_b64_tr_b16 v[52:53], v26 offset:57344
  ds_read_b64_tr_b16 v[54:55], v26 offset:58368
  v_mfma_f32_16x16x32_bf16 v[84:87], v[60:63], a[92:95], v[84:87]
  s_xor_b32 s83, s71, 896
  v_mfma_f32_16x16x32_bf16 v[84:87], v[56:59], a[84:87], v[84:87]
  ds_read_b64_tr_b16 v[56:57], v27 offset:49152
  ds_read_b64_tr_b16 v[58:59], v27 offset:50176
  s_waitcnt vmcnt(9)
  s_waitcnt lgkmcnt(6)
  v_mfma_f32_16x16x32_bf16 v[88:91], v[40:43], a[80:83], v[88:91]
  buffer_load_dwordx4 v4, s[16:19], s83 offen lds
  v_mfma_f32_16x16x32_bf16 v[88:91], v[44:47], a[88:91], v[88:91]
  ds_read_b64_tr_b16 v[60:61], v27 offset:57344
  buffer_store_dword v2, v3, s[12:15], s80 offen sc1
  v_mfma_f32_16x16x32_bf16 v[92:95], v[44:47], a[92:95], v[92:95]
  ds_read_b64_tr_b16 v[62:63], v27 offset:58368
  v_mfma_f32_16x16x32_bf16 v[92:95], v[40:43], a[84:87], v[92:95]
  ds_read_b64_tr_b16 v[40:41], v28 offset:49152
  ds_read_b64_tr_b16 v[42:43], v28 offset:50176
  s_waitcnt lgkmcnt(6)
  v_mfma_f32_16x16x32_bf16 v[96:99], v[48:51], a[80:83], v[96:99]
  buffer_load_dwordx4 v5, s[16:19], s83 offen offset:1024 lds
  s_add_u32 m0, s89, 4096
  v_mfma_f32_16x16x32_bf16 v[96:99], v[52:55], a[88:91], v[96:99]
  ds_read_b64_tr_b16 v[44:45], v28 offset:57344
  ds_read_b64_tr_b16 v[46:47], v28 offset:58368
  s_xor_b32 s83, s72, 896
  v_mfma_f32_16x16x32_bf16 v[100:103], v[52:55], a[92:95], v[100:103]
  buffer_load_dwordx4 v4, s[16:19], s83 offen lds
  v_mfma_f32_16x16x32_bf16 v[100:103], v[48:51], a[84:87], v[100:103]
  ds_read_b64_tr_b16 v[48:49], v29 offset:49152
  s_waitcnt lgkmcnt(5)
  v_mfma_f32_16x16x32_bf16 v[104:107], v[56:59], a[80:83], v[104:107]
  ds_read_b64_tr_b16 v[50:51], v29 offset:50176
  v_mfma_f32_16x16x32_bf16 v[104:107], v[60:63], a[88:91], v[104:107]
  ds_read_b64_tr_b16 v[52:53], v29 offset:57344
  ds_read_b64_tr_b16 v[54:55], v29 offset:58368
  buffer_load_dwordx4 v5, s[16:19], s83 offen offset:1024 lds
  v_mfma_f32_16x16x32_bf16 v[108:111], v[60:63], a[92:95], v[108:111]
  s_add_u32 m0, s89, 6144
  s_xor_b32 s83, s73, 896
  v_mfma_f32_16x16x32_bf16 v[108:111], v[56:59], a[84:87], v[108:111]
  s_waitcnt vmcnt(11)
  s_barrier
  s_waitcnt lgkmcnt(4)
  v_mfma_f32_16x16x32_bf16 v[112:115], v[40:43], a[80:83], v[112:115]
  ds_read_b64_tr_b16 v[56:57], v22 offset:0
  ds_read_b64_tr_b16 v[58:59], v22 offset:1024
  v_mfma_f32_16x16x32_bf16 v[112:115], v[44:47], a[88:91], v[112:115]
  ds_read_b64_tr_b16 v[60:61], v22 offset:8192
  ds_read_b64_tr_b16 v[62:63], v22 offset:9216
  v_mfma_f32_16x16x32_bf16 v[116:119], v[44:47], a[92:95], v[116:119]
  buffer_load_dwordx4 v4, s[16:19], s83 offen lds
  v_mfma_f32_16x16x32_bf16 v[116:119], v[40:43], a[84:87], v[116:119]
  ds_read_b64_tr_b16 v[40:41], v23 offset:0
  ds_read_b64_tr_b16 v[42:43], v23 offset:1024
  s_waitcnt lgkmcnt(6)
  v_mfma_f32_16x16x32_bf16 v[120:123], v[48:51], a[80:83], v[120:123]
  buffer_load_dwordx4 v5, s[16:19], s83 offen offset:1024 lds
  s_add_u32 m0, s82, 32768
  v_mfma_f32_16x16x32_bf16 v[120:123], v[52:55], a[88:91], v[120:123]
  ds_read_b64_tr_b16 v[44:45], v23 offset:8192
  ds_read_b64_tr_b16 v[46:47], v23 offset:9216
  s_add_u32 s84, s84, 221184
  v_mfma_f32_16x16x32_bf16 v[124:127], v[52:55], a[92:95], v[124:127]
  s_sub_u32 s3, s84, 2211840
  s_min_u32 s84, s84, s3
  v_mfma_f32_16x16x32_bf16 v[124:127], v[48:51], a[84:87], v[124:127]
  ds_read_b64_tr_b16 v[48:49], v24 offset:0
  ds_read_b64_tr_b16 v[50:51], v24 offset:1024
  s_waitcnt lgkmcnt(6)
  v_mfma_f32_16x16x32_bf16 v[64:67], v[56:59], a[96:99], v[64:67]
  buffer_load_dwordx4 v12, s[8:11], s84 offen offset:0 lds
  v_mfma_f32_16x16x32_bf16 v[64:67], v[60:63], a[104:107], v[64:67]
  ds_read_b64_tr_b16 v[52:53], v24 offset:8192
  ds_read_b64_tr_b16 v[54:55], v24 offset:9216
  v_mfma_f32_16x16x32_bf16 v[68:71], v[60:63], a[108:111], v[68:71]
  buffer_load_dwordx4 v13, s[8:11], s84 offen offset:1024 lds
  v_mfma_f32_16x16x32_bf16 v[68:71], v[56:59], a[100:103], v[68:71]
  ds_read_b64_tr_b16 v[56:57], v25 offset:0
  ds_read_b64_tr_b16 v[58:59], v25 offset:1024
  s_waitcnt lgkmcnt(6)
  v_mfma_f32_16x16x32_bf16 v[72:75], v[40:43], a[96:99], v[72:75]
  ds_read_b128 a[32:35], v6 offset:8192
  v_mfma_f32_16x16x32_bf16 v[72:75], v[44:47], a[104:107], v[72:75]
  ds_read_b64_tr_b16 v[60:61], v25 offset:8192
  ds_read_b64_tr_b16 v[62:63], v25 offset:9216
  v_mfma_f32_16x16x32_bf16 v[76:79], v[44:47], a[108:111], v[76:79]
  buffer_load_dwordx4 v14, s[8:11], s84 offen offset:2048 lds
  v_mfma_f32_16x16x32_bf16 v[76:79], v[40:43], a[100:103], v[76:79]
  ds_read_b64_tr_b16 v[40:41], v26 offset:0
  ds_read_b64_tr_b16 v[42:43], v26 offset:1024
  s_waitcnt lgkmcnt(7)
  v_mfma_f32_16x16x32_bf16 v[80:83], v[48:51], a[96:99], v[80:83]
  ds_read_b128 a[48:51], v7 offset:8192
  v_mfma_f32_16x16x32_bf16 v[80:83], v[52:55], a[104:107], v[80:83]
  ds_read_b64_tr_b16 v[44:45], v26 offset:8192
  ds_read_b64_tr_b16 v[46:47], v26 offset:9216
  buffer_load_dwordx4 v15, s[8:11], s84 offen offset:3072 lds
  v_mfma_f32_16x16x32_bf16 v[84:87], v[52:55], a[108:111], v[84:87]
  s_add_u32 m0, s81, 0
  s_xor_b32 s83, s70, 640
  v_mfma_f32_16x16x32_bf16 v[84:87], v[48:51], a[100:103], v[84:87]
  ds_read_b64_tr_b16 v[48:49], v27 offset:0
  ds_read_b64_tr_b16 v[50:51], v27 offset:1024
  s_waitcnt lgkmcnt(7)
  v_mfma_f32_16x16x32_bf16 v[88:91], v[56:59], a[96:99], v[88:91]
  ds_read_b128 a[36:39], v6 offset:10240
  v_mfma_f32_16x16x32_bf16 v[88:91], v[60:63], a[104:107], v[88:91]
  ds_read_b64_tr_b16 v[52:53], v27 offset:8192
  ds_read_b64_tr_b16 v[54:55], v27 offset:9216
  v_mfma_f32_16x16x32_bf16 v[92:95], v[60:63], a[108:111], v[92:95]
  buffer_load_dwordx4 v4, s[16:19], s83 offen lds
  v_mfma_f32_16x16x32_bf16 v[92:95], v[56:59], a[100:103], v[92:95]
  ds_read_b64_tr_b16 v[56:57], v28 offset:0
  ds_read_b64_tr_b16 v[58:59], v28 offset:1024
  s_waitcnt lgkmcnt(7)
  v_mfma_f32_16x16x32_bf16 v[96:99], v[40:43], a[96:99], v[96:99]
  buffer_load_dwordx4 v5, s[16:19], s83 offen offset:1024 lds
  s_add_u32 m0, s81, 2048
  v_mfma_f32_16x16x32_bf16 v[96:99], v[44:47], a[104:107], v[96:99]
  ds_read_b64_tr_b16 v[60:61], v28 offset:8192
  ds_read_b64_tr_b16 v[62:63], v28 offset:9216
  s_xor_b32 s83, s71, 640
  v_mfma_f32_16x16x32_bf16 v[100:103], v[44:47], a[108:111], v[100:103]
  ds_read_b128 a[52:55], v7 offset:10240
  v_mfma_f32_16x16x32_bf16 v[100:103], v[40:43], a[100:103], v[100:103]
  ds_read_b64_tr_b16 v[40:41], v29 offset:0
  ds_read_b64_tr_b16 v[42:43], v29 offset:1024
  s_waitcnt lgkmcnt(7)
  v_mfma_f32_16x16x32_bf16 v[104:107], v[48:51], a[96:99], v[104:107]
  buffer_load_dwordx4 v4, s[16:19], s83 offen lds
  v_mfma_f32_16x16x32_bf16 v[104:107], v[52:55], a[104:107], v[104:107]
  ds_read_b64_tr_b16 v[44:45], v29 offset:8192
  ds_read_b64_tr_b16 v[46:47], v29 offset:9216
  v_mfma_f32_16x16x32_bf16 v[108:111], v[52:55], a[108:111], v[108:111]
  ds_read_b128 a[40:43], v6 offset:12288
  v_mfma_f32_16x16x32_bf16 v[108:111], v[48:51], a[100:103], v[108:111]
  s_waitcnt vmcnt(16)
  s_barrier
  ds_read_b64_tr_b16 v[48:49], v22 offset:16384
  s_waitcnt lgkmcnt(7)
  v_mfma_f32_16x16x32_bf16 v[112:115], v[56:59], a[96:99], v[112:115]
  ds_read_b64_tr_b16 v[50:51], v22 offset:17408
  buffer_load_dwordx4 v5, s[16:19], s83 offen offset:1024 lds
  v_mfma_f32_16x16x32_bf16 v[112:115], v[60:63], a[104:107], v[112:115]
  ds_read_b64_tr_b16 v[52:53], v22 offset:24576
  ds_read_b64_tr_b16 v[54:55], v22 offset:25600
  s_add_u32 m0, s82, 49152
  v_mfma_f32_16x16x32_bf16 v[116:119], v[60:63], a[108:111], v[116:119]
  s_add_u32 s84, s84, 221184
  s_sub_u32 s3, s84, 2211840
  s_min_u32 s84, s84, s3
  v_mfma_f32_16x16x32_bf16 v[116:119], v[56:59], a[100:103], v[116:119]
  ds_read_b64_tr_b16 v[56:57], v23 offset:16384
  ds_read_b64_tr_b16 v[58:59], v23 offset:17408
  s_waitcnt lgkmcnt(7)
  v_mfma_f32_16x16x32_bf16 v[120:123], v[40:43], a[96:99], v[120:123]
  buffer_load_dwordx4 v12, s[8:11], s84 offen offset:0 lds
  v_mfma_f32_16x16x32_bf16 v[120:123], v[44:47], a[104:107], v[120:123]
  ds_read_b64_tr_b16 v[60:61], v23 offset:24576
  ds_read_b64_tr_b16 v[62:63], v23 offset:25600
  v_mfma_f32_16x16x32_bf16 v[124:127], v[44:47], a[108:111], v[124:127]
  buffer_load_dwordx4 v13, s[8:11], s84 offen offset:1024 lds
  v_mfma_f32_16x16x32_bf16 v[124:127], v[40:43], a[100:103], v[124:127]
  ds_read_b64_tr_b16 v[40:41], v24 offset:16384
  ds_read_b64_tr_b16 v[42:43], v24 offset:17408
  s_waitcnt lgkmcnt(6)
  v_mfma_f32_16x16x32_bf16 v[64:67], v[48:51], a[112:115], v[64:67]
  ds_read_b128 a[56:59], v7 offset:12288
  v_mfma_f32_16x16x32_bf16 v[64:67], v[52:55], a[120:123], v[64:67]
  ds_read_b64_tr_b16 v[44:45], v24 offset:24576
  ds_read_b64_tr_b16 v[46:47], v24 offset:25600
  v_mfma_f32_16x16x32_bf16 v[68:71], v[52:55], a[124:127], v[68:71]
  buffer_load_dwordx4 v14, s[8:11], s84 offen offset:2048 lds
  v_mfma_f32_16x16x32_bf16 v[68:71], v[48:51], a[116:119], v[68:71]
  ds_read_b64_tr_b16 v[48:49], v25 offset:16384
  ds_read_b64_tr_b16 v[50:51], v25 offset:17408
  s_waitcnt lgkmcnt(7)
  v_mfma_f32_16x16x32_bf16 v[72:75], v[56:59], a[112:115], v[72:75]
  buffer_load_dwordx4 v15, s[8:11], s84 offen offset:3072 lds
  s_add_u32 m0, s81, 4096
  v_mfma_f32_16x16x32_bf16 v[72:75], v[60:63], a[120:123], v[72:75]
  ds_read_b64_tr_b16 v[52:53], v25 offset:24576
  ds_read_b64_tr_b16 v[54:55], v25 offset:25600
  s_xor_b32 s83, s72, 640
  v_mfma_f32_16x16x32_bf16 v[76:79], v[60:63], a[124:127], v[76:79]
  ds_read_b128 a[44:47], v6 offset:14336
  v_mfma_f32_16x16x32_bf16 v[76:79], v[56:59], a[116:119], v[76:79]
  ds_read_b64_tr_b16 v[56:57], v26 offset:16384
  ds_read_b64_tr_b16 v[58:59], v26 offset:17408
  s_waitcnt lgkmcnt(7)
  v_mfma_f32_16x16x32_bf16 v[80:83], v[40:43], a[112:115], v[80:83]
  buffer_load_dwordx4 v4, s[16:19], s83 offen lds
  v_mfma_f32_16x16x32_bf16 v[80:83], v[44:47], a[120:123], v[80:83]
  ds_read_b64_tr_b16 v[60:61], v26 offset:24576
  ds_read_b64_tr_b16 v[62:63], v26 offset:25600
  v_mfma_f32_16x16x32_bf16 v[84:87], v[44:47], a[124:127], v[84:87]
  ds_read_b128 a[60:63], v7 offset:14336
  v_mfma_f32_16x16x32_bf16 v[84:87], v[40:43], a[116:119], v[84:87]
  ds_read_b64_tr_b16 v[40:41], v27 offset:16384
  ds_read_b64_tr_b16 v[42:43], v27 offset:17408
  s_waitcnt lgkmcnt(8)
  v_mfma_f32_16x16x32_bf16 v[88:91], v[48:51], a[112:115], v[88:91]
  buffer_load_dwordx4 v5, s[16:19], s83 offen offset:1024 lds
  s_add_u32 m0, s81, 6144
  v_mfma_f32_16x16x32_bf16 v[88:91], v[52:55], a[120:123], v[88:91]
  ds_read_b64_tr_b16 v[44:45], v27 offset:24576
  ds_read_b64_tr_b16 v[46:47], v27 offset:25600
  s_xor_b32 s83, s73, 640
  v_mfma_f32_16x16x32_bf16 v[92:95], v[52:55], a[124:127], v[92:95]
  buffer_load_dwordx4 v4, s[16:19], s83 offen lds
  v_mfma_f32_16x16x32_bf16 v[92:95], v[48:51], a[116:119], v[92:95]
  ds_read_b64_tr_b16 v[48:49], v28 offset:16384
  s_waitcnt lgkmcnt(6)
  v_mfma_f32_16x16x32_bf16 v[96:99], v[56:59], a[112:115], v[96:99]
  ds_read_b64_tr_b16 v[50:51], v28 offset:17408
  v_mfma_f32_16x16x32_bf16 v[96:99], v[60:63], a[120:123], v[96:99]
  ds_read_b64_tr_b16 v[52:53], v28 offset:24576
  ds_read_b64_tr_b16 v[54:55], v28 offset:25600
  buffer_load_dwordx4 v5, s[16:19], s83 offen offset:1024 lds
  v_mfma_f32_16x16x32_bf16 v[100:103], v[60:63], a[124:127], v[100:103]
  s_waitcnt lgkmcnt(8)
  s_add_u32 m0, s81, 8192
  s_xor_b32 s83, s70, 768
  v_mfma_f32_16x16x32_bf16 v[100:103], v[56:59], a[116:119], v[100:103]
  ds_read_b64_tr_b16 v[56:57], v29 offset:16384
  s_waitcnt lgkmcnt(5)
  v_mfma_f32_16x16x32_bf16 v[104:107], v[40:43], a[112:115], v[104:107]
  ds_read_b64_tr_b16 v[58:59], v29 offset:17408
  v_mfma_f32_16x16x32_bf16 v[104:107], v[44:47], a[120:123], v[104:107]
  ds_read_b64_tr_b16 v[60:61], v29 offset:24576
  ds_read_b64_tr_b16 v[62:63], v29 offset:25600
  v_mfma_f32_16x16x32_bf16 v[108:111], v[44:47], a[124:127], v[108:111]
  buffer_load_dwordx4 v4, s[16:19], s83 offen lds
  v_mfma_f32_16x16x32_bf16 v[108:111], v[40:43], a[116:119], v[108:111]
  s_waitcnt vmcnt(13)
  s_barrier
  s_waitcnt lgkmcnt(4)
  v_mfma_f32_16x16x32_bf16 v[112:115], v[48:51], a[112:115], v[112:115]
  ds_read_b64_tr_b16 v[40:41], v22 offset:32768
  ds_read_b64_tr_b16 v[42:43], v22 offset:33792
  v_mfma_f32_16x16x32_bf16 v[112:115], v[52:55], a[120:123], v[112:115]
  ds_read_b64_tr_b16 v[44:45], v22 offset:40960
  ds_read_b64_tr_b16 v[46:47], v22 offset:41984
  buffer_load_dwordx4 v5, s[16:19], s83 offen offset:1024 lds
  v_mfma_f32_16x16x32_bf16 v[116:119], v[52:55], a[124:127], v[116:119]
  s_add_u32 m0, s81, 10240
  s_xor_b32 s83, s71, 768
  v_mfma_f32_16x16x32_bf16 v[116:119], v[48:51], a[116:119], v[116:119]
  ds_read_b64_tr_b16 v[48:49], v23 offset:32768
  ds_read_b64_tr_b16 v[50:51], v23 offset:33792
  s_waitcnt lgkmcnt(6)
  v_mfma_f32_16x16x32_bf16 v[120:123], v[56:59], a[112:115], v[120:123]
  buffer_load_dwordx4 v4, s[16:19], s83 offen lds
  v_mfma_f32_16x16x32_bf16 v[120:123], v[60:63], a[120:123], v[120:123]
  ds_read_b64_tr_b16 v[52:53], v23 offset:40960
  v_mfma_f32_16x16x32_bf16 v[124:127], v[60:63], a[124:127], v[124:127]
  ds_read_b64_tr_b16 v[54:55], v23 offset:41984
  v_mfma_f32_16x16x32_bf16 v[124:127], v[56:59], a[116:119], v[124:127]
  ds_read_b64_tr_b16 v[56:57], v24 offset:32768
  ds_read_b64_tr_b16 v[58:59], v24 offset:33792
  s_waitcnt lgkmcnt(6)
  v_mfma_f32_16x16x32_bf16 v[64:67], v[40:43], a[128:131], v[64:67]
  buffer_load_dwordx4 v5, s[16:19], s83 offen offset:1024 lds
  v_mfma_f32_16x16x32_bf16 v[64:67], v[44:47], a[136:139], v[64:67]
  ds_read_b64_tr_b16 v[60:61], v24 offset:40960
  ds_read_b64_tr_b16 v[62:63], v24 offset:41984
  v_mfma_f32_16x16x32_bf16 v[68:71], v[44:47], a[140:143], v[68:71]
  buffer_load_dwordx2 v[252:253], v250, s[12:15], 0 offen sc1
  v_mfma_f32_16x16x32_bf16 v[68:71], v[40:43], a[132:135], v[68:71]
  ds_read_b64_tr_b16 v[40:41], v25 offset:32768
  s_waitcnt lgkmcnt(5)
  v_mfma_f32_16x16x32_bf16 v[72:75], v[48:51], a[128:131], v[72:75]
  ds_read_b64_tr_b16 v[42:43], v25 offset:33792
  v_mfma_f32_16x16x32_bf16 v[72:75], v[52:55], a[136:139], v[72:75]
  ds_read_b64_tr_b16 v[44:45], v25 offset:40960
  ds_read_b64_tr_b16 v[46:47], v25 offset:41984
  buffer_load_dword v243, v244, s[12:15], 0 offen sc1
  v_mfma_f32_16x16x32_bf16 v[76:79], v[52:55], a[140:143], v[76:79]
  s_add_u32 m0, s81, 12288
  s_xor_b32 s83, s72, 768
  v_mfma_f32_16x16x32_bf16 v[76:79], v[48:51], a[132:135], v[76:79]
  ds_read_b64_tr_b16 v[48:49], v26 offset:32768
  s_waitcnt lgkmcnt(5)
  v_mfma_f32_16x16x32_bf16 v[80:83], v[56:59], a[128:131], v[80:83]
  ds_read_b64_tr_b16 v[50:51], v26 offset:33792
  v_mfma_f32_16x16x32_bf16 v[80:83], v[60:63], a[136:139], v[80:83]
  ds_read_b64_tr_b16 v[52:53], v26 offset:40960
  ds_read_b64_tr_b16 v[54:55], v26 offset:41984
  v_mfma_f32_16x16x32_bf16 v[84:87], v[60:63], a[140:143], v[84:87]
  buffer_load_dwordx4 v4, s[16:19], s83 offen lds
  v_mfma_f32_16x16x32_bf16 v[84:87], v[56:59], a[132:135], v[84:87]
  ds_read_b64_tr_b16 v[56:57], v27 offset:32768
  ds_read_b64_tr_b16 v[58:59], v27 offset:33792
  s_waitcnt lgkmcnt(6)
  v_mfma_f32_16x16x32_bf16 v[88:91], v[40:43], a[128:131], v[88:91]
  buffer_load_dwordx4 v5, s[16:19], s83 offen offset:1024 lds
  s_add_u32 m0, s81, 14336
  v_mfma_f32_16x16x32_bf16 v[88:91], v[44:47], a[136:139], v[88:91]
  ds_read_b64_tr_b16 v[60:61], v27 offset:40960
  ds_read_b64_tr_b16 v[62:63], v27 offset:41984
  v_mfma_f32_16x16x32_bf16 v[92:95], v[44:47], a[140:143], v[92:95]
  s_xor_b32 s83, s73, 768
  v_mfma_f32_16x16x32_bf16 v[92:95], v[40:43], a[132:135], v[92:95]
  ds_read_b64_tr_b16 v[40:41], v28 offset:32768
  ds_read_b64_tr_b16 v[42:43], v28 offset:33792
  s_waitcnt lgkmcnt(6)
  v_mfma_f32_16x16x32_bf16 v[96:99], v[48:51], a[128:131], v[96:99]
  buffer_load_dwordx4 v4, s[16:19], s83 offen lds
  v_mfma_f32_16x16x32_bf16 v[96:99], v[52:55], a[136:139], v[96:99]
  ds_read_b64_tr_b16 v[44:45], v28 offset:40960
  v_mfma_f32_16x16x32_bf16 v[100:103], v[52:55], a[140:143], v[100:103]
  ds_read_b64_tr_b16 v[46:47], v28 offset:41984
  v_mfma_f32_16x16x32_bf16 v[100:103], v[48:51], a[132:135], v[100:103]
  ds_read_b64_tr_b16 v[48:49], v29 offset:32768
  ds_read_b64_tr_b16 v[50:51], v29 offset:33792
  s_waitcnt lgkmcnt(6)
  v_mfma_f32_16x16x32_bf16 v[104:107], v[56:59], a[128:131], v[104:107]
  buffer_load_dwordx4 v5, s[16:19], s83 offen offset:1024 lds
  v_mfma_f32_16x16x32_bf16 v[104:107], v[60:63], a[136:139], v[104:107]
  ds_read_b64_tr_b16 v[52:53], v29 offset:40960
  v_mfma_f32_16x16x32_bf16 v[108:111], v[60:63], a[140:143], v[108:111]
  ds_read_b64_tr_b16 v[54:55], v29 offset:41984
  v_mfma_f32_16x16x32_bf16 v[108:111], v[56:59], a[132:135], v[108:111]
  s_waitcnt vmcnt(14)
  s_barrier
  s_waitcnt lgkmcnt(4)
  v_mfma_f32_16x16x32_bf16 v[112:115], v[40:43], a[128:131], v[112:115]
  ds_read_b64_tr_b16 v[56:57], v22 offset:49152
  ds_read_b64_tr_b16 v[58:59], v22 offset:50176
  v_mfma_f32_16x16x32_bf16 v[112:115], v[44:47], a[136:139], v[112:115]
  ds_read_b64_tr_b16 v[60:61], v22 offset:57344
  ds_read_b64_tr_b16 v[62:63], v22 offset:58368
  s_waitcnt vmcnt(10)
  v_mfma_f32_16x16x32_bf16 v[116:119], v[44:47], a[140:143], v[116:119]
  ds_read_b128 a[64:67], v6 offset:0
  v_mfma_f32_16x16x32_bf16 v[116:119], v[40:43], a[132:135], v[116:119]
  ds_read_b64_tr_b16 v[40:41], v23 offset:49152
  ds_read_b64_tr_b16 v[42:43], v23 offset:50176
  s_waitcnt lgkmcnt(7)
  v_mfma_f32_16x16x32_bf16 v[120:123], v[48:51], a[128:131], v[120:123]
  ds_read_b128 a[80:83], v7 offset:0
  v_mfma_f32_16x16x32_bf16 v[120:123], v[52:55], a[136:139], v[120:123]
  ds_read_b64_tr_b16 v[44:45], v23 offset:57344
  ds_read_b64_tr_b16 v[46:47], v23 offset:58368
  v_mfma_f32_16x16x32_bf16 v[124:127], v[52:55], a[140:143], v[124:127]
  ds_read_b128 a[68:71], v6 offset:2048
  v_mfma_f32_16x16x32_bf16 v[124:127], v[48:51], a[132:135], v[124:127]
  ds_read_b64_tr_b16 v[48:49], v24 offset:49152
  ds_read_b64_tr_b16 v[50:51], v24 offset:50176
  s_waitcnt lgkmcnt(9)
  v_mfma_f32_16x16x32_bf16 v[64:67], v[56:59], a[144:147], v[64:67]
  ds_read_b128 a[84:87], v7 offset:2048
  v_mfma_f32_16x16x32_bf16 v[64:67], v[60:63], a[152:155], v[64:67]
  ds_read_b64_tr_b16 v[52:53], v24 offset:57344
  ds_read_b64_tr_b16 v[54:55], v24 offset:58368
  s_waitcnt vmcnt(4)
  v_cmp_ne_u32 vcc, s63, v253
  s_cbranch_vccnz L_retry0
L_back0:
  v_mfma_f32_16x16x32_bf16 v[68:71], v[60:63], a[156:159], v[68:71]
  v_cmp_ne_u32 vcc, s63, v243
  s_cbranch_vccnz L_retry1
L_back1:
  s_xor_b32 s74, s85, 0
  buffer_load_dwordx4 v[128:131], v242, s[12:15], s74 offen offset:0 sc1
  v_mfma_f32_16x16x32_bf16 v[68:71], v[56:59], a[148:151], v[68:71]
  ds_read_b64_tr_b16 v[56:57], v25 offset:49152
  ds_read_b64_tr_b16 v[58:59], v25 offset:50176
  s_waitcnt lgkmcnt(8)
  v_mfma_f32_16x16x32_bf16 v[72:75], v[40:43], a[144:147], v[72:75]
  buffer_load_dwordx4 v[132:135], v242, s[12:15], s74 offen offset:1024 sc1
  v_mfma_f32_16x16x32_bf16 v[72:75], v[44:47], a[152:155], v[72:75]
  ds_read_b64_tr_b16 v[60:61], v25 offset:57344
  ds_read_b64_tr_b16 v[62:63], v25 offset:58368
  v_mfma_f32_16x16x32_bf16 v[76:79], v[44:47], a[156:159], v[76:79]
  buffer_load_dwordx4 v[136:139], v242, s[12:15], s74 offen offset:2048 sc1
  v_mfma_f32_16x16x32_bf16 v[76:79], v[40:43], a[148:151], v[76:79]
  ds_read_b64_tr_b16 v[40:41], v26 offset:49152
  ds_read_b64_tr_b16 v[42:43], v26 offset:50176
  s_waitcnt lgkmcnt(6)
  v_mfma_f32_16x16x32_bf16 v[80:83], v[48:51], a[144:147], v[80:83]
  ds_read_b128 a[72:75], v6 offset:4096
  v_mfma_f32_16x16x32_bf16 v[80:83], v[52:55], a[152:155], v[80:83]
  ds_read_b64_tr_b16 v[44:45], v26 offset:57344
  ds_read_b64_tr_b16 v[46:47], v26 offset:58368
  v_mfma_f32_16x16x32_bf16 v[84:87], v[52:55], a[156:159], v[84:87]
  buffer_load_dwordx4 v[140:143], v242, s[12:15], s74 offen offset:3072 sc1
  s_xor_b32 s74, s85, 4096
  v_mfma_f32_16x16x32_bf16 v[84:87], v[48:51], a[148:151], v[84:87]
  ds_read_b64_tr_b16 v[48:49], v27 offset:49152
  ds_read_b64_tr_b16 v[50:51], v27 offset:50176
  s_waitcnt lgkmcnt(7)
  v_mfma_f32_16x16x32_bf16 v[88:91], v[56:59], a[144:147], v[88:91]
  ds_read_b128 a[88:91], v7 offset:4096
  v_mfma_f32_16x16x32_bf16 v[88:91], v[60:63], a[152:155], v[88:91]
  ds_read_b64_tr_b16 v[52:53], v27 offset:57344
  ds_read_b64_tr_b16 v[54:55], v27 offset:58368
  v_mfma_f32_16x16x32_bf16 v[92:95], v[60:63], a[156:159], v[92:95]
  buffer_load_dwordx4 v[144:147], v242, s[12:15], s74 offen offset:0 sc1
  v_mfma_f32_16x16x32_bf16 v[92:95], v[56:59], a[148:151], v[92:95]
  ds_read_b64_tr_b16 v[56:57], v28 offset:49152
  ds_read_b64_tr_b16 v[58:59], v28 offset:50176
  s_waitcnt lgkmcnt(7)
  v_mfma_f32_16x16x32_bf16 v[96:99], v[40:43], a[144:147], v[96:99]
  buffer_load_dwordx4 v[148:151], v242, s[12:15], s74 offen offset:1024 sc1
  v_mfma_f32_16x16x32_bf16 v[96:99], v[44:47], a[152:155], v[96:99]
  ds_read_b64_tr_b16 v[60:61], v28 offset:57344
  ds_read_b64_tr_b16 v[62:63], v28 offset:58368
  v_mfma_f32_16x16x32_bf16 v[100:103], v[44:47], a[156:159], v[100:103]
  ds_read_b128 a[76:79], v6 offset:6144
  v_mfma_f32_16x16x32_bf16 v[100:103], v[40:43], a[148:151], v[100:103]
  ds_read_b64_tr_b16 v[40:41], v29 offset:49152
  ds_read_b64_tr_b16 v[42:43], v29 offset:50176
  s_waitcnt lgkmcnt(7)
  v_mfma_f32_16x16x32_bf16 v[104:107], v[48:51], a[144:147], v[104:107]
  buffer_load_dwordx4 v[152:155], v242, s[12:15], s74 offen offset:2048 sc1
  v_mfma_f32_16x16x32_bf16 v[104:107], v[52:55], a[152:155], v[104:107]
  ds_read_b64_tr_b16 v[44:45], v29 offset:57344
  ds_read_b64_tr_b16 v[46:47], v29 offset:58368
  v_mfma_f32_16x16x32_bf16 v[108:111], v[52:55], a[156:159], v[108:111]
  ds_read_b128 a[92:95], v7 offset:6144
  v_mfma_f32_16x16x32_bf16 v[108:111], v[48:51], a[148:151], v[108:111]
  buffer_load_dwordx4 v[156:159], v242, s[12:15], s74 offen offset:3072 sc1
  s_waitcnt lgkmcnt(6)
  v_mfma_f32_16x16x32_bf16 v[112:115], v[56:59], a[144:147], v[112:115]
  s_xor_b32 s74, s85, 8192
  v_mfma_f32_16x16x32_bf16 v[112:115], v[60:63], a[152:155], v[112:115]
  buffer_load_dwordx4 v[160:163], v242, s[12:15], s74 offen offset:0 sc1
  v_mfma_f32_16x16x32_bf16 v[116:119], v[60:63], a[156:159], v[116:119]
  v_mfma_f32_16x16x32_bf16 v[116:119], v[56:59], a[148:151], v[116:119]
  s_waitcnt lgkmcnt(1)
  v_mfma_f32_16x16x32_bf16 v[120:123], v[40:43], a[144:147], v[120:123]
  v_mfma_f32_16x16x32_bf16 v[120:123], v[44:47], a[152:155], v[120:123]
  buffer_load_dwordx4 v[164:167], v242, s[12:15], s74 offen offset:1024 sc1
  v_mfma_f32_16x16x32_bf16 v[124:127], v[44:47], a[156:159], v[124:127]
  v_mfma_f32_16x16x32_bf16 v[124:127], v[40:43], a[148:151], v[124:127]
  buffer_load_dwordx4 v[168:171], v242, s[12:15], s74 offen offset:2048 sc1
  buffer_load_dwordx4 v[172:175], v242, s[12:15], s74 offen offset:3072 sc1
  s_xor_b32 s74, s85, 12288
  buffer_load_dwordx4 v[176:179], v242, s[12:15], s74 offen offset:0 sc1
  buffer_load_dwordx4 v[180:183], v242, s[12:15], s74 offen offset:1024 sc1
  buffer_load_dwordx4 v[184:187], v242, s[12:15], s74 offen offset:2048 sc1
  buffer_load_dwordx4 v[188:191], v242, s[12:15], s74 offen offset:3072 sc1
  s_waitcnt vmcnt(16)
  ds_read_b128 a[96:99], v6 offset:8192
  ds_read_b128 a[112:115], v7 offset:8192
  ds_read_b128 a[100:103], v6 offset:10240
  ds_read_b128 a[116:119], v7 offset:10240
  ds_read_b128 a[104:107], v6 offset:12288
  ds_read_b128 a[120:123], v7 offset:12288
  ds_read_b128 a[108:111], v6 offset:14336
  ds_read_b128 a[124:127], v7 offset:14336
  ds_read_b128 a[128:131], v8 offset:0
  ds_read_b128 a[144:147], v9 offset:0
  ds_read_b128 a[132:135], v8 offset:2048
  ds_read_b128 a[148:151], v9 offset:2048
  ds_read_b128 a[136:139], v8 offset:4096
  ds_read_b128 a[152:155], v9 offset:4096
  ds_read_b128 a[140:143], v8 offset:6144
  ds_read_b128 a[156:159], v9 offset:6144
  s_waitcnt lgkmcnt(0)
L_cz:
  s_nop 3
  s_waitcnt vmcnt(14)
  v_mfma_f32_16x16x32_bf16 v[40:43], v[128:131], a[160:163], 0
  v_lshlrev_b32 v13, 4, v1
  v_add_u32 v12, s43, v13
  v_sub_f32 v252, 1.0, v252
  s_movk_i32 s75, 27648
  v_mfma_f32_16x16x32_bf16 v[40:43], v[132:135], a[176:179], v[40:43]
  s_add_u32 s80, s60, 1
  s_and_b32 s80, s80, 3
  v_lshlrev_b32 v251, 16, v251
  v_mfma_f32_16x16x32_bf16 v[16:19], v[128:131], a[164:167], 0
  s_mul_i32 s80, s80, 24576
  s_add_u32 s80, s80, 0
  v_mul_f32 v251, v251, v252
  v_cvt_pk_bf16_f32 v64, v64, v65
  v_mfma_f32_16x16x32_bf16 v[16:19], v[132:135], a[180:183], v[16:19]
  v_add_u32 v4, s80, v13
  s_add_u32 s80, s60, 2
  v_cvt_pk_bf16_f32 v65, v66, v67
  v_cvt_pk_bf16_f32 v66, v72, v73
  v_mfma_f32_16x16x32_bf16 v[20:23], v[128:131], a[168:171], 0
  s_and_b32 s80, s80, 3
  s_mul_i32 s80, s80, 24576
  v_cvt_pk_bf16_f32 v67, v74, v75
  v_mfma_f32_16x16x32_bf16 v[20:23], v[132:135], a[184:187], v[20:23]
  s_add_u32 s80, s80, 8192
  v_add_u32 v5, s80, v13
  buffer_store_dwordx4 v[64:67], v240, s[12:15], 0 offen offset:0 sc1
  v_mfma_f32_16x16x32_bf16 v[24:27], v[128:131], a[172:175], 0
  s_add_u32 s80, s60, 3
  s_and_b32 s80, s80, 3
  v_mfma_f32_16x16x32_bf16 v[24:27], v[132:135], a[188:191], v[24:27]
  s_mul_i32 s80, s80, 24576
  v_cvt_pk_bf16_f32 v68, v68, v69
  v_cvt_pk_bf16_f32 v69, v70, v71
  s_waitcnt vmcnt(13)
  v_mfma_f32_16x16x32_bf16 v[40:43], v[136:139], a[192:195], v[40:43]
  s_xor_b32 s74, s85, 65536
  s_add_u32 s80, s80, 16384
  v_cvt_pk_bf16_f32 v70, v76, v77
  v_cvt_pk_bf16_f32 v71, v78, v79
  v_mfma_f32_16x16x32_bf16 v[40:43], v[140:143], a[208:211], v[40:43]
  buffer_load_dwordx4 v[128:131], v242, s[12:15], s74 offen offset:0 sc1
  v_mfma_f32_16x16x32_bf16 v[16:19], v[136:139], a[196:199], v[16:19]
  v_add_u32 v6, s80, v13
  s_mul_i32 s80, s60, 24576
  buffer_store_dwordx4 v[68:71], v240, s[12:15], s75 offen offset:0 sc1
  v_mfma_f32_16x16x32_bf16 v[16:19], v[140:143], a[212:215], v[16:19]
  s_add_u32 s80, s80, 0
  v_add_u32 v7, s80, v13
  v_mfma_f32_16x16x32_bf16 v[20:23], v[136:139], a[200:203], v[20:23]
  v_mov_b32 v8, 0xc0135761
  v_mov_b32 v9, 0xbdd2d3e8
  v_cvt_pk_bf16_f32 v80, v80, v81
  v_cvt_pk_bf16_f32 v81, v82, v83
  v_mfma_f32_16x16x32_bf16 v[20:23], v[140:143], a[216:219], v[20:23]
  buffer_load_dwordx4 v[132:135], v242, s[12:15], s74 offen offset:1024 sc1
  v_mfma_f32_16x16x32_bf16 v[24:27], v[136:139], a[204:207], v[24:27]
  v_cvt_pk_bf16_f32 v82, v88, v89
  v_cvt_pk_bf16_f32 v83, v90, v91
  buffer_store_dwordx4 v[80:83], v240, s[12:15], 0 offen offset:1024 sc1
  v_mfma_f32_16x16x32_bf16 v[24:27], v[140:143], a[220:223], v[24:27]
  v_cvt_pk_bf16_f32 v84, v84, v85
  s_waitcnt vmcnt(15)
  v_mfma_f32_16x16x32_bf16 v[40:43], v[144:147], a[224:227], v[40:43]
  v_cvt_pk_bf16_f32 v85, v86, v87
  v_cvt_pk_bf16_f32 v86, v92, v93
  v_cvt_pk_bf16_f32 v87, v94, v95
  v_mfma_f32_16x16x32_bf16 v[40:43], v[148:151], a[240:243], v[40:43]
  buffer_load_dwordx4 v[136:139], v242, s[12:15], s74 offen offset:2048 sc1
  v_mfma_f32_16x16x32_bf16 v[16:19], v[144:147], a[228:231], v[16:19]
  buffer_store_dwordx4 v[84:87], v240, s[12:15], s75 offen offset:1024 sc1
  v_mfma_f32_16x16x32_bf16 v[16:19], v[148:151], a[244:247], v[16:19]
  v_cvt_pk_bf16_f32 v96, v96, v97
  v_cvt_pk_bf16_f32 v97, v98, v99
  v_cvt_pk_bf16_f32 v98, v104, v105
  v_cvt_pk_bf16_f32 v99, v106, v107
  v_mfma_f32_16x16x32_bf16 v[20:23], v[144:147], a[232:235], v[20:23]
  buffer_store_dwordx4 v[96:99], v240, s[12:15], 0 offen offset:2048 sc1
  v_mfma_f32_16x16x32_bf16 v[20:23], v[148:151], a[248:251], v[20:23]
  buffer_load_dwordx4 v[140:143], v242, s[12:15], s74 offen offset:3072 sc1
  v_mfma_f32_16x16x32_bf16 v[24:27], v[144:147], a[236:239], v[24:27]
  v_cvt_pk_bf16_f32 v100, v100, v101
  v_cvt_pk_bf16_f32 v101, v102, v103
  v_cvt_pk_bf16_f32 v102, v108, v109
  v_cvt_pk_bf16_f32 v103, v110, v111
  v_mfma_f32_16x16x32_bf16 v[24:27], v[148:151], a[252:255], v[24:27]
  buffer_store_dwordx4 v[100:103], v240, s[12:15], s75 offen offset:2048 sc1
  s_waitcnt vmcnt(18)
  v_mfma_f32_16x16x32_bf16 v[40:43], v[152:155], a[0:3], v[40:43]
  s_xor_b32 s74, s85, 69632
  v_cvt_pk_bf16_f32 v112, v112, v113
  v_cvt_pk_bf16_f32 v113, v114, v115
  v_mfma_f32_16x16x32_bf16 v[40:43], v[156:159], a[16:19], v[40:43]
  buffer_load_dwordx4 v[144:147], v242, s[12:15], s74 offen offset:0 sc1
  v_mfma_f32_16x16x32_bf16 v[16:19], v[152:155], a[4:7], v[16:19]
  v_cvt_pk_bf16_f32 v114, v120, v121
  v_cvt_pk_bf16_f32 v115, v122, v123
  buffer_store_dwordx4 v[112:115], v241, s[12:15], 0 offen offset:3072 sc1
  v_mfma_f32_16x16x32_bf16 v[16:19], v[156:159], a[20:23], v[16:19]
  v_cvt_pk_bf16_f32 v116, v116, v117
  v_cvt_pk_bf16_f32 v117, v118, v119
  v_mfma_f32_16x16x32_bf16 v[20:23], v[152:155], a[8:11], v[20:23]
  v_cvt_pk_bf16_f32 v118, v124, v125
  v_cvt_pk_bf16_f32 v119, v126, v127
  buffer_store_dwordx4 v[116:119], v241, s[12:15], s75 offen offset:3072 sc1
  v_mfma_f32_16x16x32_bf16 v[20:23], v[156:159], a[24:27], v[20:23]
  buffer_load_dwordx4 v[148:151], v242, s[12:15], s74 offen offset:1024 sc1
  v_mfma_f32_16x16x32_bf16 v[24:27], v[152:155], a[12:15], v[24:27]
  v_mfma_f32_16x16x32_bf16 v[24:27], v[156:159], a[28:31], v[24:27]
  s_waitcnt vmcnt(20)
  v_mfma_f32_16x16x32_bf16 v[40:43], v[160:163], a[32:35], v[40:43]
  v_mfma_f32_16x16x32_bf16 v[40:43], v[164:167], a[48:51], v[40:43]
  buffer_load_dwordx4 v[152:155], v242, s[12:15], s74 offen offset:2048 sc1
  v_mfma_f32_16x16x32_bf16 v[16:19], v[160:163], a[36:39], v[16:19]
  v_mfma_f32_16x16x32_bf16 v[16:19], v[164:167], a[52:55], v[16:19]
  v_mfma_f32_16x16x32_bf16 v[20:23], v[160:163], a[40:43], v[20:23]
  v_mfma_f32_16x16x32_bf16 v[20:23], v[164:167], a[56:59], v[20:23]
  buffer_load_dwordx4 v[156:159], v242, s[12:15], s74 offen offset:3072 sc1
  v_mfma_f32_16x16x32_bf16 v[24:27], v[160:163], a[44:47], v[24:27]
  v_mfma_f32_16x16x32_bf16 v[24:27], v[164:167], a[60:63], v[24:27]
  s_waitcnt vmcnt(20)
  v_mfma_f32_16x16x32_bf16 v[40:43], v[168:171], a[64:67], v[40:43]
  s_xor_b32 s74, s85, 73728
  v_mfma_f32_16x16x32_bf16 v[40:43], v[172:175], a[80:83], v[40:43]
  buffer_load_dwordx4 v[160:163], v242, s[12:15], s74 offen offset:0 sc1
  v_mfma_f32_16x16x32_bf16 v[16:19], v[168:171], a[68:71], v[16:19]
  v_mfma_f32_16x16x32_bf16 v[16:19], v[172:175], a[84:87], v[16:19]
  v_mfma_f32_16x16x32_bf16 v[20:23], v[168:171], a[72:75], v[20:23]
  v_mfma_f32_16x16x32_bf16 v[20:23], v[172:175], a[88:91], v[20:23]
  buffer_load_dwordx4 v[164:167], v242, s[12:15], s74 offen offset:1024 sc1
  v_mfma_f32_16x16x32_bf16 v[24:27], v[168:171], a[76:79], v[24:27]
  v_mfma_f32_16x16x32_bf16 v[24:27], v[172:175], a[92:95], v[24:27]
  s_waitcnt vmcnt(20)
  v_mfma_f32_16x16x32_bf16 v[40:43], v[176:179], a[96:99], v[40:43]
  v_mfma_f32_16x16x32_bf16 v[40:43], v[180:183], a[112:115], v[40:43]
  buffer_load_dwordx4 v[168:171], v242, s[12:15], s74 offen offset:2048 sc1
  v_mfma_f32_16x16x32_bf16 v[16:19], v[176:179], a[100:103], v[16:19]
  v_mfma_f32_16x16x32_bf16 v[16:19], v[180:183], a[116:119], v[16:19]
  v_mfma_f32_16x16x32_bf16 v[20:23], v[176:179], a[104:107], v[20:23]
  v_mfma_f32_16x16x32_bf16 v[20:23], v[180:183], a[120:123], v[20:23]
  buffer_load_dwordx4 v[172:175], v242, s[12:15], s74 offen offset:3072 sc1
  v_mfma_f32_16x16x32_bf16 v[24:27], v[176:179], a[108:111], v[24:27]
  v_mfma_f32_16x16x32_bf16 v[24:27], v[180:183], a[124:127], v[24:27]
  s_waitcnt vmcnt(20)
  v_mfma_f32_16x16x32_bf16 v[40:43], v[184:187], a[128:131], v[40:43]
  s_xor_b32 s74, s85, 77824
  s_barrier
  v_mfma_f32_16x16x32_bf16 v[40:43], v[188:191], a[144:147], v[40:43]
  buffer_load_dwordx4 v[176:179], v242, s[12:15], s74 offen offset:0 sc1
  v_mfma_f32_16x16x32_bf16 v[16:19], v[184:187], a[132:135], v[16:19]
  v_mfma_f32_16x16x32_bf16 v[16:19], v[188:191], a[148:151], v[16:19]
  v_mfma_f32_16x16x32_bf16 v[20:23], v[184:187], a[136:139], v[20:23]
  v_mfma_f32_16x16x32_bf16 v[20:23], v[188:191], a[152:155], v[20:23]
  buffer_load_dwordx4 v[180:183], v242, s[12:15], s74 offen offset:1024 sc1
  v_mfma_f32_16x16x32_bf16 v[24:27], v[184:187], a[140:143], v[24:27]
  v_mfma_f32_16x16x32_bf16 v[24:27], v[188:191], a[156:159], v[24:27]
  s_waitcnt vmcnt(18)
  v_mfma_f32_16x16x32_bf16 v[44:47], v[128:131], a[160:163], 0
  v_mfma_f32_16x16x32_bf16 v[44:47], v[132:135], a[176:179], v[44:47]
  buffer_load_dwordx4 v[184:187], v242, s[12:15], s74 offen offset:2048 sc1
  v_mfma_f32_16x16x32_bf16 v[28:31], v[128:131], a[164:167], 0
  v_mfma_f32_16x16x32_bf16 v[28:31], v[132:135], a[180:183], v[28:31]
  ds_write_b128 v4, v[16:19] offset:0
  v_mfma_f32_16x16x32_bf16 v[32:35], v[128:131], a[168:171], 0
  v_mfma_f32_16x16x32_bf16 v[32:35], v[132:135], a[184:187], v[32:35]
  buffer_load_dwordx4 v[188:191], v242, s[12:15], s74 offen offset:3072 sc1
  v_mfma_f32_16x16x32_bf16 v[36:39], v[128:131], a[172:175], 0
  v_mfma_f32_16x16x32_bf16 v[36:39], v[132:135], a[188:191], v[36:39]
  s_waitcnt vmcnt(15)
  v_mfma_f32_16x16x32_bf16 v[44:47], v[136:139], a[192:195], v[44:47]
  s_xor_b32 s74, s86, 0
  v_mfma_f32_16x16x32_bf16 v[44:47], v[140:143], a[208:211], v[44:47]
  buffer_load_dwordx4 v[128:131], v242, s[12:15], s74 offen offset:0 sc1
  v_mfma_f32_16x16x32_bf16 v[28:31], v[136:139], a[196:199], v[28:31]
  ds_write_b128 v5, v[20:23] offset:0
  v_mfma_f32_16x16x32_bf16 v[28:31], v[140:143], a[212:215], v[28:31]
  s_waitcnt vmcnt(12)
  buffer_store_dword v2, v3, s[12:15], s90 offen sc1
  v_mfma_f32_16x16x32_bf16 v[32:35], v[136:139], a[200:203], v[32:35]
  v_mfma_f32_16x16x32_bf16 v[32:35], v[140:143], a[216:219], v[32:35]
  buffer_load_dwordx4 v[132:135], v242, s[12:15], s74 offen offset:1024 sc1
  v_mfma_f32_16x16x32_bf16 v[36:39], v[136:139], a[204:207], v[36:39]
  ds_write_b128 v6, v[24:27] offset:0
  v_mfma_f32_16x16x32_bf16 v[36:39], v[140:143], a[220:223], v[36:39]
  s_waitcnt vmcnt(13)
  v_mfma_f32_16x16x32_bf16 v[44:47], v[144:147], a[224:227], v[44:47]
  v_mfma_f32_16x16x32_bf16 v[44:47], v[148:151], a[240:243], v[44:47]
  buffer_load_dwordx4 v[136:139], v242, s[12:15], s74 offen offset:2048 sc1
  v_mfma_f32_16x16x32_bf16 v[28:31], v[144:147], a[228:231], v[28:31]
  s_waitcnt lgkmcnt(0)
  v_mfma_f32_16x16x32_bf16 v[28:31], v[148:151], a[244:247], v[28:31]
  s_barrier
  v_mfma_f32_16x16x32_bf16 v[32:35], v[144:147], a[232:235], v[32:35]
  ds_read_b128 v[16:19], v7 offset:0
  v_mfma_f32_16x16x32_bf16 v[32:35], v[148:151], a[248:251], v[32:35]
  buffer_load_dwordx4 v[140:143], v242, s[12:15], s74 offen offset:3072 sc1
  v_mfma_f32_16x16x32_bf16 v[36:39], v[144:147], a[236:239], v[36:39]
  ds_read_b128 v[20:23], v7 offset:8192
  v_mfma_f32_16x16x32_bf16 v[36:39], v[148:151], a[252:255], v[36:39]
  s_waitcnt vmcnt(13)
  v_mfma_f32_16x16x32_bf16 v[44:47], v[152:155], a[0:3], v[44:47]
  s_xor_b32 s74, s86, 4096
  v_mfma_f32_16x16x32_bf16 v[44:47], v[156:159], a[16:19], v[44:47]
  buffer_load_dwordx4 v[144:147], v242, s[12:15], s74 offen offset:0 sc1
  v_mfma_f32_16x16x32_bf16 v[28:31], v[152:155], a[4:7], v[28:31]
  ds_read_b128 v[24:27], v7 offset:16384
  v_mfma_f32_16x16x32_bf16 v[28:31], v[156:159], a[20:23], v[28:31]
  s_nop 0
  v_mfma_f32_16x16x32_bf16 v[32:35], v[152:155], a[8:11], v[32:35]
  v_mfma_f32_16x16x32_bf16 v[32:35], v[156:159], a[24:27], v[32:35]
  buffer_load_dwordx4 v[148:151], v242, s[12:15], s74 offen offset:1024 sc1
  v_mfma_f32_16x16x32_bf16 v[36:39], v[152:155], a[12:15], v[36:39]
  v_mfma_f32_16x16x32_bf16 v[36:39], v[156:159], a[28:31], v[36:39]
  s_waitcnt lgkmcnt(2)
  v_add_f32 v40, v40, v16
  s_waitcnt vmcnt(13)
  v_mfma_f32_16x16x32_bf16 v[44:47], v[160:163], a[32:35], v[44:47]
  v_add_f32 v41, v41, v17
  v_add_f32 v42, v42, v18
  v_mfma_f32_16x16x32_bf16 v[44:47], v[164:167], a[48:51], v[44:47]
  buffer_load_dwordx4 v[152:155], v242, s[12:15], s74 offen offset:2048 sc1
  v_mfma_f32_16x16x32_bf16 v[28:31], v[160:163], a[36:39], v[28:31]
  v_add_f32 v43, v43, v19
  s_waitcnt lgkmcnt(1)
  v_add_f32 v40, v40, v20
  v_mfma_f32_16x16x32_bf16 v[28:31], v[164:167], a[52:55], v[28:31]
  v_add_f32 v41, v41, v21
  v_add_f32 v42, v42, v22
  v_mfma_f32_16x16x32_bf16 v[32:35], v[160:163], a[40:43], v[32:35]
  v_add_f32 v43, v43, v23
  s_waitcnt lgkmcnt(0)
  v_add_f32 v40, v40, v24
  v_mfma_f32_16x16x32_bf16 v[32:35], v[164:167], a[56:59], v[32:35]
  buffer_load_dwordx4 v[156:159], v242, s[12:15], s74 offen offset:3072 sc1
  v_mfma_f32_16x16x32_bf16 v[36:39], v[160:163], a[44:47], v[36:39]
  v_add_f32 v41, v41, v25
  v_add_f32 v42, v42, v26
  v_mfma_f32_16x16x32_bf16 v[36:39], v[164:167], a[60:63], v[36:39]
  v_add_f32 v43, v43, v27
  s_waitcnt vmcnt(13)
  v_mfma_f32_16x16x32_bf16 v[44:47], v[168:171], a[64:67], v[44:47]
  s_xor_b32 s74, s86, 8192
  v_mfma_f32_16x16x32_bf16 v[44:47], v[172:175], a[80:83], v[44:47]
  buffer_load_dwordx4 v[160:163], v242, s[12:15], s74 offen offset:0 sc1
  v_mfma_f32_16x16x32_bf16 v[28:31], v[168:171], a[68:71], v[28:31]
  v_mfma_f32_16x16x32_bf16 v[28:31], v[172:175], a[84:87], v[28:31]
  v_mfma_f32_16x16x32_bf16 v[32:35], v[168:171], a[72:75], v[32:35]
  v_mfma_f32_16x16x32_bf16 v[32:35], v[172:175], a[88:91], v[32:35]
  buffer_load_dwordx4 v[164:167], v242, s[12:15], s74 offen offset:1024 sc1
  v_mfma_f32_16x16x32_bf16 v[36:39], v[168:171], a[76:79], v[36:39]
  v_mfma_f32_16x16x32_bf16 v[36:39], v[172:175], a[92:95], v[36:39]
  s_waitcnt vmcnt(13)
  v_mfma_f32_16x16x32_bf16 v[44:47], v[176:179], a[96:99], v[44:47]
  v_mfma_f32_16x16x32_bf16 v[44:47], v[180:183], a[112:115], v[44:47]
  buffer_load_dwordx4 v[168:171], v242, s[12:15], s74 offen offset:2048 sc1
  v_mfma_f32_16x16x32_bf16 v[28:31], v[176:179], a[100:103], v[28:31]
  v_mfma_f32_16x16x32_bf16 v[28:31], v[180:183], a[116:119], v[28:31]
  v_mfma_f32_16x16x32_bf16 v[32:35], v[176:179], a[104:107], v[32:35]
  v_mfma_f32_16x16x32_bf16 v[32:35], v[180:183], a[120:123], v[32:35]
  buffer_load_dwordx4 v[172:175], v242, s[12:15], s74 offen offset:3072 sc1
  v_mfma_f32_16x16x32_bf16 v[36:39], v[176:179], a[108:111], v[36:39]
  v_mfma_f32_16x16x32_bf16 v[36:39], v[180:183], a[124:127], v[36:39]
  s_waitcnt vmcnt(13)
  v_mfma_f32_16x16x32_bf16 v[44:47], v[184:187], a[128:131], v[44:47]
  s_xor_b32 s74, s86, 12288
  v_mfma_f32_16x16x32_bf16 v[44:47], v[188:191], a[144:147], v[44:47]
  buffer_load_dwordx4 v[176:179], v242, s[12:15], s74 offen offset:0 sc1
  v_mfma_f32_16x16x32_bf16 v[28:31], v[184:187], a[132:135], v[28:31]
  v_mfma_f32_16x16x32_bf16 v[28:31], v[188:191], a[148:151], v[28:31]
  v_mfma_f32_16x16x32_bf16 v[32:35], v[184:187], a[136:139], v[32:35]
  v_mfma_f32_16x16x32_bf16 v[32:35], v[188:191], a[152:155], v[32:35]
  buffer_load_dwordx4 v[180:183], v242, s[12:15], s74 offen offset:1024 sc1
  v_mfma_f32_16x16x32_bf16 v[36:39], v[184:187], a[140:143], v[36:39]
  v_mfma_f32_16x16x32_bf16 v[36:39], v[188:191], a[156:159], v[36:39]
  s_waitcnt vmcnt(12)
  v_mfma_f32_16x16x32_bf16 v[48:51], v[128:131], a[160:163], 0
  v_mfma_f32_16x16x32_bf16 v[48:51], v[132:135], a[176:179], v[48:51]
  buffer_load_dwordx4 v[184:187], v242, s[12:15], s74 offen offset:2048 sc1
  v_mfma_f32_16x16x32_bf16 v[16:19], v[128:131], a[164:167], 0
  v_mfma_f32_16x16x32_bf16 v[16:19], v[132:135], a[180:183], v[16:19]
  ds_write_b128 v4, v[28:31] offset:1024
  v_mfma_f32_16x16x32_bf16 v[20:23], v[128:131], a[168:171], 0
  v_lshrrev_b32 v10, 3, v0
  v_lshlrev_b32 v10, 8, v10
  v_add_u32 v10, s2, v10
  v_mfma_f32_16x16x32_bf16 v[20:23], v[132:135], a[184:187], v[20:23]
  buffer_load_dwordx4 v[188:191], v242, s[12:15], s74 offen offset:3072 sc1
  v_mfma_f32_16x16x32_bf16 v[24:27], v[128:131], a[172:175], 0
  v_lshlrev_b32 v10, 4, v10
  v_and_b32 v10, 0xffffff80, v10
  v_min_u32 v10, L_code_end-L_pc-4, v10
  v_mfma_f32_16x16x32_bf16 v[24:27], v[132:135], a[188:191], v[24:27]
  global_load_dword v10, v10, s[32:33]
  s_waitcnt vmcnt(13)
  v_mfma_f32_16x16x32_bf16 v[48:51], v[136:139], a[192:195], v[48:51]
  s_xor_b32 s74, s86, 65536
  v_mfma_f32_16x16x32_bf16 v[48:51], v[140:143], a[208:211], v[48:51]
  buffer_load_dwordx4 v[128:131], v242, s[12:15], s74 offen offset:0 sc1
  v_mfma_f32_16x16x32_bf16 v[16:19], v[136:139], a[196:199], v[16:19]
  ds_write_b128 v5, v[32:35] offset:1024
  v_mfma_f32_16x16x32_bf16 v[16:19], v[140:143], a[212:215], v[16:19]
  v_mfma_f32_16x16x32_bf16 v[20:23], v[136:139], a[200:203], v[20:23]
  buffer_load_dword v14, v254, s[12:15], 0 offen sc1
  v_mfma_f32_16x16x32_bf16 v[20:23], v[140:143], a[216:219], v[20:23]
  buffer_load_dwordx4 v[132:135], v242, s[12:15], s74 offen offset:1024 sc1
  v_mfma_f32_16x16x32_bf16 v[24:27], v[136:139], a[204:207], v[24:27]
  ds_write_b128 v6, v[36:39] offset:1024
  v_mfma_f32_16x16x32_bf16 v[24:27], v[140:143], a[220:223], v[24:27]
  s_waitcnt vmcnt(14)
  v_mfma_f32_16x16x32_bf16 v[48:51], v[144:147], a[224:227], v[48:51]
  v_mfma_f32_16x16x32_bf16 v[48:51], v[148:151], a[240:243], v[48:51]
  buffer_load_dwordx4 v[136:139], v242, s[12:15], s74 offen offset:2048 sc1
  v_mfma_f32_16x16x32_bf16 v[16:19], v[144:147], a[228:231], v[16:19]
  s_waitcnt lgkmcnt(0)
  v_mfma_f32_16x16x32_bf16 v[16:19], v[148:151], a[244:247], v[16:19]
  s_barrier
  v_mfma_f32_16x16x32_bf16 v[20:23], v[144:147], a[232:235], v[20:23]
  ds_read_b128 v[28:31], v7 offset:1024
  v_mfma_f32_16x16x32_bf16 v[20:23], v[148:151], a[248:251], v[20:23]
  buffer_load_dwordx4 v[140:143], v242, s[12:15], s74 offen offset:3072 sc1
  v_mfma_f32_16x16x32_bf16 v[24:27], v[144:147], a[236:239], v[24:27]
  ds_read_b128 v[32:35], v7 offset:9216
  v_mfma_f32_16x16x32_bf16 v[24:27], v[148:151], a[252:255], v[24:27]
  s_waitcnt vmcnt(14)
  v_mfma_f32_16x16x32_bf16 v[48:51], v[152:155], a[0:3], v[48:51]
  s_xor_b32 s74, s86, 69632
  v_mfma_f32_16x16x32_bf16 v[48:51], v[156:159], a[16:19], v[48:51]
  buffer_load_dwordx4 v[144:147], v242, s[12:15], s74 offen offset:0 sc1
  v_mfma_f32_16x16x32_bf16 v[16:19], v[152:155], a[4:7], v[16:19]
  ds_read_b128 v[36:39], v7 offset:17408
  v_mfma_f32_16x16x32_bf16 v[16:19], v[156:159], a[20:23], v[16:19]
  s_nop 0
  v_mfma_f32_16x16x32_bf16 v[20:23], v[152:155], a[8:11], v[20:23]
  v_mfma_f32_16x16x32_bf16 v[20:23], v[156:159], a[24:27], v[20:23]
  buffer_load_dwordx4 v[148:151], v242, s[12:15], s74 offen offset:1024 sc1
  v_mfma_f32_16x16x32_bf16 v[24:27], v[152:155], a[12:15], v[24:27]
  v_mfma_f32_16x16x32_bf16 v[24:27], v[156:159], a[28:31], v[24:27]
  s_waitcnt lgkmcnt(2)
  v_add_f32 v44, v44, v28
  s_waitcnt vmcnt(14)
  v_mfma_f32_16x16x32_bf16 v[48:51], v[160:163], a[32:35], v[48:51]
  v_add_f32 v45, v45, v29
  v_add_f32 v46, v46, v30
  v_mfma_f32_16x16x32_bf16 v[48:51], v[164:167], a[48:51], v[48:51]
  buffer_load_dwordx4 v[152:155], v242, s[12:15], s74 offen offset:2048 sc1
  v_mfma_f32_16x16x32_bf16 v[16:19], v[160:163], a[36:39], v[16:19]
  v_add_f32 v47, v47, v31
  s_waitcnt lgkmcnt(1)
  v_add_f32 v44, v44, v32
  v_mfma_f32_16x16x32_bf16 v[16:19], v[164:167], a[52:55], v[16:19]
  v_add_f32 v45, v45, v33
  v_add_f32 v46, v46, v34
  v_mfma_f32_16x16x32_bf16 v[20:23], v[160:163], a[40:43], v[20:23]
  v_add_f32 v47, v47, v35
  s_waitcnt lgkmcnt(0)
  v_add_f32 v44, v44, v36
  v_mfma_f32_16x16x32_bf16 v[20:23], v[164:167], a[56:59], v[20:23]
  buffer_load_dwordx4 v[156:159], v242, s[12:15], s74 offen offset:3072 sc1
  v_mfma_f32_16x16x32_bf16 v[24:27], v[160:163], a[44:47], v[24:27]
  v_add_f32 v45, v45, v37
  v_add_f32 v46, v46, v38
  v_mfma_f32_16x16x32_bf16 v[24:27], v[164:167], a[60:63], v[24:27]
  v_add_f32 v47, v47, v39
  s_waitcnt vmcnt(14)
  v_mfma_f32_16x16x32_bf16 v[48:51], v[168:171], a[64:67], v[48:51]
  s_xor_b32 s74, s86, 73728
  v_mfma_f32_16x16x32_bf16 v[48:51], v[172:175], a[80:83], v[48:51]
  buffer_load_dwordx4 v[160:163], v242, s[12:15], s74 offen offset:0 sc1
  v_mfma_f32_16x16x32_bf16 v[16:19], v[168:171], a[68:71], v[16:19]
  v_mfma_f32_16x16x32_bf16 v[16:19], v[172:175], a[84:87], v[16:19]
  v_mfma_f32_16x16x32_bf16 v[20:23], v[168:171], a[72:75], v[20:23]
  v_mfma_f32_16x16x32_bf16 v[20:23], v[172:175], a[88:91], v[20:23]
  buffer_load_dwordx4 v[164:167], v242, s[12:15], s74 offen offset:1024 sc1
  v_mfma_f32_16x16x32_bf16 v[24:27], v[168:171], a[76:79], v[24:27]
  v_mfma_f32_16x16x32_bf16 v[24:27], v[172:175], a[92:95], v[24:27]
  s_waitcnt vmcnt(14)
  v_mfma_f32_16x16x32_bf16 v[48:51], v[176:179], a[96:99], v[48:51]
  v_mfma_f32_16x16x32_bf16 v[48:51], v[180:183], a[112:115], v[48:51]
  buffer_load_dwordx4 v[168:171], v242, s[12:15], s74 offen offset:2048 sc1
  v_mfma_f32_16x16x32_bf16 v[16:19], v[176:179], a[100:103], v[16:19]
  v_mfma_f32_16x16x32_bf16 v[16:19], v[180:183], a[116:119], v[16:19]
  v_mfma_f32_16x16x32_bf16 v[20:23], v[176:179], a[104:107], v[20:23]
  v_mfma_f32_16x16x32_bf16 v[20:23], v[180:183], a[120:123], v[20:23]
  buffer_load_dwordx4 v[172:175], v242, s[12:15], s74 offen offset:3072 sc1
  v_mfma_f32_16x16x32_bf16 v[24:27], v[176:179], a[108:111], v[24:27]
  v_mfma_f32_16x16x32_bf16 v[24:27], v[180:183], a[124:127], v[24:27]
  s_waitcnt vmcnt(14)
  v_mfma_f32_16x16x32_bf16 v[48:51], v[184:187], a[128:131], v[48:51]
  s_xor_b32 s74, s86, 77824
  s_waitcnt vmcnt(11)
  v_cmp_ne_u32 vcc, s63, v14
  s_cbranch_vccnz L_retry3
L_back3:
  s_lshr_b32 s79, s85, 17
  s_lshl_b32 s79, s79, 10
  s_add_u32 s79, s79, s87
  buffer_load_dwordx4 v[72:75], v248, s[12:15], s79 offen sc1
  s_lshr_b32 s79, s86, 17
  s_lshl_b32 s79, s79, 10
  s_add_u32 s79, s79, s87
  buffer_load_dwordx4 v[76:79], v248, s[12:15], s79 offen sc1
  s_lshr_b32 s79, s91, 17
  s_lshl_b32 s79, s79, 10
  s_add_u32 s79, s79, s87
  buffer_load_dwordx4 v[80:83], v248, s[12:15], s79 offen sc1
  s_lshr_b32 s79, s37, 17
  s_lshl_b32 s79, s79, 10
  s_add_u32 s79, s79, s87
  buffer_load_dwordx4 v[84:87], v248, s[12:15], s79 offen sc1
  v_mfma_f32_16x16x32_bf16 v[48:51], v[188:191], a[144:147], v[48:51]
  buffer_load_dwordx4 v[176:179], v242, s[12:15], s74 offen offset:0 sc1
  v_mfma_f32_16x16x32_bf16 v[16:19], v[184:187], a[132:135], v[16:19]
  v_mfma_f32_16x16x32_bf16 v[16:19], v[188:191], a[148:151], v[16:19]
  v_mfma_f32_16x16x32_bf16 v[20:23], v[184:187], a[136:139], v[20:23]
  v_mfma_f32_16x16x32_bf16 v[20:23], v[188:191], a[152:155], v[20:23]
  buffer_load_dwordx4 v[180:183], v242, s[12:15], s74 offen offset:1024 sc1
  v_mfma_f32_16x16x32_bf16 v[24:27], v[184:187], a[140:143], v[24:27]
  v_mfma_f32_16x16x32_bf16 v[24:27], v[188:191], a[156:159], v[24:27]
  s_waitcnt vmcnt(16)
  v_mfma_f32_16x16x32_bf16 v[52:55], v[128:131], a[160:163], 0
  v_mfma_f32_16x16x32_bf16 v[52:55], v[132:135], a[176:179], v[52:55]
  buffer_load_dwordx4 v[184:187], v242, s[12:15], s74 offen offset:2048 sc1
  v_mfma_f32_16x16x32_bf16 v[28:31], v[128:131], a[164:167], 0
  v_mfma_f32_16x16x32_bf16 v[28:31], v[132:135], a[180:183], v[28:31]
  ds_write_b128 v4, v[16:19] offset:2048
  v_mfma_f32_16x16x32_bf16 v[32:35], v[128:131], a[168:171], 0
  v_mfma_f32_16x16x32_bf16 v[32:35], v[132:135], a[184:187], v[32:35]
  buffer_load_dwordx4 v[188:191], v242, s[12:15], s74 offen offset:3072 sc1
  v_mfma_f32_16x16x32_bf16 v[36:39], v[128:131], a[172:175], 0
  v_mfma_f32_16x16x32_bf16 v[36:39], v[132:135], a[188:191], v[36:39]
  s_waitcnt vmcnt(16)
  v_mfma_f32_16x16x32_bf16 v[52:55], v[136:139], a[192:195], v[52:55]
  s_xor_b32 s74, s91, 0
  v_mfma_f32_16x16x32_bf16 v[52:55], v[140:143], a[208:211], v[52:55]
  buffer_load_dwordx4 v[128:131], v242, s[12:15], s74 offen offset:0 sc1
  v_mfma_f32_16x16x32_bf16 v[28:31], v[136:139], a[196:199], v[28:31]
  ds_write_b128 v5, v[20:23] offset:2048
  v_mfma_f32_16x16x32_bf16 v[28:31], v[140:143], a[212:215], v[28:31]
  v_mfma_f32_16x16x32_bf16 v[32:35], v[136:139], a[200:203], v[32:35]
  v_mfma_f32_16x16x32_bf16 v[32:35], v[140:143], a[216:219], v[32:35]
  buffer_load_dwordx4 v[132:135], v242, s[12:15], s74 offen offset:1024 sc1
  v_mfma_f32_16x16x32_bf16 v[36:39], v[136:139], a[204:207], v[36:39]
  ds_write_b128 v6, v[24:27] offset:2048
  v_mfma_f32_16x16x32_bf16 v[36:39], v[140:143], a[220:223], v[36:39]
  s_waitcnt vmcnt(16)
  v_mfma_f32_16x16x32_bf16 v[52:55], v[144:147], a[224:227], v[52:55]
  v_mfma_f32_16x16x32_bf16 v[52:55], v[148:151], a[240:243], v[52:55]
  buffer_load_dwordx4 v[136:139], v242, s[12:15], s74 offen offset:2048 sc1
  v_mfma_f32_16x16x32_bf16 v[28:31], v[144:147], a[228:231], v[28:31]
  s_waitcnt lgkmcnt(0)
  v_mfma_f32_16x16x32_bf16 v[28:31], v[148:151], a[244:247], v[28:31]
  s_barrier
  v_mfma_f32_16x16x32_bf16 v[32:35], v[144:147], a[232:235], v[32:35]
  ds_read_b128 v[16:19], v7 offset:2048
  v_mfma_f32_16x16x32_bf16 v[32:35], v[148:151], a[248:251], v[32:35]
  buffer_load_dwordx4 v[140:143], v242, s[12:15], s74 offen offset:3072 sc1
  v_mfma_f32_16x16x32_bf16 v[36:39], v[144:147], a[236:239], v[36:39]
  ds_read_b128 v[20:23], v7 offset:10240
  v_mfma_f32_16x16x32_bf16 v[36:39], v[148:151], a[252:255], v[36:39]
  s_waitcnt vmcnt(16)
  v_mfma_f32_16x16x32_bf16 v[52:55], v[152:155], a[0:3], v[52:55]
  s_xor_b32 s74, s91, 4096
  v_mfma_f32_16x16x32_bf16 v[52:55], v[156:159], a[16:19], v[52:55]
  buffer_load_dwordx4 v[144:147], v242, s[12:15], s74 offen offset:0 sc1
  v_mfma_f32_16x16x32_bf16 v[28:31], v[152:155], a[4:7], v[28:31]
  ds_read_b128 v[24:27], v7 offset:18432
  v_mfma_f32_16x16x32_bf16 v[28:31], v[156:159], a[20:23], v[28:31]
  s_nop 0
  v_mfma_f32_16x16x32_bf16 v[32:35], v[152:155], a[8:11], v[32:35]
  v_mfma_f32_16x16x32_bf16 v[32:35], v[156:159], a[24:27], v[32:35]
  buffer_load_dwordx4 v[148:151], v242, s[12:15], s74 offen offset:1024 sc1
  v_mfma_f32_16x16x32_bf16 v[36:39], v[152:155], a[12:15], v[36:39]
  v_mfma_f32_16x16x32_bf16 v[36:39], v[156:159], a[28:31], v[36:39]
  s_waitcnt lgkmcnt(2)
  v_add_f32 v48, v48, v16
  s_waitcnt vmcnt(16)
  v_mfma_f32_16x16x32_bf16 v[52:55], v[160:163], a[32:35], v[52:55]
  v_add_f32 v49, v49, v17
  v_add_f32 v50, v50, v18
  v_mfma_f32_16x16x32_bf16 v[52:55], v[164:167], a[48:51], v[52:55]
  buffer_load_dwordx4 v[152:155], v242, s[12:15], s74 offen offset:2048 sc1
  v_mfma_f32_16x16x32_bf16 v[28:31], v[160:163], a[36:39], v[28:31]
  v_add_f32 v51, v51, v19
  s_waitcnt lgkmcnt(1)
  v_add_f32 v48, v48, v20
  v_mfma_f32_16x16x32_bf16 v[28:31], v[164:167], a[52:55], v[28:31]
  v_add_f32 v49, v49, v21
  v_add_f32 v50, v50, v22
  v_mfma_f32_16x16x32_bf16 v[32:35], v[160:163], a[40:43], v[32:35]
  v_add_f32 v51, v51, v23
  s_waitcnt lgkmcnt(0)
  v_add_f32 v48, v48, v24
  v_lshrrev_b32 v14, 5, v1
  v_mfma_f32_16x16x32_bf16 v[32:35], v[164:167], a[56:59], v[32:35]
  buffer_load_dwordx4 v[156:159], v242, s[12:15], s74 offen offset:3072 sc1
  v_mfma_f32_16x16x32_bf16 v[36:39], v[160:163], a[44:47], v[36:39]
  v_add_f32 v49, v49, v25
  v_add_f32 v50, v50, v26
  v_bfe_u32 v15, v1, 4, 1
  v_mfma_f32_16x16x32_bf16 v[36:39], v[164:167], a[60:63], v[36:39]
  v_add_f32 v51, v51, v27
  v_lshlrev_b32 v15, 2, v15
  s_waitcnt vmcnt(16)
  v_mfma_f32_16x16x32_bf16 v[52:55], v[168:171], a[64:67], v[52:55]
  s_xor_b32 s74, s91, 8192
  v_lshl_add_u32 v15, v14, 7, v15
  v_add_u32 v15, s48, v15
  v_mfma_f32_16x16x32_bf16 v[52:55], v[172:175], a[80:83], v[52:55]
  buffer_load_dwordx4 v[160:163], v242, s[12:15], s74 offen offset:0 sc1
  v_mfma_f32_16x16x32_bf16 v[28:31], v[168:171], a[68:71], v[28:31]
  v_and_b32 v254, 3, v1
  v_lshl_add_u32 v254, v254, 2, s55
  v_lshl_add_u32 v254, v14, 7, v254
  v_mfma_f32_16x16x32_bf16 v[28:31], v[172:175], a[84:87], v[28:31]
  s_waitcnt vmcnt(16)
  v_lshlrev_b32 v88, 16, v72
  v_and_b32 v89, 0xffff0000, v72
  v_lshlrev_b32 v90, 16, v73
  v_mfma_f32_16x16x32_bf16 v[32:35], v[168:171], a[72:75], v[32:35]
  v_and_b32 v91, 0xffff0000, v73
  v_mul_f32 v92, v88, v88
  v_mul_f32 v93, v89, v89
  v_mfma_f32_16x16x32_bf16 v[32:35], v[172:175], a[88:91], v[32:35]
  buffer_load_dwordx4 v[164:167], v242, s[12:15], s74 offen offset:1024 sc1
  v_mfma_f32_16x16x32_bf16 v[36:39], v[168:171], a[76:79], v[36:39]
  v_mul_f32 v94, v90, v90
  v_mul_f32 v95, v91, v91
  v_fma_f32 v92, v92, v9, v8
  v_mfma_f32_16x16x32_bf16 v[36:39], v[172:175], a[92:95], v[36:39]
  v_fma_f32 v93, v93, v9, v8
  v_fma_f32 v94, v94, v9, v8
  s_waitcnt vmcnt(12)
  v_mfma_f32_16x16x32_bf16 v[52:55], v[176:179], a[96:99], v[52:55]
  v_fma_f32 v95, v95, v9, v8
  v_mul_f32 v92, v92, v88
  v_mul_f32 v93, v93, v89
  v_mfma_f32_16x16x32_bf16 v[52:55], v[180:183], a[112:115], v[52:55]
  buffer_load_dwordx4 v[168:171], v242, s[12:15], s74 offen offset:2048 sc1
  v_mfma_f32_16x16x32_bf16 v[28:31], v[176:179], a[100:103], v[28:31]
  v_mul_f32 v94, v94, v90
  v_mul_f32 v95, v95, v91
  v_mfma_f32_16x16x32_bf16 v[28:31], v[180:183], a[116:119], v[28:31]
  v_exp_f32 v92, v92
  v_mfma_f32_16x16x32_bf16 v[32:35], v[176:179], a[104:107], v[32:35]
  v_exp_f32 v93, v93
  v_mfma_f32_16x16x32_bf16 v[32:35], v[180:183], a[120:123], v[32:35]
  buffer_load_dwordx4 v[172:175], v242, s[12:15], s74 offen offset:3072 sc1
  v_mfma_f32_16x16x32_bf16 v[36:39], v[176:179], a[108:111], v[36:39]
  v_exp_f32 v94, v94
  v_mfma_f32_16x16x32_bf16 v[36:39], v[180:183], a[124:127], v[36:39]
  v_exp_f32 v95, v95
  s_waitcnt vmcnt(12)
  v_mfma_f32_16x16x32_bf16 v[52:55], v[184:187], a[128:131], v[52:55]
  s_xor_b32 s74, s91, 12288
  v_add_f32 v92, 1.0, v92
  v_add_f32 v93, 1.0, v93
  v_mfma_f32_16x16x32_bf16 v[52:55], v[188:191], a[144:147], v[52:55]
  buffer_load_dwordx4 v[176:179], v242, s[12:15], s74 offen offset:0 sc1
  v_mfma_f32_16x16x32_bf16 v[28:31], v[184:187], a[132:135], v[28:31]
  v_add_f32 v94, 1.0, v94
  v_add_f32 v95, 1.0, v95
  v_mfma_f32_16x16x32_bf16 v[28:31], v[188:191], a[148:151], v[28:31]
  v_rcp_f32 v92, v92
  v_mfma_f32_16x16x32_bf16 v[32:35], v[184:187], a[136:139], v[32:35]
  v_rcp_f32 v93, v93
  v_mfma_f32_16x16x32_bf16 v[32:35], v[188:191], a[152:155], v[32:35]
  buffer_load_dwordx4 v[180:183], v242, s[12:15], s74 offen offset:1024 sc1
  v_mfma_f32_16x16x32_bf16 v[36:39], v[184:187], a[140:143], v[36:39]
  v_rcp_f32 v94, v94
  v_mfma_f32_16x16x32_bf16 v[36:39], v[188:191], a[156:159], v[36:39]
  v_rcp_f32 v95, v95
  s_waitcnt vmcnt(12)
  v_mfma_f32_16x16x32_bf16 v[56:59], v[128:131], a[160:163], 0
  v_mul_f32 v88, v88, v92
  v_mul_f32 v89, v89, v93
  v_mul_f32 v90, v90, v94
  v_mfma_f32_16x16x32_bf16 v[56:59], v[132:135], a[176:179], v[56:59]
  buffer_load_dwordx4 v[184:187], v242, s[12:15], s74 offen offset:2048 sc1
  v_mfma_f32_16x16x32_bf16 v[16:19], v[128:131], a[164:167], 0
  v_mul_f32 v91, v91, v95
  v_fma_f32 v40, v40, v252, v251
  v_fma_f32 v41, v41, v252, v251
  v_mfma_f32_16x16x32_bf16 v[16:19], v[132:135], a[180:183], v[16:19]
  ds_write_b128 v4, v[28:31] offset:3072
  v_mfma_f32_16x16x32_bf16 v[20:23], v[128:131], a[168:171], 0
  v_fma_f32 v42, v42, v252, v251
  v_fma_f32 v43, v43, v252, v251
  v_mul_f32 v40, v40, v88
  v_mfma_f32_16x16x32_bf16 v[20:23], v[132:135], a[184:187], v[20:23]
  buffer_load_dwordx4 v[188:191], v242, s[12:15], s74 offen offset:3072 sc1
  v_mfma_f32_16x16x32_bf16 v[24:27], v[128:131], a[172:175], 0
  v_mul_f32 v41, v41, v89
  v_mul_f32 v42, v42, v90
  v_mul_f32 v43, v43, v91
  v_mfma_f32_16x16x32_bf16 v[24:27], v[132:135], a[188:191], v[24:27]
  v_cvt_pk_bf16_f32 v72, v40, v41
  v_cvt_pk_bf16_f32 v73, v42, v43
  s_waitcnt vmcnt(12)
  v_mfma_f32_16x16x32_bf16 v[56:59], v[136:139], a[192:195], v[56:59]
  s_xor_b32 s74, s91, 65536
  v_lshlrev_b32 v88, 16, v74
  v_and_b32 v89, 0xffff0000, v74
  v_mfma_f32_16x16x32_bf16 v[56:59], v[140:143], a[208:211], v[56:59]
  buffer_load_dwordx4 v[128:131], v242, s[12:15], s74 offen offset:0 sc1
  v_mfma_f32_16x16x32_bf16 v[16:19], v[136:139], a[196:199], v[16:19]
  ds_write_b128 v5, v[32:35] offset:3072
  v_mfma_f32_16x16x32_bf16 v[16:19], v[140:143], a[212:215], v[16:19]
  v_lshlrev_b32 v90, 16, v75
  v_and_b32 v91, 0xffff0000, v75
  v_mul_f32 v92, v88, v88
  v_mfma_f32_16x16x32_bf16 v[20:23], v[136:139], a[200:203], v[20:23]
  v_mul_f32 v93, v89, v89
  v_mul_f32 v94, v90, v90
  v_mul_f32 v95, v91, v91
  v_mfma_f32_16x16x32_bf16 v[20:23], v[140:143], a[216:219], v[20:23]
  buffer_load_dwordx4 v[132:135], v242, s[12:15], s74 offen offset:1024 sc1
  v_mfma_f32_16x16x32_bf16 v[24:27], v[136:139], a[204:207], v[24:27]
  ds_write_b128 v6, v[36:39] offset:3072
  v_mfma_f32_16x16x32_bf16 v[24:27], v[140:143], a[220:223], v[24:27]
  v_fma_f32 v92, v92, v9, v8
  v_fma_f32 v93, v93, v9, v8
  s_waitcnt vmcnt(12)
  v_mfma_f32_16x16x32_bf16 v[56:59], v[144:147], a[224:227], v[56:59]
  v_fma_f32 v94, v94, v9, v8
  v_fma_f32 v95, v95, v9, v8
  v_mul_f32 v92, v92, v88
  v_mfma_f32_16x16x32_bf16 v[56:59], v[148:151], a[240:243], v[56:59]
  buffer_load_dwordx4 v[136:139], v242, s[12:15], s74 offen offset:2048 sc1
  v_mfma_f32_16x16x32_bf16 v[16:19], v[144:147], a[228:231], v[16:19]
  v_mul_f32 v93, v93, v89
  v_mul_f32 v94, v94, v90
  s_waitcnt lgkmcnt(0)
  v_mfma_f32_16x16x32_bf16 v[16:19], v[148:151], a[244:247], v[16:19]
  s_barrier
  v_mul_f32 v95, v95, v91
  v_mfma_f32_16x16x32_bf16 v[20:23], v[144:147], a[232:235], v[20:23]
  ds_read_b128 v[28:31], v7 offset:3072
  v_mfma_f32_16x16x32_bf16 v[20:23], v[148:151], a[248:251], v[20:23]
  buffer_load_dwordx4 v[140:143], v242, s[12:15], s74 offen offset:3072 sc1
  v_mfma_f32_16x16x32_bf16 v[24:27], v[144:147], a[236:239], v[24:27]
  ds_read_b128 v[32:35], v7 offset:11264
  v_mfma_f32_16x16x32_bf16 v[24:27], v[148:151], a[252:255], v[24:27]
  v_exp_f32 v92, v92
  s_waitcnt vmcnt(12)
  v_mfma_f32_16x16x32_bf16 v[56:59], v[152:155], a[0:3], v[56:59]
  s_xor_b32 s74, s91, 69632
  v_exp_f32 v93, v93
  v_mfma_f32_16x16x32_bf16 v[56:59], v[156:159], a[16:19], v[56:59]
  buffer_load_dwordx4 v[144:147], v242, s[12:15], s74 offen offset:0 sc1
  v_mfma_f32_16x16x32_bf16 v[16:19], v[152:155], a[4:7], v[16:19]
  ds_read_b128 v[36:39], v7 offset:19456
  v_mfma_f32_16x16x32_bf16 v[16:19], v[156:159], a[20:23], v[16:19]
  s_nop 0
  v_mfma_f32_16x16x32_bf16 v[20:23], v[152:155], a[8:11], v[20:23]
  v_exp_f32 v94, v94
  v_mfma_f32_16x16x32_bf16 v[20:23], v[156:159], a[24:27], v[20:23]
  buffer_load_dwordx4 v[148:151], v242, s[12:15], s74 offen offset:1024 sc1
  v_mfma_f32_16x16x32_bf16 v[24:27], v[152:155], a[12:15], v[24:27]
  v_exp_f32 v95, v95
  v_add_f32 v92, 1.0, v92
  v_mfma_f32_16x16x32_bf16 v[24:27], v[156:159], a[28:31], v[24:27]
  s_waitcnt lgkmcnt(2)
  v_add_f32 v52, v52, v28
  v_add_f32 v93, 1.0, v93
  s_waitcnt vmcnt(12)
  v_mfma_f32_16x16x32_bf16 v[56:59], v[160:163], a[32:35], v[56:59]
  v_add_f32 v53, v53, v29
  v_add_f32 v54, v54, v30
  v_add_f32 v94, 1.0, v94
  v_mfma_f32_16x16x32_bf16 v[56:59], v[164:167], a[48:51], v[56:59]
  buffer_load_dwordx4 v[152:155], v242, s[12:15], s74 offen offset:2048 sc1
  v_mfma_f32_16x16x32_bf16 v[16:19], v[160:163], a[36:39], v[16:19]
  v_add_f32 v55, v55, v31
  s_waitcnt lgkmcnt(1)
  v_add_f32 v52, v52, v32
  v_add_f32 v95, 1.0, v95
  v_mfma_f32_16x16x32_bf16 v[16:19], v[164:167], a[52:55], v[16:19]
  v_add_f32 v53, v53, v33
  v_add_f32 v54, v54, v34
  v_mfma_f32_16x16x32_bf16 v[20:23], v[160:163], a[40:43], v[20:23]
  v_add_f32 v55, v55, v35
  s_waitcnt lgkmcnt(0)
  v_add_f32 v52, v52, v36
  v_mfma_f32_16x16x32_bf16 v[20:23], v[164:167], a[56:59], v[20:23]
  buffer_load_dwordx4 v[156:159], v242, s[12:15], s74 offen offset:3072 sc1
  v_mfma_f32_16x16x32_bf16 v[24:27], v[160:163], a[44:47], v[24:27]
  v_add_f32 v53, v53, v37
  v_add_f32 v54, v54, v38
  v_mfma_f32_16x16x32_bf16 v[24:27], v[164:167], a[60:63], v[24:27]
  v_add_f32 v55, v55, v39
  s_waitcnt vmcnt(12)
  v_mfma_f32_16x16x32_bf16 v[56:59], v[168:171], a[64:67], v[56:59]
  s_xor_b32 s74, s91, 73728
  v_rcp_f32 v92, v92
  v_mfma_f32_16x16x32_bf16 v[56:59], v[172:175], a[80:83], v[56:59]
  buffer_load_dwordx4 v[160:163], v242, s[12:15], s74 offen offset:0 sc1
  v_mfma_f32_16x16x32_bf16 v[16:19], v[168:171], a[68:71], v[16:19]
  v_rcp_f32 v93, v93
  v_mfma_f32_16x16x32_bf16 v[16:19], v[172:175], a[84:87], v[16:19]
  v_rcp_f32 v94, v94
  v_mfma_f32_16x16x32_bf16 v[20:23], v[168:171], a[72:75], v[20:23]
  v_rcp_f32 v95, v95
  v_mul_f32 v88, v88, v92
  v_mfma_f32_16x16x32_bf16 v[20:23], v[172:175], a[88:91], v[20:23]
  buffer_load_dwordx4 v[164:167], v242, s[12:15], s74 offen offset:1024 sc1
  v_mfma_f32_16x16x32_bf16 v[24:27], v[168:171], a[76:79], v[24:27]
  v_mul_f32 v89, v89, v93
  v_mul_f32 v90, v90, v94
  v_mul_f32 v91, v91, v95
  v_mfma_f32_16x16x32_bf16 v[24:27], v[172:175], a[92:95], v[24:27]
  v_fma_f32 v44, v44, v252, v251
  v_fma_f32 v45, v45, v252, v251
  s_waitcnt vmcnt(12)
  v_mfma_f32_16x16x32_bf16 v[56:59], v[176:179], a[96:99], v[56:59]
  v_fma_f32 v46, v46, v252, v251
  v_fma_f32 v47, v47, v252, v251
  v_mul_f32 v44, v44, v88
  v_mfma_f32_16x16x32_bf16 v[56:59], v[180:183], a[112:115], v[56:59]
  buffer_load_dwordx4 v[168:171], v242, s[12:15], s74 offen offset:2048 sc1
  v_mfma_f32_16x16x32_bf16 v[16:19], v[176:179], a[100:103], v[16:19]
  v_mul_f32 v45, v45, v89
  v_mul_f32 v46, v46, v90
  v_mul_f32 v47, v47, v91
  v_mfma_f32_16x16x32_bf16 v[16:19], v[180:183], a[116:119], v[16:19]
  v_cvt_pk_bf16_f32 v74, v44, v45
  v_cvt_pk_bf16_f32 v75, v46, v47
  s_lshr_b32 s79, s85, 17
  v_mfma_f32_16x16x32_bf16 v[20:23], v[176:179], a[104:107], v[20:23]
  s_lshl_b32 s79, s79, 10
  s_add_u32 s79, s79, s88
  v_mfma_f32_16x16x32_bf16 v[20:23], v[180:183], a[120:123], v[20:23]
  buffer_load_dwordx4 v[172:175], v242, s[12:15], s74 offen offset:3072 sc1
  v_mfma_f32_16x16x32_bf16 v[24:27], v[176:179], a[108:111], v[24:27]
  buffer_store_dwordx4 v[72:75], v248, s[12:15], s79 offen sc1
  v_mfma_f32_16x16x32_bf16 v[24:27], v[180:183], a[124:127], v[24:27]
  s_waitcnt vmcnt(13)
  v_mfma_f32_16x16x32_bf16 v[56:59], v[184:187], a[128:131], v[56:59]
  s_xor_b32 s74, s91, 77824
  v_lshlrev_b32 v88, 16, v76
  v_mfma_f32_16x16x32_bf16 v[56:59], v[188:191], a[144:147], v[56:59]
  buffer_load_dwordx4 v[176:179], v242, s[12:15], s74 offen offset:0 sc1
  v_mfma_f32_16x16x32_bf16 v[16:19], v[184:187], a[132:135], v[16:19]
  v_and_b32 v89, 0xffff0000, v76
  v_lshlrev_b32 v90, 16, v77
  v_and_b32 v91, 0xffff0000, v77
  v_mfma_f32_16x16x32_bf16 v[16:19], v[188:191], a[148:151], v[16:19]
  v_mul_f32 v92, v88, v88
  v_mul_f32 v93, v89, v89
  v_mul_f32 v94, v90, v90
  v_mfma_f32_16x16x32_bf16 v[20:23], v[184:187], a[136:139], v[20:23]
  v_mul_f32 v95, v91, v91
  v_fma_f32 v92, v92, v9, v8
  v_fma_f32 v93, v93, v9, v8
  v_mfma_f32_16x16x32_bf16 v[20:23], v[188:191], a[152:155], v[20:23]
  buffer_load_dwordx4 v[180:183], v242, s[12:15], s74 offen offset:1024 sc1
  v_mfma_f32_16x16x32_bf16 v[24:27], v[184:187], a[140:143], v[24:27]
  v_fma_f32 v94, v94, v9, v8
  v_fma_f32 v95, v95, v9, v8
  v_mul_f32 v92, v92, v88
  v_mfma_f32_16x16x32_bf16 v[24:27], v[188:191], a[156:159], v[24:27]
  v_mul_f32 v93, v93, v89
  v_mul_f32 v94, v94, v90
  s_waitcnt vmcnt(13)
  v_mfma_f32_16x16x32_bf16 v[60:63], v[128:131], a[160:163], 0
  v_mul_f32 v95, v95, v91
  v_exp_f32 v92, v92
  v_mfma_f32_16x16x32_bf16 v[60:63], v[132:135], a[176:179], v[60:63]
  buffer_load_dwordx4 v[184:187], v242, s[12:15], s74 offen offset:2048 sc1
  v_mfma_f32_16x16x32_bf16 v[28:31], v[128:131], a[164:167], 0
  v_exp_f32 v93, v93
  v_mfma_f32_16x16x32_bf16 v[28:31], v[132:135], a[180:183], v[28:31]
  ds_write_b128 v4, v[16:19] offset:4096
  v_mfma_f32_16x16x32_bf16 v[32:35], v[128:131], a[168:171], 0
  v_exp_f32 v94, v94
  v_mfma_f32_16x16x32_bf16 v[32:35], v[132:135], a[184:187], v[32:35]
  buffer_load_dwordx4 v[188:191], v242, s[12:15], s74 offen offset:3072 sc1
  v_mfma_f32_16x16x32_bf16 v[36:39], v[128:131], a[172:175], 0
  v_exp_f32 v95, v95
  v_add_f32 v92, 1.0, v92
  v_mfma_f32_16x16x32_bf16 v[36:39], v[132:135], a[188:191], v[36:39]
  v_add_f32 v93, 1.0, v93
  v_add_f32 v94, 1.0, v94
  s_waitcnt vmcnt(13)
  v_mfma_f32_16x16x32_bf16 v[60:63], v[136:139], a[192:195], v[60:63]
  v_add_u32 v242, s59, v242
  s_xor_b32 s74, s37, 0
  v_add_f32 v95, 1.0, v95
  v_mfma_f32_16x16x32_bf16 v[60:63], v[140:143], a[208:211], v[60:63]
  buffer_load_dwordx4 v[128:131], v242, s[12:15], s74 offen offset:0 sc1
  v_mfma_f32_16x16x32_bf16 v[28:31], v[136:139], a[196:199], v[28:31]
  ds_write_b128 v5, v[20:23] offset:4096
  v_mfma_f32_16x16x32_bf16 v[28:31], v[140:143], a[212:215], v[28:31]
  v_rcp_f32 v92, v92
  v_mfma_f32_16x16x32_bf16 v[32:35], v[136:139], a[200:203], v[32:35]
  v_rcp_f32 v93, v93
  v_mfma_f32_16x16x32_bf16 v[32:35], v[140:143], a[216:219], v[32:35]
  buffer_load_dwordx4 v[132:135], v242, s[12:15], s74 offen offset:1024 sc1
  v_mfma_f32_16x16x32_bf16 v[36:39], v[136:139], a[204:207], v[36:39]
  ds_write_b128 v6, v[24:27] offset:4096
  v_mfma_f32_16x16x32_bf16 v[36:39], v[140:143], a[220:223], v[36:39]
  v_rcp_f32 v94, v94
  s_waitcnt vmcnt(13)
  v_mfma_f32_16x16x32_bf16 v[60:63], v[144:147], a[224:227], v[60:63]
  v_rcp_f32 v95, v95
  v_mul_f32 v88, v88, v92
  v_mfma_f32_16x16x32_bf16 v[60:63], v[148:151], a[240:243], v[60:63]
  buffer_load_dwordx4 v[136:139], v242, s[12:15], s74 offen offset:2048 sc1
  v_mfma_f32_16x16x32_bf16 v[28:31], v[144:147], a[228:231], v[28:31]
  v_mul_f32 v89, v89, v93
  v_mul_f32 v90, v90, v94
  s_waitcnt lgkmcnt(0)
  v_mfma_f32_16x16x32_bf16 v[28:31], v[148:151], a[244:247], v[28:31]
  s_barrier
  v_mul_f32 v91, v91, v95
  v_fma_f32 v48, v48, v252, v251
  v_mfma_f32_16x16x32_bf16 v[32:35], v[144:147], a[232:235], v[32:35]
  ds_read_b128 v[16:19], v7 offset:4096
  v_fma_f32 v49, v49, v252, v251
  v_mfma_f32_16x16x32_bf16 v[32:35], v[148:151], a[248:251], v[32:35]
  buffer_load_dwordx4 v[140:143], v242, s[12:15], s74 offen offset:3072 sc1
  v_mfma_f32_16x16x32_bf16 v[36:39], v[144:147], a[236:239], v[36:39]
  ds_read_b128 v[20:23], v7 offset:12288
  v_fma_f32 v50, v50, v252, v251
  v_mfma_f32_16x16x32_bf16 v[36:39], v[148:151], a[252:255], v[36:39]
  v_fma_f32 v51, v51, v252, v251
  v_mul_f32 v48, v48, v88
  s_waitcnt vmcnt(13)
  v_mfma_f32_16x16x32_bf16 v[60:63], v[152:155], a[0:3], v[60:63]
  s_xor_b32 s74, s37, 4096
  v_mul_f32 v49, v49, v89
  v_mul_f32 v50, v50, v90
  v_mfma_f32_16x16x32_bf16 v[60:63], v[156:159], a[16:19], v[60:63]
  buffer_load_dwordx4 v[144:147], v242, s[12:15], s74 offen offset:0 sc1
  v_mfma_f32_16x16x32_bf16 v[28:31], v[152:155], a[4:7], v[28:31]
  ds_read_b128 v[24:27], v7 offset:20480
  v_mul_f32 v51, v51, v91
  v_mfma_f32_16x16x32_bf16 v[28:31], v[156:159], a[20:23], v[28:31]
  s_nop 0
  v_mfma_f32_16x16x32_bf16 v[32:35], v[152:155], a[8:11], v[32:35]
  v_cvt_pk_bf16_f32 v76, v48, v49
  v_cvt_pk_bf16_f32 v77, v50, v51
  v_lshlrev_b32 v88, 16, v78
  v_mfma_f32_16x16x32_bf16 v[32:35], v[156:159], a[24:27], v[32:35]
  buffer_load_dwordx4 v[148:151], v242, s[12:15], s74 offen offset:1024 sc1
  v_mfma_f32_16x16x32_bf16 v[36:39], v[152:155], a[12:15], v[36:39]
  v_and_b32 v89, 0xffff0000, v78
  v_lshlrev_b32 v90, 16, v79
  v_and_b32 v91, 0xffff0000, v79
  v_mfma_f32_16x16x32_bf16 v[36:39], v[156:159], a[28:31], v[36:39]
  s_waitcnt lgkmcnt(2)
  v_add_f32 v56, v56, v16
  v_mul_f32 v92, v88, v88
  s_waitcnt vmcnt(13)
  v_mfma_f32_16x16x32_bf16 v[60:63], v[160:163], a[32:35], v[60:63]
  v_add_f32 v57, v57, v17
  v_add_f32 v58, v58, v18
  v_mul_f32 v93, v89, v89
  v_mfma_f32_16x16x32_bf16 v[60:63], v[164:167], a[48:51], v[60:63]
  buffer_load_dwordx4 v[152:155], v242, s[12:15], s74 offen offset:2048 sc1
  v_mfma_f32_16x16x32_bf16 v[28:31], v[160:163], a[36:39], v[28:31]
  v_add_f32 v59, v59, v19
  s_waitcnt lgkmcnt(1)
  v_add_f32 v56, v56, v20
  v_mul_f32 v94, v90, v90
  v_mfma_f32_16x16x32_bf16 v[28:31], v[164:167], a[52:55], v[28:31]
  v_add_f32 v57, v57, v21
  v_add_f32 v58, v58, v22
  v_mul_f32 v95, v91, v91
  v_mfma_f32_16x16x32_bf16 v[32:35], v[160:163], a[40:43], v[32:35]
  v_add_f32 v59, v59, v23
  s_waitcnt lgkmcnt(0)
  v_add_f32 v56, v56, v24
  v_fma_f32 v92, v92, v9, v8
  v_mfma_f32_16x16x32_bf16 v[32:35], v[164:167], a[56:59], v[32:35]
  buffer_load_dwordx4 v[156:159], v242, s[12:15], s74 offen offset:3072 sc1
  v_mfma_f32_16x16x32_bf16 v[36:39], v[160:163], a[44:47], v[36:39]
  v_add_f32 v57, v57, v25
  v_add_f32 v58, v58, v26
  v_fma_f32 v93, v93, v9, v8
  v_mfma_f32_16x16x32_bf16 v[36:39], v[164:167], a[60:63], v[36:39]
  v_add_f32 v59, v59, v27
  v_fma_f32 v94, v94, v9, v8
  s_waitcnt vmcnt(13)
  v_mfma_f32_16x16x32_bf16 v[60:63], v[168:171], a[64:67], v[60:63]
  s_xor_b32 s74, s37, 8192
  v_fma_f32 v95, v95, v9, v8
  v_mul_f32 v92, v92, v88
  v_mfma_f32_16x16x32_bf16 v[60:63], v[172:175], a[80:83], v[60:63]
  buffer_load_dwordx4 v[160:163], v242, s[12:15], s74 offen offset:0 sc1
  v_mfma_f32_16x16x32_bf16 v[28:31], v[168:171], a[68:71], v[28:31]
  v_mul_f32 v93, v93, v89
  v_mul_f32 v94, v94, v90
  v_mul_f32 v95, v95, v91
  v_mfma_f32_16x16x32_bf16 v[28:31], v[172:175], a[84:87], v[28:31]
  v_exp_f32 v92, v92
  v_mfma_f32_16x16x32_bf16 v[32:35], v[168:171], a[72:75], v[32:35]
  v_exp_f32 v93, v93
  v_mfma_f32_16x16x32_bf16 v[32:35], v[172:175], a[88:91], v[32:35]
  buffer_load_dwordx4 v[164:167], v242, s[12:15], s74 offen offset:1024 sc1
  v_mfma_f32_16x16x32_bf16 v[36:39], v[168:171], a[76:79], v[36:39]
  v_exp_f32 v94, v94
  v_mfma_f32_16x16x32_bf16 v[36:39], v[172:175], a[92:95], v[36:39]
  v_exp_f32 v95, v95
  s_waitcnt vmcnt(12)
  v_mfma_f32_16x16x32_bf16 v[60:63], v[176:179], a[96:99], v[60:63]
  v_add_f32 v92, 1.0, v92
  v_add_f32 v93, 1.0, v93
  v_add_f32 v94, 1.0, v94
  v_mfma_f32_16x16x32_bf16 v[60:63], v[180:183], a[112:115], v[60:63]
  buffer_load_dwordx4 v[168:171], v242, s[12:15], s74 offen offset:2048 sc1
  v_mfma_f32_16x16x32_bf16 v[28:31], v[176:179], a[100:103], v[28:31]
  v_add_f32 v95, 1.0, v95
  v_rcp_f32 v92, v92
  v_mfma_f32_16x16x32_bf16 v[28:31], v[180:183], a[116:119], v[28:31]
  v_rcp_f32 v93, v93
  v_mfma_f32_16x16x32_bf16 v[32:35], v[176:179], a[104:107], v[32:35]
  v_rcp_f32 v94, v94
  v_mfma_f32_16x16x32_bf16 v[32:35], v[180:183], a[120:123], v[32:35]
  buffer_load_dwordx4 v[172:175], v242, s[12:15], s74 offen offset:3072 sc1
  v_mfma_f32_16x16x32_bf16 v[36:39], v[176:179], a[108:111], v[36:39]
  v_rcp_f32 v95, v95
  v_mul_f32 v88, v88, v92
  v_mfma_f32_16x16x32_bf16 v[36:39], v[180:183], a[124:127], v[36:39]
  v_mul_f32 v89, v89, v93
  v_mul_f32 v90, v90, v94
  s_waitcnt vmcnt(12)
  v_mfma_f32_16x16x32_bf16 v[60:63], v[184:187], a[128:131], v[60:63]
  s_xor_b32 s74, s37, 12288
  v_mul_f32 v91, v91, v95
  v_fma_f32 v52, v52, v252, v251
  v_mfma_f32_16x16x32_bf16 v[60:63], v[188:191], a[144:147], v[60:63]
  buffer_load_dwordx4 v[176:179], v242, s[12:15], s74 offen offset:0 sc1
  v_mfma_f32_16x16x32_bf16 v[28:31], v[184:187], a[132:135], v[28:31]
  v_fma_f32 v53, v53, v252, v251
  v_fma_f32 v54, v54, v252, v251
  v_fma_f32 v55, v55, v252, v251
  v_mfma_f32_16x16x32_bf16 v[28:31], v[188:191], a[148:151], v[28:31]
  v_mul_f32 v52, v52, v88
  v_mul_f32 v53, v53, v89
  v_mul_f32 v54, v54, v90
  v_mfma_f32_16x16x32_bf16 v[32:35], v[184:187], a[136:139], v[32:35]
  v_mul_f32 v55, v55, v91
  v_cvt_pk_bf16_f32 v78, v52, v53
  v_cvt_pk_bf16_f32 v79, v54, v55
  v_mfma_f32_16x16x32_bf16 v[32:35], v[188:191], a[152:155], v[32:35]
  buffer_load_dwordx4 v[180:183], v242, s[12:15], s74 offen offset:1024 sc1
  v_mfma_f32_16x16x32_bf16 v[36:39], v[184:187], a[140:143], v[36:39]
  s_lshr_b32 s79, s86, 17
  s_lshl_b32 s79, s79, 10
  s_add_u32 s79, s79, s88
  v_mfma_f32_16x16x32_bf16 v[36:39], v[188:191], a[156:159], v[36:39]
  buffer_store_dwordx4 v[76:79], v248, s[12:15], s79 offen sc1
  s_waitcnt vmcnt(13)
  v_mfma_f32_16x16x32_bf16 v[64:67], v[128:131], a[160:163], 0
  v_mfma_f32_16x16x32_bf16 v[64:67], v[132:135], a[176:179], v[64:67]
  buffer_load_dwordx4 v[184:187], v242, s[12:15], s74 offen offset:2048 sc1
  v_mfma_f32_16x16x32_bf16 v[16:19], v[128:131], a[164:167], 0
  v_lshlrev_b32 v88, 16, v80
  v_and_b32 v89, 0xffff0000, v80
  v_mfma_f32_16x16x32_bf16 v[16:19], v[132:135], a[180:183], v[16:19]
  ds_write_b128 v4, v[28:31] offset:5120
  v_mfma_f32_16x16x32_bf16 v[20:23], v[128:131], a[168:171], 0
  v_lshlrev_b32 v90, 16, v81
  v_and_b32 v91, 0xffff0000, v81
  v_mul_f32 v92, v88, v88
  v_mfma_f32_16x16x32_bf16 v[20:23], v[132:135], a[184:187], v[20:23]
  buffer_load_dwordx4 v[188:191], v242, s[12:15], s74 offen offset:3072 sc1
  v_mfma_f32_16x16x32_bf16 v[24:27], v[128:131], a[172:175], 0
  v_mul_f32 v93, v89, v89
  v_mul_f32 v94, v90, v90
  v_mul_f32 v95, v91, v91
  v_mfma_f32_16x16x32_bf16 v[24:27], v[132:135], a[188:191], v[24:27]
  v_fma_f32 v92, v92, v9, v8
  v_fma_f32 v93, v93, v9, v8
  s_waitcnt vmcnt(13)
  v_mfma_f32_16x16x32_bf16 v[64:67], v[136:139], a[192:195], v[64:67]
  s_xor_b32 s74, s37, 65536
  v_fma_f32 v94, v94, v9, v8
  v_fma_f32 v95, v95, v9, v8
  v_mfma_f32_16x16x32_bf16 v[64:67], v[140:143], a[208:211], v[64:67]
  buffer_load_dwordx4 v[128:131], v242, s[12:15], s74 offen offset:0 sc1
  v_mfma_f32_16x16x32_bf16 v[16:19], v[136:139], a[196:199], v[16:19]
  ds_write_b128 v5, v[32:35] offset:5120
  v_mfma_f32_16x16x32_bf16 v[16:19], v[140:143], a[212:215], v[16:19]
  v_mul_f32 v92, v92, v88
  v_mul_f32 v93, v93, v89
  v_mul_f32 v94, v94, v90
  v_mfma_f32_16x16x32_bf16 v[20:23], v[136:139], a[200:203], v[20:23]
  v_mul_f32 v95, v95, v91
  v_exp_f32 v92, v92
  v_mfma_f32_16x16x32_bf16 v[20:23], v[140:143], a[216:219], v[20:23]
  buffer_load_dwordx4 v[132:135], v242, s[12:15], s74 offen offset:1024 sc1
  v_mfma_f32_16x16x32_bf16 v[24:27], v[136:139], a[204:207], v[24:27]
  ds_write_b128 v6, v[36:39] offset:5120
  v_mfma_f32_16x16x32_bf16 v[24:27], v[140:143], a[220:223], v[24:27]
  v_exp_f32 v93, v93
  s_waitcnt vmcnt(13)
  v_mfma_f32_16x16x32_bf16 v[64:67], v[144:147], a[224:227], v[64:67]
  v_exp_f32 v94, v94
  v_mfma_f32_16x16x32_bf16 v[64:67], v[148:151], a[240:243], v[64:67]
  buffer_load_dwordx4 v[136:139], v242, s[12:15], s74 offen offset:2048 sc1
  v_mfma_f32_16x16x32_bf16 v[16:19], v[144:147], a[228:231], v[16:19]
  v_exp_f32 v95, v95
  s_waitcnt lgkmcnt(0)
  v_mfma_f32_16x16x32_bf16 v[16:19], v[148:151], a[244:247], v[16:19]
  s_barrier
  v_add_f32 v92, 1.0, v92
  v_add_f32 v93, 1.0, v93
  v_mfma_f32_16x16x32_bf16 v[20:23], v[144:147], a[232:235], v[20:23]
  ds_read_b128 v[28:31], v7 offset:5120
  v_add_f32 v94, 1.0, v94
  v_mfma_f32_16x16x32_bf16 v[20:23], v[148:151], a[248:251], v[20:23]
  buffer_load_dwordx4 v[140:143], v242, s[12:15], s74 offen offset:3072 sc1
  v_mfma_f32_16x16x32_bf16 v[24:27], v[144:147], a[236:239], v[24:27]
  ds_read_b128 v[32:35], v7 offset:13312
  v_add_f32 v95, 1.0, v95
  v_mfma_f32_16x16x32_bf16 v[24:27], v[148:151], a[252:255], v[24:27]
  v_rcp_f32 v92, v92
  s_waitcnt vmcnt(13)
  v_mfma_f32_16x16x32_bf16 v[64:67], v[152:155], a[0:3], v[64:67]
  s_xor_b32 s74, s37, 69632
  v_rcp_f32 v93, v93
  v_mfma_f32_16x16x32_bf16 v[64:67], v[156:159], a[16:19], v[64:67]
  buffer_load_dwordx4 v[144:147], v242, s[12:15], s74 offen offset:0 sc1
  v_mfma_f32_16x16x32_bf16 v[16:19], v[152:155], a[4:7], v[16:19]
  ds_read_b128 v[36:39], v7 offset:21504
  v_mfma_f32_16x16x32_bf16 v[16:19], v[156:159], a[20:23], v[16:19]
  s_nop 0
  v_mfma_f32_16x16x32_bf16 v[20:23], v[152:155], a[8:11], v[20:23]
  v_rcp_f32 v94, v94
  v_mfma_f32_16x16x32_bf16 v[20:23], v[156:159], a[24:27], v[20:23]
  buffer_load_dwordx4 v[148:151], v242, s[12:15], s74 offen offset:1024 sc1
  v_mfma_f32_16x16x32_bf16 v[24:27], v[152:155], a[12:15], v[24:27]
  v_rcp_f32 v95, v95
  v_mul_f32 v88, v88, v92
  v_mfma_f32_16x16x32_bf16 v[24:27], v[156:159], a[28:31], v[24:27]
  s_waitcnt lgkmcnt(2)
  v_add_f32 v60, v60, v28
  v_mul_f32 v89, v89, v93
  s_waitcnt vmcnt(13)
  v_mfma_f32_16x16x32_bf16 v[64:67], v[160:163], a[32:35], v[64:67]
  v_add_f32 v61, v61, v29
  v_add_f32 v62, v62, v30
  v_mul_f32 v90, v90, v94
  v_mfma_f32_16x16x32_bf16 v[64:67], v[164:167], a[48:51], v[64:67]
  buffer_load_dwordx4 v[152:155], v242, s[12:15], s74 offen offset:2048 sc1
  v_mfma_f32_16x16x32_bf16 v[16:19], v[160:163], a[36:39], v[16:19]
  v_add_f32 v63, v63, v31
  s_waitcnt lgkmcnt(1)
  v_add_f32 v60, v60, v32
  v_mul_f32 v91, v91, v95
  v_mfma_f32_16x16x32_bf16 v[16:19], v[164:167], a[52:55], v[16:19]
  v_add_f32 v61, v61, v33
  v_add_f32 v62, v62, v34
  v_fma_f32 v56, v56, v252, v251
  v_mfma_f32_16x16x32_bf16 v[20:23], v[160:163], a[40:43], v[20:23]
  v_add_f32 v63, v63, v35
  s_waitcnt lgkmcnt(0)
  v_add_f32 v60, v60, v36
  v_fma_f32 v57, v57, v252, v251
  v_mfma_f32_16x16x32_bf16 v[20:23], v[164:167], a[56:59], v[20:23]
  buffer_load_dwordx4 v[156:159], v242, s[12:15], s74 offen offset:3072 sc1
  v_mfma_f32_16x16x32_bf16 v[24:27], v[160:163], a[44:47], v[24:27]
  v_add_f32 v61, v61, v37
  v_add_f32 v62, v62, v38
  v_fma_f32 v58, v58, v252, v251
  v_mfma_f32_16x16x32_bf16 v[24:27], v[164:167], a[60:63], v[24:27]
  v_add_f32 v63, v63, v39
  v_fma_f32 v59, v59, v252, v251
  s_waitcnt vmcnt(13)
  v_mfma_f32_16x16x32_bf16 v[64:67], v[168:171], a[64:67], v[64:67]
  s_xor_b32 s74, s37, 73728
  v_mul_f32 v56, v56, v88
  v_mul_f32 v57, v57, v89
  v_mfma_f32_16x16x32_bf16 v[64:67], v[172:175], a[80:83], v[64:67]
  buffer_load_dwordx4 v[160:163], v242, s[12:15], s74 offen offset:0 sc1
  v_mfma_f32_16x16x32_bf16 v[16:19], v[168:171], a[68:71], v[16:19]
  v_mul_f32 v58, v58, v90
  v_mul_f32 v59, v59, v91
  v_cvt_pk_bf16_f32 v80, v56, v57
  v_mfma_f32_16x16x32_bf16 v[16:19], v[172:175], a[84:87], v[16:19]
  v_cvt_pk_bf16_f32 v81, v58, v59
  v_lshlrev_b32 v88, 16, v82
  v_and_b32 v89, 0xffff0000, v82
  v_mfma_f32_16x16x32_bf16 v[20:23], v[168:171], a[72:75], v[20:23]
  v_lshlrev_b32 v90, 16, v83
  v_and_b32 v91, 0xffff0000, v83
  v_mul_f32 v92, v88, v88
  v_mfma_f32_16x16x32_bf16 v[20:23], v[172:175], a[88:91], v[20:23]
  buffer_load_dwordx4 v[164:167], v242, s[12:15], s74 offen offset:1024 sc1
  v_mfma_f32_16x16x32_bf16 v[24:27], v[168:171], a[76:79], v[24:27]
  v_mul_f32 v93, v89, v89
  v_mul_f32 v94, v90, v90
  v_mul_f32 v95, v91, v91
  v_mfma_f32_16x16x32_bf16 v[24:27], v[172:175], a[92:95], v[24:27]
  v_fma_f32 v92, v92, v9, v8
  v_fma_f32 v93, v93, v9, v8
  s_waitcnt vmcnt(13)
  v_mfma_f32_16x16x32_bf16 v[64:67], v[176:179], a[96:99], v[64:67]
  v_fma_f32 v94, v94, v9, v8
  v_fma_f32 v95, v95, v9, v8
  v_mul_f32 v92, v92, v88
  v_mfma_f32_16x16x32_bf16 v[64:67], v[180:183], a[112:115], v[64:67]
  buffer_load_dwordx4 v[168:171], v242, s[12:15], s74 offen offset:2048 sc1
  v_mfma_f32_16x16x32_bf16 v[16:19], v[176:179], a[100:103], v[16:19]
  v_mul_f32 v93, v93, v89
  v_mul_f32 v94, v94, v90
  v_mul_f32 v95, v95, v91
  v_mfma_f32_16x16x32_bf16 v[16:19], v[180:183], a[116:119], v[16:19]
  v_exp_f32 v92, v92
  v_mfma_f32_16x16x32_bf16 v[20:23], v[176:179], a[104:107], v[20:23]
  v_exp_f32 v93, v93
  v_mfma_f32_16x16x32_bf16 v[20:23], v[180:183], a[120:123], v[20:23]
  buffer_load_dwordx4 v[172:175], v242, s[12:15], s74 offen offset:3072 sc1
  v_mfma_f32_16x16x32_bf16 v[24:27], v[176:179], a[108:111], v[24:27]
  v_exp_f32 v94, v94
  v_mfma_f32_16x16x32_bf16 v[24:27], v[180:183], a[124:127], v[24:27]
  v_exp_f32 v95, v95
  s_waitcnt vmcnt(12)
  v_mfma_f32_16x16x32_bf16 v[64:67], v[184:187], a[128:131], v[64:67]
  s_xor_b32 s74, s37, 77824
  v_add_f32 v92, 1.0, v92
  v_add_f32 v93, 1.0, v93
  v_mfma_f32_16x16x32_bf16 v[64:67], v[188:191], a[144:147], v[64:67]
  buffer_load_dwordx4 v[176:179], v242, s[12:15], s74 offen offset:0 sc1
  v_mfma_f32_16x16x32_bf16 v[16:19], v[184:187], a[132:135], v[16:19]
  v_add_f32 v94, 1.0, v94
  v_add_f32 v95, 1.0, v95
  v_mfma_f32_16x16x32_bf16 v[16:19], v[188:191], a[148:151], v[16:19]
  v_rcp_f32 v92, v92
  v_mfma_f32_16x16x32_bf16 v[20:23], v[184:187], a[136:139], v[20:23]
  v_rcp_f32 v93, v93
  v_mfma_f32_16x16x32_bf16 v[20:23], v[188:191], a[152:155], v[20:23]
  buffer_load_dwordx4 v[180:183], v242, s[12:15], s74 offen offset:1024 sc1
  v_mfma_f32_16x16x32_bf16 v[24:27], v[184:187], a[140:143], v[24:27]
  v_rcp_f32 v94, v94
  v_mfma_f32_16x16x32_bf16 v[24:27], v[188:191], a[156:159], v[24:27]
  v_rcp_f32 v95, v95
  s_waitcnt vmcnt(12)
  v_mfma_f32_16x16x32_bf16 v[68:71], v[128:131], a[160:163], 0
  v_mul_f32 v88, v88, v92
  v_mul_f32 v89, v89, v93
  v_mul_f32 v90, v90, v94
  v_mfma_f32_16x16x32_bf16 v[68:71], v[132:135], a[176:179], v[68:71]
  buffer_load_dwordx4 v[184:187], v242, s[12:15], s74 offen offset:2048 sc1
  v_mfma_f32_16x16x32_bf16 v[28:31], v[128:131], a[164:167], 0
  v_mul_f32 v91, v91, v95
  v_fma_f32 v60, v60, v252, v251
  v_fma_f32 v61, v61, v252, v251
  v_mfma_f32_16x16x32_bf16 v[28:31], v[132:135], a[180:183], v[28:31]
  ds_write_b128 v4, v[16:19] offset:6144
  v_mfma_f32_16x16x32_bf16 v[32:35], v[128:131], a[168:171], 0
  v_fma_f32 v62, v62, v252, v251
  v_fma_f32 v63, v63, v252, v251
  v_mul_f32 v60, v60, v88
  v_mfma_f32_16x16x32_bf16 v[32:35], v[132:135], a[184:187], v[32:35]
  buffer_load_dwordx4 v[188:191], v242, s[12:15], s74 offen offset:3072 sc1
  v_mfma_f32_16x16x32_bf16 v[36:39], v[128:131], a[172:175], 0
  v_mul_f32 v61, v61, v89
  v_mul_f32 v62, v62, v90
  v_mul_f32 v63, v63, v91
  v_mfma_f32_16x16x32_bf16 v[36:39], v[132:135], a[188:191], v[36:39]
  v_cvt_pk_bf16_f32 v82, v60, v61
  v_cvt_pk_bf16_f32 v83, v62, v63
  s_waitcnt vmcnt(12)
  v_mfma_f32_16x16x32_bf16 v[68:71], v[136:139], a[192:195], v[68:71]
  ds_write_b128 v5, v[20:23] offset:6144
  v_mfma_f32_16x16x32_bf16 v[68:71], v[140:143], a[208:211], v[68:71]
  s_add_u32 s80, s44, 0
  buffer_load_dwordx4 a[160:163], v13, s[12:15], s80 offen offset:0 sc1
  v_mfma_f32_16x16x32_bf16 v[28:31], v[136:139], a[196:199], v[28:31]
  s_lshr_b32 s79, s91, 17
  s_lshl_b32 s79, s79, 10
  s_add_u32 s79, s79, s88
  v_mfma_f32_16x16x32_bf16 v[28:31], v[140:143], a[212:215], v[28:31]
  buffer_store_dwordx4 v[80:83], v248, s[12:15], s79 offen sc1
  v_mfma_f32_16x16x32_bf16 v[32:35], v[136:139], a[200:203], v[32:35]
  ds_write_b128 v6, v[24:27] offset:6144
  v_mfma_f32_16x16x32_bf16 v[32:35], v[140:143], a[216:219], v[32:35]
  buffer_load_dwordx4 a[164:167], v13, s[12:15], s80 offen offset:1024 sc1
  v_mfma_f32_16x16x32_bf16 v[36:39], v[136:139], a[204:207], v[36:39]
  v_mfma_f32_16x16x32_bf16 v[36:39], v[140:143], a[220:223], v[36:39]
  v_lshlrev_b32 v88, 16, v84
  v_and_b32 v89, 0xffff0000, v84
  s_waitcnt vmcnt(13)
  v_mfma_f32_16x16x32_bf16 v[68:71], v[144:147], a[224:227], v[68:71]
  v_lshlrev_b32 v90, 16, v85
  v_and_b32 v91, 0xffff0000, v85
  s_waitcnt lgkmcnt(0)
  v_mfma_f32_16x16x32_bf16 v[68:71], v[148:151], a[240:243], v[68:71]
  buffer_load_dwordx4 a[168:171], v13, s[12:15], s80 offen offset:2048 sc1
  v_mfma_f32_16x16x32_bf16 v[28:31], v[144:147], a[228:231], v[28:31]
  s_barrier
  v_mul_f32 v92, v88, v88
  v_mul_f32 v93, v89, v89
  v_mfma_f32_16x16x32_bf16 v[28:31], v[148:151], a[244:247], v[28:31]
  ds_read_b128 v[16:19], v7 offset:6144
  v_mul_f32 v94, v90, v90
  v_mfma_f32_16x16x32_bf16 v[32:35], v[144:147], a[232:235], v[32:35]
  ds_read_b128 v[20:23], v7 offset:14336
  v_mul_f32 v95, v91, v91
  v_mfma_f32_16x16x32_bf16 v[32:35], v[148:151], a[248:251], v[32:35]
  buffer_load_dwordx4 a[172:175], v13, s[12:15], s80 offen offset:3072 sc1
  v_mfma_f32_16x16x32_bf16 v[36:39], v[144:147], a[236:239], v[36:39]
  ds_read_b128 v[24:27], v7 offset:22528
  v_fma_f32 v92, v92, v9, v8
  v_mfma_f32_16x16x32_bf16 v[36:39], v[148:151], a[252:255], v[36:39]
  v_fma_f32 v93, v93, v9, v8
  v_fma_f32 v94, v94, v9, v8
  s_waitcnt vmcnt(13)
  v_mfma_f32_16x16x32_bf16 v[68:71], v[152:155], a[0:3], v[68:71]
  s_nop 0
  v_mfma_f32_16x16x32_bf16 v[68:71], v[156:159], a[16:19], v[68:71]
  s_add_u32 s80, s44, 40960
  buffer_load_dwordx4 a[176:179], v13, s[12:15], s80 offen offset:0 sc1
  v_mfma_f32_16x16x32_bf16 v[28:31], v[152:155], a[4:7], v[28:31]
  v_fma_f32 v95, v95, v9, v8
  v_mul_f32 v92, v92, v88
  v_mul_f32 v93, v93, v89
  v_mfma_f32_16x16x32_bf16 v[28:31], v[156:159], a[20:23], v[28:31]
  v_mul_f32 v94, v94, v90
  v_mul_f32 v95, v95, v91
  v_mfma_f32_16x16x32_bf16 v[32:35], v[152:155], a[8:11], v[32:35]
  s_waitcnt lgkmcnt(2)
  v_add_f32 v64, v64, v16
  v_add_f32 v65, v65, v17
  buffer_load_dword v14, v15, s[12:15], 0 offen sc1
  v_mfma_f32_16x16x32_bf16 v[32:35], v[156:159], a[24:27], v[32:35]
  buffer_load_dwordx4 a[180:183], v13, s[12:15], s80 offen offset:1024 sc1
  v_mfma_f32_16x16x32_bf16 v[36:39], v[152:155], a[12:15], v[36:39]
  v_add_f32 v66, v66, v18
  v_add_f32 v67, v67, v19
  v_mfma_f32_16x16x32_bf16 v[36:39], v[156:159], a[28:31], v[36:39]
  s_waitcnt lgkmcnt(1)
  v_add_f32 v64, v64, v20
  s_waitcnt vmcnt(14)
  v_mfma_f32_16x16x32_bf16 v[68:71], v[160:163], a[32:35], v[68:71]
  v_add_f32 v65, v65, v21
  v_add_f32 v66, v66, v22
  v_mfma_f32_16x16x32_bf16 v[68:71], v[164:167], a[48:51], v[68:71]
  buffer_load_dwordx4 a[184:187], v13, s[12:15], s80 offen offset:2048 sc1
  v_mfma_f32_16x16x32_bf16 v[28:31], v[160:163], a[36:39], v[28:31]
  v_add_f32 v67, v67, v23
  s_waitcnt lgkmcnt(0)
  v_add_f32 v64, v64, v24
  v_mfma_f32_16x16x32_bf16 v[28:31], v[164:167], a[52:55], v[28:31]
  v_add_f32 v65, v65, v25
  v_add_f32 v66, v66, v26
  v_mfma_f32_16x16x32_bf16 v[32:35], v[160:163], a[40:43], v[32:35]
  v_add_f32 v67, v67, v27
  v_exp_f32 v92, v92
  v_mfma_f32_16x16x32_bf16 v[32:35], v[164:167], a[56:59], v[32:35]
  buffer_load_dwordx4 a[188:191], v13, s[12:15], s80 offen offset:3072 sc1
  v_mfma_f32_16x16x32_bf16 v[36:39], v[160:163], a[44:47], v[36:39]
  v_exp_f32 v93, v93
  v_mfma_f32_16x16x32_bf16 v[36:39], v[164:167], a[60:63], v[36:39]
  v_exp_f32 v94, v94
  s_waitcnt vmcnt(14)
  v_mfma_f32_16x16x32_bf16 v[68:71], v[168:171], a[64:67], v[68:71]
  v_exp_f32 v95, v95
  v_add_f32 v92, 1.0, v92
  v_mfma_f32_16x16x32_bf16 v[68:71], v[172:175], a[80:83], v[68:71]
  s_add_u32 s80, s44, 81920
  buffer_load_dwordx4 a[192:195], v13, s[12:15], s80 offen offset:0 sc1
  v_mfma_f32_16x16x32_bf16 v[28:31], v[168:171], a[68:71], v[28:31]
  v_add_f32 v93, 1.0, v93
  v_add_f32 v94, 1.0, v94
  v_add_f32 v95, 1.0, v95
  v_mfma_f32_16x16x32_bf16 v[28:31], v[172:175], a[84:87], v[28:31]
  v_rcp_f32 v92, v92
  v_mfma_f32_16x16x32_bf16 v[32:35], v[168:171], a[72:75], v[32:35]
  v_rcp_f32 v93, v93
  s_waitcnt vmcnt(9)
  buffer_store_dword v2, v3, s[12:15], s49 offen sc1
  v_mfma_f32_16x16x32_bf16 v[32:35], v[172:175], a[88:91], v[32:35]
  buffer_load_dwordx4 a[196:199], v13, s[12:15], s80 offen offset:1024 sc1
  v_mfma_f32_16x16x32_bf16 v[36:39], v[168:171], a[76:79], v[36:39]
  v_rcp_f32 v94, v94
  v_mfma_f32_16x16x32_bf16 v[36:39], v[172:175], a[92:95], v[36:39]
  v_rcp_f32 v95, v95
  v_mfma_f32_16x16x32_bf16 v[68:71], v[176:179], a[96:99], v[68:71]
  v_mul_f32 v88, v88, v92
  v_mul_f32 v89, v89, v93
  v_mul_f32 v90, v90, v94
  v_mfma_f32_16x16x32_bf16 v[68:71], v[180:183], a[112:115], v[68:71]
  buffer_load_dwordx4 a[200:203], v13, s[12:15], s80 offen offset:2048 sc1
  v_mfma_f32_16x16x32_bf16 v[28:31], v[176:179], a[100:103], v[28:31]
  v_mul_f32 v91, v91, v95
  v_fma_f32 v64, v64, v252, v251
  v_fma_f32 v65, v65, v252, v251
  v_mfma_f32_16x16x32_bf16 v[28:31], v[180:183], a[116:119], v[28:31]
  v_fma_f32 v66, v66, v252, v251
  v_fma_f32 v67, v67, v252, v251
  v_mul_f32 v64, v64, v88
  v_mfma_f32_16x16x32_bf16 v[32:35], v[176:179], a[104:107], v[32:35]
  v_mul_f32 v65, v65, v89
  v_mul_f32 v66, v66, v90
  v_mul_f32 v67, v67, v91
  v_mfma_f32_16x16x32_bf16 v[32:35], v[180:183], a[120:123], v[32:35]
  buffer_load_dwordx4 a[204:207], v13, s[12:15], s80 offen offset:3072 sc1
  v_mfma_f32_16x16x32_bf16 v[36:39], v[176:179], a[108:111], v[36:39]
  v_cvt_pk_bf16_f32 v84, v64, v65
  v_cvt_pk_bf16_f32 v85, v66, v67
  v_lshlrev_b32 v88, 16, v86
  v_mfma_f32_16x16x32_bf16 v[36:39], v[180:183], a[124:127], v[36:39]
  v_and_b32 v89, 0xffff0000, v86
  v_lshlrev_b32 v90, 16, v87
  v_mfma_f32_16x16x32_bf16 v[68:71], v[184:187], a[128:131], v[68:71]
  v_and_b32 v91, 0xffff0000, v87
  v_mul_f32 v92, v88, v88
  v_mul_f32 v93, v89, v89
  v_mfma_f32_16x16x32_bf16 v[68:71], v[188:191], a[144:147], v[68:71]
  s_add_u32 s80, s44, 122880
  buffer_load_dwordx4 a[208:211], v13, s[12:15], s80 offen offset:0 sc1
  v_mfma_f32_16x16x32_bf16 v[28:31], v[184:187], a[132:135], v[28:31]
  v_mul_f32 v94, v90, v90
  v_mul_f32 v95, v91, v91
  v_fma_f32 v92, v92, v9, v8
  v_mfma_f32_16x16x32_bf16 v[28:31], v[188:191], a[148:151], v[28:31]
  v_fma_f32 v93, v93, v9, v8
  v_fma_f32 v94, v94, v9, v8
  v_fma_f32 v95, v95, v9, v8
  v_mfma_f32_16x16x32_bf16 v[32:35], v[184:187], a[136:139], v[32:35]
  v_mul_f32 v92, v92, v88
  v_mul_f32 v93, v93, v89
  v_mul_f32 v94, v94, v90
  v_mfma_f32_16x16x32_bf16 v[32:35], v[188:191], a[152:155], v[32:35]
  buffer_load_dwordx4 a[212:215], v13, s[12:15], s80 offen offset:1024 sc1
  v_mfma_f32_16x16x32_bf16 v[36:39], v[184:187], a[140:143], v[36:39]
  v_mul_f32 v95, v95, v91
  v_exp_f32 v92, v92
  v_mfma_f32_16x16x32_bf16 v[36:39], v[188:191], a[156:159], v[36:39]
  ds_write_b128 v4, v[28:31] offset:7168
  s_nop 1
  ds_write_b128 v5, v[32:35] offset:7168
  s_nop 3
  ds_write_b128 v6, v[36:39] offset:7168
  v_exp_f32 v93, v93
  v_exp_f32 v94, v94
  v_exp_f32 v95, v95
  v_add_f32 v92, 1.0, v92
  v_add_f32 v93, 1.0, v93
  v_add_f32 v94, 1.0, v94
  v_add_f32 v95, 1.0, v95
  v_rcp_f32 v92, v92
  v_rcp_f32 v93, v93
  v_rcp_f32 v94, v94
  v_rcp_f32 v95, v95
  v_mul_f32 v88, v88, v92
  v_mul_f32 v89, v89, v93
  v_mul_f32 v90, v90, v94
  v_mul_f32 v91, v91, v95
  s_waitcnt lgkmcnt(0)
  s_barrier
  ds_read_b128 v[28:31], v7 offset:7168
  ds_read_b128 v[32:35], v7 offset:15360
  ds_read_b128 v[36:39], v7 offset:23552
  s_waitcnt lgkmcnt(2)
  v_add_f32 v68, v68, v28
  v_add_f32 v69, v69, v29
  v_add_f32 v70, v70, v30
  v_add_f32 v71, v71, v31
  s_waitcnt lgkmcnt(1)
  v_add_f32 v68, v68, v32
  v_add_f32 v69, v69, v33
  v_add_f32 v70, v70, v34
  v_add_f32 v71, v71, v35
  s_waitcnt lgkmcnt(0)
  v_add_f32 v68, v68, v36
  v_add_f32 v69, v69, v37
  v_add_f32 v70, v70, v38
  v_add_f32 v71, v71, v39
  v_fma_f32 v68, v68, v252, v251
  v_fma_f32 v69, v69, v252, v251
  v_fma_f32 v70, v70, v252, v251
  v_fma_f32 v71, v71, v252, v251
  v_mul_f32 v68, v68, v88
  v_mul_f32 v69, v69, v89
  v_mul_f32 v70, v70, v90
  v_mul_f32 v71, v71, v91
  v_cvt_pk_bf16_f32 v86, v68, v69
  v_cvt_pk_bf16_f32 v87, v70, v71
  s_waitcnt vmcnt(10)
  v_mov_b32 v14, v14
  v_add_u32 v248, s59, v248
  s_lshr_b32 s79, s37, 17
  s_lshl_b32 s79, s79, 10
  s_add_u32 s79, s79, s88
  buffer_store_dwordx4 v[84:87], v248, s[12:15], s79 offen sc1
  buffer_load_dwordx4 a[216:219], v13, s[12:15], s80 offen offset:2048 sc1
  buffer_load_dwordx4 a[220:223], v13, s[12:15], s80 offen offset:3072 sc1
  s_add_u32 s80, s44, 163840
  buffer_load_dwordx4 a[224:227], v13, s[12:15], s80 offen offset:0 sc1
  buffer_load_dwordx4 a[228:231], v13, s[12:15], s80 offen offset:1024 sc1
  buffer_load_dwordx4 a[232:235], v13, s[12:15], s80 offen offset:2048 sc1
  buffer_load_dwordx4 a[236:239], v13, s[12:15], s80 offen offset:3072 sc1
  s_add_u32 s80, s45, 0
  buffer_load_dwordx4 a[240:243], v13, s[12:15], s80 offen offset:0 sc1
  buffer_load_dwordx4 a[244:247], v13, s[12:15], s80 offen offset:1024 sc1
  buffer_load_dwordx4 a[248:251], v13, s[12:15], s80 offen offset:2048 sc1
  buffer_load_dwordx4 a[252:255], v13, s[12:15], s80 offen offset:3072 sc1
  s_branch L_tail
L_misc:
  s_and_b32 s76, s2, 1
  s_lshl3_add_u32 s64, s77, s78
  s_lshl2_add_u32 s66, s76, s67
  s_lshl1_add_u32 s65, s76, s79
  s_lshr_b32 s79, s67, 1
  s_lshl1_add_u32 s65, s65, s79
  v_cmp_eq_u32 vcc, 0, v1
  v_mov_b32 v3, 1073741824
  s_nop 0
  v_cndmask_b32_e64 v3, v3, 0, vcc
  s_mov_b64 s[12:13], s[58:59]
  s_mov_b32 s14, 33554432
  s_mov_b32 s15, 0x20000
  s_mov_b64 s[16:17], s[46:47]
  s_mov_b32 s18, 8388608
  s_mov_b32 s19, 0x20000
  s_mov_b64 s[20:21], s[54:55]
  s_mov_b32 s22, 2621440
  s_mov_b32 s23, 0x20000
  s_mov_b64 s[24:25], s[48:49]
  s_mov_b32 s26, 4096
  s_mov_b32 s27, 0x20000
  s_mov_b64 s[28:29], s[52:53]
  s_mov_b32 s30, 1280
  s_mov_b32 s31, 0x20000
  v_mov_b32 v2, 19931136
  buffer_load_dword v2, v2, s[12:15], 0 offen sc1
  s_mov_b64 s[8:9], s[44:45]
  s_mov_b32 s10, 2211840
  v_lshrrev_b32 v28, 4, v0
  s_mul_i32 s75, s61, 40
  v_add_u32 v28, s75, v28
  v_mul_u32_u24 v28, 3456, v28
  v_and_b32 v29, 15, v0
  v_min_u32 v29, 13, v29
  v_lshl_add_u32 v39, v29, 7, v28
  s_cmp_lt_u32 s60, 2
  s_cselect_b32 s76, 0, 1073741824
  v_add_u32 v38, s76, v39
  s_mov_b32 s75, 0
  buffer_load_dword v237, v39, s[8:11], s75 offen
  s_mov_b32 s75, 55296
  buffer_load_dword v237, v39, s[8:11], s75 offen
  s_mov_b32 s75, 110592
  buffer_load_dword v237, v38, s[8:11], s75 offen
  v_add_u32 v28, 0, v1
  v_mul_u32_u24 v29, 820, v28
  v_lshrrev_b32 v29, 16, v29
  v_mul_u32_u24 v30, 80, v29
  v_sub_u32 v28, v28, v30
  v_lshlrev_b32 v30, 1, v29
  v_xor_b32 v28, v28, v30
  v_mul_u32_u24 v29, 1280, v29
  v_lshl_add_u32 v12, v28, 4, v29
  v_add_u32 v28, 64, v1
  v_mul_u32_u24 v29, 820, v28
  v_lshrrev_b32 v29, 16, v29
  v_mul_u32_u24 v30, 80, v29
  v_sub_u32 v28, v28, v30
  v_lshlrev_b32 v30, 1, v29
  v_xor_b32 v28, v28, v30
  v_mul_u32_u24 v29, 1280, v29
  v_lshl_add_u32 v13, v28, 4, v29
  v_add_u32 v28, 128, v1
  v_mul_u32_u24 v29, 820, v28
  v_lshrrev_b32 v29, 16, v29
  v_mul_u32_u24 v30, 80, v29
  v_sub_u32 v28, v28, v30
  v_lshlrev_b32 v30, 1, v29
  v_xor_b32 v28, v28, v30
  v_mul_u32_u24 v29, 1280, v29
  v_lshl_add_u32 v14, v28, 4, v29
  v_add_u32 v28, 192, v1
  v_mul_u32_u24 v29, 820, v28
  v_lshrrev_b32 v29, 16, v29
  v_mul_u32_u24 v30, 80, v29
  v_sub_u32 v28, v28, v30
  v_lshlrev_b32 v30, 1, v29
  v_xor_b32 v28, v28, v30
  v_mul_u32_u24 v29, 1280, v29
  v_lshl_add_u32 v15, v28, 4, v29
  v_add_u32 v28, 256, v1
  v_mul_u32_u24 v29, 820, v28
  v_lshrrev_b32 v29, 16, v29
  v_mul_u32_u24 v30, 80, v29
  v_sub_u32 v28, v28, v30
  v_lshlrev_b32 v30, 1, v29
  v_xor_b32 v28, v28, v30
  v_mul_u32_u24 v29, 1280, v29
  v_lshl_add_u32 v16, v28, 4, v29
  v_add_u32 v28, 320, v1
  v_mul_u32_u24 v29, 820, v28
  v_lshrrev_b32 v29, 16, v29
  v_mul_u32_u24 v30, 80, v29
  v_sub_u32 v28, v28, v30
  v_lshlrev_b32 v30, 1, v29
  v_xor_b32 v28, v28, v30
  v_mul_u32_u24 v29, 1280, v29
  v_lshl_add_u32 v17, v28, 4, v29
  v_add_u32 v28, 384, v1
  v_mul_u32_u24 v29, 820, v28
  v_lshrrev_b32 v29, 16, v29
  v_mul_u32_u24 v30, 80, v29
  v_sub_u32 v28, v28, v30
  v_lshlrev_b32 v30, 1, v29
  v_xor_b32 v28, v28, v30
  v_mul_u32_u24 v29, 1280, v29
  v_lshl_add_u32 v18, v28, 4, v29
  v_add_u32 v28, 448, v1
  v_mul_u32_u24 v29, 820, v28
  v_lshrrev_b32 v29, 16, v29
  v_mul_u32_u24 v30, 80, v29
  v_sub_u32 v28, v28, v30
  v_lshlrev_b32 v30, 1, v29
  v_xor_b32 v28, v28, v30
  v_mul_u32_u24 v29, 1280, v29
  v_lshl_add_u32 v19, v28, 4, v29
  v_add_u32 v28, 512, v1
  v_mul_u32_u24 v29, 820, v28
  v_lshrrev_b32 v29, 16, v29
  v_mul_u32_u24 v30, 80, v29
  v_sub_u32 v28, v28, v30
  v_lshlrev_b32 v30, 1, v29
  v_xor_b32 v28, v28, v30
  v_mul_u32_u24 v29, 1280, v29
  v_lshl_add_u32 v20, v28, 4, v29
  v_add_u32 v28, 576, v1
  v_mul_u32_u24 v29, 820, v28
  v_lshrrev_b32 v29, 16, v29
  v_mul_u32_u24 v30, 80, v29
  v_sub_u32 v28, v28, v30
  v_lshlrev_b32 v30, 1, v29
  v_xor_b32 v28, v28, v30
  v_mul_u32_u24 v29, 1280, v29
  v_lshl_add_u32 v21, v28, 4, v29
  s_add_u32 s92, s61, 0
  s_mul_i32 s75, s92, 13
  s_lshr_b32 s75, s75, 6
  s_mul_i32 s76, s75, 5
  s_sub_u32 s76, s92, s76
  s_mul_i32 s75, s75, 160
  s_lshl_b32 s77, s76, 5
  s_add_u32 s75, s75, s77
  s_cmp_ge_u32 s76, 3
  s_cselect_b32 s77, 16, 0
  s_sub_u32 s75, s75, s77
  s_cmp_ge_u32 s60, 2
  s_cselect_b32 s77, 64, 0
  s_cmp_eq_u32 s76, 2
  s_cselect_b32 s77, s77, 0
  s_add_u32 s75, s75, s77
  s_min_u32 s76, s92, 46
  s_sub_u32 s76, s76, 20
  s_lshl_b32 s76, s76, 5
  s_mov_b32 s78, 1105920
  s_cmp_lt_u32 s92, 20
  s_cselect_b32 s75, s75, s76
  s_cselect_b32 s8, s40, s50
  s_cselect_b32 s9, s41, s51
  s_cselect_b32 s10, 819200, s78
  s_lshl_b32 s76, s60, 3
  s_add_u32 s75, s75, s76
  s_mul_i32 s84, s75, 1280
  s_mul_i32 s82, s60, 10240
  s_add_u32 m0, s82, 0
  s_nop 0
  buffer_load_dwordx4 v12, s[8:11], s84 offen lds
  s_add_u32 m0, s82, 1024
  s_nop 0
  buffer_load_dwordx4 v13, s[8:11], s84 offen lds
  s_add_u32 m0, s82, 2048
  s_nop 0
  buffer_load_dwordx4 v14, s[8:11], s84 offen lds
  s_add_u32 m0, s82, 3072
  s_nop 0
  buffer_load_dwordx4 v15, s[8:11], s84 offen lds
  s_add_u32 m0, s82, 4096
  s_nop 0
  buffer_load_dwordx4 v16, s[8:11], s84 offen lds
  s_add_u32 m0, s82, 5120
  s_nop 0
  buffer_load_dwordx4 v17, s[8:11], s84 offen lds
  s_add_u32 m0, s82, 6144
  s_nop 0
  buffer_load_dwordx4 v18, s[8:11], s84 offen lds
  s_add_u32 m0, s82, 7168
  s_nop 0
  buffer_load_dwordx4 v19, s[8:11], s84 offen lds
  s_add_u32 m0, s82, 8192
  s_nop 0
  buffer_load_dwordx4 v20, s[8:11], s84 offen lds
  s_add_u32 m0, s82, 9216
  s_nop 0
  buffer_load_dwordx4 v21, s[8:11], s84 offen lds
  s_add_u32 s93, s61, 16
  s_mul_i32 s75, s93, 13
  s_lshr_b32 s75, s75, 6
  s_mul_i32 s76, s75, 5
  s_sub_u32 s76, s93, s76
  s_mul_i32 s75, s75, 160
  s_lshl_b32 s77, s76, 5
  s_add_u32 s75, s75, s77
  s_cmp_ge_u32 s76, 3
  s_cselect_b32 s77, 16, 0
  s_sub_u32 s75, s75, s77
  s_cmp_ge_u32 s60, 2
  s_cselect_b32 s77, 64, 0
  s_cmp_eq_u32 s76, 2
  s_cselect_b32 s77, s77, 0
  s_add_u32 s75, s75, s77
  s_min_u32 s76, s93, 46
  s_sub_u32 s76, s76, 20
  s_lshl_b32 s76, s76, 5
  s_mov_b32 s78, 1105920
  s_cmp_lt_u32 s93, 20
  s_cselect_b32 s75, s75, s76
  s_cselect_b32 s8, s40, s50
  s_cselect_b32 s9, s41, s51
  s_cselect_b32 s10, 819200, s78
  s_lshl_b32 s76, s60, 3
  s_add_u32 s75, s75, s76
  s_mul_i32 s84, s75, 1280
  s_mul_i32 s82, s60, 10240
  s_add_u32 m0, s82, 40960
  s_nop 0
  buffer_load_dwordx4 v12, s[8:11], s84 offen lds
  s_add_u32 m0, s82, 41984
  s_nop 0
  buffer_load_dwordx4 v13, s[8:11], s84 offen lds
  s_add_u32 m0, s82, 43008
  s_nop 0
  buffer_load_dwordx4 v14, s[8:11], s84 offen lds
  s_add_u32 m0, s82, 44032
  s_nop 0
  buffer_load_dwordx4 v15, s[8:11], s84 offen lds
  s_add_u32 m0, s82, 45056
  s_nop 0
  buffer_load_dwordx4 v16, s[8:11], s84 offen lds
  s_add_u32 m0, s82, 46080
  s_nop 0
  buffer_load_dwordx4 v17, s[8:11], s84 offen lds
  s_add_u32 m0, s82, 47104
  s_nop 0
  buffer_load_dwordx4 v18, s[8:11], s84 offen lds
  s_add_u32 m0, s82, 48128
  s_nop 0
  buffer_load_dwordx4 v19, s[8:11], s84 offen lds
  s_add_u32 m0, s82, 49152
  s_nop 0
  buffer_load_dwordx4 v20, s[8:11], s84 offen lds
  s_add_u32 m0, s82, 50176
  s_nop 0
  buffer_load_dwordx4 v21, s[8:11], s84 offen lds
  s_add_u32 s94, s61, 32
  s_mul_i32 s75, s94, 13
  s_lshr_b32 s75, s75, 6
  s_mul_i32 s76, s75, 5
  s_sub_u32 s76, s94, s76
  s_mul_i32 s75, s75, 160
  s_lshl_b32 s77, s76, 5
  s_add_u32 s75, s75, s77
  s_cmp_ge_u32 s76, 3
  s_cselect_b32 s77, 16, 0
  s_sub_u32 s75, s75, s77
  s_cmp_ge_u32 s60, 2
  s_cselect_b32 s77, 64, 0
  s_cmp_eq_u32 s76, 2
  s_cselect_b32 s77, s77, 0
  s_add_u32 s75, s75, s77
  s_min_u32 s76, s94, 46
  s_sub_u32 s76, s76, 20
  s_lshl_b32 s76, s76, 5
  s_mov_b32 s78, 1105920
  s_cmp_lt_u32 s94, 20
  s_cselect_b32 s75, s75, s76
  s_cselect_b32 s8, s40, s50
  s_cselect_b32 s9, s41, s51
  s_cselect_b32 s10, 819200, s78
  s_lshl_b32 s76, s60, 3
  s_add_u32 s75, s75, s76
  s_mul_i32 s84, s75, 1280
  s_mul_i32 s82, s60, 10240
  s_add_u32 m0, s82, 81920
  s_nop 0
  buffer_load_dwordx4 v12, s[8:11], s84 offen lds
  s_add_u32 m0, s82, 82944
  s_nop 0
  buffer_load_dwordx4 v13, s[8:11], s84 offen lds
  s_add_u32 m0, s82, 83968
  s_nop 0
  buffer_load_dwordx4 v14, s[8:11], s84 offen lds
  s_add_u32 m0, s82, 84992
  s_nop 0
  buffer_load_dwordx4 v15, s[8:11], s84 offen lds
  s_add_u32 m0, s82, 86016
  s_nop 0
  buffer_load_dwordx4 v16, s[8:11], s84 offen lds
  s_add_u32 m0, s82, 87040
  s_nop 0
  buffer_load_dwordx4 v17, s[8:11], s84 offen lds
  s_add_u32 m0, s82, 88064
  s_nop 0
  buffer_load_dwordx4 v18, s[8:11], s84 offen lds
  s_add_u32 m0, s82, 89088
  s_nop 0
  buffer_load_dwordx4 v19, s[8:11], s84 offen lds
  s_add_u32 m0, s82, 90112
  s_nop 0
  buffer_load_dwordx4 v20, s[8:11], s84 offen lds
  s_add_u32 m0, s82, 91136
  s_nop 0
  buffer_load_dwordx4 v21, s[8:11], s84 offen lds
  s_lshl_b32 s89, s60, 13
  s_add_u32 s89, s89, 131072
  s_lshl_b32 s52, s64, 18
  s_lshl_b32 s53, s60, 10
  s_add_u32 s52, s52, s53
  s_and_b32 s53, s2, 1
  s_mul_i32 s53, s53, 2
  s_and_b32 s54, s67, 1
  s_mul_i32 s54, s54, 1
  s_xor_b32 s53, s53, s54
  s_lshl_b32 s53, s53, 1
  s_lshl_b32 s54, s64, 0
  s_and_b32 s54, s54, 6
  s_xor_b32 s53, s53, s54
  s_lshl_b32 s95, s53, 11
  s_lshl_b32 s53, s53, 7
  s_add_u32 s52, s52, s53
  s_add_u32 s53, s60, 0
  s_and_b32 s53, s53, 3
  s_lshl_b32 s53, s53, 16
  s_add_u32 s70, s52, s53
  s_add_u32 s53, s60, 1
  s_and_b32 s53, s53, 3
  s_lshl_b32 s53, s53, 16
  s_add_u32 s71, s52, s53
  s_add_u32 s53, s60, 2
  s_and_b32 s53, s53, 3
  s_lshl_b32 s53, s53, 16
  s_add_u32 s72, s52, s53
  s_add_u32 s53, s60, 3
  s_and_b32 s53, s53, 3
  s_lshl_b32 s53, s53, 16
  s_add_u32 s73, s52, s53
  s_lshr_b32 s52, s65, 1
  s_and_b32 s53, s65, 1
  s_mul_i32 s52, s52, 14
  s_mul_i32 s54, s53, 6
  s_add_u32 s85, s52, s54
  s_mul_i32 s52, s60, 16384
  s_add_u32 s52, s52, 196608
  s_mul_i32 s36, s85, 65536
  s_add_u32 s36, s36, s52
  s_mov_b32 s52, s85
  s_lshl_b32 s53, s53, 1
  s_add_u32 s53, s53, s85
  s_add_u32 s53, s53, 5
  s_min_u32 s53, s53, 53
  s_add_u32 s38, s52, 2
  s_add_u32 s39, s53, 2
  s_lshr_b32 s38, s38, 3
  s_lshr_b32 s39, s39, 3
  s_sub_u32 s39, s39, s38
  s_lshl_b32 s39, s39, 11
  s_lshl_b32 s38, s38, 11
  s_lshl_b32 s54, s60, 9
  s_add_u32 s38, s38, s54
  s_add_u32 s38, s38, 19988480
  s_lshr_b32 s52, s52, 3
  s_lshr_b32 s53, s53, 3
  s_lshl_b32 s52, s52, 11
  s_lshl_b32 s53, s53, 11
  s_lshl_b32 s42, s64, 2
  s_add_u32 s42, s42, s60
  s_lshr_b32 s54, s42, 3
  s_lshl_b32 s54, s54, 7
  s_add_u32 s52, s52, s54
  s_add_u32 s53, s53, s54
  s_bfe_u32 s54, s42, 0x20001
  s_lshl_b32 s54, s54, 2
  s_add_u32 s54, s54, 20054016
  s_add_u32 s52, s52, s54
  s_add_u32 s53, s53, s54
  v_and_b32 v252, 15, v1
  s_sub_u32 s53, s53, s52
  v_bfe_u32 v254, v1, 4, 1
  v_mul_u32_u24 v254, s53, v254
  v_add_u32 v254, s52, v254
  s_lshl_b32 s52, s42, 4
  v_add_u32 v252, s52, v252
  v_lshlrev_b32 v250, 3, v252
  v_add_u32 v250, 19660800, v250
  v_lshlrev_b32 v252, 1, v252
  buffer_load_ushort v251, v252, s[24:27], 0 offen
  v_lshlrev_b32 v253, 4, v1
  s_lshr_b32 s52, s85, 1
  s_lshl_b32 s52, s52, 10
  v_add_u32 v248, s52, v253
  s_mul_i32 s87, s42, 27648
  s_add_u32 s87, s87, 4194304
  s_mul_i32 s88, s42, 48128
  s_add_u32 s88, s88, 8409088
  s_mul_i32 s52, s66, 5120
  s_add_u32 s52, s52, 16777216
  s_cmp_eq_u32 s60, 3
  s_cselect_b32 s43, 1073741824, 0
  s_mul_i32 s44, s60, 204800
  s_add_u32 s44, s44, s52
  s_mul_i32 s45, s60, 286720
  s_add_u32 s45, s45, s52
  s_add_u32 s45, s45, 819200
  s_mul_i32 s46, s60, 5120
  s_add_u32 s46, s46, 8388608
  s_lshl_b32 s47, s60, 11
  s_add_u32 s47, s47, 20480
  s_lshr_b32 s48, s64, 1
  s_lshl_b32 s48, s48, 10
  s_and_b32 s52, s64, 1
  s_lshl_b32 s52, s52, 3
  s_add_u32 s48, s48, s52
  s_lshl_b32 s52, s60, 8
  s_add_u32 s48, s48, s52
  s_add_u32 s48, s48, 20185088
  s_lshl_b32 s52, s64, 10
  s_add_u32 s52, s52, 20250624
  s_lshl_b32 s53, s65, 7
  s_lshl_b32 s54, s60, 2
  s_add_u32 s53, s53, s54
  s_add_u32 s49, s52, s53
  s_lshl_b32 s54, s60, 8
  s_add_u32 s55, s52, s54
  s_mul_i32 s54, s67, 1
  s_add_u32 s54, s54, s60
  s_and_b32 s52, s54, 3
  s_lshl_b32 s53, s64, 2
  s_add_u32 s52, s52, s53
  s_mul_i32 s58, s52, 20480
  s_mul_i32 s52, s66, 160
  s_add_u32 s58, s58, s52
  s_and_b32 s52, s64, 7
  s_and_b32 s53, s65, 1
  s_lshl_b32 s53, s53, 3
  s_add_u32 s52, s52, s53
  s_lshl_b32 s52, s52, 1
  s_lshr_b32 s52, 0x0, s52
  s_and_b32 s52, s52, 3
  s_and_b32 s101, s65, 1
  s_add_u32 s101, s101, 3
  s_cmp_eq_u32 s65, 7
  s_cselect_b32 s59, 2, 3
  s_min_u32 s53, s52, s59
  s_lshl_b32 s53, s53, 17
  s_or_b32 s85, s53, s95
  s_add_u32 s52, s52, 1
  s_sub_u32 s53, s52, s101
  s_min_u32 s52, s52, s53
  s_min_u32 s53, s52, s59
  s_lshl_b32 s53, s53, 17
  s_or_b32 s86, s53, s95
  s_add_u32 s52, s52, 1
  s_sub_u32 s53, s52, s101
  s_min_u32 s52, s52, s53
  s_min_u32 s53, s52, s59
  s_lshl_b32 s53, s53, 17
  s_or_b32 s91, s53, s95
  s_add_u32 s52, s52, 1
  s_sub_u32 s53, s52, s101
  s_min_u32 s52, s52, s53
  s_min_u32 s53, s52, s59
  s_lshl_b32 s53, s53, 17
  s_or_b32 s37, s53, s95
  s_add_u32 s52, s52, 1
  s_sub_u32 s53, s52, s101
  s_min_u32 s52, s52, s53
  s_add_u32 s52, s54, 0
  s_and_b32 s52, s52, 3
  s_lshl_b32 s53, s64, 2
  s_add_u32 s52, s52, s53
  s_mul_i32 s52, s52, 48128
  s_add_u32 s40, s52, s46
  s_add_u32 s52, s54, 1
  s_and_b32 s52, s52, 3
  s_lshl_b32 s53, s64, 2
  s_add_u32 s52, s52, s53
  s_mul_i32 s52, s52, 48128
  s_add_u32 s41, s52, s46
  s_add_u32 s52, s54, 2
  s_and_b32 s52, s52, 3
  s_lshl_b32 s53, s64, 2
  s_add_u32 s52, s52, s53
  s_mul_i32 s52, s52, 48128
  s_add_u32 s50, s52, s46
  s_add_u32 s52, s54, 3
  s_and_b32 s52, s52, 3
  s_lshl_b32 s53, s64, 2
  s_add_u32 s52, s52, s53
  s_mul_i32 s52, s52, 48128
  s_add_u32 s51, s52, s46
  s_waitcnt vmcnt(34)
  v_add_u32 v2, 2654435761, v2
  s_nop 0
  v_readfirstlane_b32 s63, v2
  v_mov_b32 v32, 0
  v_mov_b32 v33, 0
  v_mov_b32 v34, 0
  v_mov_b32 v35, 0
  v_lshlrev_b32 v36, 4, v1
  s_cmp_eq_u32 s60, 0
  s_cselect_b32 s76, 0, 1073741824
  v_add_u32 v37, s76, v36
  v_add_u32 v38, s76, v3
  s_mul_i32 s75, s61, 6144
  s_add_u32 s75, s75, 18874368
  s_add_u32 s76, s75, 4096
  buffer_store_dwordx4 v[32:35], v37, s[12:15], s75 offen offset:0 sc1
  buffer_store_dwordx4 v[32:35], v37, s[12:15], s75 offen offset:1024 sc1
  buffer_store_dwordx4 v[32:35], v37, s[12:15], s75 offen offset:2048 sc1
  buffer_store_dwordx4 v[32:35], v37, s[12:15], s75 offen offset:3072 sc1
  buffer_store_dwordx4 v[32:35], v37, s[12:15], s76 offen offset:0 sc1
  buffer_store_dwordx4 v[32:35], v37, s[12:15], s76 offen offset:1024 sc1
  v_and_b32 v28, 15, v1
  v_lshrrev_b32 v29, 4, v1
  v_lshlrev_b32 v30, 4, v28
  s_lshl_b32 s77, s68, 5
  v_add_u32 v29, s77, v29
  v_mul_u32_u24 v31, 1280, v29
  v_add_u32 v31, v31, v30
  buffer_load_dwordx4 v[40:43], v30, s[28:31], 0 offen offset:0
  buffer_load_dwordx4 v[44:47], v30, s[28:31], 0 offen offset:256
  buffer_load_dwordx4 v[48:51], v30, s[28:31], 0 offen offset:512
  buffer_load_dwordx4 v[52:55], v30, s[28:31], 0 offen offset:768
  buffer_load_dwordx4 v[56:59], v30, s[28:31], 0 offen offset:1024
  s_lshl_b32 s77, s61, 7
  s_add_u32 s77, s77, 19922944
  s_waitcnt vmcnt(5)
  buffer_store_dword v2, v38, s[12:15], s77 offen sc1
  s_mov_b32 s77, 0
  buffer_load_dwordx4 v[64:67], v31, s[4:7], s77 offen offset:0
  buffer_load_dwordx4 v[68:71], v31, s[4:7], s77 offen offset:256
  buffer_load_dwordx4 v[72:75], v31, s[4:7], s77 offen offset:512
  buffer_load_dwordx4 v[76:79], v31, s[4:7], s77 offen offset:768
  buffer_load_dwordx4 v[80:83], v31, s[4:7], s77 offen offset:1024
  s_mov_b32 s77, 5120
  buffer_load_dwordx4 v[84:87], v31, s[4:7], s77 offen offset:0
  buffer_load_dwordx4 v[88:91], v31, s[4:7], s77 offen offset:256
  buffer_load_dwordx4 v[92:95], v31, s[4:7], s77 offen offset:512
  buffer_load_dwordx4 v[96:99], v31, s[4:7], s77 offen offset:768
  buffer_load_dwordx4 v[100:103], v31, s[4:7], s77 offen offset:1024
  s_mov_b32 s77, 10240
  buffer_load_dwordx4 v[104:107], v31, s[4:7], s77 offen offset:0
  buffer_load_dwordx4 v[108:111], v31, s[4:7], s77 offen offset:256
  buffer_load_dwordx4 v[112:115], v31, s[4:7], s77 offen offset:512
  buffer_load_dwordx4 v[116:119], v31, s[4:7], s77 offen offset:768
  buffer_load_dwordx4 v[120:123], v31, s[4:7], s77 offen offset:1024
  s_mov_b32 s77, 15360
  buffer_load_dwordx4 v[124:127], v31, s[4:7], s77 offen offset:0
  buffer_load_dwordx4 v[128:131], v31, s[4:7], s77 offen offset:256
  buffer_load_dwordx4 v[132:135], v31, s[4:7], s77 offen offset:512
  buffer_load_dwordx4 v[136:139], v31, s[4:7], s77 offen offset:768
  buffer_load_dwordx4 v[140:143], v31, s[4:7], s77 offen offset:1024
  s_mov_b32 s77, 20480
  buffer_load_dwordx4 v[144:147], v31, s[4:7], s77 offen offset:0
  buffer_load_dwordx4 v[148:151], v31, s[4:7], s77 offen offset:256
  buffer_load_dwordx4 v[152:155], v31, s[4:7], s77 offen offset:512
  buffer_load_dwordx4 v[156:159], v31, s[4:7], s77 offen offset:768
  buffer_load_dwordx4 v[160:163], v31, s[4:7], s77 offen offset:1024
  s_mov_b32 s77, 25600
  buffer_load_dwordx4 v[164:167], v31, s[4:7], s77 offen offset:0
  buffer_load_dwordx4 v[168:171], v31, s[4:7], s77 offen offset:256
  buffer_load_dwordx4 v[172:175], v31, s[4:7], s77 offen offset:512
  buffer_load_dwordx4 v[176:179], v31, s[4:7], s77 offen offset:768
  buffer_load_dwordx4 v[180:183], v31, s[4:7], s77 offen offset:1024
  s_mov_b32 s77, 30720
  buffer_load_dwordx4 v[184:187], v31, s[4:7], s77 offen offset:0
  buffer_load_dwordx4 v[188:191], v31, s[4:7], s77 offen offset:256
  buffer_load_dwordx4 v[192:195], v31, s[4:7], s77 offen offset:512
  buffer_load_dwordx4 v[196:199], v31, s[4:7], s77 offen offset:768
  buffer_load_dwordx4 v[200:203], v31, s[4:7], s77 offen offset:1024
  s_mov_b32 s77, 35840
  buffer_load_dwordx4 v[204:207], v31, s[4:7], s77 offen offset:0
  buffer_load_dwordx4 v[208:211], v31, s[4:7], s77 offen offset:256
  buffer_load_dwordx4 v[212:215], v31, s[4:7], s77 offen offset:512
  buffer_load_dwordx4 v[216:219], v31, s[4:7], s77 offen offset:768
  buffer_load_dwordx4 v[220:223], v31, s[4:7], s77 offen offset:1024
  v_mov_b32 v224, 0
  v_mov_b32 v225, 0
  v_mov_b32 v226, 0
  v_mov_b32 v227, 0
  v_mov_b32 v228, 0
  v_mov_b32 v229, 0
  v_mov_b32 v230, 0
  v_mov_b32 v231, 0
  s_waitcnt vmcnt(39)
  v_dot2_f32_bf16 v224, v64, v40, v224
  s_waitcnt vmcnt(34)
  v_dot2_f32_bf16 v225, v84, v40, v225
  s_waitcnt vmcnt(29)
  v_dot2_f32_bf16 v226, v104, v40, v226
  s_waitcnt vmcnt(24)
  v_dot2_f32_bf16 v227, v124, v40, v227
  s_waitcnt vmcnt(19)
  v_dot2_f32_bf16 v228, v144, v40, v228
  s_waitcnt vmcnt(14)
  v_dot2_f32_bf16 v229, v164, v40, v229
  s_waitcnt vmcnt(9)
  v_dot2_f32_bf16 v230, v184, v40, v230
  s_waitcnt vmcnt(4)
  v_dot2_f32_bf16 v231, v204, v40, v231
  v_dot2_f32_bf16 v224, v65, v41, v224
  v_dot2_f32_bf16 v225, v85, v41, v225
  v_dot2_f32_bf16 v226, v105, v41, v226
  v_dot2_f32_bf16 v227, v125, v41, v227
  v_dot2_f32_bf16 v228, v145, v41, v228
  v_dot2_f32_bf16 v229, v165, v41, v229
  v_dot2_f32_bf16 v230, v185, v41, v230
  v_dot2_f32_bf16 v231, v205, v41, v231
  v_dot2_f32_bf16 v224, v66, v42, v224
  v_dot2_f32_bf16 v225, v86, v42, v225
  v_dot2_f32_bf16 v226, v106, v42, v226
  v_dot2_f32_bf16 v227, v126, v42, v227
  v_dot2_f32_bf16 v228, v146, v42, v228
  v_dot2_f32_bf16 v229, v166, v42, v229
  v_dot2_f32_bf16 v230, v186, v42, v230
  v_dot2_f32_bf16 v231, v206, v42, v231
  v_dot2_f32_bf16 v224, v67, v43, v224
  v_dot2_f32_bf16 v225, v87, v43, v225
  v_dot2_f32_bf16 v226, v107, v43, v226
  v_dot2_f32_bf16 v227, v127, v43, v227
  v_dot2_f32_bf16 v228, v147, v43, v228
  v_dot2_f32_bf16 v229, v167, v43, v229
  v_dot2_f32_bf16 v230, v187, v43, v230
  v_dot2_f32_bf16 v231, v207, v43, v231
  v_dot2_f32_bf16 v224, v68, v44, v224
  v_dot2_f32_bf16 v225, v88, v44, v225
  v_dot2_f32_bf16 v226, v108, v44, v226
  v_dot2_f32_bf16 v227, v128, v44, v227
  v_dot2_f32_bf16 v228, v148, v44, v228
  v_dot2_f32_bf16 v229, v168, v44, v229
  v_dot2_f32_bf16 v230, v188, v44, v230
  s_waitcnt vmcnt(3)
  v_dot2_f32_bf16 v231, v208, v44, v231
  v_dot2_f32_bf16 v224, v69, v45, v224
  v_dot2_f32_bf16 v225, v89, v45, v225
  v_dot2_f32_bf16 v226, v109, v45, v226
  v_dot2_f32_bf16 v227, v129, v45, v227
  v_dot2_f32_bf16 v228, v149, v45, v228
  v_dot2_f32_bf16 v229, v169, v45, v229
  v_dot2_f32_bf16 v230, v189, v45, v230
  v_dot2_f32_bf16 v231, v209, v45, v231
  v_dot2_f32_bf16 v224, v70, v46, v224
  v_dot2_f32_bf16 v225, v90, v46, v225
  v_dot2_f32_bf16 v226, v110, v46, v226
  v_dot2_f32_bf16 v227, v130, v46, v227
  v_dot2_f32_bf16 v228, v150, v46, v228
  v_dot2_f32_bf16 v229, v170, v46, v229
  v_dot2_f32_bf16 v230, v190, v46, v230
  v_dot2_f32_bf16 v231, v210, v46, v231
  v_dot2_f32_bf16 v224, v71, v47, v224
  v_dot2_f32_bf16 v225, v91, v47, v225
  v_dot2_f32_bf16 v226, v111, v47, v226
  v_dot2_f32_bf16 v227, v131, v47, v227
  v_dot2_f32_bf16 v228, v151, v47, v228
  v_dot2_f32_bf16 v229, v171, v47, v229
  v_dot2_f32_bf16 v230, v191, v47, v230
  v_dot2_f32_bf16 v231, v211, v47, v231
  v_dot2_f32_bf16 v224, v72, v48, v224
  v_dot2_f32_bf16 v225, v92, v48, v225
  v_dot2_f32_bf16 v226, v112, v48, v226
  v_dot2_f32_bf16 v227, v132, v48, v227
  v_dot2_f32_bf16 v228, v152, v48, v228
  v_dot2_f32_bf16 v229, v172, v48, v229
  v_dot2_f32_bf16 v230, v192, v48, v230
  s_waitcnt vmcnt(2)
  v_dot2_f32_bf16 v231, v212, v48, v231
  v_dot2_f32_bf16 v224, v73, v49, v224
  v_dot2_f32_bf16 v225, v93, v49, v225
  v_dot2_f32_bf16 v226, v113, v49, v226
  v_dot2_f32_bf16 v227, v133, v49, v227
  v_dot2_f32_bf16 v228, v153, v49, v228
  v_dot2_f32_bf16 v229, v173, v49, v229
  v_dot2_f32_bf16 v230, v193, v49, v230
  v_dot2_f32_bf16 v231, v213, v49, v231
  v_dot2_f32_bf16 v224, v74, v50, v224
  v_dot2_f32_bf16 v225, v94, v50, v225
  v_dot2_f32_bf16 v226, v114, v50, v226
  v_dot2_f32_bf16 v227, v134, v50, v227
  v_dot2_f32_bf16 v228, v154, v50, v228
  v_dot2_f32_bf16 v229, v174, v50, v229
  v_dot2_f32_bf16 v230, v194, v50, v230
  v_dot2_f32_bf16 v231, v214, v50, v231
  v_dot2_f32_bf16 v224, v75, v51, v224
  v_dot2_f32_bf16 v225, v95, v51, v225
  v_dot2_f32_bf16 v226, v115, v51, v226
  v_dot2_f32_bf16 v227, v135, v51, v227
  v_dot2_f32_bf16 v228, v155, v51, v228
  v_dot2_f32_bf16 v229, v175, v51, v229
  v_dot2_f32_bf16 v230, v195, v51, v230
  v_dot2_f32_bf16 v231, v215, v51, v231
  v_dot2_f32_bf16 v224, v76, v52, v224
  v_dot2_f32_bf16 v225, v96, v52, v225
  v_dot2_f32_bf16 v226, v116, v52, v226
  v_dot2_f32_bf16 v227, v136, v52, v227
  v_dot2_f32_bf16 v228, v156, v52, v228
  v_dot2_f32_bf16 v229, v176, v52, v229
  v_dot2_f32_bf16 v230, v196, v52, v230
  s_waitcnt vmcnt(1)
  v_dot2_f32_bf16 v231, v216, v52, v231
  v_dot2_f32_bf16 v224, v77, v53, v224
  v_dot2_f32_bf16 v225, v97, v53, v225
  v_dot2_f32_bf16 v226, v117, v53, v226
  v_dot2_f32_bf16 v227, v137, v53, v227
  v_dot2_f32_bf16 v228, v157, v53, v228
  v_dot2_f32_bf16 v229, v177, v53, v229
  v_dot2_f32_bf16 v230, v197, v53, v230
  v_dot2_f32_bf16 v231, v217, v53, v231
  v_dot2_f32_bf16 v224, v78, v54, v224
  v_dot2_f32_bf16 v225, v98, v54, v225
  v_dot2_f32_bf16 v226, v118, v54, v226
  v_dot2_f32_bf16 v227, v138, v54, v227
  v_dot2_f32_bf16 v228, v158, v54, v228
  v_dot2_f32_bf16 v229, v178, v54, v229
  v_dot2_f32_bf16 v230, v198, v54, v230
  v_dot2_f32_bf16 v231, v218, v54, v231
  v_dot2_f32_bf16 v224, v79, v55, v224
  v_dot2_f32_bf16 v225, v99, v55, v225
  v_dot2_f32_bf16 v226, v119, v55, v226
  v_dot2_f32_bf16 v227, v139, v55, v227
  v_dot2_f32_bf16 v228, v159, v55, v228
  v_dot2_f32_bf16 v229, v179, v55, v229
  v_dot2_f32_bf16 v230, v199, v55, v230
  v_dot2_f32_bf16 v231, v219, v55, v231
  v_dot2_f32_bf16 v224, v80, v56, v224
  v_dot2_f32_bf16 v225, v100, v56, v225
  v_dot2_f32_bf16 v226, v120, v56, v226
  v_dot2_f32_bf16 v227, v140, v56, v227
  v_dot2_f32_bf16 v228, v160, v56, v228
  v_dot2_f32_bf16 v229, v180, v56, v229
  v_dot2_f32_bf16 v230, v200, v56, v230
  s_waitcnt vmcnt(0)
  v_dot2_f32_bf16 v231, v220, v56, v231
  v_dot2_f32_bf16 v224, v81, v57, v224
  v_dot2_f32_bf16 v225, v101, v57, v225
  v_dot2_f32_bf16 v226, v121, v57, v226
  v_dot2_f32_bf16 v227, v141, v57, v227
  v_dot2_f32_bf16 v228, v161, v57, v228
  v_dot2_f32_bf16 v229, v181, v57, v229
  v_dot2_f32_bf16 v230, v201, v57, v230
  v_dot2_f32_bf16 v231, v221, v57, v231
  v_dot2_f32_bf16 v224, v82, v58, v224
  v_dot2_f32_bf16 v225, v102, v58, v225
  v_dot2_f32_bf16 v226, v122, v58, v226
  v_dot2_f32_bf16 v227, v142, v58, v227
  v_dot2_f32_bf16 v228, v162, v58, v228
  v_dot2_f32_bf16 v229, v182, v58, v229
  v_dot2_f32_bf16 v230, v202, v58, v230
  v_dot2_f32_bf16 v231, v222, v58, v231
  v_dot2_f32_bf16 v224, v83, v59, v224
  v_dot2_f32_bf16 v225, v103, v59, v225
  v_dot2_f32_bf16 v226, v123, v59, v226
  v_dot2_f32_bf16 v227, v143, v59, v227
  v_dot2_f32_bf16 v228, v163, v59, v228
  v_dot2_f32_bf16 v229, v183, v59, v229
  v_dot2_f32_bf16 v230, v203, v59, v230
  v_dot2_f32_bf16 v231, v223, v59, v231
  v_add_f32_dpp v224, v224, v224 row_ror:8 row_mask:0xf bank_mask:0xf
  v_add_f32_dpp v225, v225, v225 row_ror:8 row_mask:0xf bank_mask:0xf
  v_add_f32_dpp v226, v226, v226 row_ror:8 row_mask:0xf bank_mask:0xf
  v_add_f32_dpp v227, v227, v227 row_ror:8 row_mask:0xf bank_mask:0xf
  v_add_f32_dpp v228, v228, v228 row_ror:8 row_mask:0xf bank_mask:0xf
  v_add_f32_dpp v229, v229, v229 row_ror:8 row_mask:0xf bank_mask:0xf
  v_add_f32_dpp v230, v230, v230 row_ror:8 row_mask:0xf bank_mask:0xf
  v_add_f32_dpp v231, v231, v231 row_ror:8 row_mask:0xf bank_mask:0xf
  v_add_f32_dpp v224, v224, v224 row_ror:4 row_mask:0xf bank_mask:0xf
  v_add_f32_dpp v225, v225, v225 row_ror:4 row_mask:0xf bank_mask:0xf
  v_add_f32_dpp v226, v226, v226 row_ror:4 row_mask:0xf bank_mask:0xf
  v_add_f32_dpp v227, v227, v227 row_ror:4 row_mask:0xf bank_mask:0xf
  v_add_f32_dpp v228, v228, v228 row_ror:4 row_mask:0xf bank_mask:0xf
  v_add_f32_dpp v229, v229, v229 row_ror:4 row_mask:0xf bank_mask:0xf
  v_add_f32_dpp v230, v230, v230 row_ror:4 row_mask:0xf bank_mask:0xf
  v_add_f32_dpp v231, v231, v231 row_ror:4 row_mask:0xf bank_mask:0xf
  v_add_f32_dpp v224, v224, v224 row_ror:2 row_mask:0xf bank_mask:0xf
  v_add_f32_dpp v225, v225, v225 row_ror:2 row_mask:0xf bank_mask:0xf
  v_add_f32_dpp v226, v226, v226 row_ror:2 row_mask:0xf bank_mask:0xf
  v_add_f32_dpp v227, v227, v227 row_ror:2 row_mask:0xf bank_mask:0xf
  v_add_f32_dpp v228, v228, v228 row_ror:2 row_mask:0xf bank_mask:0xf
  v_add_f32_dpp v229, v229, v229 row_ror:2 row_mask:0xf bank_mask:0xf
  v_add_f32_dpp v230, v230, v230 row_ror:2 row_mask:0xf bank_mask:0xf
  v_add_f32_dpp v231, v231, v231 row_ror:2 row_mask:0xf bank_mask:0xf
  v_add_f32_dpp v224, v224, v224 row_ror:1 row_mask:0xf bank_mask:0xf
  v_add_f32_dpp v225, v225, v225 row_ror:1 row_mask:0xf bank_mask:0xf
  v_add_f32_dpp v226, v226, v226 row_ror:1 row_mask:0xf bank_mask:0xf
  v_add_f32_dpp v227, v227, v227 row_ror:1 row_mask:0xf bank_mask:0xf
  v_add_f32_dpp v228, v228, v228 row_ror:1 row_mask:0xf bank_mask:0xf
  v_add_f32_dpp v229, v229, v229 row_ror:1 row_mask:0xf bank_mask:0xf
  v_add_f32_dpp v230, v230, v230 row_ror:1 row_mask:0xf bank_mask:0xf
  v_add_f32_dpp v231, v231, v231 row_ror:1 row_mask:0xf bank_mask:0xf
  v_mul_f32 v224, 0xbfb8aa3b, v224
  v_mul_f32 v225, 0xbfb8aa3b, v225
  v_mul_f32 v226, 0xbfb8aa3b, v226
  v_mul_f32 v227, 0xbfb8aa3b, v227
  v_mul_f32 v228, 0xbfb8aa3b, v228
  v_mul_f32 v229, 0xbfb8aa3b, v229
  v_mul_f32 v230, 0xbfb8aa3b, v230
  v_mul_f32 v231, 0xbfb8aa3b, v231
  v_exp_f32 v224, v224
  v_exp_f32 v225, v225
  v_exp_f32 v226, v226
  v_exp_f32 v227, v227
  v_exp_f32 v228, v228
  v_exp_f32 v229, v229
  v_exp_f32 v230, v230
  v_exp_f32 v231, v231
  v_add_f32 v224, 1.0, v224
  v_add_f32 v225, 1.0, v225
  v_add_f32 v226, 1.0, v226
  v_add_f32 v227, 1.0, v227
  v_add_f32 v228, 1.0, v228
  v_add_f32 v229, 1.0, v229
  v_add_f32 v230, 1.0, v230
  v_add_f32 v231, 1.0, v231
  v_rcp_f32 v64, v224
  v_mov_b32 v65, v2
  v_rcp_f32 v66, v225
  v_mov_b32 v67, v2
  v_rcp_f32 v68, v226
  v_mov_b32 v69, v2
  v_rcp_f32 v70, v227
  v_mov_b32 v71, v2
  v_rcp_f32 v72, v228
  v_mov_b32 v73, v2
  v_rcp_f32 v74, v229
  v_mov_b32 v75, v2
  v_rcp_f32 v76, v230
  v_mov_b32 v77, v2
  v_rcp_f32 v78, v231
  v_mov_b32 v79, v2
  v_lshlrev_b32 v29, 3, v29
  v_add_u32 v29, 19660800, v29
  v_mov_b32 v30, 1073741824
  v_cmp_eq_u32 vcc, 0, v28
  s_nop 1
  v_cndmask_b32 v29, v30, v29, vcc
  buffer_store_dwordx2 v[64:65], v29, s[12:15], 0 offen offset:0 sc1
  buffer_store_dwordx2 v[66:67], v29, s[12:15], 0 offen offset:32 sc1
  buffer_store_dwordx2 v[68:69], v29, s[12:15], 0 offen offset:64 sc1
  buffer_store_dwordx2 v[70:71], v29, s[12:15], 0 offen offset:96 sc1
  buffer_store_dwordx2 v[72:73], v29, s[12:15], 0 offen offset:128 sc1
  buffer_store_dwordx2 v[74:75], v29, s[12:15], 0 offen offset:160 sc1
  buffer_store_dwordx2 v[76:77], v29, s[12:15], 0 offen offset:192 sc1
  buffer_store_dwordx2 v[78:79], v29, s[12:15], 0 offen offset:224 sc1
  v_lshrrev_b32 v39, 3, v0
  v_lshlrev_b32 v39, 8, v39
  v_add_u32 v39, s2, v39
  v_lshlrev_b32 v39, 4, v39
  v_and_b32 v39, 0xffffff80, v39
  v_min_u32 v39, L_code_end-L_pc-4, v39
  global_load_dword v39, v39, s[32:33]
  s_barrier
  v_lshrrev_b32 v28, 2, v1
  v_and_b32 v29, 7, v28
  v_lshlrev_b32 v29, 5, v29
  v_mul_u32_u24 v28, 1280, v28
  v_and_b32 v30, 3, v1
  v_lshl_add_u32 v28, v30, 3, v28
  v_add_u32 v28, v28, v29
  s_mul_i32 s75, s60, 10
  s_add_u32 s76, s75, 0
  s_and_b32 s77, s76, 7
  s_lshl_b32 s77, s77, 5
  s_lshr_b32 s76, s76, 3
  s_lshl_b32 s76, s76, 8
  v_xor_b32 v12, s77, v28
  v_add_u32 v12, s76, v12
  s_add_u32 s76, s75, 1
  s_and_b32 s77, s76, 7
  s_lshl_b32 s77, s77, 5
  s_lshr_b32 s76, s76, 3
  s_lshl_b32 s76, s76, 8
  v_xor_b32 v13, s77, v28
  v_add_u32 v13, s76, v13
  s_add_u32 s76, s75, 2
  s_and_b32 s77, s76, 7
  s_lshl_b32 s77, s77, 5
  s_lshr_b32 s76, s76, 3
  s_lshl_b32 s76, s76, 8
  v_xor_b32 v14, s77, v28
  v_add_u32 v14, s76, v14
  s_add_u32 s76, s75, 3
  s_and_b32 s77, s76, 7
  s_lshl_b32 s77, s77, 5
  s_lshr_b32 s76, s76, 3
  s_lshl_b32 s76, s76, 8
  v_xor_b32 v15, s77, v28
  v_add_u32 v15, s76, v15
  s_add_u32 s76, s75, 4
  s_and_b32 s77, s76, 7
  s_lshl_b32 s77, s77, 5
  s_lshr_b32 s76, s76, 3
  s_lshl_b32 s76, s76, 8
  v_xor_b32 v16, s77, v28
  v_add_u32 v16, s76, v16
  s_add_u32 s76, s75, 5
  s_and_b32 s77, s76, 7
  s_lshl_b32 s77, s77, 5
  s_lshr_b32 s76, s76, 3
  s_lshl_b32 s76, s76, 8
  v_xor_b32 v17, s77, v28
  v_add_u32 v17, s76, v17
  s_add_u32 s76, s75, 6
  s_and_b32 s77, s76, 7
  s_lshl_b32 s77, s77, 5
  s_lshr_b32 s76, s76, 3
  s_lshl_b32 s76, s76, 8
  v_xor_b32 v18, s77, v28
  v_add_u32 v18, s76, v18
  s_add_u32 s76, s75, 7
  s_and_b32 s77, s76, 7
  s_lshl_b32 s77, s77, 5
  s_lshr_b32 s76, s76, 3
  s_lshl_b32 s76, s76, 8
  v_xor_b32 v19, s77, v28
  v_add_u32 v19, s76, v19
  s_add_u32 s76, s75, 8
  s_and_b32 s77, s76, 7
  s_lshl_b32 s77, s77, 5
  s_lshr_b32 s76, s76, 3
  s_lshl_b32 s76, s76, 8
  v_xor_b32 v20, s77, v28
  v_add_u32 v20, s76, v20
  s_add_u32 s76, s75, 9
  s_and_b32 s77, s76, 7
  s_lshl_b32 s77, s77, 5
  s_lshr_b32 s76, s76, 3
  s_lshl_b32 s76, s76, 8
  v_xor_b32 v21, s77, v28
  v_add_u32 v21, s76, v21
  ds_read_b64_tr_b16 v[96:97], v12 offset:0
  ds_read_b64_tr_b16 v[98:99], v12 offset:20480
  ds_read_b64_tr_b16 v[100:101], v13 offset:0
  ds_read_b64_tr_b16 v[102:103], v13 offset:20480
  ds_read_b64_tr_b16 v[104:105], v14 offset:0
  ds_read_b64_tr_b16 v[106:107], v14 offset:20480
  ds_read_b64_tr_b16 v[108:109], v15 offset:0
  ds_read_b64_tr_b16 v[110:111], v15 offset:20480
  ds_read_b64_tr_b16 v[112:113], v16 offset:0
  ds_read_b64_tr_b16 v[114:115], v16 offset:20480
  ds_read_b64_tr_b16 v[116:117], v17 offset:0
  ds_read_b64_tr_b16 v[118:119], v17 offset:20480
  ds_read_b64_tr_b16 v[120:121], v18 offset:0
  ds_read_b64_tr_b16 v[122:123], v18 offset:20480
  ds_read_b64_tr_b16 v[124:125], v19 offset:0
  ds_read_b64_tr_b16 v[126:127], v19 offset:20480
  ds_read_b64_tr_b16 v[128:129], v20 offset:0
  ds_read_b64_tr_b16 v[130:131], v20 offset:20480
  ds_read_b64_tr_b16 v[132:133], v21 offset:0
  ds_read_b64_tr_b16 v[134:135], v21 offset:20480
  s_mul_i32 s76, s92, 40
  s_add_u32 s76, s76, s75
  s_lshl_b32 s76, s76, 10
  s_add_u32 s76, s76, 16777216
  s_cmp_lt_u32 s92, 47
  s_cselect_b32 s77, 0, 1073741824
  v_add_u32 v37, s77, v36
  s_waitcnt lgkmcnt(15)
  buffer_store_dwordx4 v[96:99], v37, s[12:15], s76 offen offset:0 sc1
  buffer_store_dwordx4 v[100:103], v37, s[12:15], s76 offen offset:1024 sc1
  s_waitcnt lgkmcnt(14)
  buffer_store_dwordx4 v[104:107], v37, s[12:15], s76 offen offset:2048 sc1
  s_waitcnt lgkmcnt(12)
  buffer_store_dwordx4 v[108:111], v37, s[12:15], s76 offen offset:3072 sc1
  s_add_u32 s76, s76, 4096
  s_waitcnt lgkmcnt(10)
  buffer_store_dwordx4 v[112:115], v37, s[12:15], s76 offen offset:0 sc1
  s_waitcnt lgkmcnt(8)
  buffer_store_dwordx4 v[116:119], v37, s[12:15], s76 offen offset:1024 sc1
  s_waitcnt lgkmcnt(6)
  buffer_store_dwordx4 v[120:123], v37, s[12:15], s76 offen offset:2048 sc1
  s_waitcnt lgkmcnt(4)
  buffer_store_dwordx4 v[124:127], v37, s[12:15], s76 offen offset:3072 sc1
  s_add_u32 s76, s76, 4096
  s_waitcnt lgkmcnt(2)
  buffer_store_dwordx4 v[128:131], v37, s[12:15], s76 offen offset:0 sc1
  s_waitcnt lgkmcnt(0)
  buffer_store_dwordx4 v[132:135], v37, s[12:15], s76 offen offset:1024 sc1
  ds_read_b64_tr_b16 v[136:137], v12 offset:40960
  ds_read_b64_tr_b16 v[138:139], v12 offset:61440
  v_add_u32 v12, 81920, v12
  ds_read_b64_tr_b16 v[140:141], v13 offset:40960
  ds_read_b64_tr_b16 v[142:143], v13 offset:61440
  v_add_u32 v13, 81920, v13
  ds_read_b64_tr_b16 v[144:145], v14 offset:40960
  ds_read_b64_tr_b16 v[146:147], v14 offset:61440
  v_add_u32 v14, 81920, v14
  ds_read_b64_tr_b16 v[148:149], v15 offset:40960
  ds_read_b64_tr_b16 v[150:151], v15 offset:61440
  v_add_u32 v15, 81920, v15
  ds_read_b64_tr_b16 v[152:153], v16 offset:40960
  ds_read_b64_tr_b16 v[154:155], v16 offset:61440
  v_add_u32 v16, 81920, v16
  ds_read_b64_tr_b16 v[156:157], v17 offset:40960
  ds_read_b64_tr_b16 v[158:159], v17 offset:61440
  v_add_u32 v17, 81920, v17
  ds_read_b64_tr_b16 v[160:161], v18 offset:40960
  ds_read_b64_tr_b16 v[162:163], v18 offset:61440
  v_add_u32 v18, 81920, v18
  ds_read_b64_tr_b16 v[164:165], v19 offset:40960
  ds_read_b64_tr_b16 v[166:167], v19 offset:61440
  v_add_u32 v19, 81920, v19
  ds_read_b64_tr_b16 v[168:169], v20 offset:40960
  ds_read_b64_tr_b16 v[170:171], v20 offset:61440
  v_add_u32 v20, 81920, v20
  ds_read_b64_tr_b16 v[172:173], v21 offset:40960
  ds_read_b64_tr_b16 v[174:175], v21 offset:61440
  v_add_u32 v21, 81920, v21
  s_mul_i32 s76, s93, 40
  s_add_u32 s76, s76, s75
  s_lshl_b32 s76, s76, 10
  s_add_u32 s76, s76, 16777216
  s_cmp_lt_u32 s93, 47
  s_cselect_b32 s77, 0, 1073741824
  v_add_u32 v37, s77, v36
  s_waitcnt lgkmcnt(15)
  buffer_store_dwordx4 v[136:139], v37, s[12:15], s76 offen offset:0 sc1
  buffer_store_dwordx4 v[140:143], v37, s[12:15], s76 offen offset:1024 sc1
  s_waitcnt lgkmcnt(14)
  buffer_store_dwordx4 v[144:147], v37, s[12:15], s76 offen offset:2048 sc1
  s_waitcnt lgkmcnt(12)
  buffer_store_dwordx4 v[148:151], v37, s[12:15], s76 offen offset:3072 sc1
  s_add_u32 s76, s76, 4096
  s_waitcnt lgkmcnt(10)
  buffer_store_dwordx4 v[152:155], v37, s[12:15], s76 offen offset:0 sc1
  s_waitcnt lgkmcnt(8)
  buffer_store_dwordx4 v[156:159], v37, s[12:15], s76 offen offset:1024 sc1
  s_waitcnt lgkmcnt(6)
  buffer_store_dwordx4 v[160:163], v37, s[12:15], s76 offen offset:2048 sc1
  s_waitcnt lgkmcnt(4)
  buffer_store_dwordx4 v[164:167], v37, s[12:15], s76 offen offset:3072 sc1
  s_add_u32 s76, s76, 4096
  s_waitcnt lgkmcnt(2)
  buffer_store_dwordx4 v[168:171], v37, s[12:15], s76 offen offset:0 sc1
  s_waitcnt lgkmcnt(0)
  buffer_store_dwordx4 v[172:175], v37, s[12:15], s76 offen offset:1024 sc1
  ds_read_b64_tr_b16 v[176:177], v12 offset:0
  ds_read_b64_tr_b16 v[178:179], v12 offset:20480
  ds_read_b64_tr_b16 v[180:181], v13 offset:0
  ds_read_b64_tr_b16 v[182:183], v13 offset:20480
  ds_read_b64_tr_b16 v[184:185], v14 offset:0
  ds_read_b64_tr_b16 v[186:187], v14 offset:20480
  ds_read_b64_tr_b16 v[188:189], v15 offset:0
  ds_read_b64_tr_b16 v[190:191], v15 offset:20480
  ds_read_b64_tr_b16 v[192:193], v16 offset:0
  ds_read_b64_tr_b16 v[194:195], v16 offset:20480
  ds_read_b64_tr_b16 v[196:197], v17 offset:0
  ds_read_b64_tr_b16 v[198:199], v17 offset:20480
  ds_read_b64_tr_b16 v[200:201], v18 offset:0
  ds_read_b64_tr_b16 v[202:203], v18 offset:20480
  ds_read_b64_tr_b16 v[204:205], v19 offset:0
  ds_read_b64_tr_b16 v[206:207], v19 offset:20480
  ds_read_b64_tr_b16 v[208:209], v20 offset:0
  ds_read_b64_tr_b16 v[210:211], v20 offset:20480
  ds_read_b64_tr_b16 v[212:213], v21 offset:0
  ds_read_b64_tr_b16 v[214:215], v21 offset:20480
  s_mul_i32 s76, s94, 40
  s_add_u32 s76, s76, s75
  s_lshl_b32 s76, s76, 10
  s_add_u32 s76, s76, 16777216
  s_cmp_lt_u32 s94, 47
  s_cselect_b32 s77, 0, 1073741824
  v_add_u32 v37, s77, v36
  s_waitcnt lgkmcnt(15)
  buffer_store_dwordx4 v[176:179], v37, s[12:15], s76 offen offset:0 sc1
  buffer_store_dwordx4 v[180:183], v37, s[12:15], s76 offen offset:1024 sc1
  s_waitcnt lgkmcnt(14)
  buffer_store_dwordx4 v[184:187], v37, s[12:15], s76 offen offset:2048 sc1
  s_waitcnt lgkmcnt(12)
  buffer_store_dwordx4 v[188:191], v37, s[12:15], s76 offen offset:3072 sc1
  s_add_u32 s76, s76, 4096
  s_waitcnt lgkmcnt(10)
  buffer_store_dwordx4 v[192:195], v37, s[12:15], s76 offen offset:0 sc1
  s_waitcnt lgkmcnt(8)
  buffer_store_dwordx4 v[196:199], v37, s[12:15], s76 offen offset:1024 sc1
  s_waitcnt lgkmcnt(6)
  buffer_store_dwordx4 v[200:203], v37, s[12:15], s76 offen offset:2048 sc1
  s_waitcnt lgkmcnt(4)
  buffer_store_dwordx4 v[204:207], v37, s[12:15], s76 offen offset:3072 sc1
  s_add_u32 s76, s76, 4096
  s_waitcnt lgkmcnt(2)
  buffer_store_dwordx4 v[208:211], v37, s[12:15], s76 offen offset:0 sc1
  s_waitcnt lgkmcnt(0)
  buffer_store_dwordx4 v[212:215], v37, s[12:15], s76 offen offset:1024 sc1
  s_waitcnt vmcnt(0)
  s_waitcnt lgkmcnt(0)
  s_barrier
  s_lshl_b32 s90, s61, 7
  s_add_u32 s90, s90, 19927040
  buffer_store_dword v2, v38, s[12:15], s90 offen sc1
  s_add_u32 s90, s90, 0x2000
  v_lshrrev_b32 v39, 3, v0
  v_lshlrev_b32 v39, 8, v39
  v_add_u32 v39, s2, v39
  v_lshlrev_b32 v39, 4, v39
  v_and_b32 v39, 0xffffff80, v39
  v_min_u32 v39, L_code_end-L_pc-4, v39
  global_load_dword v39, v39, s[32:33]
  v_lshrrev_b32 v4, 3, v1
  v_and_b32 v5, 7, v1
  v_lshrrev_b32 v6, 4, v1
  v_xor_b32 v5, v5, v6
  v_lshlrev_b32 v5, 4, v5
  v_lshl_add_u32 v4, v4, 12, v5
  v_xor_b32 v5, 64, v4
  v_add_u32 v5, 31744, v5
  v_and_b32 v10, 15, v1
  v_lshrrev_b32 v11, 1, v10
  v_lshrrev_b32 v6, 4, v1
  v_xor_b32 v11, v11, v6
  v_lshlrev_b32 v11, 4, v11
  v_lshl_add_u32 v10, v10, 7, v11
  v_add_u32 v6, s81, v10
  v_xor_b32 v7, 64, v6
  v_add_u32 v8, s89, v10
  v_xor_b32 v9, 64, v8
  s_add_u32 m0, s81, 0
  s_xor_b32 s83, s70, 0
  buffer_load_dwordx4 v4, s[16:19], s83 offen lds
  buffer_load_dwordx4 v5, s[16:19], s83 offen offset:1024 lds
  s_add_u32 m0, s81, 2048
  s_xor_b32 s83, s71, 0
  buffer_load_dwordx4 v4, s[16:19], s83 offen lds
  buffer_load_dwordx4 v5, s[16:19], s83 offen offset:1024 lds
  s_add_u32 m0, s81, 4096
  s_xor_b32 s83, s72, 0
  buffer_load_dwordx4 v4, s[16:19], s83 offen lds
  buffer_load_dwordx4 v5, s[16:19], s83 offen offset:1024 lds
  s_add_u32 m0, s81, 6144
  s_xor_b32 s83, s73, 0
  buffer_load_dwordx4 v4, s[16:19], s83 offen lds
  buffer_load_dwordx4 v5, s[16:19], s83 offen offset:1024 lds
  s_add_u32 m0, s81, 8192
  s_xor_b32 s83, s70, 128
  buffer_load_dwordx4 v4, s[16:19], s83 offen lds
  buffer_load_dwordx4 v5, s[16:19], s83 offen offset:1024 lds
  s_add_u32 m0, s81, 10240
  s_xor_b32 s83, s71, 128
  buffer_load_dwordx4 v4, s[16:19], s83 offen lds
  buffer_load_dwordx4 v5, s[16:19], s83 offen offset:1024 lds
  s_add_u32 m0, s81, 12288
  s_xor_b32 s83, s72, 128
  buffer_load_dwordx4 v4, s[16:19], s83 offen lds
  buffer_load_dwordx4 v5, s[16:19], s83 offen offset:1024 lds
  s_add_u32 m0, s81, 14336
  s_xor_b32 s83, s73, 128
  buffer_load_dwordx4 v4, s[16:19], s83 offen lds
  buffer_load_dwordx4 v5, s[16:19], s83 offen offset:1024 lds
  s_add_u32 m0, s89, 0
  s_xor_b32 s83, s70, 256
  buffer_load_dwordx4 v4, s[16:19], s83 offen lds
  buffer_load_dwordx4 v5, s[16:19], s83 offen offset:1024 lds
  s_add_u32 m0, s89, 2048
  s_xor_b32 s83, s71, 256
  buffer_load_dwordx4 v4, s[16:19], s83 offen lds
  buffer_load_dwordx4 v5, s[16:19], s83 offen offset:1024 lds
  s_add_u32 m0, s89, 4096
  s_xor_b32 s83, s72, 256
  buffer_load_dwordx4 v4, s[16:19], s83 offen lds
  buffer_load_dwordx4 v5, s[16:19], s83 offen offset:1024 lds
  s_add_u32 m0, s89, 6144
  s_xor_b32 s83, s73, 256
  buffer_load_dwordx4 v4, s[16:19], s83 offen lds
  buffer_load_dwordx4 v5, s[16:19], s83 offen offset:1024 lds
  s_waitcnt vmcnt(16)
  ds_read_b128 a[160:163], v6 offset:0
  ds_read_b128 a[176:179], v7 offset:0
  ds_read_b128 a[164:167], v6 offset:2048
  ds_read_b128 a[180:183], v7 offset:2048
  ds_read_b128 a[168:171], v6 offset:4096
  ds_read_b128 a[184:187], v7 offset:4096
  ds_read_b128 a[172:175], v6 offset:6144
  ds_read_b128 a[188:191], v7 offset:6144
  s_waitcnt lgkmcnt(0)
  s_add_u32 m0, s81, 0
  s_xor_b32 s83, s70, 384
  buffer_load_dwordx4 v4, s[16:19], s83 offen lds
  buffer_load_dwordx4 v5, s[16:19], s83 offen offset:1024 lds
  s_add_u32 m0, s81, 2048
  s_xor_b32 s83, s71, 384
  buffer_load_dwordx4 v4, s[16:19], s83 offen lds
  buffer_load_dwordx4 v5, s[16:19], s83 offen offset:1024 lds
  s_add_u32 m0, s81, 4096
  s_xor_b32 s83, s72, 384
  buffer_load_dwordx4 v4, s[16:19], s83 offen lds
  buffer_load_dwordx4 v5, s[16:19], s83 offen offset:1024 lds
  s_add_u32 m0, s81, 6144
  s_xor_b32 s83, s73, 384
  buffer_load_dwordx4 v4, s[16:19], s83 offen lds
  buffer_load_dwordx4 v5, s[16:19], s83 offen offset:1024 lds
  s_waitcnt vmcnt(16)
  ds_read_b128 a[192:195], v6 offset:8192
  ds_read_b128 a[208:211], v7 offset:8192
  ds_read_b128 a[196:199], v6 offset:10240
  ds_read_b128 a[212:215], v7 offset:10240
  ds_read_b128 a[200:203], v6 offset:12288
  ds_read_b128 a[216:219], v7 offset:12288
  ds_read_b128 a[204:207], v6 offset:14336
  ds_read_b128 a[220:223], v7 offset:14336
  s_waitcnt lgkmcnt(0)
  s_add_u32 m0, s81, 8192
  s_xor_b32 s83, s70, 512
  buffer_load_dwordx4 v4, s[16:19], s83 offen lds
  buffer_load_dwordx4 v5, s[16:19], s83 offen offset:1024 lds
  s_add_u32 m0, s81, 10240
  s_xor_b32 s83, s71, 512
  buffer_load_dwordx4 v4, s[16:19], s83 offen lds
  buffer_load_dwordx4 v5, s[16:19], s83 offen offset:1024 lds
  s_add_u32 m0, s81, 12288
  s_xor_b32 s83, s72, 512
  buffer_load_dwordx4 v4, s[16:19], s83 offen lds
  buffer_load_dwordx4 v5, s[16:19], s83 offen offset:1024 lds
  s_add_u32 m0, s81, 14336
  s_xor_b32 s83, s73, 512
  buffer_load_dwordx4 v4, s[16:19], s83 offen lds
  buffer_load_dwordx4 v5, s[16:19], s83 offen offset:1024 lds
  s_waitcnt vmcnt(16)
  ds_read_b128 a[224:227], v8 offset:0
  ds_read_b128 a[240:243], v9 offset:0
  ds_read_b128 a[228:231], v8 offset:2048
  ds_read_b128 a[244:247], v9 offset:2048
  ds_read_b128 a[232:235], v8 offset:4096
  ds_read_b128 a[248:251], v9 offset:4096
  ds_read_b128 a[236:239], v8 offset:6144
  ds_read_b128 a[252:255], v9 offset:6144
  s_waitcnt lgkmcnt(0)
  s_add_u32 m0, s89, 0
  s_xor_b32 s83, s70, 640
  buffer_load_dwordx4 v4, s[16:19], s83 offen lds
  buffer_load_dwordx4 v5, s[16:19], s83 offen offset:1024 lds
  s_add_u32 m0, s89, 2048
  s_xor_b32 s83, s71, 640
  buffer_load_dwordx4 v4, s[16:19], s83 offen lds
  buffer_load_dwordx4 v5, s[16:19], s83 offen offset:1024 lds
  s_add_u32 m0, s89, 4096
  s_xor_b32 s83, s72, 640
  buffer_load_dwordx4 v4, s[16:19], s83 offen lds
  buffer_load_dwordx4 v5, s[16:19], s83 offen offset:1024 lds
  s_add_u32 m0, s89, 6144
  s_xor_b32 s83, s73, 640
  buffer_load_dwordx4 v4, s[16:19], s83 offen lds
  buffer_load_dwordx4 v5, s[16:19], s83 offen offset:1024 lds
  s_waitcnt vmcnt(16)
  ds_read_b128 a[0:3], v6 offset:0
  ds_read_b128 a[16:19], v7 offset:0
  ds_read_b128 a[4:7], v6 offset:2048
  ds_read_b128 a[20:23], v7 offset:2048
  ds_read_b128 a[8:11], v6 offset:4096
  ds_read_b128 a[24:27], v7 offset:4096
  ds_read_b128 a[12:15], v6 offset:6144
  ds_read_b128 a[28:31], v7 offset:6144
  s_waitcnt lgkmcnt(0)
  s_add_u32 m0, s81, 0
  s_xor_b32 s83, s70, 768
  buffer_load_dwordx4 v4, s[16:19], s83 offen lds
  buffer_load_dwordx4 v5, s[16:19], s83 offen offset:1024 lds
  s_add_u32 m0, s81, 2048
  s_xor_b32 s83, s71, 768
  buffer_load_dwordx4 v4, s[16:19], s83 offen lds
  buffer_load_dwordx4 v5, s[16:19], s83 offen offset:1024 lds
  s_add_u32 m0, s81, 4096
  s_xor_b32 s83, s72, 768
  buffer_load_dwordx4 v4, s[16:19], s83 offen lds
  buffer_load_dwordx4 v5, s[16:19], s83 offen offset:1024 lds
  s_add_u32 m0, s81, 6144
  s_xor_b32 s83, s73, 768
  buffer_load_dwordx4 v4, s[16:19], s83 offen lds
  buffer_load_dwordx4 v5, s[16:19], s83 offen offset:1024 lds
  s_waitcnt vmcnt(16)
  ds_read_b128 a[32:35], v6 offset:8192
  ds_read_b128 a[48:51], v7 offset:8192
  ds_read_b128 a[36:39], v6 offset:10240
  ds_read_b128 a[52:55], v7 offset:10240
  ds_read_b128 a[40:43], v6 offset:12288
  ds_read_b128 a[56:59], v7 offset:12288
  ds_read_b128 a[44:47], v6 offset:14336
  ds_read_b128 a[60:63], v7 offset:14336
  s_waitcnt lgkmcnt(0)
  s_add_u32 m0, s81, 8192
  s_xor_b32 s83, s70, 896
  buffer_load_dwordx4 v4, s[16:19], s83 offen lds
  buffer_load_dwordx4 v5, s[16:19], s83 offen offset:1024 lds
  s_add_u32 m0, s81, 10240
  s_xor_b32 s83, s71, 896
  buffer_load_dwordx4 v4, s[16:19], s83 offen lds
  buffer_load_dwordx4 v5, s[16:19], s83 offen offset:1024 lds
  s_add_u32 m0, s81, 12288
  s_xor_b32 s83, s72, 896
  buffer_load_dwordx4 v4, s[16:19], s83 offen lds
  buffer_load_dwordx4 v5, s[16:19], s83 offen offset:1024 lds
  s_add_u32 m0, s81, 14336
  s_xor_b32 s83, s73, 896
  buffer_load_dwordx4 v4, s[16:19], s83 offen lds
  buffer_load_dwordx4 v5, s[16:19], s83 offen offset:1024 lds
  v_lshlrev_b32 v242, 4, v1
  v_add_u32 v242, s36, v242
  s_cmp_eq_u32 s65, 7
  s_cselect_b32 s59, 1073741824, 0
  v_bfe_u32 v243, v1, 4, 1
  v_mul_u32_u24 v243, s39, v243
  v_add_u32 v243, s38, v243
  v_and_b32 v244, 3, v1
  v_lshl_add_u32 v243, v244, 2, v243
  v_bfe_u32 v244, v1, 2, 2
  v_lshl_add_u32 v243, v244, 7, v243
  s_lshl_b32 s52, s60, 9
  s_add_u32 s52, s52, 19927040
  v_bfe_u32 v30, v1, 3, 2
  v_lshl_add_u32 v30, v30, 7, s52
  v_cmp_gt_u32 vcc, 32, v1
  s_nop 1
  v_cndmask_b32 v244, v30, v243, vcc
  buffer_load_dwordx2 v[252:253], v250, s[12:15], 0 offen sc1
  buffer_load_dword v243, v244, s[12:15], 0 offen sc1
  s_waitcnt vmcnt(18)
  ds_read_b128 a[64:67], v8 offset:0
  ds_read_b128 a[80:83], v9 offset:0
  ds_read_b128 a[68:71], v8 offset:2048
  ds_read_b128 a[84:87], v9 offset:2048
  ds_read_b128 a[72:75], v8 offset:4096
  ds_read_b128 a[88:91], v9 offset:4096
  ds_read_b128 a[76:79], v8 offset:6144
  ds_read_b128 a[92:95], v9 offset:6144
  s_waitcnt vmcnt(10)
  ds_read_b128 a[96:99], v6 offset:0
  ds_read_b128 a[112:115], v7 offset:0
  ds_read_b128 a[100:103], v6 offset:2048
  ds_read_b128 a[116:119], v7 offset:2048
  ds_read_b128 a[104:107], v6 offset:4096
  ds_read_b128 a[120:123], v7 offset:4096
  ds_read_b128 a[108:111], v6 offset:6144
  ds_read_b128 a[124:127], v7 offset:6144
  s_waitcnt vmcnt(2)
  ds_read_b128 a[128:131], v6 offset:8192
  ds_read_b128 a[144:147], v7 offset:8192
  ds_read_b128 a[132:135], v6 offset:10240
  ds_read_b128 a[148:151], v7 offset:10240
  ds_read_b128 a[136:139], v6 offset:12288
  ds_read_b128 a[152:155], v7 offset:12288
  ds_read_b128 a[140:143], v6 offset:14336
  ds_read_b128 a[156:159], v7 offset:14336
  v_mov_b32 v240, 1073741824
  v_mov_b32 v241, 1073741824
  s_waitcnt vmcnt(1)
  v_cmp_ne_u32 vcc, s63, v253
  s_cbranch_vccnz L_retry4
L_back4:
  s_waitcnt vmcnt(0)
  v_cmp_ne_u32 vcc, s63, v243
  s_cbranch_vccnz L_retry5
L_back5:
  s_xor_b32 s74, s85, 0
  buffer_load_dwordx4 v[128:131], v242, s[12:15], s74 offen offset:0 sc1
  buffer_load_dwordx4 v[132:135], v242, s[12:15], s74 offen offset:1024 sc1
  buffer_load_dwordx4 v[136:139], v242, s[12:15], s74 offen offset:2048 sc1
  buffer_load_dwordx4 v[140:143], v242, s[12:15], s74 offen offset:3072 sc1
  s_xor_b32 s74, s85, 4096
  buffer_load_dwordx4 v[144:147], v242, s[12:15], s74 offen offset:0 sc1
  buffer_load_dwordx4 v[148:151], v242, s[12:15], s74 offen offset:1024 sc1
  buffer_load_dwordx4 v[152:155], v242, s[12:15], s74 offen offset:2048 sc1
  buffer_load_dwordx4 v[156:159], v242, s[12:15], s74 offen offset:3072 sc1
  s_xor_b32 s74, s85, 8192
  buffer_load_dwordx4 v[160:163], v242, s[12:15], s74 offen offset:0 sc1
  buffer_load_dwordx4 v[164:167], v242, s[12:15], s74 offen offset:1024 sc1
  buffer_load_dwordx4 v[168:171], v242, s[12:15], s74 offen offset:2048 sc1
  buffer_load_dwordx4 v[172:175], v242, s[12:15], s74 offen offset:3072 sc1
  s_xor_b32 s74, s85, 12288
  buffer_load_dwordx4 v[176:179], v242, s[12:15], s74 offen offset:0 sc1
  buffer_load_dwordx4 v[180:183], v242, s[12:15], s74 offen offset:1024 sc1
  buffer_load_dwordx4 v[184:187], v242, s[12:15], s74 offen offset:2048 sc1
  buffer_load_dwordx4 v[188:191], v242, s[12:15], s74 offen offset:3072 sc1
  s_waitcnt lgkmcnt(0)
  s_branch L_cz
L_qkv:
  s_mul_i32 s75, s62, 160
  s_mul_i32 s76, s60, 30720
  s_add_u32 s76, s76, s75
  s_lshl_b32 s82, s60, 12
  s_add_u32 s82, s82, 65536
  s_mul_i32 s84, s80, 245760
  s_sub_u32 s84, s84, 122880
  s_and_b32 s75, s60, 1
  s_lshl_b32 s75, s75, 2
  v_add_u32 v28, 0, v1
  v_mul_u32_u24 v29, 2185, v28
  v_lshrrev_b32 v29, 16, v29
  v_mul_u32_u24 v30, 30, v29
  v_sub_u32 v28, v28, v30
  v_mul_u32_u24 v30, 26, v28
  v_lshrrev_b32 v30, 8, v30
  v_mul_u32_u24 v30, 1120, v30
  v_lshl_add_u32 v28, v28, 4, v30
  v_xor_b32 v29, s75, v29
  v_mul_u32_u24 v29, 3840, v29
  v_add3_u32 v28, v28, v29, s76
  v_subrev_u32 v12, 0, v28
  v_add_u32 v28, 64, v1
  v_mul_u32_u24 v29, 2185, v28
  v_lshrrev_b32 v29, 16, v29
  v_mul_u32_u24 v30, 30, v29
  v_sub_u32 v28, v28, v30
  v_mul_u32_u24 v30, 26, v28
  v_lshrrev_b32 v30, 8, v30
  v_mul_u32_u24 v30, 1120, v30
  v_lshl_add_u32 v28, v28, 4, v30
  v_xor_b32 v29, s75, v29
  v_mul_u32_u24 v29, 3840, v29
  v_add3_u32 v28, v28, v29, s76
  v_subrev_u32 v13, 1024, v28
  v_add_u32 v28, 128, v1
  v_mul_u32_u24 v29, 2185, v28
  v_lshrrev_b32 v29, 16, v29
  v_mul_u32_u24 v30, 30, v29
  v_sub_u32 v28, v28, v30
  v_mul_u32_u24 v30, 26, v28
  v_lshrrev_b32 v30, 8, v30
  v_mul_u32_u24 v30, 1120, v30
  v_lshl_add_u32 v28, v28, 4, v30
  v_xor_b32 v29, s75, v29
  v_mul_u32_u24 v29, 3840, v29
  v_add3_u32 v28, v28, v29, s76
  v_subrev_u32 v14, 2048, v28
  v_add_u32 v28, 192, v1
  v_mul_u32_u24 v29, 2185, v28
  v_lshrrev_b32 v29, 16, v29
  v_mul_u32_u24 v30, 30, v29
  v_sub_u32 v28, v28, v30
  v_mul_u32_u24 v30, 26, v28
  v_lshrrev_b32 v30, 8, v30
  v_mul_u32_u24 v30, 1120, v30
  v_lshl_add_u32 v28, v28, 4, v30
  v_xor_b32 v29, s75, v29
  v_mul_u32_u24 v29, 3840, v29
  v_add3_u32 v28, v28, v29, s76
  v_subrev_u32 v15, 3072, v28
  v_mov_b32 v28, 1073741824
  v_cmp_gt_u32 vcc, 48, v1
  s_nop 1
  v_cndmask_b32 v15, v28, v15, vcc
  s_mov_b32 s10, 2457600
  s_mov_b64 s[8:9], s[38:39]
  s_add_u32 m0, s82, 0
  s_add_u32 s84, s84, 122880
  s_sub_u32 s3, s84, 2457600
  s_min_u32 s84, s84, s3
  buffer_load_dwordx4 v12, s[8:11], s84 offen offset:0 lds
  buffer_load_dwordx4 v13, s[8:11], s84 offen offset:1024 lds
  buffer_load_dwordx4 v14, s[8:11], s84 offen offset:2048 lds
  buffer_load_dwordx4 v15, s[8:11], s84 offen offset:3072 lds
  s_and_b32 s76, s2, 1
  s_lshl3_add_u32 s64, s77, s78
  s_lshl2_add_u32 s66, s76, s67
  s_lshl1_add_u32 s65, s76, s79
  s_lshr_b32 s79, s67, 1
  s_lshl1_add_u32 s65, s65, s79
  v_cmp_eq_u32 vcc, 0, v1
  v_mov_b32 v3, 1073741824
  s_nop 0
  v_cndmask_b32_e64 v3, v3, 0, vcc
  s_mov_b64 s[12:13], s[58:59]
  s_mov_b32 s14, 33554432
  s_mov_b32 s15, 0x20000
  s_mov_b64 s[16:17], s[46:47]
  s_mov_b32 s18, 8388608
  s_mov_b32 s19, 0x20000
  s_mov_b64 s[20:21], s[54:55]
  s_mov_b32 s22, 2621440
  s_mov_b32 s23, 0x20000
  s_mov_b64 s[24:25], s[48:49]
  s_mov_b32 s26, 4096
  s_mov_b32 s27, 0x20000
  s_mov_b64 s[28:29], s[52:53]
  s_mov_b32 s30, 1280
  s_mov_b32 s31, 0x20000
  v_mov_b32 v2, 19931136
  buffer_load_dword v2, v2, s[12:15], 0 offen sc1
  v_and_b32 v30, 15, v1
  v_lshrrev_b32 v31, 1, v30
  v_lshrrev_b32 v8, 4, v1
  v_xor_b32 v31, v31, v8
  s_add_u32 m0, s82, 16384
  s_add_u32 s84, s84, 122880
  s_sub_u32 s3, s84, 2457600
  s_min_u32 s84, s84, s3
  buffer_load_dwordx4 v12, s[8:11], s84 offen offset:0 lds
  v_lshlrev_b32 v31, 4, v31
  v_lshl_add_u32 v30, v30, 7, v31
  v_add_u32 v8, s81, v30
  v_xor_b32 v9, 64, v8
  buffer_load_dwordx4 v13, s[8:11], s84 offen offset:1024 lds
  v_bfe_u32 v28, v1, 2, 3
  v_lshrrev_b32 v29, 4, v1
  v_lshlrev_b32 v29, 12, v29
  v_and_b32 v30, 3, v1
  buffer_load_dwordx4 v14, s[8:11], s84 offen offset:2048 lds
  v_lshl_add_u32 v29, v30, 3, v29
  v_add_u32 v29, 65536, v29
  v_mul_u32_u24 v30, 480, v28
  v_add_u32 v22, v29, v30
  buffer_load_dwordx4 v15, s[8:11], s84 offen offset:3072 lds
  v_add_u32 v23, 49152, v22
  v_xor_b32 v28, 4, v28
  v_mul_u32_u24 v30, 480, v28
  v_add_u32 v24, v29, v30
  s_add_u32 m0, s81, 4096
  s_add_u32 s83, s83, 128
  s_sub_u32 s3, s83, 1280
  s_min_u32 s83, s83, s3
  buffer_load_dwordx4 v4, s[4:7], s83 offen offset:0 lds
  v_add_u32 v25, 49152, v24
  s_lshl_b32 s89, s60, 13
  s_add_u32 s89, s89, 131072
  s_lshl_b32 s52, s64, 18
  buffer_load_dwordx4 v5, s[4:7], s83 offen offset:1024 lds
  s_lshl_b32 s53, s60, 10
  s_add_u32 s52, s52, s53
  s_and_b32 s53, s2, 1
  s_mul_i32 s53, s53, 2
  buffer_load_dwordx4 v6, s[4:7], s83 offen offset:2048 lds
  s_and_b32 s54, s67, 1
  s_mul_i32 s54, s54, 1
  s_xor_b32 s53, s53, s54
  s_lshl_b32 s53, s53, 1
  buffer_load_dwordx4 v7, s[4:7], s83 offen offset:3072 lds
  s_lshl_b32 s54, s64, 0
  s_and_b32 s54, s54, 6
  s_xor_b32 s53, s53, s54
  s_lshl_b32 s95, s53, 11
  s_add_u32 m0, s82, 32768
  s_add_u32 s84, s84, 122880
  s_sub_u32 s3, s84, 2457600
  s_min_u32 s84, s84, s3
  buffer_load_dwordx4 v12, s[8:11], s84 offen offset:0 lds
  s_lshl_b32 s53, s53, 7
  s_add_u32 s52, s52, s53
  s_add_u32 s53, s60, 0
  s_and_b32 s53, s53, 3
  buffer_load_dwordx4 v13, s[8:11], s84 offen offset:1024 lds
  s_lshl_b32 s53, s53, 16
  s_add_u32 s70, s52, s53
  s_add_u32 s53, s60, 1
  s_and_b32 s53, s53, 3
  buffer_load_dwordx4 v14, s[8:11], s84 offen offset:2048 lds
  s_lshl_b32 s53, s53, 16
  s_add_u32 s71, s52, s53
  s_add_u32 s53, s60, 2
  s_and_b32 s53, s53, 3
  buffer_load_dwordx4 v15, s[8:11], s84 offen offset:3072 lds
  s_lshl_b32 s53, s53, 16
  s_add_u32 s72, s52, s53
  s_add_u32 s53, s60, 3
  s_and_b32 s53, s53, 3
  s_lshl_b32 s53, s53, 16
  s_add_u32 s73, s52, s53
  s_sub_u32 s93, s89, 32768
  v_and_b32 v30, 15, v1
  v_lshrrev_b32 v31, 1, v30
  v_lshrrev_b32 v218, 4, v1
  v_xor_b32 v31, v31, v218
  v_lshlrev_b32 v31, 4, v31
  v_lshl_add_u32 v30, v30, 7, v31
  v_add_u32 v218, s81, v30
  v_xor_b32 v219, 64, v218
  v_add_u32 v220, s89, v30
  v_xor_b32 v221, 64, v220
  v_add_u32 v222, s93, v30
  v_xor_b32 v223, 64, v222
  v_lshrrev_b32 v20, 3, v1
  v_and_b32 v21, 7, v1
  v_lshrrev_b32 v30, 4, v1
  v_xor_b32 v21, v21, v30
  v_lshlrev_b32 v21, 4, v21
  v_lshl_add_u32 v20, v20, 12, v21
  v_xor_b32 v21, 64, v20
  v_add_u32 v21, 31744, v21
  s_waitcnt vmcnt(8)
  s_barrier
  ds_read_b128 a[0:3], v8 offset:0
  ds_read_b128 a[4:7], v8 offset:2048
  ds_read_b64_tr_b16 v[40:41], v22 offset:160
  ds_read_b64_tr_b16 v[42:43], v24 offset:160
  ds_read_b128 a[8:11], v9 offset:0
  ds_read_b128 a[12:15], v9 offset:2048
  ds_read_b64_tr_b16 v[44:45], v22 offset:16544
  ds_read_b64_tr_b16 v[46:47], v24 offset:16544
  ds_read_b64_tr_b16 v[48:49], v22 offset:192
  ds_read_b64_tr_b16 v[50:51], v24 offset:192
  ds_read_b64_tr_b16 v[52:53], v22 offset:16576
  ds_read_b64_tr_b16 v[54:55], v24 offset:16576
  ds_read_b64_tr_b16 v[56:57], v22 offset:224
  ds_read_b64_tr_b16 v[58:59], v24 offset:224
  s_waitcnt lgkmcnt(6)
  v_mfma_f32_16x16x32_bf16 v[128:131], a[0:3], v[40:43], 0
  v_mfma_f32_16x16x32_bf16 v[128:131], a[8:11], v[44:47], v[128:131]
  ds_read_b64_tr_b16 v[60:61], v22 offset:16608
  ds_read_b64_tr_b16 v[62:63], v24 offset:16608
  s_add_u32 m0, s82, 49152
  v_mfma_f32_16x16x32_bf16 v[132:135], a[12:15], v[44:47], 0
  s_add_u32 s84, s84, 122880
  s_sub_u32 s3, s84, 2457600
  s_min_u32 s84, s84, s3
  v_mfma_f32_16x16x32_bf16 v[132:135], a[4:7], v[40:43], v[132:135]
  ds_read_b64_tr_b16 v[40:41], v22 offset:256
  ds_read_b64_tr_b16 v[42:43], v24 offset:256
  s_waitcnt lgkmcnt(6)
  v_mfma_f32_16x16x32_bf16 v[136:139], a[0:3], v[48:51], 0
  buffer_load_dwordx4 v12, s[8:11], s84 offen offset:0 lds
  v_mfma_f32_16x16x32_bf16 v[136:139], a[8:11], v[52:55], v[136:139]
  ds_read_b64_tr_b16 v[44:45], v22 offset:16640
  v_mfma_f32_16x16x32_bf16 v[140:143], a[12:15], v[52:55], 0
  ds_read_b64_tr_b16 v[46:47], v24 offset:16640
  v_mfma_f32_16x16x32_bf16 v[140:143], a[4:7], v[48:51], v[140:143]
  ds_read_b64_tr_b16 v[48:49], v22 offset:288
  ds_read_b64_tr_b16 v[50:51], v24 offset:288
  s_waitcnt lgkmcnt(6)
  v_mfma_f32_16x16x32_bf16 v[144:147], a[0:3], v[56:59], 0
  buffer_load_dwordx4 v13, s[8:11], s84 offen offset:1024 lds
  v_mfma_f32_16x16x32_bf16 v[144:147], a[8:11], v[60:63], v[144:147]
  ds_read_b64_tr_b16 v[52:53], v22 offset:16672
  v_mfma_f32_16x16x32_bf16 v[148:151], a[12:15], v[60:63], 0
  ds_read_b64_tr_b16 v[54:55], v24 offset:16672
  v_mfma_f32_16x16x32_bf16 v[148:151], a[4:7], v[56:59], v[148:151]
  ds_read_b64_tr_b16 v[56:57], v22 offset:320
  ds_read_b64_tr_b16 v[58:59], v24 offset:320
  s_waitcnt lgkmcnt(6)
  v_mfma_f32_16x16x32_bf16 v[152:155], a[0:3], v[40:43], 0
  buffer_load_dwordx4 v14, s[8:11], s84 offen offset:2048 lds
  v_mfma_f32_16x16x32_bf16 v[152:155], a[8:11], v[44:47], v[152:155]
  ds_read_b64_tr_b16 v[60:61], v22 offset:16704
  v_mfma_f32_16x16x32_bf16 v[156:159], a[12:15], v[44:47], 0
  ds_read_b64_tr_b16 v[62:63], v24 offset:16704
  v_mfma_f32_16x16x32_bf16 v[156:159], a[4:7], v[40:43], v[156:159]
  ds_read_b64_tr_b16 v[40:41], v22 offset:352
  ds_read_b64_tr_b16 v[42:43], v24 offset:352
  s_waitcnt lgkmcnt(6)
  v_mfma_f32_16x16x32_bf16 v[160:163], a[0:3], v[48:51], 0
  buffer_load_dwordx4 v15, s[8:11], s84 offen offset:3072 lds
  s_add_u32 m0, s82, 65536
  v_mfma_f32_16x16x32_bf16 v[160:163], a[8:11], v[52:55], v[160:163]
  ds_read_b64_tr_b16 v[44:45], v22 offset:16736
  ds_read_b64_tr_b16 v[46:47], v24 offset:16736
  s_add_u32 s84, s84, 122880
  v_mfma_f32_16x16x32_bf16 v[164:167], a[12:15], v[52:55], 0
  s_sub_u32 s3, s84, 2457600
  s_min_u32 s84, s84, s3
  v_mfma_f32_16x16x32_bf16 v[164:167], a[4:7], v[48:51], v[164:167]
  ds_read_b64_tr_b16 v[48:49], v22 offset:384
  ds_read_b64_tr_b16 v[50:51], v24 offset:384
  s_waitcnt lgkmcnt(6)
  v_mfma_f32_16x16x32_bf16 v[168:171], a[0:3], v[56:59], 0
  buffer_load_dwordx4 v12, s[8:11], s84 offen offset:0 lds
  v_mfma_f32_16x16x32_bf16 v[168:171], a[8:11], v[60:63], v[168:171]
  ds_read_b64_tr_b16 v[52:53], v22 offset:16768
  v_mfma_f32_16x16x32_bf16 v[172:175], a[12:15], v[60:63], 0
  ds_read_b64_tr_b16 v[54:55], v24 offset:16768
  v_mfma_f32_16x16x32_bf16 v[172:175], a[4:7], v[56:59], v[172:175]
  ds_read_b64_tr_b16 v[56:57], v22 offset:416
  s_waitcnt lgkmcnt(5)
  v_mfma_f32_16x16x32_bf16 v[176:179], a[0:3], v[40:43], 0
  ds_read_b64_tr_b16 v[58:59], v24 offset:416
  v_mfma_f32_16x16x32_bf16 v[176:179], a[8:11], v[44:47], v[176:179]
  ds_read_b64_tr_b16 v[60:61], v22 offset:16800
  ds_read_b64_tr_b16 v[62:63], v24 offset:16800
  v_mfma_f32_16x16x32_bf16 v[180:183], a[12:15], v[44:47], 0
  buffer_load_dwordx4 v13, s[8:11], s84 offen offset:1024 lds
  v_mfma_f32_16x16x32_bf16 v[180:183], a[4:7], v[40:43], v[180:183]
  ds_read_b64_tr_b16 v[40:41], v22 offset:448
  s_waitcnt lgkmcnt(5)
  v_mfma_f32_16x16x32_bf16 v[184:187], a[0:3], v[48:51], 0
  ds_read_b64_tr_b16 v[42:43], v24 offset:448
  v_mfma_f32_16x16x32_bf16 v[184:187], a[8:11], v[52:55], v[184:187]
  ds_read_b64_tr_b16 v[44:45], v22 offset:16832
  ds_read_b64_tr_b16 v[46:47], v24 offset:16832
  v_mfma_f32_16x16x32_bf16 v[188:191], a[12:15], v[52:55], 0
  buffer_load_dwordx4 v14, s[8:11], s84 offen offset:2048 lds
  v_mfma_f32_16x16x32_bf16 v[188:191], a[4:7], v[48:51], v[188:191]
  ds_read_b64_tr_b16 v[48:49], v22 offset:0
  s_waitcnt lgkmcnt(5)
  v_mfma_f32_16x16x32_bf16 v[192:195], a[0:3], v[56:59], 0
  ds_read_b64_tr_b16 v[50:51], v24 offset:0
  v_mfma_f32_16x16x32_bf16 v[192:195], a[8:11], v[60:63], v[192:195]
  ds_read_b64_tr_b16 v[52:53], v22 offset:16384
  ds_read_b64_tr_b16 v[54:55], v24 offset:16384
  buffer_load_dwordx4 v15, s[8:11], s84 offen offset:3072 lds
  v_mfma_f32_16x16x32_bf16 v[196:199], a[12:15], v[60:63], 0
  s_add_u32 m0, s82, 81920
  s_add_u32 s84, s84, 122880
  v_mfma_f32_16x16x32_bf16 v[196:199], a[4:7], v[56:59], v[196:199]
  ds_read_b64_tr_b16 v[56:57], v22 offset:32
  ds_read_b64_tr_b16 v[58:59], v24 offset:32
  s_waitcnt lgkmcnt(6)
  v_mfma_f32_16x16x32_bf16 v[200:203], a[0:3], v[40:43], 0
  s_sub_u32 s3, s84, 2457600
  s_min_u32 s84, s84, s3
  v_mfma_f32_16x16x32_bf16 v[200:203], a[8:11], v[44:47], v[200:203]
  ds_read_b64_tr_b16 v[60:61], v22 offset:16416
  ds_read_b64_tr_b16 v[62:63], v24 offset:16416
  v_mfma_f32_16x16x32_bf16 v[204:207], a[12:15], v[44:47], 0
  buffer_load_dwordx4 v12, s[8:11], s84 offen offset:0 lds
  v_mfma_f32_16x16x32_bf16 v[204:207], a[4:7], v[40:43], v[204:207]
  ds_read_b64_tr_b16 v[40:41], v22 offset:64
  s_waitcnt lgkmcnt(5)
  v_mfma_f32_16x16x32_bf16 v[64:67], v[48:51], a[0:3], 0
  ds_read_b64_tr_b16 v[42:43], v24 offset:64
  v_mfma_f32_16x16x32_bf16 v[64:67], v[52:55], a[8:11], v[64:67]
  ds_read_b64_tr_b16 v[44:45], v22 offset:16448
  v_mfma_f32_16x16x32_bf16 v[68:71], v[52:55], a[12:15], 0
  ds_read_b64_tr_b16 v[46:47], v24 offset:16448
  v_mfma_f32_16x16x32_bf16 v[68:71], v[48:51], a[4:7], v[68:71]
  ds_read_b64_tr_b16 v[48:49], v22 offset:96
  ds_read_b64_tr_b16 v[50:51], v24 offset:96
  s_waitcnt lgkmcnt(6)
  v_mfma_f32_16x16x32_bf16 v[72:75], v[56:59], a[0:3], 0
  buffer_load_dwordx4 v13, s[8:11], s84 offen offset:1024 lds
  v_mfma_f32_16x16x32_bf16 v[72:75], v[60:63], a[8:11], v[72:75]
  ds_read_b64_tr_b16 v[52:53], v22 offset:16480
  v_mfma_f32_16x16x32_bf16 v[76:79], v[60:63], a[12:15], 0
  ds_read_b64_tr_b16 v[54:55], v24 offset:16480
  v_mfma_f32_16x16x32_bf16 v[76:79], v[56:59], a[4:7], v[76:79]
  ds_read_b64_tr_b16 v[56:57], v22 offset:128
  ds_read_b64_tr_b16 v[58:59], v24 offset:128
  s_waitcnt lgkmcnt(6)
  v_mfma_f32_16x16x32_bf16 v[80:83], v[40:43], a[0:3], 0
  buffer_load_dwordx4 v14, s[8:11], s84 offen offset:2048 lds
  v_mfma_f32_16x16x32_bf16 v[80:83], v[44:47], a[8:11], v[80:83]
  ds_read_b64_tr_b16 v[60:61], v22 offset:16512
  v_mfma_f32_16x16x32_bf16 v[84:87], v[44:47], a[12:15], 0
  ds_read_b64_tr_b16 v[62:63], v24 offset:16512
  v_mfma_f32_16x16x32_bf16 v[84:87], v[40:43], a[4:7], v[84:87]
  s_waitcnt vmcnt(7) lgkmcnt(0)
  s_barrier
  ds_read_b128 a[16:19], v8 offset:4096
  v_mfma_f32_16x16x32_bf16 v[88:91], v[48:51], a[0:3], 0
  ds_read_b128 a[20:23], v8 offset:6144
  ds_read_b64_tr_b16 v[40:41], v22 offset:32928
  ds_read_b64_tr_b16 v[42:43], v24 offset:32928
  v_mfma_f32_16x16x32_bf16 v[88:91], v[52:55], a[8:11], v[88:91]
  ds_read_b128 a[24:27], v9 offset:4096
  ds_read_b128 a[28:31], v9 offset:6144
  ds_read_b64_tr_b16 v[44:45], v23 offset:160
  v_mfma_f32_16x16x32_bf16 v[92:95], v[52:55], a[12:15], 0
  ds_read_b64_tr_b16 v[46:47], v25 offset:160
  buffer_load_dwordx4 v15, s[8:11], s84 offen offset:3072 lds
  v_mfma_f32_16x16x32_bf16 v[92:95], v[48:51], a[4:7], v[92:95]
  ds_read_b64_tr_b16 v[48:49], v22 offset:32960
  ds_read_b64_tr_b16 v[50:51], v24 offset:32960
  v_add_u32 v2, 2654435761, v2
  v_mfma_f32_16x16x32_bf16 v[96:99], v[56:59], a[0:3], 0
  v_readfirstlane_b32 s63, v2
  s_add_u32 m0, s81, 0
  v_mfma_f32_16x16x32_bf16 v[96:99], v[60:63], a[8:11], v[96:99]
  ds_read_b64_tr_b16 v[52:53], v23 offset:192
  ds_read_b64_tr_b16 v[54:55], v25 offset:192
  s_add_u32 s83, s83, 128
  s_sub_u32 s3, s83, 1280
  v_mfma_f32_16x16x32_bf16 v[100:103], v[60:63], a[12:15], 0
  s_min_u32 s83, s83, s3
  buffer_load_dwordx4 v4, s[4:7], s83 offen offset:0 lds
  v_mfma_f32_16x16x32_bf16 v[100:103], v[56:59], a[4:7], v[100:103]
  ds_read_b64_tr_b16 v[56:57], v22 offset:32992
  ds_read_b64_tr_b16 v[58:59], v24 offset:32992
  s_waitcnt lgkmcnt(6)
  v_mfma_f32_16x16x32_bf16 v[128:131], a[16:19], v[40:43], v[128:131]
  buffer_load_dwordx4 v5, s[4:7], s83 offen offset:1024 lds
  v_mfma_f32_16x16x32_bf16 v[128:131], a[24:27], v[44:47], v[128:131]
  ds_read_b64_tr_b16 v[60:61], v23 offset:224
  ds_read_b64_tr_b16 v[62:63], v25 offset:224
  v_mfma_f32_16x16x32_bf16 v[132:135], a[28:31], v[44:47], v[132:135]
  buffer_load_dwordx4 v6, s[4:7], s83 offen offset:2048 lds
  v_mfma_f32_16x16x32_bf16 v[132:135], a[20:23], v[40:43], v[132:135]
  ds_read_b64_tr_b16 v[40:41], v22 offset:33024
  s_waitcnt lgkmcnt(5)
  v_mfma_f32_16x16x32_bf16 v[136:139], a[16:19], v[48:51], v[136:139]
  ds_read_b64_tr_b16 v[42:43], v24 offset:33024
  v_mfma_f32_16x16x32_bf16 v[136:139], a[24:27], v[52:55], v[136:139]
  ds_read_b64_tr_b16 v[44:45], v23 offset:256
  ds_read_b64_tr_b16 v[46:47], v25 offset:256
  buffer_load_dwordx4 v7, s[4:7], s83 offen offset:3072 lds
  v_mfma_f32_16x16x32_bf16 v[140:143], a[28:31], v[52:55], v[140:143]
  s_add_u32 m0, s82, 0
  s_add_u32 s84, s84, 122880
  v_mfma_f32_16x16x32_bf16 v[140:143], a[20:23], v[48:51], v[140:143]
  ds_read_b64_tr_b16 v[48:49], v22 offset:33056
  ds_read_b64_tr_b16 v[50:51], v24 offset:33056
  s_waitcnt lgkmcnt(6)
  v_mfma_f32_16x16x32_bf16 v[144:147], a[16:19], v[56:59], v[144:147]
  s_sub_u32 s3, s84, 2457600
  s_min_u32 s84, s84, s3
  v_mfma_f32_16x16x32_bf16 v[144:147], a[24:27], v[60:63], v[144:147]
  ds_read_b64_tr_b16 v[52:53], v23 offset:288
  ds_read_b64_tr_b16 v[54:55], v25 offset:288
  v_mfma_f32_16x16x32_bf16 v[148:151], a[28:31], v[60:63], v[148:151]
  buffer_load_dwordx4 v12, s[8:11], s84 offen offset:0 lds
  v_mfma_f32_16x16x32_bf16 v[148:151], a[20:23], v[56:59], v[148:151]
  ds_read_b64_tr_b16 v[56:57], v22 offset:33088
  ds_read_b64_tr_b16 v[58:59], v24 offset:33088
  s_waitcnt lgkmcnt(6)
  v_mfma_f32_16x16x32_bf16 v[152:155], a[16:19], v[40:43], v[152:155]
  buffer_load_dwordx4 v13, s[8:11], s84 offen offset:1024 lds
  v_mfma_f32_16x16x32_bf16 v[152:155], a[24:27], v[44:47], v[152:155]
  ds_read_b64_tr_b16 v[60:61], v23 offset:320
  v_mfma_f32_16x16x32_bf16 v[156:159], a[28:31], v[44:47], v[156:159]
  ds_read_b64_tr_b16 v[62:63], v25 offset:320
  v_mfma_f32_16x16x32_bf16 v[156:159], a[20:23], v[40:43], v[156:159]
  ds_read_b64_tr_b16 v[40:41], v22 offset:33120
  ds_read_b64_tr_b16 v[42:43], v24 offset:33120
  s_waitcnt lgkmcnt(6)
  v_mfma_f32_16x16x32_bf16 v[160:163], a[16:19], v[48:51], v[160:163]
  buffer_load_dwordx4 v14, s[8:11], s84 offen offset:2048 lds
  v_mfma_f32_16x16x32_bf16 v[160:163], a[24:27], v[52:55], v[160:163]
  ds_read_b64_tr_b16 v[44:45], v23 offset:352
  v_mfma_f32_16x16x32_bf16 v[164:167], a[28:31], v[52:55], v[164:167]
  ds_read_b64_tr_b16 v[46:47], v25 offset:352
  v_mfma_f32_16x16x32_bf16 v[164:167], a[20:23], v[48:51], v[164:167]
  ds_read_b64_tr_b16 v[48:49], v22 offset:33152
  ds_read_b64_tr_b16 v[50:51], v24 offset:33152
  s_waitcnt lgkmcnt(6)
  v_mfma_f32_16x16x32_bf16 v[168:171], a[16:19], v[56:59], v[168:171]
  buffer_load_dwordx4 v15, s[8:11], s84 offen offset:3072 lds
  s_add_u32 m0, s82, 16384
  v_mfma_f32_16x16x32_bf16 v[168:171], a[24:27], v[60:63], v[168:171]
  ds_read_b64_tr_b16 v[52:53], v23 offset:384
  ds_read_b64_tr_b16 v[54:55], v25 offset:384
  s_add_u32 s84, s84, 122880
  v_mfma_f32_16x16x32_bf16 v[172:175], a[28:31], v[60:63], v[172:175]
  s_sub_u32 s3, s84, 2457600
  s_min_u32 s84, s84, s3
  v_mfma_f32_16x16x32_bf16 v[172:175], a[20:23], v[56:59], v[172:175]
  ds_read_b64_tr_b16 v[56:57], v22 offset:33184
  ds_read_b64_tr_b16 v[58:59], v24 offset:33184
  s_waitcnt lgkmcnt(6)
  v_mfma_f32_16x16x32_bf16 v[176:179], a[16:19], v[40:43], v[176:179]
  buffer_load_dwordx4 v12, s[8:11], s84 offen offset:0 lds
  v_mfma_f32_16x16x32_bf16 v[176:179], a[24:27], v[44:47], v[176:179]
  ds_read_b64_tr_b16 v[60:61], v23 offset:416
  ds_read_b64_tr_b16 v[62:63], v25 offset:416
  v_mfma_f32_16x16x32_bf16 v[180:183], a[28:31], v[44:47], v[180:183]
  buffer_load_dwordx4 v13, s[8:11], s84 offen offset:1024 lds
  v_mfma_f32_16x16x32_bf16 v[180:183], a[20:23], v[40:43], v[180:183]
  ds_read_b64_tr_b16 v[40:41], v22 offset:33216
  s_waitcnt lgkmcnt(5)
  v_mfma_f32_16x16x32_bf16 v[184:187], a[16:19], v[48:51], v[184:187]
  ds_read_b64_tr_b16 v[42:43], v24 offset:33216
  v_mfma_f32_16x16x32_bf16 v[184:187], a[24:27], v[52:55], v[184:187]
  ds_read_b64_tr_b16 v[44:45], v23 offset:448
  ds_read_b64_tr_b16 v[46:47], v25 offset:448
  v_mfma_f32_16x16x32_bf16 v[188:191], a[28:31], v[52:55], v[188:191]
  buffer_load_dwordx4 v14, s[8:11], s84 offen offset:2048 lds
  v_mfma_f32_16x16x32_bf16 v[188:191], a[20:23], v[48:51], v[188:191]
  ds_read_b64_tr_b16 v[48:49], v22 offset:32768
  ds_read_b64_tr_b16 v[50:51], v24 offset:32768
  s_waitcnt lgkmcnt(6)
  v_mfma_f32_16x16x32_bf16 v[192:195], a[16:19], v[56:59], v[192:195]
  buffer_load_dwordx4 v15, s[8:11], s84 offen offset:3072 lds
  s_add_u32 m0, s81, 4096
  v_mfma_f32_16x16x32_bf16 v[192:195], a[24:27], v[60:63], v[192:195]
  ds_read_b64_tr_b16 v[52:53], v23 offset:0
  ds_read_b64_tr_b16 v[54:55], v25 offset:0
  s_add_u32 s83, s83, 128
  v_mfma_f32_16x16x32_bf16 v[196:199], a[28:31], v[60:63], v[196:199]
  s_sub_u32 s3, s83, 1280
  s_min_u32 s83, s83, s3
  v_mfma_f32_16x16x32_bf16 v[196:199], a[20:23], v[56:59], v[196:199]
  ds_read_b64_tr_b16 v[56:57], v22 offset:32800
  ds_read_b64_tr_b16 v[58:59], v24 offset:32800
  s_waitcnt lgkmcnt(6)
  v_mfma_f32_16x16x32_bf16 v[200:203], a[16:19], v[40:43], v[200:203]
  buffer_load_dwordx4 v4, s[4:7], s83 offen offset:0 lds
  v_mfma_f32_16x16x32_bf16 v[200:203], a[24:27], v[44:47], v[200:203]
  ds_read_b64_tr_b16 v[60:61], v23 offset:32
  v_mfma_f32_16x16x32_bf16 v[204:207], a[28:31], v[44:47], v[204:207]
  ds_read_b64_tr_b16 v[62:63], v25 offset:32
  v_mfma_f32_16x16x32_bf16 v[204:207], a[20:23], v[40:43], v[204:207]
  ds_read_b64_tr_b16 v[40:41], v22 offset:32832
  ds_read_b64_tr_b16 v[42:43], v24 offset:32832
  s_waitcnt lgkmcnt(6)
  v_mfma_f32_16x16x32_bf16 v[64:67], v[48:51], a[16:19], v[64:67]
  buffer_load_dwordx4 v5, s[4:7], s83 offen offset:1024 lds
  v_mfma_f32_16x16x32_bf16 v[64:67], v[52:55], a[24:27], v[64:67]
  ds_read_b64_tr_b16 v[44:45], v23 offset:64
  ds_read_b64_tr_b16 v[46:47], v25 offset:64
  v_mfma_f32_16x16x32_bf16 v[68:71], v[52:55], a[28:31], v[68:71]
  buffer_load_dwordx4 v6, s[4:7], s83 offen offset:2048 lds
  v_mfma_f32_16x16x32_bf16 v[68:71], v[48:51], a[20:23], v[68:71]
  ds_read_b64_tr_b16 v[48:49], v22 offset:32864
  s_waitcnt lgkmcnt(5)
  v_mfma_f32_16x16x32_bf16 v[72:75], v[56:59], a[16:19], v[72:75]
  ds_read_b64_tr_b16 v[50:51], v24 offset:32864
  v_mfma_f32_16x16x32_bf16 v[72:75], v[60:63], a[24:27], v[72:75]
  ds_read_b64_tr_b16 v[52:53], v23 offset:96
  ds_read_b64_tr_b16 v[54:55], v25 offset:96
  buffer_load_dwordx4 v7, s[4:7], s83 offen offset:3072 lds
  v_mfma_f32_16x16x32_bf16 v[76:79], v[60:63], a[28:31], v[76:79]
  s_add_u32 m0, s81, 8192
  s_xor_b32 s74, s70, 0
  v_mfma_f32_16x16x32_bf16 v[76:79], v[56:59], a[20:23], v[76:79]
  ds_read_b64_tr_b16 v[56:57], v22 offset:32896
  s_waitcnt lgkmcnt(5)
  v_mfma_f32_16x16x32_bf16 v[80:83], v[40:43], a[16:19], v[80:83]
  ds_read_b64_tr_b16 v[58:59], v24 offset:32896
  v_mfma_f32_16x16x32_bf16 v[80:83], v[44:47], a[24:27], v[80:83]
  ds_read_b64_tr_b16 v[60:61], v23 offset:128
  ds_read_b64_tr_b16 v[62:63], v25 offset:128
  v_mfma_f32_16x16x32_bf16 v[84:87], v[44:47], a[28:31], v[84:87]
  buffer_load_dwordx4 v20, s[16:19], s74 offen lds
  v_mfma_f32_16x16x32_bf16 v[84:87], v[40:43], a[20:23], v[84:87]
  s_waitcnt vmcnt(13) lgkmcnt(0)
  s_barrier
  ds_read_b128 a[32:35], v8 offset:0
  v_mfma_f32_16x16x32_bf16 v[88:91], v[48:51], a[16:19], v[88:91]
  ds_read_b128 a[36:39], v8 offset:2048
  ds_read_b64_tr_b16 v[40:41], v23 offset:16544
  ds_read_b64_tr_b16 v[42:43], v25 offset:16544
  v_mfma_f32_16x16x32_bf16 v[88:91], v[52:55], a[24:27], v[88:91]
  ds_read_b128 a[40:43], v9 offset:0
  ds_read_b128 a[44:47], v9 offset:2048
  ds_read_b64_tr_b16 v[44:45], v23 offset:32928
  v_mfma_f32_16x16x32_bf16 v[92:95], v[52:55], a[28:31], v[92:95]
  ds_read_b64_tr_b16 v[46:47], v25 offset:32928
  buffer_load_dwordx4 v21, s[16:19], s74 offen offset:1024 lds
  v_mfma_f32_16x16x32_bf16 v[92:95], v[48:51], a[20:23], v[92:95]
  ds_read_b64_tr_b16 v[48:49], v23 offset:16576
  ds_read_b64_tr_b16 v[50:51], v25 offset:16576
  v_mfma_f32_16x16x32_bf16 v[96:99], v[56:59], a[16:19], v[96:99]
  s_add_u32 m0, s82, 32768
  s_add_u32 s84, s84, 122880
  s_sub_u32 s3, s84, 2457600
  v_mfma_f32_16x16x32_bf16 v[96:99], v[60:63], a[24:27], v[96:99]
  ds_read_b64_tr_b16 v[52:53], v23 offset:32960
  ds_read_b64_tr_b16 v[54:55], v25 offset:32960
  s_min_u32 s84, s84, s3
  v_mfma_f32_16x16x32_bf16 v[100:103], v[60:63], a[28:31], v[100:103]
  buffer_load_dwordx4 v12, s[8:11], s84 offen offset:0 lds
  v_mfma_f32_16x16x32_bf16 v[100:103], v[56:59], a[20:23], v[100:103]
  ds_read_b64_tr_b16 v[56:57], v23 offset:16608
  ds_read_b64_tr_b16 v[58:59], v25 offset:16608
  s_waitcnt lgkmcnt(6)
  v_mfma_f32_16x16x32_bf16 v[128:131], a[32:35], v[40:43], v[128:131]
  buffer_load_dwordx4 v13, s[8:11], s84 offen offset:1024 lds
  s_lshr_b32 s52, s65, 1
  s_and_b32 s53, s65, 1
  s_mul_i32 s52, s52, 14
  s_mul_i32 s54, s53, 6
  v_mfma_f32_16x16x32_bf16 v[128:131], a[40:43], v[44:47], v[128:131]
  ds_read_b64_tr_b16 v[60:61], v23 offset:32992
  ds_read_b64_tr_b16 v[62:63], v25 offset:32992
  s_add_u32 s85, s52, s54
  s_mul_i32 s52, s60, 16384
  s_add_u32 s52, s52, 196608
  s_mul_i32 s36, s85, 65536
  s_add_u32 s36, s36, s52
  v_mfma_f32_16x16x32_bf16 v[132:135], a[44:47], v[44:47], v[132:135]
  buffer_load_dwordx4 v14, s[8:11], s84 offen offset:2048 lds
  s_mov_b32 s52, s85
  s_lshl_b32 s53, s53, 1
  s_add_u32 s53, s53, s85
  s_add_u32 s53, s53, 5
  v_mfma_f32_16x16x32_bf16 v[132:135], a[36:39], v[40:43], v[132:135]
  ds_read_b64_tr_b16 v[40:41], v23 offset:16640
  s_min_u32 s53, s53, 53
  s_add_u32 s38, s52, 2
  s_add_u32 s39, s53, 2
  s_lshr_b32 s38, s38, 3
  s_lshr_b32 s39, s39, 3
  s_waitcnt lgkmcnt(5)
  v_mfma_f32_16x16x32_bf16 v[136:139], a[32:35], v[48:51], v[136:139]
  ds_read_b64_tr_b16 v[42:43], v25 offset:16640
  s_sub_u32 s39, s39, s38
  s_lshl_b32 s39, s39, 11
  s_lshl_b32 s38, s38, 11
  s_lshl_b32 s54, s60, 9
  s_add_u32 s38, s38, s54
  v_mfma_f32_16x16x32_bf16 v[136:139], a[40:43], v[52:55], v[136:139]
  ds_read_b64_tr_b16 v[44:45], v23 offset:33024
  ds_read_b64_tr_b16 v[46:47], v25 offset:33024
  buffer_load_dwordx4 v15, s[8:11], s84 offen offset:3072 lds
  s_add_u32 s38, s38, 19988480
  s_lshr_b32 s52, s52, 3
  s_lshr_b32 s53, s53, 3
  v_mfma_f32_16x16x32_bf16 v[140:143], a[44:47], v[52:55], v[140:143]
  s_add_u32 m0, s82, 49152
  s_add_u32 s84, s84, 122880
  s_lshl_b32 s52, s52, 11
  s_lshl_b32 s53, s53, 11
  s_lshl_b32 s42, s64, 2
  s_add_u32 s42, s42, s60
  v_mfma_f32_16x16x32_bf16 v[140:143], a[36:39], v[48:51], v[140:143]
  ds_read_b64_tr_b16 v[48:49], v23 offset:16672
  ds_read_b64_tr_b16 v[50:51], v25 offset:16672
  s_lshr_b32 s54, s42, 3
  s_lshl_b32 s54, s54, 7
  s_add_u32 s52, s52, s54
  s_add_u32 s53, s53, s54
  s_waitcnt lgkmcnt(6)
  v_mfma_f32_16x16x32_bf16 v[144:147], a[32:35], v[56:59], v[144:147]
  s_sub_u32 s3, s84, 2457600
  s_min_u32 s84, s84, s3
  s_bfe_u32 s54, s42, 0x20001
  s_lshl_b32 s54, s54, 2
  s_add_u32 s54, s54, 20054016
  s_add_u32 s52, s52, s54
  v_mfma_f32_16x16x32_bf16 v[144:147], a[40:43], v[60:63], v[144:147]
  ds_read_b64_tr_b16 v[52:53], v23 offset:33056
  ds_read_b64_tr_b16 v[54:55], v25 offset:33056
  s_add_u32 s53, s53, s54
  v_and_b32 v252, 15, v1
  s_sub_u32 s53, s53, s52
  v_bfe_u32 v254, v1, 4, 1
  v_mul_u32_u24 v254, s53, v254
  v_mfma_f32_16x16x32_bf16 v[148:151], a[44:47], v[60:63], v[148:151]
  buffer_load_dwordx4 v12, s[8:11], s84 offen offset:0 lds
  v_add_u32 v254, s52, v254
  s_lshl_b32 s52, s42, 4
  v_add_u32 v252, s52, v252
  v_lshlrev_b32 v250, 3, v252
  v_mfma_f32_16x16x32_bf16 v[148:151], a[36:39], v[56:59], v[148:151]
  ds_read_b64_tr_b16 v[56:57], v23 offset:16704
  ds_read_b64_tr_b16 v[58:59], v25 offset:16704
  v_add_u32 v250, 19660800, v250
  v_lshlrev_b32 v252, 1, v252
  buffer_load_ushort v251, v252, s[24:27], 0 offen
  s_waitcnt lgkmcnt(6)
  v_mfma_f32_16x16x32_bf16 v[152:155], a[32:35], v[40:43], v[152:155]
  buffer_load_dwordx4 v13, s[8:11], s84 offen offset:1024 lds
  v_lshlrev_b32 v253, 4, v1
  s_lshr_b32 s52, s85, 1
  s_lshl_b32 s52, s52, 10
  v_add_u32 v248, s52, v253
  v_mfma_f32_16x16x32_bf16 v[152:155], a[40:43], v[44:47], v[152:155]
  ds_read_b64_tr_b16 v[60:61], v23 offset:33088
  s_mul_i32 s87, s42, 27648
  s_add_u32 s87, s87, 4194304
  s_mul_i32 s88, s42, 48128
  s_add_u32 s88, s88, 8409088
  s_mul_i32 s52, s66, 5120
  s_add_u32 s52, s52, 16777216
  v_mfma_f32_16x16x32_bf16 v[156:159], a[44:47], v[44:47], v[156:159]
  ds_read_b64_tr_b16 v[62:63], v25 offset:33088
  s_cmp_eq_u32 s60, 3
  s_cselect_b32 s43, 1073741824, 0
  s_mul_i32 s44, s60, 204800
  s_add_u32 s44, s44, s52
  s_mul_i32 s45, s60, 286720
  v_mfma_f32_16x16x32_bf16 v[156:159], a[36:39], v[40:43], v[156:159]
  ds_read_b64_tr_b16 v[40:41], v23 offset:16736
  ds_read_b64_tr_b16 v[42:43], v25 offset:16736
  s_add_u32 s45, s45, s52
  s_add_u32 s45, s45, 819200
  s_mul_i32 s46, s60, 5120
  s_add_u32 s46, s46, 8388608
  s_waitcnt lgkmcnt(6)
  v_mfma_f32_16x16x32_bf16 v[160:163], a[32:35], v[48:51], v[160:163]
  buffer_load_dwordx4 v14, s[8:11], s84 offen offset:2048 lds
  s_lshl_b32 s47, s60, 11
  s_add_u32 s47, s47, 20480
  s_lshr_b32 s48, s64, 1
  s_lshl_b32 s48, s48, 10
  v_mfma_f32_16x16x32_bf16 v[160:163], a[40:43], v[52:55], v[160:163]
  ds_read_b64_tr_b16 v[44:45], v23 offset:33120
  s_and_b32 s52, s64, 1
  s_lshl_b32 s52, s52, 3
  s_add_u32 s48, s48, s52
  s_lshl_b32 s52, s60, 8
  s_add_u32 s48, s48, s52
  s_add_u32 s48, s48, 20185088
  v_mfma_f32_16x16x32_bf16 v[164:167], a[44:47], v[52:55], v[164:167]
  ds_read_b64_tr_b16 v[46:47], v25 offset:33120
  s_lshl_b32 s52, s64, 10
  s_add_u32 s52, s52, 20250624
  s_lshl_b32 s53, s65, 7
  s_lshl_b32 s54, s60, 2
  s_add_u32 s53, s53, s54
  v_mfma_f32_16x16x32_bf16 v[164:167], a[36:39], v[48:51], v[164:167]
  ds_read_b64_tr_b16 v[48:49], v23 offset:16768
  ds_read_b64_tr_b16 v[50:51], v25 offset:16768
  s_add_u32 s49, s52, s53
  s_lshl_b32 s54, s60, 8
  s_add_u32 s55, s52, s54
  s_mul_i32 s54, s67, 1
  s_waitcnt lgkmcnt(6)
  v_mfma_f32_16x16x32_bf16 v[168:171], a[32:35], v[56:59], v[168:171]
  buffer_load_dwordx4 v15, s[8:11], s84 offen offset:3072 lds
  s_add_u32 m0, s81, 0
  s_add_u32 s54, s54, s60
  s_and_b32 s52, s54, 3
  v_mfma_f32_16x16x32_bf16 v[168:171], a[40:43], v[60:63], v[168:171]
  ds_read_b64_tr_b16 v[52:53], v23 offset:33152
  ds_read_b64_tr_b16 v[54:55], v25 offset:33152
  s_add_u32 s83, s83, 128
  s_lshl_b32 s53, s64, 2
  s_add_u32 s52, s52, s53
  s_mul_i32 s58, s52, 20480
  s_mul_i32 s52, s66, 160
  v_mfma_f32_16x16x32_bf16 v[172:175], a[44:47], v[60:63], v[172:175]
  s_sub_u32 s3, s83, 1280
  s_min_u32 s83, s83, s3
  s_add_u32 s58, s58, s52
  s_and_b32 s52, s64, 7
  s_and_b32 s53, s65, 1
  s_lshl_b32 s53, s53, 3
  v_mfma_f32_16x16x32_bf16 v[172:175], a[36:39], v[56:59], v[172:175]
  ds_read_b64_tr_b16 v[56:57], v23 offset:16800
  ds_read_b64_tr_b16 v[58:59], v25 offset:16800
  s_add_u32 s52, s52, s53
  s_lshl_b32 s52, s52, 1
  s_lshr_b32 s52, 0x0, s52
  s_and_b32 s52, s52, 3
  s_waitcnt lgkmcnt(6)
  v_mfma_f32_16x16x32_bf16 v[176:179], a[32:35], v[40:43], v[176:179]
  buffer_load_dwordx4 v4, s[4:7], s83 offen offset:0 lds
  s_and_b32 s101, s65, 1
  s_add_u32 s101, s101, 3
  s_cmp_eq_u32 s65, 7
  s_cselect_b32 s59, 2, 3
  v_mfma_f32_16x16x32_bf16 v[176:179], a[40:43], v[44:47], v[176:179]
  ds_read_b64_tr_b16 v[60:61], v23 offset:33184
  ds_read_b64_tr_b16 v[62:63], v25 offset:33184
  s_min_u32 s53, s52, s59
  s_lshl_b32 s53, s53, 17
  s_or_b32 s85, s53, s95
  s_add_u32 s52, s52, 1
  s_sub_u32 s53, s52, s101
  v_mfma_f32_16x16x32_bf16 v[180:183], a[44:47], v[44:47], v[180:183]
  buffer_load_dwordx4 v5, s[4:7], s83 offen offset:1024 lds
  s_min_u32 s52, s52, s53
  s_min_u32 s53, s52, s59
  s_lshl_b32 s53, s53, 17
  s_or_b32 s86, s53, s95
  v_mfma_f32_16x16x32_bf16 v[180:183], a[36:39], v[40:43], v[180:183]
  ds_read_b64_tr_b16 v[40:41], v23 offset:16832
  s_add_u32 s52, s52, 1
  s_sub_u32 s53, s52, s101
  s_min_u32 s52, s52, s53
  s_min_u32 s53, s52, s59
  s_lshl_b32 s53, s53, 17
  s_waitcnt lgkmcnt(5)
  v_mfma_f32_16x16x32_bf16 v[184:187], a[32:35], v[48:51], v[184:187]
  ds_read_b64_tr_b16 v[42:43], v25 offset:16832
  s_or_b32 s91, s53, s95
  s_add_u32 s52, s52, 1
  s_sub_u32 s53, s52, s101
  s_min_u32 s52, s52, s53
  s_min_u32 s53, s52, s59
  v_mfma_f32_16x16x32_bf16 v[184:187], a[40:43], v[52:55], v[184:187]
  ds_read_b64_tr_b16 v[44:45], v23 offset:33216
  ds_read_b64_tr_b16 v[46:47], v25 offset:33216
  s_lshl_b32 s53, s53, 17
  s_or_b32 s37, s53, s95
  s_add_u32 s52, s52, 1
  s_sub_u32 s53, s52, s101
  s_min_u32 s52, s52, s53
  v_mfma_f32_16x16x32_bf16 v[188:191], a[44:47], v[52:55], v[188:191]
  buffer_load_dwordx4 v6, s[4:7], s83 offen offset:2048 lds
  s_add_u32 s52, s54, 0
  s_and_b32 s52, s52, 3
  s_lshl_b32 s53, s64, 2
  s_add_u32 s52, s52, s53
  v_mfma_f32_16x16x32_bf16 v[188:191], a[36:39], v[48:51], v[188:191]
  ds_read_b64_tr_b16 v[48:49], v23 offset:16384
  ds_read_b64_tr_b16 v[50:51], v25 offset:16384
  s_mul_i32 s52, s52, 48128
  s_add_u32 s40, s52, s46
  s_add_u32 s52, s54, 1
  s_and_b32 s52, s52, 3
  s_waitcnt lgkmcnt(6)
  v_mfma_f32_16x16x32_bf16 v[192:195], a[32:35], v[56:59], v[192:195]
  buffer_load_dwordx4 v7, s[4:7], s83 offen offset:3072 lds
  s_add_u32 m0, s81, 10240
  s_lshl_b32 s53, s64, 2
  s_add_u32 s52, s52, s53
  s_mul_i32 s52, s52, 48128
  v_mfma_f32_16x16x32_bf16 v[192:195], a[40:43], v[60:63], v[192:195]
  ds_read_b64_tr_b16 v[52:53], v23 offset:32768
  ds_read_b64_tr_b16 v[54:55], v25 offset:32768
  s_add_u32 s41, s52, s46
  s_add_u32 s52, s54, 2
  s_and_b32 s52, s52, 3
  s_lshl_b32 s53, s64, 2
  s_add_u32 s52, s52, s53
  v_mfma_f32_16x16x32_bf16 v[196:199], a[44:47], v[60:63], v[196:199]
  s_xor_b32 s74, s71, 0
  s_mul_i32 s52, s52, 48128
  s_add_u32 s50, s52, s46
  s_add_u32 s52, s54, 3
  s_and_b32 s52, s52, 3
  s_lshl_b32 s53, s64, 2
  v_mfma_f32_16x16x32_bf16 v[196:199], a[36:39], v[56:59], v[196:199]
  ds_read_b64_tr_b16 v[56:57], v23 offset:16416
  ds_read_b64_tr_b16 v[58:59], v25 offset:16416
  s_add_u32 s52, s52, s53
  s_mul_i32 s52, s52, 48128
  s_add_u32 s51, s52, s46
  s_mov_b32 s92, 0x3fb8aa3b
  s_waitcnt lgkmcnt(6)
  v_mfma_f32_16x16x32_bf16 v[200:203], a[32:35], v[40:43], v[200:203]
  buffer_load_dwordx4 v20, s[16:19], s74 offen lds
  s_mov_b32 s94, 0x358637bd
  s_lshl_b32 s77, s62, 2
  s_add_u32 s77, s77, s60
  s_lshr_b32 s75, s77, 1
  v_mfma_f32_16x16x32_bf16 v[200:203], a[40:43], v[44:47], v[200:203]
  ds_read_b64_tr_b16 v[60:61], v23 offset:32800
  s_lshl_b32 s75, s75, 7
  s_add_u32 s75, s75, 19922944
  v_mov_b32 v39, s75
  s_mul_i32 s78, s77, 3072
  s_add_u32 s78, s78, 18874368
  v_and_b32 v230, 31, v1
  v_mfma_f32_16x16x32_bf16 v[204:207], a[44:47], v[44:47], v[204:207]
  ds_read_b64_tr_b16 v[62:63], v25 offset:32800
  v_lshrrev_b32 v231, 5, v1
  v_and_b32 v30, 15, v1
  v_mul_u32_u24 v30, 272, v30
  v_and_b32 v31, 48, v1
  v_add_u32 v30, v30, v31
  v_mfma_f32_16x16x32_bf16 v[204:207], a[36:39], v[40:43], v[204:207]
  ds_read_b64_tr_b16 v[40:41], v23 offset:16448
  ds_read_b64_tr_b16 v[42:43], v25 offset:16448
  s_lshl_b32 s75, s60, 6
  s_add_u32 s75, s75, 65536
  v_add_u32 v32, s75, v30
  v_lshlrev_b32 v36, 2, v1
  s_waitcnt lgkmcnt(6)
  v_mfma_f32_16x16x32_bf16 v[64:67], v[48:51], a[32:35], v[64:67]
  buffer_load_dwordx4 v21, s[16:19], s74 offen offset:1024 lds
  s_add_u32 m0, s81, 12288
  s_mul_i32 s75, s60, 20
  v_min_u32 v30, 19, v230
  v_add_u32 v30, s75, v30
  v_mfma_f32_16x16x32_bf16 v[64:67], v[52:55], a[40:43], v[64:67]
  ds_read_b64_tr_b16 v[44:45], v23 offset:32832
  ds_read_b64_tr_b16 v[46:47], v25 offset:32832
  s_xor_b32 s74, s72, 0
  v_mul_u32_u24 v30, 272, v30
  v_add_u32 v30, 65536, v30
  v_lshl_add_u32 v34, v231, 4, v30
  v_add_u32 v30, 21760, v30
  v_mfma_f32_16x16x32_bf16 v[68:71], v[52:55], a[44:47], v[68:71]
  buffer_load_dwordx4 v20, s[16:19], s74 offen lds
  v_mov_b32 v31, 109056
  v_add_u32 v26, v31, v36
  v_cmp_gt_u32 vcc, 20, v230
  s_nop 1
  v_cndmask_b32 v30, v31, v30, vcc
  v_mfma_f32_16x16x32_bf16 v[68:71], v[48:51], a[36:39], v[68:71]
  ds_read_b64_tr_b16 v[48:49], v23 offset:16480
  v_lshl_add_u32 v35, v231, 4, v30
  v_mov_b32 v31, 1073741824
  v_cmp_gt_u32 vcc, 22, v230
  s_nop 1
  v_cndmask_b32 v37, v31, v36, vcc
  v_cmp_gt_u32 vcc, 22, v1
  s_waitcnt lgkmcnt(5)
  v_mfma_f32_16x16x32_bf16 v[72:75], v[56:59], a[32:35], v[72:75]
  ds_read_b64_tr_b16 v[50:51], v25 offset:16480
  v_cndmask_b32 v38, v31, v36, vcc
  v_mov_b32 v27, 0x3f803f80
  s_lshl_b32 s35, s62, 11
  s_lshl_b32 s34, s60, 2
  s_add_u32 s35, s35, s34
  v_mfma_f32_16x16x32_bf16 v[72:75], v[60:63], a[40:43], v[72:75]
  ds_read_b64_tr_b16 v[52:53], v23 offset:32864
  ds_read_b64_tr_b16 v[54:55], v25 offset:32864
  buffer_load_dwordx4 v21, s[16:19], s74 offen offset:1024 lds
  s_add_u32 s35, s35, 20119552
  s_lshl_b32 s90, s61, 7
  s_add_u32 s90, s90, s35
  v_mfma_f32_16x16x32_bf16 v[76:79], v[60:63], a[44:47], v[76:79]
  s_add_u32 m0, s81, 14336
  s_xor_b32 s74, s73, 0
  v_lshrrev_b32 v245, 2, v1
  v_lshl_add_u32 v247, v245, 7, s35
  s_lshl_b32 s79, s68, 8
  s_add_u32 s79, s79, 19660800
  v_mfma_f32_16x16x32_bf16 v[76:79], v[56:59], a[36:39], v[76:79]
  ds_read_b64_tr_b16 v[56:57], v23 offset:16512
  v_lshl_add_u32 v239, v230, 3, s79
  v_add_u32 v232, s75, v230
  v_subrev_u32 v233, 20, v230
  v_lshlrev_b32 v233, 2, v233
  s_add_u32 s76, s60, 80
  s_waitcnt lgkmcnt(5)
  v_mfma_f32_16x16x32_bf16 v[80:83], v[40:43], a[32:35], v[80:83]
  ds_read_b64_tr_b16 v[58:59], v25 offset:16512
  v_add_u32 v233, s76, v233
  v_cmp_gt_u32 vcc, 20, v230
  s_nop 1
  v_cndmask_b32 v232, v233, v232, vcc
  v_mul_u32_u24 v232, 176, v232
  v_add_u32 v232, 109568, v232
  v_mfma_f32_16x16x32_bf16 v[80:83], v[44:47], a[40:43], v[80:83]
  ds_read_b64_tr_b16 v[60:61], v23 offset:32896
  ds_read_b64_tr_b16 v[62:63], v25 offset:32896
  v_mov_b32 v233, 125408
  v_cmp_gt_u32 vcc, 22, v230
  s_nop 1
  v_cndmask_b32 v232, v233, v232, vcc
  v_mul_u32_u24 v234, 80, v231
  v_add_u32 v234, v234, v232
  v_mfma_f32_16x16x32_bf16 v[84:87], v[44:47], a[44:47], v[84:87]
  buffer_load_dwordx4 v20, s[16:19], s74 offen lds
  s_lshl_b32 s75, s75, 1
  v_lshl_add_u32 v232, v231, 3, v232
  v_add_u32 v240, s75, v232
  v_cmp_gt_u32 vcc, 22, v1
  v_mfma_f32_16x16x32_bf16 v[84:87], v[40:43], a[36:39], v[84:87]
  s_waitcnt vmcnt(20) lgkmcnt(0)
  s_barrier
  ds_read_b128 a[48:51], v8 offset:4096
  v_cndmask_b32 v241, v233, v240, vcc
  v_mul_u32_u24 v232, 176, v230
  v_lshl_add_u32 v232, v231, 3, v232
  v_mfma_f32_16x16x32_bf16 v[88:91], v[48:51], a[32:35], v[88:91]
  ds_read_b128 a[52:55], v8 offset:6144
  ds_read_b64_tr_b16 v[40:41], v22 offset:160
  ds_read_b64_tr_b16 v[42:43], v24 offset:160
  v_add_u32 v238, 109568, v232
  v_lshlrev_b32 v242, 4, v1
  v_add_u32 v242, s36, v242
  v_mfma_f32_16x16x32_bf16 v[88:91], v[52:55], a[40:43], v[88:91]
  ds_read_b128 a[56:59], v9 offset:4096
  ds_read_b128 a[60:63], v9 offset:6144
  ds_read_b64_tr_b16 v[44:45], v22 offset:16544
  s_cmp_eq_u32 s65, 7
  s_cselect_b32 s59, 1073741824, 0
  v_bfe_u32 v243, v1, 4, 1
  v_mfma_f32_16x16x32_bf16 v[92:95], v[52:55], a[44:47], v[92:95]
  ds_read_b64_tr_b16 v[46:47], v24 offset:16544
  buffer_load_dwordx4 v21, s[16:19], s74 offen offset:1024 lds
  v_mul_u32_u24 v243, s39, v243
  v_add_u32 v243, s38, v243
  v_and_b32 v244, 3, v1
  v_mfma_f32_16x16x32_bf16 v[92:95], v[48:51], a[36:39], v[92:95]
  ds_read_b64_tr_b16 v[48:49], v22 offset:192
  ds_read_b64_tr_b16 v[50:51], v24 offset:192
  v_lshl_add_u32 v243, v244, 2, v243
  v_bfe_u32 v244, v1, 2, 2
  v_lshl_add_u32 v243, v244, 7, v243
  s_lshl_b32 s52, s60, 9
  v_mfma_f32_16x16x32_bf16 v[96:99], v[56:59], a[32:35], v[96:99]
  s_add_u32 m0, s82, 65536
  s_add_u32 s84, s84, 122880
  s_sub_u32 s3, s84, 2457600
  s_add_u32 s52, s52, 19927040
  v_bfe_u32 v30, v1, 3, 2
  v_lshl_add_u32 v30, v30, 7, s52
  v_mfma_f32_16x16x32_bf16 v[96:99], v[60:63], a[40:43], v[96:99]
  ds_read_b64_tr_b16 v[52:53], v22 offset:16576
  ds_read_b64_tr_b16 v[54:55], v24 offset:16576
  s_min_u32 s84, s84, s3
  v_cmp_gt_u32 vcc, 32, v1
  s_nop 1
  v_cndmask_b32 v244, v30, v243, vcc
  v_lshrrev_b32 v10, 3, v0
  v_lshlrev_b32 v10, 8, v10
  v_mfma_f32_16x16x32_bf16 v[100:103], v[60:63], a[44:47], v[100:103]
  buffer_load_dwordx4 v12, s[8:11], s84 offen offset:0 lds
  v_add_u32 v10, s2, v10
  v_lshlrev_b32 v10, 4, v10
  v_and_b32 v10, 0xffffff80, v10
  v_min_u32 v10, L_code_end-L_pc-4, v10
  v_mfma_f32_16x16x32_bf16 v[100:103], v[56:59], a[36:39], v[100:103]
  ds_read_b64_tr_b16 v[56:57], v22 offset:224
  ds_read_b64_tr_b16 v[58:59], v24 offset:224
  global_load_dword v10, v10, s[32:33]
  s_waitcnt lgkmcnt(6)
  v_mfma_f32_16x16x32_bf16 v[128:131], a[48:51], v[40:43], v[128:131]
  buffer_load_dwordx4 v13, s[8:11], s84 offen offset:1024 lds
  v_mfma_f32_16x16x32_bf16 v[128:131], a[56:59], v[44:47], v[128:131]
  ds_read_b64_tr_b16 v[60:61], v22 offset:16608
  v_mfma_f32_16x16x32_bf16 v[132:135], a[60:63], v[44:47], v[132:135]
  ds_read_b64_tr_b16 v[62:63], v24 offset:16608
  v_mfma_f32_16x16x32_bf16 v[132:135], a[52:55], v[40:43], v[132:135]
  ds_read_b64_tr_b16 v[40:41], v22 offset:256
  ds_read_b64_tr_b16 v[42:43], v24 offset:256
  s_waitcnt lgkmcnt(6)
  v_mfma_f32_16x16x32_bf16 v[136:139], a[48:51], v[48:51], v[136:139]
  buffer_load_dwordx4 v14, s[8:11], s84 offen offset:2048 lds
  v_mfma_f32_16x16x32_bf16 v[136:139], a[56:59], v[52:55], v[136:139]
  ds_read_b64_tr_b16 v[44:45], v22 offset:16640
  v_mfma_f32_16x16x32_bf16 v[140:143], a[60:63], v[52:55], v[140:143]
  ds_read_b64_tr_b16 v[46:47], v24 offset:16640
  v_mfma_f32_16x16x32_bf16 v[140:143], a[52:55], v[48:51], v[140:143]
  ds_read_b64_tr_b16 v[48:49], v22 offset:288
  ds_read_b64_tr_b16 v[50:51], v24 offset:288
  s_waitcnt lgkmcnt(6)
  v_mfma_f32_16x16x32_bf16 v[144:147], a[48:51], v[56:59], v[144:147]
  buffer_load_dwordx4 v15, s[8:11], s84 offen offset:3072 lds
  s_add_u32 m0, s82, 81920
  v_mfma_f32_16x16x32_bf16 v[144:147], a[56:59], v[60:63], v[144:147]
  ds_read_b64_tr_b16 v[52:53], v22 offset:16672
  ds_read_b64_tr_b16 v[54:55], v24 offset:16672
  s_add_u32 s84, s84, 122880
  v_mfma_f32_16x16x32_bf16 v[148:151], a[60:63], v[60:63], v[148:151]
  s_sub_u32 s3, s84, 2457600
  s_min_u32 s84, s84, s3
  v_mfma_f32_16x16x32_bf16 v[148:151], a[52:55], v[56:59], v[148:151]
  ds_read_b64_tr_b16 v[56:57], v22 offset:320
  ds_read_b64_tr_b16 v[58:59], v24 offset:320
  s_waitcnt lgkmcnt(6)
  v_mfma_f32_16x16x32_bf16 v[152:155], a[48:51], v[40:43], v[152:155]
  buffer_load_dwordx4 v12, s[8:11], s84 offen offset:0 lds
  v_mfma_f32_16x16x32_bf16 v[152:155], a[56:59], v[44:47], v[152:155]
  ds_read_b64_tr_b16 v[60:61], v22 offset:16704
  v_mfma_f32_16x16x32_bf16 v[156:159], a[60:63], v[44:47], v[156:159]
  ds_read_b64_tr_b16 v[62:63], v24 offset:16704
  v_mfma_f32_16x16x32_bf16 v[156:159], a[52:55], v[40:43], v[156:159]
  ds_read_b64_tr_b16 v[40:41], v22 offset:352
  ds_read_b64_tr_b16 v[42:43], v24 offset:352
  s_waitcnt lgkmcnt(6)
  v_mfma_f32_16x16x32_bf16 v[160:163], a[48:51], v[48:51], v[160:163]
  buffer_load_dwordx4 v13, s[8:11], s84 offen offset:1024 lds
  v_mfma_f32_16x16x32_bf16 v[160:163], a[56:59], v[52:55], v[160:163]
  ds_read_b64_tr_b16 v[44:45], v22 offset:16736
  ds_read_b64_tr_b16 v[46:47], v24 offset:16736
  v_mfma_f32_16x16x32_bf16 v[164:167], a[60:63], v[52:55], v[164:167]
  buffer_load_dwordx4 v14, s[8:11], s84 offen offset:2048 lds
  v_mfma_f32_16x16x32_bf16 v[164:167], a[52:55], v[48:51], v[164:167]
  ds_read_b64_tr_b16 v[48:49], v22 offset:384
  s_waitcnt lgkmcnt(5)
  v_mfma_f32_16x16x32_bf16 v[168:171], a[48:51], v[56:59], v[168:171]
  ds_read_b64_tr_b16 v[50:51], v24 offset:384
  v_mfma_f32_16x16x32_bf16 v[168:171], a[56:59], v[60:63], v[168:171]
  ds_read_b64_tr_b16 v[52:53], v22 offset:16768
  ds_read_b64_tr_b16 v[54:55], v24 offset:16768
  buffer_load_dwordx4 v15, s[8:11], s84 offen offset:3072 lds
  v_mfma_f32_16x16x32_bf16 v[172:175], a[60:63], v[60:63], v[172:175]
  s_add_u32 m0, s81, 4096
  s_add_u32 s83, s83, 128
  v_mfma_f32_16x16x32_bf16 v[172:175], a[52:55], v[56:59], v[172:175]
  ds_read_b64_tr_b16 v[56:57], v22 offset:416
  ds_read_b64_tr_b16 v[58:59], v24 offset:416
  s_waitcnt lgkmcnt(6)
  v_mfma_f32_16x16x32_bf16 v[176:179], a[48:51], v[40:43], v[176:179]
  s_sub_u32 s3, s83, 1280
  s_min_u32 s83, s83, s3
  v_mfma_f32_16x16x32_bf16 v[176:179], a[56:59], v[44:47], v[176:179]
  ds_read_b64_tr_b16 v[60:61], v22 offset:16800
  ds_read_b64_tr_b16 v[62:63], v24 offset:16800
  v_mfma_f32_16x16x32_bf16 v[180:183], a[60:63], v[44:47], v[180:183]
  buffer_load_dwordx4 v4, s[4:7], s83 offen offset:0 lds
  v_mfma_f32_16x16x32_bf16 v[180:183], a[52:55], v[40:43], v[180:183]
  ds_read_b64_tr_b16 v[40:41], v22 offset:448
  s_waitcnt lgkmcnt(5)
  v_mfma_f32_16x16x32_bf16 v[184:187], a[48:51], v[48:51], v[184:187]
  ds_read_b64_tr_b16 v[42:43], v24 offset:448
  v_mfma_f32_16x16x32_bf16 v[184:187], a[56:59], v[52:55], v[184:187]
  ds_read_b64_tr_b16 v[44:45], v22 offset:16832
  ds_read_b64_tr_b16 v[46:47], v24 offset:16832
  v_mfma_f32_16x16x32_bf16 v[188:191], a[60:63], v[52:55], v[188:191]
  buffer_load_dwordx4 v5, s[4:7], s83 offen offset:1024 lds
  v_mfma_f32_16x16x32_bf16 v[188:191], a[52:55], v[48:51], v[188:191]
  ds_read_b64_tr_b16 v[48:49], v22 offset:0
  s_waitcnt lgkmcnt(5)
  v_mfma_f32_16x16x32_bf16 v[192:195], a[48:51], v[56:59], v[192:195]
  ds_read_b64_tr_b16 v[50:51], v24 offset:0
  v_mfma_f32_16x16x32_bf16 v[192:195], a[56:59], v[60:63], v[192:195]
  ds_read_b64_tr_b16 v[52:53], v22 offset:16384
  ds_read_b64_tr_b16 v[54:55], v24 offset:16384
  v_mfma_f32_16x16x32_bf16 v[196:199], a[60:63], v[60:63], v[196:199]
  buffer_load_dwordx4 v6, s[4:7], s83 offen offset:2048 lds
  v_mfma_f32_16x16x32_bf16 v[196:199], a[52:55], v[56:59], v[196:199]
  ds_read_b64_tr_b16 v[56:57], v22 offset:32
  s_waitcnt lgkmcnt(5)
  v_mfma_f32_16x16x32_bf16 v[200:203], a[48:51], v[40:43], v[200:203]
  ds_read_b64_tr_b16 v[58:59], v24 offset:32
  v_mfma_f32_16x16x32_bf16 v[200:203], a[56:59], v[44:47], v[200:203]
  ds_read_b64_tr_b16 v[60:61], v22 offset:16416
  ds_read_b64_tr_b16 v[62:63], v24 offset:16416
  v_mfma_f32_16x16x32_bf16 v[204:207], a[60:63], v[44:47], v[204:207]
  buffer_load_dwordx4 v7, s[4:7], s83 offen offset:3072 lds
  v_mfma_f32_16x16x32_bf16 v[204:207], a[52:55], v[40:43], v[204:207]
  ds_read_b64_tr_b16 v[40:41], v22 offset:64
  s_waitcnt lgkmcnt(5)
  v_mfma_f32_16x16x32_bf16 v[64:67], v[48:51], a[48:51], v[64:67]
  ds_read_b64_tr_b16 v[42:43], v24 offset:64
  v_mfma_f32_16x16x32_bf16 v[64:67], v[52:55], a[56:59], v[64:67]
  ds_read_b64_tr_b16 v[44:45], v22 offset:16448
  v_mfma_f32_16x16x32_bf16 v[68:71], v[52:55], a[60:63], v[68:71]
  ds_read_b64_tr_b16 v[46:47], v24 offset:16448
  v_mfma_f32_16x16x32_bf16 v[68:71], v[48:51], a[52:55], v[68:71]
  ds_read_b64_tr_b16 v[48:49], v22 offset:96
  s_waitcnt lgkmcnt(5)
  v_mfma_f32_16x16x32_bf16 v[72:75], v[56:59], a[48:51], v[72:75]
  ds_read_b64_tr_b16 v[50:51], v24 offset:96
  v_mfma_f32_16x16x32_bf16 v[72:75], v[60:63], a[56:59], v[72:75]
  ds_read_b64_tr_b16 v[52:53], v22 offset:16480
  v_mfma_f32_16x16x32_bf16 v[76:79], v[60:63], a[60:63], v[76:79]
  ds_read_b64_tr_b16 v[54:55], v24 offset:16480
  v_mfma_f32_16x16x32_bf16 v[76:79], v[56:59], a[52:55], v[76:79]
  ds_read_b64_tr_b16 v[56:57], v22 offset:128
  s_waitcnt lgkmcnt(5)
  v_mfma_f32_16x16x32_bf16 v[80:83], v[40:43], a[48:51], v[80:83]
  ds_read_b64_tr_b16 v[58:59], v24 offset:128
  v_mfma_f32_16x16x32_bf16 v[80:83], v[44:47], a[56:59], v[80:83]
  ds_read_b64_tr_b16 v[60:61], v22 offset:16512
  v_mfma_f32_16x16x32_bf16 v[84:87], v[44:47], a[60:63], v[84:87]
  ds_read_b64_tr_b16 v[62:63], v24 offset:16512
  v_mfma_f32_16x16x32_bf16 v[84:87], v[40:43], a[52:55], v[84:87]
  s_waitcnt vmcnt(19) lgkmcnt(0)
  s_barrier
  ds_read_b128 a[64:67], v8 offset:0
  v_mfma_f32_16x16x32_bf16 v[88:91], v[48:51], a[48:51], v[88:91]
  ds_read_b128 a[68:71], v8 offset:2048
  ds_read_b64_tr_b16 v[40:41], v22 offset:32928
  ds_read_b64_tr_b16 v[42:43], v24 offset:32928
  v_mfma_f32_16x16x32_bf16 v[88:91], v[52:55], a[56:59], v[88:91]
  ds_read_b128 a[72:75], v9 offset:0
  ds_read_b128 a[76:79], v9 offset:2048
  v_mfma_f32_16x16x32_bf16 v[92:95], v[52:55], a[60:63], v[92:95]
  ds_read_b64_tr_b16 v[44:45], v23 offset:160
  ds_read_b64_tr_b16 v[46:47], v25 offset:160
  s_add_u32 m0, s82, 0
  v_mfma_f32_16x16x32_bf16 v[92:95], v[48:51], a[52:55], v[92:95]
  ds_read_b64_tr_b16 v[48:49], v22 offset:32960
  ds_read_b64_tr_b16 v[50:51], v24 offset:32960
  s_add_u32 s84, s84, 122880
  v_mfma_f32_16x16x32_bf16 v[96:99], v[56:59], a[48:51], v[96:99]
  s_sub_u32 s3, s84, 2457600
  s_min_u32 s84, s84, s3
  buffer_load_dwordx4 v12, s[8:11], s84 offen offset:0 lds
  v_mfma_f32_16x16x32_bf16 v[96:99], v[60:63], a[56:59], v[96:99]
  ds_read_b64_tr_b16 v[52:53], v23 offset:192
  ds_read_b64_tr_b16 v[54:55], v25 offset:192
  v_mfma_f32_16x16x32_bf16 v[100:103], v[60:63], a[60:63], v[100:103]
  buffer_load_dwordx4 v13, s[8:11], s84 offen offset:1024 lds
  v_mfma_f32_16x16x32_bf16 v[100:103], v[56:59], a[52:55], v[100:103]
  ds_read_b64_tr_b16 v[56:57], v22 offset:32992
  ds_read_b64_tr_b16 v[58:59], v24 offset:32992
  s_waitcnt lgkmcnt(6)
  v_mfma_f32_16x16x32_bf16 v[128:131], a[64:67], v[40:43], v[128:131]
  s_waitcnt vmcnt(15)
  ds_read_b128 a[160:163], v218 offset:8192
  v_mfma_f32_16x16x32_bf16 v[128:131], a[72:75], v[44:47], v[128:131]
  ds_read_b64_tr_b16 v[60:61], v23 offset:224
  ds_read_b64_tr_b16 v[62:63], v25 offset:224
  v_mfma_f32_16x16x32_bf16 v[132:135], a[76:79], v[44:47], v[132:135]
  buffer_load_dwordx4 v14, s[8:11], s84 offen offset:2048 lds
  v_mfma_f32_16x16x32_bf16 v[132:135], a[68:71], v[40:43], v[132:135]
  ds_read_b64_tr_b16 v[40:41], v22 offset:33024
  ds_read_b64_tr_b16 v[42:43], v24 offset:33024
  s_waitcnt lgkmcnt(7)
  v_mfma_f32_16x16x32_bf16 v[136:139], a[64:67], v[48:51], v[136:139]
  ds_read_b128 a[176:179], v219 offset:8192
  v_mfma_f32_16x16x32_bf16 v[136:139], a[72:75], v[52:55], v[136:139]
  ds_read_b64_tr_b16 v[44:45], v23 offset:256
  ds_read_b64_tr_b16 v[46:47], v25 offset:256
  buffer_load_dwordx4 v15, s[8:11], s84 offen offset:3072 lds
  v_mfma_f32_16x16x32_bf16 v[140:143], a[76:79], v[52:55], v[140:143]
  s_add_u32 m0, s82, 16384
  s_add_u32 s84, s84, 122880
  v_mfma_f32_16x16x32_bf16 v[140:143], a[68:71], v[48:51], v[140:143]
  ds_read_b64_tr_b16 v[48:49], v22 offset:33056
  ds_read_b64_tr_b16 v[50:51], v24 offset:33056
  s_waitcnt lgkmcnt(7)
  v_mfma_f32_16x16x32_bf16 v[144:147], a[64:67], v[56:59], v[144:147]
  s_sub_u32 s3, s84, 2457600
  s_min_u32 s84, s84, s3
  v_mfma_f32_16x16x32_bf16 v[144:147], a[72:75], v[60:63], v[144:147]
  ds_read_b64_tr_b16 v[52:53], v23 offset:288
  ds_read_b64_tr_b16 v[54:55], v25 offset:288
  v_mfma_f32_16x16x32_bf16 v[148:151], a[76:79], v[60:63], v[148:151]
  buffer_load_dwordx4 v12, s[8:11], s84 offen offset:0 lds
  v_mfma_f32_16x16x32_bf16 v[148:151], a[68:71], v[56:59], v[148:151]
  ds_read_b64_tr_b16 v[56:57], v22 offset:33088
  ds_read_b64_tr_b16 v[58:59], v24 offset:33088
  s_waitcnt lgkmcnt(6)
  v_mfma_f32_16x16x32_bf16 v[152:155], a[64:67], v[40:43], v[152:155]
  ds_read_b128 a[164:167], v218 offset:10240
  v_mfma_f32_16x16x32_bf16 v[152:155], a[72:75], v[44:47], v[152:155]
  ds_read_b64_tr_b16 v[60:61], v23 offset:320
  ds_read_b64_tr_b16 v[62:63], v25 offset:320
  v_mfma_f32_16x16x32_bf16 v[156:159], a[76:79], v[44:47], v[156:159]
  buffer_load_dwordx4 v13, s[8:11], s84 offen offset:1024 lds
  v_mfma_f32_16x16x32_bf16 v[156:159], a[68:71], v[40:43], v[156:159]
  ds_read_b64_tr_b16 v[40:41], v22 offset:33120
  ds_read_b64_tr_b16 v[42:43], v24 offset:33120
  s_waitcnt lgkmcnt(7)
  v_mfma_f32_16x16x32_bf16 v[160:163], a[64:67], v[48:51], v[160:163]
  ds_read_b128 a[180:183], v219 offset:10240
  v_mfma_f32_16x16x32_bf16 v[160:163], a[72:75], v[52:55], v[160:163]
  ds_read_b64_tr_b16 v[44:45], v23 offset:352
  ds_read_b64_tr_b16 v[46:47], v25 offset:352
  v_mfma_f32_16x16x32_bf16 v[164:167], a[76:79], v[52:55], v[164:167]
  buffer_load_dwordx4 v14, s[8:11], s84 offen offset:2048 lds
  v_mfma_f32_16x16x32_bf16 v[164:167], a[68:71], v[48:51], v[164:167]
  ds_read_b64_tr_b16 v[48:49], v22 offset:33152
  ds_read_b64_tr_b16 v[50:51], v24 offset:33152
  s_waitcnt lgkmcnt(7)
  v_mfma_f32_16x16x32_bf16 v[168:171], a[64:67], v[56:59], v[168:171]
  ds_read_b128 a[168:171], v218 offset:12288
  v_mfma_f32_16x16x32_bf16 v[168:171], a[72:75], v[60:63], v[168:171]
  ds_read_b64_tr_b16 v[52:53], v23 offset:384
  ds_read_b64_tr_b16 v[54:55], v25 offset:384
  buffer_load_dwordx4 v15, s[8:11], s84 offen offset:3072 lds
  v_mfma_f32_16x16x32_bf16 v[172:175], a[76:79], v[60:63], v[172:175]
  s_add_u32 m0, s81, 0
  s_add_u32 s83, s83, 128
  v_mfma_f32_16x16x32_bf16 v[172:175], a[68:71], v[56:59], v[172:175]
  ds_read_b64_tr_b16 v[56:57], v22 offset:33184
  ds_read_b64_tr_b16 v[58:59], v24 offset:33184
  s_waitcnt lgkmcnt(7)
  v_mfma_f32_16x16x32_bf16 v[176:179], a[64:67], v[40:43], v[176:179]
  s_sub_u32 s3, s83, 1280
  s_min_u32 s83, s83, s3
  v_mfma_f32_16x16x32_bf16 v[176:179], a[72:75], v[44:47], v[176:179]
  ds_read_b64_tr_b16 v[60:61], v23 offset:416
  ds_read_b64_tr_b16 v[62:63], v25 offset:416
  v_mfma_f32_16x16x32_bf16 v[180:183], a[76:79], v[44:47], v[180:183]
  buffer_load_dwordx4 v4, s[4:7], s83 offen offset:0 lds
  v_mfma_f32_16x16x32_bf16 v[180:183], a[68:71], v[40:43], v[180:183]
  ds_read_b64_tr_b16 v[40:41], v22 offset:33216
  ds_read_b64_tr_b16 v[42:43], v24 offset:33216
  s_waitcnt lgkmcnt(6)
  v_mfma_f32_16x16x32_bf16 v[184:187], a[64:67], v[48:51], v[184:187]
  ds_read_b128 a[184:187], v219 offset:12288
  v_mfma_f32_16x16x32_bf16 v[184:187], a[72:75], v[52:55], v[184:187]
  ds_read_b64_tr_b16 v[44:45], v23 offset:448
  ds_read_b64_tr_b16 v[46:47], v25 offset:448
  v_mfma_f32_16x16x32_bf16 v[188:191], a[76:79], v[52:55], v[188:191]
  buffer_load_dwordx4 v5, s[4:7], s83 offen offset:1024 lds
  v_mfma_f32_16x16x32_bf16 v[188:191], a[68:71], v[48:51], v[188:191]
  ds_read_b64_tr_b16 v[48:49], v22 offset:32768
  ds_read_b64_tr_b16 v[50:51], v24 offset:32768
  s_waitcnt lgkmcnt(7)
  v_mfma_f32_16x16x32_bf16 v[192:195], a[64:67], v[56:59], v[192:195]
  ds_read_b128 a[172:175], v218 offset:14336
  v_mfma_f32_16x16x32_bf16 v[192:195], a[72:75], v[60:63], v[192:195]
  ds_read_b64_tr_b16 v[52:53], v23 offset:0
  ds_read_b64_tr_b16 v[54:55], v25 offset:0
  v_mfma_f32_16x16x32_bf16 v[196:199], a[76:79], v[60:63], v[196:199]
  buffer_load_dwordx4 v6, s[4:7], s83 offen offset:2048 lds
  v_mfma_f32_16x16x32_bf16 v[196:199], a[68:71], v[56:59], v[196:199]
  ds_read_b64_tr_b16 v[56:57], v22 offset:32800
  ds_read_b64_tr_b16 v[58:59], v24 offset:32800
  s_waitcnt lgkmcnt(7)
  v_mfma_f32_16x16x32_bf16 v[200:203], a[64:67], v[40:43], v[200:203]
  ds_read_b128 a[188:191], v219 offset:14336
  v_mfma_f32_16x16x32_bf16 v[200:203], a[72:75], v[44:47], v[200:203]
  ds_read_b64_tr_b16 v[60:61], v23 offset:32
  ds_read_b64_tr_b16 v[62:63], v25 offset:32
  v_mfma_f32_16x16x32_bf16 v[204:207], a[76:79], v[44:47], v[204:207]
  buffer_load_dwordx4 v7, s[4:7], s83 offen offset:3072 lds
  v_mfma_f32_16x16x32_bf16 v[204:207], a[68:71], v[40:43], v[204:207]
  ds_read_b64_tr_b16 v[40:41], v22 offset:32832
  s_waitcnt lgkmcnt(6)
  v_mfma_f32_16x16x32_bf16 v[64:67], v[48:51], a[64:67], v[64:67]
  ds_read_b64_tr_b16 v[42:43], v24 offset:32832
  v_mfma_f32_16x16x32_bf16 v[64:67], v[52:55], a[72:75], v[64:67]
  ds_read_b64_tr_b16 v[44:45], v23 offset:64
  v_mfma_f32_16x16x32_bf16 v[68:71], v[52:55], a[76:79], v[68:71]
  ds_read_b64_tr_b16 v[46:47], v25 offset:64
  v_mfma_f32_16x16x32_bf16 v[68:71], v[48:51], a[68:71], v[68:71]
  ds_read_b64_tr_b16 v[48:49], v22 offset:32864
  s_waitcnt lgkmcnt(5)
  v_mfma_f32_16x16x32_bf16 v[72:75], v[56:59], a[64:67], v[72:75]
  ds_read_b64_tr_b16 v[50:51], v24 offset:32864
  v_mfma_f32_16x16x32_bf16 v[72:75], v[60:63], a[72:75], v[72:75]
  ds_read_b64_tr_b16 v[52:53], v23 offset:96
  v_mfma_f32_16x16x32_bf16 v[76:79], v[60:63], a[76:79], v[76:79]
  ds_read_b64_tr_b16 v[54:55], v25 offset:96
  v_mfma_f32_16x16x32_bf16 v[76:79], v[56:59], a[68:71], v[76:79]
  ds_read_b64_tr_b16 v[56:57], v22 offset:32896
  s_waitcnt lgkmcnt(5)
  v_mfma_f32_16x16x32_bf16 v[80:83], v[40:43], a[64:67], v[80:83]
  ds_read_b64_tr_b16 v[58:59], v24 offset:32896
  v_mfma_f32_16x16x32_bf16 v[80:83], v[44:47], a[72:75], v[80:83]
  ds_read_b64_tr_b16 v[60:61], v23 offset:128
  v_mfma_f32_16x16x32_bf16 v[84:87], v[44:47], a[76:79], v[84:87]
  ds_read_b64_tr_b16 v[62:63], v25 offset:128
  v_mfma_f32_16x16x32_bf16 v[84:87], v[40:43], a[68:71], v[84:87]
  s_waitcnt vmcnt(12) lgkmcnt(0)
  s_barrier
  ds_read_b128 a[80:83], v8 offset:4096
  v_mfma_f32_16x16x32_bf16 v[88:91], v[48:51], a[64:67], v[88:91]
  ds_read_b128 a[84:87], v8 offset:6144
  ds_read_b64_tr_b16 v[40:41], v23 offset:16544
  ds_read_b64_tr_b16 v[42:43], v25 offset:16544
  v_mfma_f32_16x16x32_bf16 v[88:91], v[52:55], a[72:75], v[88:91]
  ds_read_b128 a[88:91], v9 offset:4096
  ds_read_b128 a[92:95], v9 offset:6144
  v_mfma_f32_16x16x32_bf16 v[92:95], v[52:55], a[76:79], v[92:95]
  ds_read_b64_tr_b16 v[44:45], v23 offset:32928
  ds_read_b64_tr_b16 v[46:47], v25 offset:32928
  s_add_u32 m0, s82, 32768
  v_mfma_f32_16x16x32_bf16 v[92:95], v[48:51], a[68:71], v[92:95]
  ds_read_b64_tr_b16 v[48:49], v23 offset:16576
  ds_read_b64_tr_b16 v[50:51], v25 offset:16576
  s_add_u32 s84, s84, 122880
  v_mfma_f32_16x16x32_bf16 v[96:99], v[56:59], a[64:67], v[96:99]
  s_sub_u32 s3, s84, 2457600
  s_min_u32 s84, s84, s3
  buffer_load_dwordx4 v12, s[8:11], s84 offen offset:0 lds
  v_mfma_f32_16x16x32_bf16 v[96:99], v[60:63], a[72:75], v[96:99]
  ds_read_b64_tr_b16 v[52:53], v23 offset:32960
  ds_read_b64_tr_b16 v[54:55], v25 offset:32960
  v_mfma_f32_16x16x32_bf16 v[100:103], v[60:63], a[76:79], v[100:103]
  buffer_load_dwordx4 v13, s[8:11], s84 offen offset:1024 lds
  v_mfma_f32_16x16x32_bf16 v[100:103], v[56:59], a[68:71], v[100:103]
  ds_read_b64_tr_b16 v[56:57], v23 offset:16608
  s_waitcnt lgkmcnt(5)
  v_mfma_f32_16x16x32_bf16 v[128:131], a[80:83], v[40:43], v[128:131]
  ds_read_b64_tr_b16 v[58:59], v25 offset:16608
  v_mfma_f32_16x16x32_bf16 v[128:131], a[88:91], v[44:47], v[128:131]
  ds_read_b64_tr_b16 v[60:61], v23 offset:32992
  ds_read_b64_tr_b16 v[62:63], v25 offset:32992
  v_mfma_f32_16x16x32_bf16 v[132:135], a[92:95], v[44:47], v[132:135]
  buffer_load_dwordx4 v14, s[8:11], s84 offen offset:2048 lds
  v_mfma_f32_16x16x32_bf16 v[132:135], a[84:87], v[40:43], v[132:135]
  ds_read_b64_tr_b16 v[40:41], v23 offset:16640
  s_waitcnt lgkmcnt(5)
  v_mfma_f32_16x16x32_bf16 v[136:139], a[80:83], v[48:51], v[136:139]
  ds_read_b64_tr_b16 v[42:43], v25 offset:16640
  v_mfma_f32_16x16x32_bf16 v[136:139], a[88:91], v[52:55], v[136:139]
  ds_read_b64_tr_b16 v[44:45], v23 offset:33024
  ds_read_b64_tr_b16 v[46:47], v25 offset:33024
  buffer_load_dwordx4 v15, s[8:11], s84 offen offset:3072 lds
  v_mfma_f32_16x16x32_bf16 v[140:143], a[92:95], v[52:55], v[140:143]
  s_add_u32 m0, s82, 49152
  s_add_u32 s84, s84, 122880
  v_mfma_f32_16x16x32_bf16 v[140:143], a[84:87], v[48:51], v[140:143]
  ds_read_b64_tr_b16 v[48:49], v23 offset:16672
  ds_read_b64_tr_b16 v[50:51], v25 offset:16672
  s_waitcnt lgkmcnt(6)
  v_mfma_f32_16x16x32_bf16 v[144:147], a[80:83], v[56:59], v[144:147]
  s_sub_u32 s3, s84, 2457600
  s_min_u32 s84, s84, s3
  v_mfma_f32_16x16x32_bf16 v[144:147], a[88:91], v[60:63], v[144:147]
  ds_read_b64_tr_b16 v[52:53], v23 offset:33056
  ds_read_b64_tr_b16 v[54:55], v25 offset:33056
  v_mfma_f32_16x16x32_bf16 v[148:151], a[92:95], v[60:63], v[148:151]
  buffer_load_dwordx4 v12, s[8:11], s84 offen offset:0 lds
  v_mfma_f32_16x16x32_bf16 v[148:151], a[84:87], v[56:59], v[148:151]
  ds_read_b64_tr_b16 v[56:57], v23 offset:16704
  s_waitcnt lgkmcnt(5)
  v_mfma_f32_16x16x32_bf16 v[152:155], a[80:83], v[40:43], v[152:155]
  ds_read_b64_tr_b16 v[58:59], v25 offset:16704
  v_mfma_f32_16x16x32_bf16 v[152:155], a[88:91], v[44:47], v[152:155]
  ds_read_b64_tr_b16 v[60:61], v23 offset:33088
  ds_read_b64_tr_b16 v[62:63], v25 offset:33088
  v_mfma_f32_16x16x32_bf16 v[156:159], a[92:95], v[44:47], v[156:159]
  buffer_load_dwordx4 v13, s[8:11], s84 offen offset:1024 lds
  v_mfma_f32_16x16x32_bf16 v[156:159], a[84:87], v[40:43], v[156:159]
  ds_read_b64_tr_b16 v[40:41], v23 offset:16736
  s_waitcnt lgkmcnt(5)
  v_mfma_f32_16x16x32_bf16 v[160:163], a[80:83], v[48:51], v[160:163]
  ds_read_b64_tr_b16 v[42:43], v25 offset:16736
  v_mfma_f32_16x16x32_bf16 v[160:163], a[88:91], v[52:55], v[160:163]
  ds_read_b64_tr_b16 v[44:45], v23 offset:33120
  ds_read_b64_tr_b16 v[46:47], v25 offset:33120
  v_mfma_f32_16x16x32_bf16 v[164:167], a[92:95], v[52:55], v[164:167]
  buffer_load_dwordx4 v14, s[8:11], s84 offen offset:2048 lds
  v_mfma_f32_16x16x32_bf16 v[164:167], a[84:87], v[48:51], v[164:167]
  ds_read_b64_tr_b16 v[48:49], v23 offset:16768
  s_waitcnt lgkmcnt(5)
  v_mfma_f32_16x16x32_bf16 v[168:171], a[80:83], v[56:59], v[168:171]
  ds_read_b64_tr_b16 v[50:51], v25 offset:16768
  v_mfma_f32_16x16x32_bf16 v[168:171], a[88:91], v[60:63], v[168:171]
  ds_read_b64_tr_b16 v[52:53], v23 offset:33152
  ds_read_b64_tr_b16 v[54:55], v25 offset:33152
  buffer_load_dwordx4 v15, s[8:11], s84 offen offset:3072 lds
  v_mfma_f32_16x16x32_bf16 v[172:175], a[92:95], v[60:63], v[172:175]
  s_add_u32 m0, s81, 4096
  s_add_u32 s83, s83, 128
  v_mfma_f32_16x16x32_bf16 v[172:175], a[84:87], v[56:59], v[172:175]
  ds_read_b64_tr_b16 v[56:57], v23 offset:16800
  ds_read_b64_tr_b16 v[58:59], v25 offset:16800
  s_waitcnt lgkmcnt(6)
  v_mfma_f32_16x16x32_bf16 v[176:179], a[80:83], v[40:43], v[176:179]
  s_sub_u32 s3, s83, 1280
  s_min_u32 s83, s83, s3
  v_mfma_f32_16x16x32_bf16 v[176:179], a[88:91], v[44:47], v[176:179]
  ds_read_b64_tr_b16 v[60:61], v23 offset:33184
  ds_read_b64_tr_b16 v[62:63], v25 offset:33184
  v_mfma_f32_16x16x32_bf16 v[180:183], a[92:95], v[44:47], v[180:183]
  buffer_load_dwordx4 v4, s[4:7], s83 offen offset:0 lds
  v_mfma_f32_16x16x32_bf16 v[180:183], a[84:87], v[40:43], v[180:183]
  ds_read_b64_tr_b16 v[40:41], v23 offset:16832
  s_waitcnt lgkmcnt(5)
  v_mfma_f32_16x16x32_bf16 v[184:187], a[80:83], v[48:51], v[184:187]
  ds_read_b64_tr_b16 v[42:43], v25 offset:16832
  v_mfma_f32_16x16x32_bf16 v[184:187], a[88:91], v[52:55], v[184:187]
  ds_read_b64_tr_b16 v[44:45], v23 offset:33216
  ds_read_b64_tr_b16 v[46:47], v25 offset:33216
  v_mfma_f32_16x16x32_bf16 v[188:191], a[92:95], v[52:55], v[188:191]
  buffer_load_dwordx4 v5, s[4:7], s83 offen offset:1024 lds
  v_mfma_f32_16x16x32_bf16 v[188:191], a[84:87], v[48:51], v[188:191]
  ds_read_b64_tr_b16 v[48:49], v23 offset:16384
  s_waitcnt lgkmcnt(5)
  v_mfma_f32_16x16x32_bf16 v[192:195], a[80:83], v[56:59], v[192:195]
  ds_read_b64_tr_b16 v[50:51], v25 offset:16384
  v_mfma_f32_16x16x32_bf16 v[192:195], a[88:91], v[60:63], v[192:195]
  ds_read_b64_tr_b16 v[52:53], v23 offset:32768
  ds_read_b64_tr_b16 v[54:55], v25 offset:32768
  v_mfma_f32_16x16x32_bf16 v[196:199], a[92:95], v[60:63], v[196:199]
  buffer_load_dwordx4 v6, s[4:7], s83 offen offset:2048 lds
  v_mfma_f32_16x16x32_bf16 v[196:199], a[84:87], v[56:59], v[196:199]
  ds_read_b64_tr_b16 v[56:57], v23 offset:16416
  s_waitcnt lgkmcnt(5)
  v_mfma_f32_16x16x32_bf16 v[200:203], a[80:83], v[40:43], v[200:203]
  ds_read_b64_tr_b16 v[58:59], v25 offset:16416
  v_mfma_f32_16x16x32_bf16 v[200:203], a[88:91], v[44:47], v[200:203]
  ds_read_b64_tr_b16 v[60:61], v23 offset:32800
  ds_read_b64_tr_b16 v[62:63], v25 offset:32800
  v_mfma_f32_16x16x32_bf16 v[204:207], a[92:95], v[44:47], v[204:207]
  buffer_load_dwordx4 v7, s[4:7], s83 offen offset:3072 lds
  v_mfma_f32_16x16x32_bf16 v[204:207], a[84:87], v[40:43], v[204:207]
  ds_read_b64_tr_b16 v[40:41], v23 offset:16448
  s_waitcnt lgkmcnt(5)
  v_mfma_f32_16x16x32_bf16 v[64:67], v[48:51], a[80:83], v[64:67]
  ds_read_b64_tr_b16 v[42:43], v25 offset:16448
  v_mfma_f32_16x16x32_bf16 v[64:67], v[52:55], a[88:91], v[64:67]
  ds_read_b64_tr_b16 v[44:45], v23 offset:32832
  v_mfma_f32_16x16x32_bf16 v[68:71], v[52:55], a[92:95], v[68:71]
  ds_read_b64_tr_b16 v[46:47], v25 offset:32832
  v_mfma_f32_16x16x32_bf16 v[68:71], v[48:51], a[84:87], v[68:71]
  ds_read_b64_tr_b16 v[48:49], v23 offset:16480
  s_waitcnt lgkmcnt(5)
  v_mfma_f32_16x16x32_bf16 v[72:75], v[56:59], a[80:83], v[72:75]
  ds_read_b64_tr_b16 v[50:51], v25 offset:16480
  v_mfma_f32_16x16x32_bf16 v[72:75], v[60:63], a[88:91], v[72:75]
  ds_read_b64_tr_b16 v[52:53], v23 offset:32864
  v_mfma_f32_16x16x32_bf16 v[76:79], v[60:63], a[92:95], v[76:79]
  ds_read_b64_tr_b16 v[54:55], v25 offset:32864
  v_mfma_f32_16x16x32_bf16 v[76:79], v[56:59], a[84:87], v[76:79]
  ds_read_b64_tr_b16 v[56:57], v23 offset:16512
  s_waitcnt lgkmcnt(5)
  v_mfma_f32_16x16x32_bf16 v[80:83], v[40:43], a[80:83], v[80:83]
  ds_read_b64_tr_b16 v[58:59], v25 offset:16512
  v_mfma_f32_16x16x32_bf16 v[80:83], v[44:47], a[88:91], v[80:83]
  ds_read_b64_tr_b16 v[60:61], v23 offset:32896
  v_mfma_f32_16x16x32_bf16 v[84:87], v[44:47], a[92:95], v[84:87]
  ds_read_b64_tr_b16 v[62:63], v25 offset:32896
  v_mfma_f32_16x16x32_bf16 v[84:87], v[40:43], a[84:87], v[84:87]
  s_waitcnt vmcnt(12) lgkmcnt(0)
  s_barrier
  ds_read_b128 a[96:99], v8 offset:0
  v_mfma_f32_16x16x32_bf16 v[88:91], v[48:51], a[80:83], v[88:91]
  ds_read_b128 a[100:103], v8 offset:2048
  ds_read_b64_tr_b16 v[40:41], v22 offset:160
  ds_read_b64_tr_b16 v[42:43], v24 offset:160
  v_mfma_f32_16x16x32_bf16 v[88:91], v[52:55], a[88:91], v[88:91]
  ds_read_b128 a[104:107], v9 offset:0
  ds_read_b128 a[108:111], v9 offset:2048
  v_mfma_f32_16x16x32_bf16 v[92:95], v[52:55], a[92:95], v[92:95]
  ds_read_b64_tr_b16 v[44:45], v22 offset:16544
  ds_read_b64_tr_b16 v[46:47], v24 offset:16544
  s_add_u32 m0, s82, 65536
  v_mfma_f32_16x16x32_bf16 v[92:95], v[48:51], a[84:87], v[92:95]
  ds_read_b64_tr_b16 v[48:49], v22 offset:192
  ds_read_b64_tr_b16 v[50:51], v24 offset:192
  s_add_u32 s84, s84, 122880
  v_mfma_f32_16x16x32_bf16 v[96:99], v[56:59], a[80:83], v[96:99]
  s_sub_u32 s3, s84, 2457600
  s_min_u32 s84, s84, s3
  buffer_load_dwordx4 v12, s[8:11], s84 offen offset:0 lds
  v_mfma_f32_16x16x32_bf16 v[96:99], v[60:63], a[88:91], v[96:99]
  ds_read_b64_tr_b16 v[52:53], v22 offset:16576
  ds_read_b64_tr_b16 v[54:55], v24 offset:16576
  v_mfma_f32_16x16x32_bf16 v[100:103], v[60:63], a[92:95], v[100:103]
  buffer_load_dwordx4 v13, s[8:11], s84 offen offset:1024 lds
  v_mfma_f32_16x16x32_bf16 v[100:103], v[56:59], a[84:87], v[100:103]
  ds_read_b64_tr_b16 v[56:57], v22 offset:224
  s_waitcnt lgkmcnt(5)
  v_mfma_f32_16x16x32_bf16 v[128:131], a[96:99], v[40:43], v[128:131]
  ds_read_b64_tr_b16 v[58:59], v24 offset:224
  v_mfma_f32_16x16x32_bf16 v[128:131], a[104:107], v[44:47], v[128:131]
  ds_read_b64_tr_b16 v[60:61], v22 offset:16608
  ds_read_b64_tr_b16 v[62:63], v24 offset:16608
  v_mfma_f32_16x16x32_bf16 v[132:135], a[108:111], v[44:47], v[132:135]
  buffer_load_dwordx4 v14, s[8:11], s84 offen offset:2048 lds
  v_mfma_f32_16x16x32_bf16 v[132:135], a[100:103], v[40:43], v[132:135]
  ds_read_b64_tr_b16 v[40:41], v22 offset:256
  s_waitcnt lgkmcnt(5)
  v_mfma_f32_16x16x32_bf16 v[136:139], a[96:99], v[48:51], v[136:139]
  ds_read_b64_tr_b16 v[42:43], v24 offset:256
  v_mfma_f32_16x16x32_bf16 v[136:139], a[104:107], v[52:55], v[136:139]
  ds_read_b64_tr_b16 v[44:45], v22 offset:16640
  ds_read_b64_tr_b16 v[46:47], v24 offset:16640
  buffer_load_dwordx4 v15, s[8:11], s84 offen offset:3072 lds
  v_mfma_f32_16x16x32_bf16 v[140:143], a[108:111], v[52:55], v[140:143]
  s_add_u32 m0, s82, 81920
  s_add_u32 s84, s84, 122880
  v_mfma_f32_16x16x32_bf16 v[140:143], a[100:103], v[48:51], v[140:143]
  ds_read_b64_tr_b16 v[48:49], v22 offset:288
  ds_read_b64_tr_b16 v[50:51], v24 offset:288
  s_waitcnt lgkmcnt(6)
  v_mfma_f32_16x16x32_bf16 v[144:147], a[96:99], v[56:59], v[144:147]
  s_sub_u32 s3, s84, 2457600
  s_min_u32 s84, s84, s3
  v_mfma_f32_16x16x32_bf16 v[144:147], a[104:107], v[60:63], v[144:147]
  ds_read_b64_tr_b16 v[52:53], v22 offset:16672
  ds_read_b64_tr_b16 v[54:55], v24 offset:16672
  v_mfma_f32_16x16x32_bf16 v[148:151], a[108:111], v[60:63], v[148:151]
  buffer_load_dwordx4 v12, s[8:11], s84 offen offset:0 lds
  v_mfma_f32_16x16x32_bf16 v[148:151], a[100:103], v[56:59], v[148:151]
  ds_read_b64_tr_b16 v[56:57], v22 offset:320
  s_waitcnt lgkmcnt(5)
  v_mfma_f32_16x16x32_bf16 v[152:155], a[96:99], v[40:43], v[152:155]
  ds_read_b64_tr_b16 v[58:59], v24 offset:320
  v_mfma_f32_16x16x32_bf16 v[152:155], a[104:107], v[44:47], v[152:155]
  ds_read_b64_tr_b16 v[60:61], v22 offset:16704
  ds_read_b64_tr_b16 v[62:63], v24 offset:16704
  v_mfma_f32_16x16x32_bf16 v[156:159], a[108:111], v[44:47], v[156:159]
  buffer_load_dwordx4 v13, s[8:11], s84 offen offset:1024 lds
  v_mfma_f32_16x16x32_bf16 v[156:159], a[100:103], v[40:43], v[156:159]
  ds_read_b64_tr_b16 v[40:41], v22 offset:352
  s_waitcnt lgkmcnt(5)
  v_mfma_f32_16x16x32_bf16 v[160:163], a[96:99], v[48:51], v[160:163]
  ds_read_b64_tr_b16 v[42:43], v24 offset:352
  v_mfma_f32_16x16x32_bf16 v[160:163], a[104:107], v[52:55], v[160:163]
  ds_read_b64_tr_b16 v[44:45], v22 offset:16736
  ds_read_b64_tr_b16 v[46:47], v24 offset:16736
  v_mfma_f32_16x16x32_bf16 v[164:167], a[108:111], v[52:55], v[164:167]
  buffer_load_dwordx4 v14, s[8:11], s84 offen offset:2048 lds
  v_mfma_f32_16x16x32_bf16 v[164:167], a[100:103], v[48:51], v[164:167]
  ds_read_b64_tr_b16 v[48:49], v22 offset:384
  s_waitcnt lgkmcnt(5)
  v_mfma_f32_16x16x32_bf16 v[168:171], a[96:99], v[56:59], v[168:171]
  ds_read_b64_tr_b16 v[50:51], v24 offset:384
  v_mfma_f32_16x16x32_bf16 v[168:171], a[104:107], v[60:63], v[168:171]
  ds_read_b64_tr_b16 v[52:53], v22 offset:16768
  ds_read_b64_tr_b16 v[54:55], v24 offset:16768
  buffer_load_dwordx4 v15, s[8:11], s84 offen offset:3072 lds
  v_mfma_f32_16x16x32_bf16 v[172:175], a[108:111], v[60:63], v[172:175]
  s_add_u32 m0, s81, 0
  s_add_u32 s83, s83, 128
  v_mfma_f32_16x16x32_bf16 v[172:175], a[100:103], v[56:59], v[172:175]
  ds_read_b64_tr_b16 v[56:57], v22 offset:416
  ds_read_b64_tr_b16 v[58:59], v24 offset:416
  s_waitcnt lgkmcnt(6)
  v_mfma_f32_16x16x32_bf16 v[176:179], a[96:99], v[40:43], v[176:179]
  s_sub_u32 s3, s83, 1280
  s_min_u32 s83, s83, s3
  v_mfma_f32_16x16x32_bf16 v[176:179], a[104:107], v[44:47], v[176:179]
  ds_read_b64_tr_b16 v[60:61], v22 offset:16800
  ds_read_b64_tr_b16 v[62:63], v24 offset:16800
  v_mfma_f32_16x16x32_bf16 v[180:183], a[108:111], v[44:47], v[180:183]
  buffer_load_dwordx4 v4, s[4:7], s83 offen offset:0 lds
  v_mfma_f32_16x16x32_bf16 v[180:183], a[100:103], v[40:43], v[180:183]
  ds_read_b64_tr_b16 v[40:41], v22 offset:448
  s_waitcnt lgkmcnt(5)
  v_mfma_f32_16x16x32_bf16 v[184:187], a[96:99], v[48:51], v[184:187]
  ds_read_b64_tr_b16 v[42:43], v24 offset:448
  v_mfma_f32_16x16x32_bf16 v[184:187], a[104:107], v[52:55], v[184:187]
  ds_read_b64_tr_b16 v[44:45], v22 offset:16832
  ds_read_b64_tr_b16 v[46:47], v24 offset:16832
  v_mfma_f32_16x16x32_bf16 v[188:191], a[108:111], v[52:55], v[188:191]
  buffer_load_dwordx4 v5, s[4:7], s83 offen offset:1024 lds
  v_mfma_f32_16x16x32_bf16 v[188:191], a[100:103], v[48:51], v[188:191]
  ds_read_b64_tr_b16 v[48:49], v22 offset:0
  s_waitcnt lgkmcnt(5)
  v_mfma_f32_16x16x32_bf16 v[192:195], a[96:99], v[56:59], v[192:195]
  ds_read_b64_tr_b16 v[50:51], v24 offset:0
  v_mfma_f32_16x16x32_bf16 v[192:195], a[104:107], v[60:63], v[192:195]
  ds_read_b64_tr_b16 v[52:53], v22 offset:16384
  ds_read_b64_tr_b16 v[54:55], v24 offset:16384
  v_mfma_f32_16x16x32_bf16 v[196:199], a[108:111], v[60:63], v[196:199]
  buffer_load_dwordx4 v6, s[4:7], s83 offen offset:2048 lds
  v_mfma_f32_16x16x32_bf16 v[196:199], a[100:103], v[56:59], v[196:199]
  ds_read_b64_tr_b16 v[56:57], v22 offset:32
  s_waitcnt lgkmcnt(5)
  v_mfma_f32_16x16x32_bf16 v[200:203], a[96:99], v[40:43], v[200:203]
  ds_read_b64_tr_b16 v[58:59], v24 offset:32
  v_mfma_f32_16x16x32_bf16 v[200:203], a[104:107], v[44:47], v[200:203]
  ds_read_b64_tr_b16 v[60:61], v22 offset:16416
  ds_read_b64_tr_b16 v[62:63], v24 offset:16416
  v_mfma_f32_16x16x32_bf16 v[204:207], a[108:111], v[44:47], v[204:207]
  buffer_load_dwordx4 v7, s[4:7], s83 offen offset:3072 lds
  v_mfma_f32_16x16x32_bf16 v[204:207], a[100:103], v[40:43], v[204:207]
  ds_read_b64_tr_b16 v[40:41], v22 offset:64
  s_waitcnt lgkmcnt(5)
  v_mfma_f32_16x16x32_bf16 v[64:67], v[48:51], a[96:99], v[64:67]
  ds_read_b64_tr_b16 v[42:43], v24 offset:64
  v_mfma_f32_16x16x32_bf16 v[64:67], v[52:55], a[104:107], v[64:67]
  ds_read_b64_tr_b16 v[44:45], v22 offset:16448
  v_mfma_f32_16x16x32_bf16 v[68:71], v[52:55], a[108:111], v[68:71]
  ds_read_b64_tr_b16 v[46:47], v24 offset:16448
  v_mfma_f32_16x16x32_bf16 v[68:71], v[48:51], a[100:103], v[68:71]
  ds_read_b64_tr_b16 v[48:49], v22 offset:96
  s_waitcnt lgkmcnt(5)
  v_mfma_f32_16x16x32_bf16 v[72:75], v[56:59], a[96:99], v[72:75]
  ds_read_b64_tr_b16 v[50:51], v24 offset:96
  v_mfma_f32_16x16x32_bf16 v[72:75], v[60:63], a[104:107], v[72:75]
  ds_read_b64_tr_b16 v[52:53], v22 offset:16480
  v_mfma_f32_16x16x32_bf16 v[76:79], v[60:63], a[108:111], v[76:79]
  ds_read_b64_tr_b16 v[54:55], v24 offset:16480
  v_mfma_f32_16x16x32_bf16 v[76:79], v[56:59], a[100:103], v[76:79]
  ds_read_b64_tr_b16 v[56:57], v22 offset:128
  s_waitcnt lgkmcnt(5)
  v_mfma_f32_16x16x32_bf16 v[80:83], v[40:43], a[96:99], v[80:83]
  ds_read_b64_tr_b16 v[58:59], v24 offset:128
  v_mfma_f32_16x16x32_bf16 v[80:83], v[44:47], a[104:107], v[80:83]
  ds_read_b64_tr_b16 v[60:61], v22 offset:16512
  v_mfma_f32_16x16x32_bf16 v[84:87], v[44:47], a[108:111], v[84:87]
  ds_read_b64_tr_b16 v[62:63], v24 offset:16512
  v_mfma_f32_16x16x32_bf16 v[84:87], v[40:43], a[100:103], v[84:87]
  s_waitcnt vmcnt(12) lgkmcnt(0)
  s_barrier
  ds_read_b128 a[112:115], v8 offset:4096
  v_mfma_f32_16x16x32_bf16 v[88:91], v[48:51], a[96:99], v[88:91]
  ds_read_b128 a[116:119], v8 offset:6144
  ds_read_b64_tr_b16 v[40:41], v22 offset:32928
  ds_read_b64_tr_b16 v[42:43], v24 offset:32928
  v_mfma_f32_16x16x32_bf16 v[88:91], v[52:55], a[104:107], v[88:91]
  ds_read_b128 a[120:123], v9 offset:4096
  ds_read_b128 a[124:127], v9 offset:6144
  v_mfma_f32_16x16x32_bf16 v[92:95], v[52:55], a[108:111], v[92:95]
  ds_read_b64_tr_b16 v[44:45], v23 offset:160
  ds_read_b64_tr_b16 v[46:47], v25 offset:160
  s_add_u32 m0, s82, 0
  v_mfma_f32_16x16x32_bf16 v[92:95], v[48:51], a[100:103], v[92:95]
  ds_read_b64_tr_b16 v[48:49], v22 offset:32960
  ds_read_b64_tr_b16 v[50:51], v24 offset:32960
  s_add_u32 s84, s84, 122880
  v_mfma_f32_16x16x32_bf16 v[96:99], v[56:59], a[96:99], v[96:99]
  s_sub_u32 s3, s84, 2457600
  s_min_u32 s84, s84, s3
  buffer_load_dwordx4 v12, s[8:11], s84 offen offset:0 lds
  v_mfma_f32_16x16x32_bf16 v[96:99], v[60:63], a[104:107], v[96:99]
  ds_read_b64_tr_b16 v[52:53], v23 offset:192
  ds_read_b64_tr_b16 v[54:55], v25 offset:192
  v_mfma_f32_16x16x32_bf16 v[100:103], v[60:63], a[108:111], v[100:103]
  buffer_load_dwordx4 v13, s[8:11], s84 offen offset:1024 lds
  v_mfma_f32_16x16x32_bf16 v[100:103], v[56:59], a[100:103], v[100:103]
  ds_read_b64_tr_b16 v[56:57], v22 offset:32992
  s_waitcnt lgkmcnt(5)
  v_mfma_f32_16x16x32_bf16 v[128:131], a[112:115], v[40:43], v[128:131]
  ds_read_b64_tr_b16 v[58:59], v24 offset:32992
  v_mfma_f32_16x16x32_bf16 v[128:131], a[120:123], v[44:47], v[128:131]
  ds_read_b64_tr_b16 v[60:61], v23 offset:224
  ds_read_b64_tr_b16 v[62:63], v25 offset:224
  v_mfma_f32_16x16x32_bf16 v[132:135], a[124:127], v[44:47], v[132:135]
  buffer_load_dwordx4 v14, s[8:11], s84 offen offset:2048 lds
  v_mfma_f32_16x16x32_bf16 v[132:135], a[116:119], v[40:43], v[132:135]
  ds_read_b64_tr_b16 v[40:41], v22 offset:33024
  s_waitcnt lgkmcnt(5)
  v_mfma_f32_16x16x32_bf16 v[136:139], a[112:115], v[48:51], v[136:139]
  ds_read_b64_tr_b16 v[42:43], v24 offset:33024
  v_mfma_f32_16x16x32_bf16 v[136:139], a[120:123], v[52:55], v[136:139]
  ds_read_b64_tr_b16 v[44:45], v23 offset:256
  ds_read_b64_tr_b16 v[46:47], v25 offset:256
  buffer_load_dwordx4 v15, s[8:11], s84 offen offset:3072 lds
  v_mfma_f32_16x16x32_bf16 v[140:143], a[124:127], v[52:55], v[140:143]
  s_add_u32 m0, s82, 16384
  s_add_u32 s84, s84, 122880
  v_mfma_f32_16x16x32_bf16 v[140:143], a[116:119], v[48:51], v[140:143]
  ds_read_b64_tr_b16 v[48:49], v22 offset:33056
  ds_read_b64_tr_b16 v[50:51], v24 offset:33056
  s_waitcnt lgkmcnt(6)
  v_mfma_f32_16x16x32_bf16 v[144:147], a[112:115], v[56:59], v[144:147]
  s_sub_u32 s3, s84, 2457600
  s_min_u32 s84, s84, s3
  v_mfma_f32_16x16x32_bf16 v[144:147], a[120:123], v[60:63], v[144:147]
  ds_read_b64_tr_b16 v[52:53], v23 offset:288
  ds_read_b64_tr_b16 v[54:55], v25 offset:288
  v_mfma_f32_16x16x32_bf16 v[148:151], a[124:127], v[60:63], v[148:151]
  buffer_load_dwordx4 v12, s[8:11], s84 offen offset:0 lds
  v_mfma_f32_16x16x32_bf16 v[148:151], a[116:119], v[56:59], v[148:151]
  ds_read_b64_tr_b16 v[56:57], v22 offset:33088
  s_waitcnt lgkmcnt(5)
  v_mfma_f32_16x16x32_bf16 v[152:155], a[112:115], v[40:43], v[152:155]
  ds_read_b64_tr_b16 v[58:59], v24 offset:33088
  v_mfma_f32_16x16x32_bf16 v[152:155], a[120:123], v[44:47], v[152:155]
  ds_read_b64_tr_b16 v[60:61], v23 offset:320
  ds_read_b64_tr_b16 v[62:63], v25 offset:320
  v_mfma_f32_16x16x32_bf16 v[156:159], a[124:127], v[44:47], v[156:159]
  buffer_load_dwordx4 v13, s[8:11], s84 offen offset:1024 lds
  v_mfma_f32_16x16x32_bf16 v[156:159], a[116:119], v[40:43], v[156:159]
  ds_read_b64_tr_b16 v[40:41], v22 offset:33120
  s_waitcnt lgkmcnt(5)
  v_mfma_f32_16x16x32_bf16 v[160:163], a[112:115], v[48:51], v[160:163]
  ds_read_b64_tr_b16 v[42:43], v24 offset:33120
  v_mfma_f32_16x16x32_bf16 v[160:163], a[120:123], v[52:55], v[160:163]
  ds_read_b64_tr_b16 v[44:45], v23 offset:352
  ds_read_b64_tr_b16 v[46:47], v25 offset:352
  v_mfma_f32_16x16x32_bf16 v[164:167], a[124:127], v[52:55], v[164:167]
  buffer_load_dwordx4 v14, s[8:11], s84 offen offset:2048 lds
  v_mfma_f32_16x16x32_bf16 v[164:167], a[116:119], v[48:51], v[164:167]
  ds_read_b64_tr_b16 v[48:49], v22 offset:33152
  s_waitcnt lgkmcnt(5)
  v_mfma_f32_16x16x32_bf16 v[168:171], a[112:115], v[56:59], v[168:171]
  ds_read_b64_tr_b16 v[50:51], v24 offset:33152
  v_mfma_f32_16x16x32_bf16 v[168:171], a[120:123], v[60:63], v[168:171]
  ds_read_b64_tr_b16 v[52:53], v23 offset:384
  ds_read_b64_tr_b16 v[54:55], v25 offset:384
  buffer_load_dwordx4 v15, s[8:11], s84 offen offset:3072 lds
  v_mfma_f32_16x16x32_bf16 v[172:175], a[124:127], v[60:63], v[172:175]
  s_add_u32 m0, s81, 4096
  s_add_u32 s83, s83, 128
  v_mfma_f32_16x16x32_bf16 v[172:175], a[116:119], v[56:59], v[172:175]
  ds_read_b64_tr_b16 v[56:57], v22 offset:33184
  ds_read_b64_tr_b16 v[58:59], v24 offset:33184
  s_waitcnt lgkmcnt(6)
  v_mfma_f32_16x16x32_bf16 v[176:179], a[112:115], v[40:43], v[176:179]
  s_sub_u32 s3, s83, 1280
  s_min_u32 s83, s83, s3
  v_mfma_f32_16x16x32_bf16 v[176:179], a[120:123], v[44:47], v[176:179]
  ds_read_b64_tr_b16 v[60:61], v23 offset:416
  ds_read_b64_tr_b16 v[62:63], v25 offset:416
  v_mfma_f32_16x16x32_bf16 v[180:183], a[124:127], v[44:47], v[180:183]
  buffer_load_dwordx4 v4, s[4:7], s83 offen offset:0 lds
  v_mfma_f32_16x16x32_bf16 v[180:183], a[116:119], v[40:43], v[180:183]
  ds_read_b64_tr_b16 v[40:41], v22 offset:33216
  s_waitcnt lgkmcnt(5)
  v_mfma_f32_16x16x32_bf16 v[184:187], a[112:115], v[48:51], v[184:187]
  ds_read_b64_tr_b16 v[42:43], v24 offset:33216
  v_mfma_f32_16x16x32_bf16 v[184:187], a[120:123], v[52:55], v[184:187]
  ds_read_b64_tr_b16 v[44:45], v23 offset:448
  ds_read_b64_tr_b16 v[46:47], v25 offset:448
  v_mfma_f32_16x16x32_bf16 v[188:191], a[124:127], v[52:55], v[188:191]
  buffer_load_dwordx4 v5, s[4:7], s83 offen offset:1024 lds
  v_mfma_f32_16x16x32_bf16 v[188:191], a[116:119], v[48:51], v[188:191]
  ds_read_b64_tr_b16 v[48:49], v22 offset:32768
  s_waitcnt lgkmcnt(5)
  v_mfma_f32_16x16x32_bf16 v[192:195], a[112:115], v[56:59], v[192:195]
  ds_read_b64_tr_b16 v[50:51], v24 offset:32768
  v_mfma_f32_16x16x32_bf16 v[192:195], a[120:123], v[60:63], v[192:195]
  ds_read_b64_tr_b16 v[52:53], v23 offset:0
  ds_read_b64_tr_b16 v[54:55], v25 offset:0
  v_mfma_f32_16x16x32_bf16 v[196:199], a[124:127], v[60:63], v[196:199]
  buffer_load_dwordx4 v6, s[4:7], s83 offen offset:2048 lds
  v_mfma_f32_16x16x32_bf16 v[196:199], a[116:119], v[56:59], v[196:199]
  ds_read_b64_tr_b16 v[56:57], v22 offset:32800
  s_waitcnt lgkmcnt(5)
  v_mfma_f32_16x16x32_bf16 v[200:203], a[112:115], v[40:43], v[200:203]
  ds_read_b64_tr_b16 v[58:59], v24 offset:32800
  v_mfma_f32_16x16x32_bf16 v[200:203], a[120:123], v[44:47], v[200:203]
  ds_read_b64_tr_b16 v[60:61], v23 offset:32
  ds_read_b64_tr_b16 v[62:63], v25 offset:32
  v_mfma_f32_16x16x32_bf16 v[204:207], a[124:127], v[44:47], v[204:207]
  buffer_load_dwordx4 v7, s[4:7], s83 offen offset:3072 lds
  v_mfma_f32_16x16x32_bf16 v[204:207], a[116:119], v[40:43], v[204:207]
  ds_read_b64_tr_b16 v[40:41], v22 offset:32832
  s_waitcnt lgkmcnt(5)
  v_mfma_f32_16x16x32_bf16 v[64:67], v[48:51], a[112:115], v[64:67]
  ds_read_b64_tr_b16 v[42:43], v24 offset:32832
  v_mfma_f32_16x16x32_bf16 v[64:67], v[52:55], a[120:123], v[64:67]
  ds_read_b64_tr_b16 v[44:45], v23 offset:64
  v_mfma_f32_16x16x32_bf16 v[68:71], v[52:55], a[124:127], v[68:71]
  ds_read_b64_tr_b16 v[46:47], v25 offset:64
  v_mfma_f32_16x16x32_bf16 v[68:71], v[48:51], a[116:119], v[68:71]
  ds_read_b64_tr_b16 v[48:49], v22 offset:32864
  s_waitcnt lgkmcnt(5)
  v_mfma_f32_16x16x32_bf16 v[72:75], v[56:59], a[112:115], v[72:75]
  ds_read_b64_tr_b16 v[50:51], v24 offset:32864
  v_mfma_f32_16x16x32_bf16 v[72:75], v[60:63], a[120:123], v[72:75]
  ds_read_b64_tr_b16 v[52:53], v23 offset:96
  v_mfma_f32_16x16x32_bf16 v[76:79], v[60:63], a[124:127], v[76:79]
  ds_read_b64_tr_b16 v[54:55], v25 offset:96
  v_mfma_f32_16x16x32_bf16 v[76:79], v[56:59], a[116:119], v[76:79]
  ds_read_b64_tr_b16 v[56:57], v22 offset:32896
  s_waitcnt lgkmcnt(5)
  v_mfma_f32_16x16x32_bf16 v[80:83], v[40:43], a[112:115], v[80:83]
  ds_read_b64_tr_b16 v[58:59], v24 offset:32896
  v_mfma_f32_16x16x32_bf16 v[80:83], v[44:47], a[120:123], v[80:83]
  ds_read_b64_tr_b16 v[60:61], v23 offset:128
  v_mfma_f32_16x16x32_bf16 v[84:87], v[44:47], a[124:127], v[84:87]
  ds_read_b64_tr_b16 v[62:63], v25 offset:128
  v_mfma_f32_16x16x32_bf16 v[84:87], v[40:43], a[116:119], v[84:87]
  s_waitcnt vmcnt(12) lgkmcnt(0)
  s_barrier
  ds_read_b128 a[128:131], v8 offset:0
  v_mfma_f32_16x16x32_bf16 v[88:91], v[48:51], a[112:115], v[88:91]
  ds_read_b128 a[132:135], v8 offset:2048
  ds_read_b64_tr_b16 v[40:41], v23 offset:16544
  ds_read_b64_tr_b16 v[42:43], v25 offset:16544
  v_mfma_f32_16x16x32_bf16 v[88:91], v[52:55], a[120:123], v[88:91]
  ds_read_b128 a[136:139], v9 offset:0
  ds_read_b128 a[140:143], v9 offset:2048
  v_mfma_f32_16x16x32_bf16 v[92:95], v[52:55], a[124:127], v[92:95]
  ds_read_b64_tr_b16 v[44:45], v23 offset:32928
  ds_read_b64_tr_b16 v[46:47], v25 offset:32928
  s_add_u32 m0, s81, 8192
  v_mfma_f32_16x16x32_bf16 v[92:95], v[48:51], a[116:119], v[92:95]
  ds_read_b64_tr_b16 v[48:49], v23 offset:16576
  ds_read_b64_tr_b16 v[50:51], v25 offset:16576
  v_mfma_f32_16x16x32_bf16 v[96:99], v[56:59], a[112:115], v[96:99]
  s_xor_b32 s74, s70, 128
  buffer_load_dwordx4 v20, s[16:19], s74 offen lds
  v_mfma_f32_16x16x32_bf16 v[96:99], v[60:63], a[120:123], v[96:99]
  ds_read_b64_tr_b16 v[52:53], v23 offset:32960
  ds_read_b64_tr_b16 v[54:55], v25 offset:32960
  buffer_load_dwordx4 v21, s[16:19], s74 offen offset:1024 lds
  v_mfma_f32_16x16x32_bf16 v[100:103], v[60:63], a[124:127], v[100:103]
  s_add_u32 m0, s81, 10240
  s_xor_b32 s74, s71, 128
  v_mfma_f32_16x16x32_bf16 v[100:103], v[56:59], a[116:119], v[100:103]
  ds_read_b64_tr_b16 v[56:57], v23 offset:16608
  ds_read_b64_tr_b16 v[58:59], v25 offset:16608
  s_waitcnt lgkmcnt(6)
  v_mfma_f32_16x16x32_bf16 v[128:131], a[128:131], v[40:43], v[128:131]
  buffer_load_dwordx4 v20, s[16:19], s74 offen lds
  v_mfma_f32_16x16x32_bf16 v[128:131], a[136:139], v[44:47], v[128:131]
  ds_read_b64_tr_b16 v[60:61], v23 offset:32992
  v_mfma_f32_16x16x32_bf16 v[132:135], a[140:143], v[44:47], v[132:135]
  ds_read_b64_tr_b16 v[62:63], v25 offset:32992
  v_mfma_f32_16x16x32_bf16 v[132:135], a[132:135], v[40:43], v[132:135]
  ds_read_b64_tr_b16 v[40:41], v23 offset:16640
  ds_read_b64_tr_b16 v[42:43], v25 offset:16640
  s_waitcnt lgkmcnt(6)
  v_mfma_f32_16x16x32_bf16 v[136:139], a[128:131], v[48:51], v[136:139]
  buffer_load_dwordx4 v21, s[16:19], s74 offen offset:1024 lds
  s_add_u32 m0, s81, 12288
  v_mfma_f32_16x16x32_bf16 v[136:139], a[136:139], v[52:55], v[136:139]
  ds_read_b64_tr_b16 v[44:45], v23 offset:33024
  ds_read_b64_tr_b16 v[46:47], v25 offset:33024
  v_mfma_f32_16x16x32_bf16 v[140:143], a[140:143], v[52:55], v[140:143]
  s_xor_b32 s74, s72, 128
  v_mfma_f32_16x16x32_bf16 v[140:143], a[132:135], v[48:51], v[140:143]
  ds_read_b64_tr_b16 v[48:49], v23 offset:16672
  ds_read_b64_tr_b16 v[50:51], v25 offset:16672
  s_waitcnt lgkmcnt(6)
  v_mfma_f32_16x16x32_bf16 v[144:147], a[128:131], v[56:59], v[144:147]
  buffer_load_dwordx4 v20, s[16:19], s74 offen lds
  v_mfma_f32_16x16x32_bf16 v[144:147], a[136:139], v[60:63], v[144:147]
  ds_read_b64_tr_b16 v[52:53], v23 offset:33056
  ds_read_b64_tr_b16 v[54:55], v25 offset:33056
  buffer_load_dwordx4 v21, s[16:19], s74 offen offset:1024 lds
  v_mfma_f32_16x16x32_bf16 v[148:151], a[140:143], v[60:63], v[148:151]
  s_add_u32 m0, s81, 14336
  s_xor_b32 s74, s73, 128
  v_mfma_f32_16x16x32_bf16 v[148:151], a[132:135], v[56:59], v[148:151]
  ds_read_b64_tr_b16 v[56:57], v23 offset:16704
  s_waitcnt lgkmcnt(5)
  v_mfma_f32_16x16x32_bf16 v[152:155], a[128:131], v[40:43], v[152:155]
  ds_read_b64_tr_b16 v[58:59], v25 offset:16704
  v_mfma_f32_16x16x32_bf16 v[152:155], a[136:139], v[44:47], v[152:155]
  ds_read_b64_tr_b16 v[60:61], v23 offset:33088
  ds_read_b64_tr_b16 v[62:63], v25 offset:33088
  v_mfma_f32_16x16x32_bf16 v[156:159], a[140:143], v[44:47], v[156:159]
  buffer_load_dwordx4 v20, s[16:19], s74 offen lds
  v_mfma_f32_16x16x32_bf16 v[156:159], a[132:135], v[40:43], v[156:159]
  ds_read_b64_tr_b16 v[40:41], v23 offset:16736
  s_waitcnt lgkmcnt(5)
  v_mfma_f32_16x16x32_bf16 v[160:163], a[128:131], v[48:51], v[160:163]
  ds_read_b64_tr_b16 v[42:43], v25 offset:16736
  v_mfma_f32_16x16x32_bf16 v[160:163], a[136:139], v[52:55], v[160:163]
  ds_read_b64_tr_b16 v[44:45], v23 offset:33120
  ds_read_b64_tr_b16 v[46:47], v25 offset:33120
  v_mfma_f32_16x16x32_bf16 v[164:167], a[140:143], v[52:55], v[164:167]
  buffer_load_dwordx4 v21, s[16:19], s74 offen offset:1024 lds
  v_mfma_f32_16x16x32_bf16 v[164:167], a[132:135], v[48:51], v[164:167]
  ds_read_b64_tr_b16 v[48:49], v23 offset:16768
  ds_read_b64_tr_b16 v[50:51], v25 offset:16768
  s_waitcnt lgkmcnt(6)
  v_mfma_f32_16x16x32_bf16 v[168:171], a[128:131], v[56:59], v[168:171]
  buffer_load_dword v216, v39, s[12:15], 0 offen sc1
  s_add_u32 m0, s93, 0
  v_mfma_f32_16x16x32_bf16 v[168:171], a[136:139], v[60:63], v[168:171]
  ds_read_b64_tr_b16 v[52:53], v23 offset:33152
  ds_read_b64_tr_b16 v[54:55], v25 offset:33152
  v_mfma_f32_16x16x32_bf16 v[172:175], a[140:143], v[60:63], v[172:175]
  s_xor_b32 s74, s70, 256
  v_mfma_f32_16x16x32_bf16 v[172:175], a[132:135], v[56:59], v[172:175]
  ds_read_b64_tr_b16 v[56:57], v23 offset:16800
  ds_read_b64_tr_b16 v[58:59], v25 offset:16800
  s_waitcnt lgkmcnt(6)
  v_mfma_f32_16x16x32_bf16 v[176:179], a[128:131], v[40:43], v[176:179]
  buffer_load_dwordx4 v20, s[16:19], s74 offen lds
  v_mfma_f32_16x16x32_bf16 v[176:179], a[136:139], v[44:47], v[176:179]
  ds_read_b64_tr_b16 v[60:61], v23 offset:33184
  v_mfma_f32_16x16x32_bf16 v[180:183], a[140:143], v[44:47], v[180:183]
  ds_read_b64_tr_b16 v[62:63], v25 offset:33184
  v_mfma_f32_16x16x32_bf16 v[180:183], a[132:135], v[40:43], v[180:183]
  ds_read_b64_tr_b16 v[40:41], v23 offset:16832
  ds_read_b64_tr_b16 v[42:43], v25 offset:16832
  s_waitcnt lgkmcnt(6)
  v_mfma_f32_16x16x32_bf16 v[184:187], a[128:131], v[48:51], v[184:187]
  buffer_load_dwordx4 v21, s[16:19], s74 offen offset:1024 lds
  s_add_u32 m0, s93, 2048
  v_mfma_f32_16x16x32_bf16 v[184:187], a[136:139], v[52:55], v[184:187]
  ds_read_b64_tr_b16 v[44:45], v23 offset:33216
  ds_read_b64_tr_b16 v[46:47], v25 offset:33216
  s_xor_b32 s74, s71, 256
  v_mfma_f32_16x16x32_bf16 v[188:191], a[140:143], v[52:55], v[188:191]
  buffer_load_dwordx4 v20, s[16:19], s74 offen lds
  v_mfma_f32_16x16x32_bf16 v[188:191], a[132:135], v[48:51], v[188:191]
  ds_read_b64_tr_b16 v[48:49], v23 offset:16384
  s_waitcnt lgkmcnt(5)
  v_mfma_f32_16x16x32_bf16 v[192:195], a[128:131], v[56:59], v[192:195]
  ds_read_b64_tr_b16 v[50:51], v25 offset:16384
  v_mfma_f32_16x16x32_bf16 v[192:195], a[136:139], v[60:63], v[192:195]
  ds_read_b64_tr_b16 v[52:53], v23 offset:32768
  ds_read_b64_tr_b16 v[54:55], v25 offset:32768
  buffer_load_dwordx4 v21, s[16:19], s74 offen offset:1024 lds
  v_mfma_f32_16x16x32_bf16 v[196:199], a[140:143], v[60:63], v[196:199]
  s_add_u32 m0, s93, 4096
  s_xor_b32 s74, s72, 256
  v_mfma_f32_16x16x32_bf16 v[196:199], a[132:135], v[56:59], v[196:199]
  ds_read_b64_tr_b16 v[56:57], v23 offset:16416
  s_waitcnt lgkmcnt(5)
  v_mfma_f32_16x16x32_bf16 v[200:203], a[128:131], v[40:43], v[200:203]
  ds_read_b64_tr_b16 v[58:59], v25 offset:16416
  v_mfma_f32_16x16x32_bf16 v[200:203], a[136:139], v[44:47], v[200:203]
  ds_read_b64_tr_b16 v[60:61], v23 offset:32800
  ds_read_b64_tr_b16 v[62:63], v25 offset:32800
  v_mfma_f32_16x16x32_bf16 v[204:207], a[140:143], v[44:47], v[204:207]
  buffer_load_dwordx4 v20, s[16:19], s74 offen lds
  v_mfma_f32_16x16x32_bf16 v[204:207], a[132:135], v[40:43], v[204:207]
  ds_read_b64_tr_b16 v[40:41], v23 offset:16448
  ds_read_b64_tr_b16 v[42:43], v25 offset:16448
  s_waitcnt lgkmcnt(6)
  v_mfma_f32_16x16x32_bf16 v[64:67], v[48:51], a[128:131], v[64:67]
  buffer_load_dwordx4 v21, s[16:19], s74 offen offset:1024 lds
  s_add_u32 m0, s93, 6144
  v_mfma_f32_16x16x32_bf16 v[64:67], v[52:55], a[136:139], v[64:67]
  ds_read_b64_tr_b16 v[44:45], v23 offset:32832
  ds_read_b64_tr_b16 v[46:47], v25 offset:32832
  v_mfma_f32_16x16x32_bf16 v[68:71], v[52:55], a[140:143], v[68:71]
  s_xor_b32 s74, s73, 256
  v_mfma_f32_16x16x32_bf16 v[68:71], v[48:51], a[132:135], v[68:71]
  ds_read_b64_tr_b16 v[48:49], v23 offset:16480
  ds_read_b64_tr_b16 v[50:51], v25 offset:16480
  s_waitcnt lgkmcnt(6)
  v_mfma_f32_16x16x32_bf16 v[72:75], v[56:59], a[128:131], v[72:75]
  buffer_load_dwordx4 v20, s[16:19], s74 offen lds
  v_mfma_f32_16x16x32_bf16 v[72:75], v[60:63], a[136:139], v[72:75]
  ds_read_b64_tr_b16 v[52:53], v23 offset:32864
  v_mfma_f32_16x16x32_bf16 v[76:79], v[60:63], a[140:143], v[76:79]
  ds_read_b64_tr_b16 v[54:55], v25 offset:32864
  v_mfma_f32_16x16x32_bf16 v[76:79], v[56:59], a[132:135], v[76:79]
  ds_read_b64_tr_b16 v[56:57], v23 offset:16512
  ds_read_b64_tr_b16 v[58:59], v25 offset:16512
  s_waitcnt lgkmcnt(6)
  v_mfma_f32_16x16x32_bf16 v[80:83], v[40:43], a[128:131], v[80:83]
  buffer_load_dwordx4 v21, s[16:19], s74 offen offset:1024 lds
  v_mfma_f32_16x16x32_bf16 v[80:83], v[44:47], a[136:139], v[80:83]
  ds_read_b64_tr_b16 v[60:61], v23 offset:32896
  v_mfma_f32_16x16x32_bf16 v[84:87], v[44:47], a[140:143], v[84:87]
  ds_read_b64_tr_b16 v[62:63], v25 offset:32896
  v_mfma_f32_16x16x32_bf16 v[84:87], v[40:43], a[132:135], v[84:87]
  s_waitcnt vmcnt(17) lgkmcnt(0)
  s_barrier
  ds_read_b128 a[144:147], v8 offset:4096
  v_mfma_f32_16x16x32_bf16 v[88:91], v[48:51], a[128:131], v[88:91]
  ds_read_b128 a[148:151], v8 offset:6144
  ds_read_b64_tr_b16 v[40:41], v22 offset:160
  ds_read_b64_tr_b16 v[42:43], v24 offset:160
  v_mfma_f32_16x16x32_bf16 v[88:91], v[52:55], a[136:139], v[88:91]
  ds_read_b128 a[152:155], v9 offset:4096
  ds_read_b128 a[156:159], v9 offset:6144
  v_mfma_f32_16x16x32_bf16 v[92:95], v[52:55], a[140:143], v[92:95]
  ds_read_b64_tr_b16 v[44:45], v22 offset:16544
  ds_read_b64_tr_b16 v[46:47], v24 offset:16544
  v_mfma_f32_16x16x32_bf16 v[92:95], v[48:51], a[132:135], v[92:95]
  ds_read_b64_tr_b16 v[48:49], v22 offset:192
  v_mfma_f32_16x16x32_bf16 v[96:99], v[56:59], a[128:131], v[96:99]
  ds_read_b64_tr_b16 v[50:51], v24 offset:192
  v_mfma_f32_16x16x32_bf16 v[96:99], v[60:63], a[136:139], v[96:99]
  ds_read_b64_tr_b16 v[52:53], v22 offset:16576
  ds_read_b64_tr_b16 v[54:55], v24 offset:16576
  s_waitcnt vmcnt(9)
  v_mfma_f32_16x16x32_bf16 v[100:103], v[60:63], a[140:143], v[100:103]
  ds_read_b128 a[192:195], v218 offset:8192
  v_mfma_f32_16x16x32_bf16 v[100:103], v[56:59], a[132:135], v[100:103]
  ds_read_b64_tr_b16 v[56:57], v22 offset:224
  ds_read_b64_tr_b16 v[58:59], v24 offset:224
  s_waitcnt lgkmcnt(7)
  v_mfma_f32_16x16x32_bf16 v[128:131], a[144:147], v[40:43], v[128:131]
  ds_read_b128 a[208:211], v219 offset:8192
  v_mfma_f32_16x16x32_bf16 v[128:131], a[152:155], v[44:47], v[128:131]
  ds_read_b64_tr_b16 v[60:61], v22 offset:16608
  ds_read_b64_tr_b16 v[62:63], v24 offset:16608
  v_mfma_f32_16x16x32_bf16 v[132:135], a[156:159], v[44:47], v[132:135]
  ds_read_b128 a[196:199], v218 offset:10240
  v_mfma_f32_16x16x32_bf16 v[132:135], a[148:151], v[40:43], v[132:135]
  ds_read_b64_tr_b16 v[40:41], v22 offset:256
  ds_read_b64_tr_b16 v[42:43], v24 offset:256
  s_waitcnt lgkmcnt(9)
  v_mfma_f32_16x16x32_bf16 v[136:139], a[144:147], v[48:51], v[136:139]
  ds_read_b128 a[212:215], v219 offset:10240
  v_mfma_f32_16x16x32_bf16 v[136:139], a[152:155], v[52:55], v[136:139]
  ds_read_b64_tr_b16 v[44:45], v22 offset:16640
  ds_read_b64_tr_b16 v[46:47], v24 offset:16640
  v_mfma_f32_16x16x32_bf16 v[140:143], a[156:159], v[52:55], v[140:143]
  ds_read_b128 a[200:203], v218 offset:12288
  v_mfma_f32_16x16x32_bf16 v[140:143], a[148:151], v[48:51], v[140:143]
  ds_read_b64_tr_b16 v[48:49], v22 offset:288
  ds_read_b64_tr_b16 v[50:51], v24 offset:288
  s_waitcnt lgkmcnt(9)
  v_mfma_f32_16x16x32_bf16 v[144:147], a[144:147], v[56:59], v[144:147]
  ds_read_b128 a[216:219], v219 offset:12288
  v_mfma_f32_16x16x32_bf16 v[144:147], a[152:155], v[60:63], v[144:147]
  ds_read_b64_tr_b16 v[52:53], v22 offset:16672
  ds_read_b64_tr_b16 v[54:55], v24 offset:16672
  v_mfma_f32_16x16x32_bf16 v[148:151], a[156:159], v[60:63], v[148:151]
  ds_read_b128 a[204:207], v218 offset:14336
  v_mfma_f32_16x16x32_bf16 v[148:151], a[148:151], v[56:59], v[148:151]
  ds_read_b64_tr_b16 v[56:57], v22 offset:320
  ds_read_b64_tr_b16 v[58:59], v24 offset:320
  s_waitcnt lgkmcnt(9)
  v_mfma_f32_16x16x32_bf16 v[152:155], a[144:147], v[40:43], v[152:155]
  ds_read_b128 a[220:223], v219 offset:14336
  v_mfma_f32_16x16x32_bf16 v[152:155], a[152:155], v[44:47], v[152:155]
  ds_read_b64_tr_b16 v[60:61], v22 offset:16704
  v_mfma_f32_16x16x32_bf16 v[156:159], a[156:159], v[44:47], v[156:159]
  ds_read_b64_tr_b16 v[62:63], v24 offset:16704
  v_mfma_f32_16x16x32_bf16 v[156:159], a[148:151], v[40:43], v[156:159]
  ds_read_b64_tr_b16 v[40:41], v22 offset:352
  s_waitcnt lgkmcnt(7)
  v_mfma_f32_16x16x32_bf16 v[160:163], a[144:147], v[48:51], v[160:163]
  ds_read_b64_tr_b16 v[42:43], v24 offset:352
  v_mfma_f32_16x16x32_bf16 v[160:163], a[152:155], v[52:55], v[160:163]
  ds_read_b64_tr_b16 v[44:45], v22 offset:16736
  ds_read_b64_tr_b16 v[46:47], v24 offset:16736
  s_waitcnt lgkmcnt(6)
  s_add_u32 m0, s81, 8192
  v_mfma_f32_16x16x32_bf16 v[164:167], a[156:159], v[52:55], v[164:167]
  s_xor_b32 s74, s70, 384
  buffer_load_dwordx4 v20, s[16:19], s74 offen lds
  v_mfma_f32_16x16x32_bf16 v[164:167], a[148:151], v[48:51], v[164:167]
  ds_read_b64_tr_b16 v[48:49], v22 offset:384
  ds_read_b64_tr_b16 v[50:51], v24 offset:384
  s_waitcnt lgkmcnt(6)
  v_mfma_f32_16x16x32_bf16 v[168:171], a[144:147], v[56:59], v[168:171]
  buffer_load_dwordx4 v21, s[16:19], s74 offen offset:1024 lds
  s_add_u32 m0, s81, 10240
  v_mfma_f32_16x16x32_bf16 v[168:171], a[152:155], v[60:63], v[168:171]
  ds_read_b64_tr_b16 v[52:53], v22 offset:16768
  ds_read_b64_tr_b16 v[54:55], v24 offset:16768
  v_mfma_f32_16x16x32_bf16 v[172:175], a[156:159], v[60:63], v[172:175]
  s_xor_b32 s74, s71, 384
  v_mfma_f32_16x16x32_bf16 v[172:175], a[148:151], v[56:59], v[172:175]
  ds_read_b64_tr_b16 v[56:57], v22 offset:416
  s_waitcnt lgkmcnt(5)
  v_mfma_f32_16x16x32_bf16 v[176:179], a[144:147], v[40:43], v[176:179]
  ds_read_b64_tr_b16 v[58:59], v24 offset:416
  v_mfma_f32_16x16x32_bf16 v[176:179], a[152:155], v[44:47], v[176:179]
  ds_read_b64_tr_b16 v[60:61], v22 offset:16800
  ds_read_b64_tr_b16 v[62:63], v24 offset:16800
  v_mfma_f32_16x16x32_bf16 v[180:183], a[156:159], v[44:47], v[180:183]
  buffer_load_dwordx4 v20, s[16:19], s74 offen lds
  v_mfma_f32_16x16x32_bf16 v[180:183], a[148:151], v[40:43], v[180:183]
  ds_read_b64_tr_b16 v[40:41], v22 offset:448
  ds_read_b64_tr_b16 v[42:43], v24 offset:448
  s_waitcnt lgkmcnt(6)
  v_mfma_f32_16x16x32_bf16 v[184:187], a[144:147], v[48:51], v[184:187]
  s_waitcnt vmcnt(3)
  ds_read_b128 a[224:227], v222 offset:0
  v_mfma_f32_16x16x32_bf16 v[184:187], a[152:155], v[52:55], v[184:187]
  ds_read_b64_tr_b16 v[44:45], v22 offset:16832
  ds_read_b64_tr_b16 v[46:47], v24 offset:16832
  v_mfma_f32_16x16x32_bf16 v[188:191], a[156:159], v[52:55], v[188:191]
  ds_read_b128 a[240:243], v223 offset:0
  v_mfma_f32_16x16x32_bf16 v[188:191], a[148:151], v[48:51], v[188:191]
  ds_read_b64_tr_b16 v[48:49], v22 offset:0
  ds_read_b64_tr_b16 v[50:51], v24 offset:0
  s_waitcnt lgkmcnt(8)
  v_mfma_f32_16x16x32_bf16 v[192:195], a[144:147], v[56:59], v[192:195]
  buffer_load_dwordx4 v21, s[16:19], s74 offen offset:1024 lds
  s_add_u32 m0, s81, 12288
  v_mfma_f32_16x16x32_bf16 v[192:195], a[152:155], v[60:63], v[192:195]
  ds_read_b64_tr_b16 v[52:53], v22 offset:16384
  ds_read_b64_tr_b16 v[54:55], v24 offset:16384
  s_xor_b32 s74, s72, 384
  v_mfma_f32_16x16x32_bf16 v[196:199], a[156:159], v[60:63], v[196:199]
  ds_read_b128 a[228:231], v222 offset:2048
  v_mfma_f32_16x16x32_bf16 v[196:199], a[148:151], v[56:59], v[196:199]
  ds_read_b64_tr_b16 v[56:57], v22 offset:32
  ds_read_b64_tr_b16 v[58:59], v24 offset:32
  s_waitcnt lgkmcnt(8)
  v_mfma_f32_16x16x32_bf16 v[200:203], a[144:147], v[40:43], v[200:203]
  ds_read_b128 a[244:247], v223 offset:2048
  v_mfma_f32_16x16x32_bf16 v[200:203], a[152:155], v[44:47], v[200:203]
  ds_read_b64_tr_b16 v[60:61], v22 offset:16416
  ds_read_b64_tr_b16 v[62:63], v24 offset:16416
  v_mfma_f32_16x16x32_bf16 v[204:207], a[156:159], v[44:47], v[204:207]
  buffer_load_dwordx4 v20, s[16:19], s74 offen lds
  v_mfma_f32_16x16x32_bf16 v[204:207], a[148:151], v[40:43], v[204:207]
  ds_read_b64_tr_b16 v[40:41], v22 offset:64
  ds_read_b64_tr_b16 v[42:43], v24 offset:64
  s_waitcnt lgkmcnt(8)
  v_mfma_f32_16x16x32_bf16 v[64:67], v[48:51], a[144:147], v[64:67]
  ds_read_b128 a[232:235], v222 offset:4096
  v_mfma_f32_16x16x32_bf16 v[64:67], v[52:55], a[152:155], v[64:67]
  ds_read_b64_tr_b16 v[44:45], v22 offset:16448
  ds_read_b64_tr_b16 v[46:47], v24 offset:16448
  v_mfma_f32_16x16x32_bf16 v[68:71], v[52:55], a[156:159], v[68:71]
  ds_read_b128 a[248:251], v223 offset:4096
  v_mfma_f32_16x16x32_bf16 v[68:71], v[48:51], a[148:151], v[68:71]
  ds_read_b64_tr_b16 v[48:49], v22 offset:96
  ds_read_b64_tr_b16 v[50:51], v24 offset:96
  s_waitcnt lgkmcnt(8)
  v_mfma_f32_16x16x32_bf16 v[72:75], v[56:59], a[144:147], v[72:75]
  buffer_load_dwordx4 v21, s[16:19], s74 offen offset:1024 lds
  s_add_u32 m0, s81, 14336
  v_mfma_f32_16x16x32_bf16 v[72:75], v[60:63], a[152:155], v[72:75]
  ds_read_b64_tr_b16 v[52:53], v22 offset:16480
  ds_read_b64_tr_b16 v[54:55], v24 offset:16480
  s_xor_b32 s74, s73, 384
  v_mfma_f32_16x16x32_bf16 v[76:79], v[60:63], a[156:159], v[76:79]
  ds_read_b128 a[236:239], v222 offset:6144
  v_mfma_f32_16x16x32_bf16 v[76:79], v[56:59], a[148:151], v[76:79]
  ds_read_b64_tr_b16 v[56:57], v22 offset:128
  ds_read_b64_tr_b16 v[58:59], v24 offset:128
  s_waitcnt lgkmcnt(8)
  v_mfma_f32_16x16x32_bf16 v[80:83], v[40:43], a[144:147], v[80:83]
  ds_read_b128 a[252:255], v223 offset:6144
  v_mfma_f32_16x16x32_bf16 v[80:83], v[44:47], a[152:155], v[80:83]
  ds_read_b64_tr_b16 v[60:61], v22 offset:16512
  ds_read_b64_tr_b16 v[62:63], v24 offset:16512
  v_mfma_f32_16x16x32_bf16 v[84:87], v[44:47], a[156:159], v[84:87]
  buffer_load_dwordx4 v20, s[16:19], s74 offen lds
  v_mfma_f32_16x16x32_bf16 v[84:87], v[40:43], a[148:151], v[84:87]
  s_waitcnt lgkmcnt(6)
  v_mfma_f32_16x16x32_bf16 v[88:91], v[48:51], a[144:147], v[88:91]
  v_mfma_f32_16x16x32_bf16 v[88:91], v[52:55], a[152:155], v[88:91]
  v_mfma_f32_16x16x32_bf16 v[92:95], v[52:55], a[156:159], v[92:95]
  v_mfma_f32_16x16x32_bf16 v[92:95], v[48:51], a[148:151], v[92:95]
  s_waitcnt lgkmcnt(0)
  v_mfma_f32_16x16x32_bf16 v[96:99], v[56:59], a[144:147], v[96:99]
  buffer_load_dwordx4 v21, s[16:19], s74 offen offset:1024 lds
  v_mfma_f32_16x16x32_bf16 v[96:99], v[60:63], a[152:155], v[96:99]
  v_mfma_f32_16x16x32_bf16 v[100:103], v[60:63], a[156:159], v[100:103]
  v_mfma_f32_16x16x32_bf16 v[100:103], v[56:59], a[148:151], v[100:103]
  s_waitcnt lgkmcnt(0)
  s_barrier
  ds_write_b32 v26, v27
  v_mul_f32 v208, s92, v128
  v_mul_f32 v209, s92, v129
  v_mul_f32 v210, s92, v130
  v_mul_f32 v211, s92, v131
  v_exp_f32_e64 v208, v208 clamp
  v_exp_f32_e64 v209, v209 clamp
  v_exp_f32_e64 v210, v210 clamp
  v_exp_f32_e64 v211, v211 clamp
  v_max_f32 v128, s94, v128
  v_max_f32 v129, s94, v129
  v_max_f32 v130, s94, v130
  v_max_f32 v131, s94, v131
  v_add_f32 v128, v128, v208
  s_add_u32 m0, s81, 0
  s_xor_b32 s74, s70, 512
  buffer_load_dwordx4 v20, s[16:19], s74 offen lds
  v_add_f32 v129, v129, v209
  v_add_f32 v130, v130, v210
  v_add_f32 v131, v131, v211
  v_mul_f32 v208, s92, v132
  v_mul_f32 v209, s92, v133
  v_mul_f32 v210, s92, v134
  v_mul_f32 v211, s92, v135
  v_exp_f32_e64 v208, v208 clamp
  v_exp_f32_e64 v209, v209 clamp
  v_exp_f32_e64 v210, v210 clamp
  v_exp_f32_e64 v211, v211 clamp
  v_max_f32 v132, s94, v132
  v_max_f32 v133, s94, v133
  v_max_f32 v134, s94, v134
  v_max_f32 v135, s94, v135
  v_add_f32 v132, v132, v208
  buffer_load_dwordx4 v21, s[16:19], s74 offen offset:1024 lds
  v_add_f32 v133, v133, v209
  v_add_f32 v134, v134, v210
  v_add_f32 v135, v135, v211
  v_cvt_pk_bf16_f32 v128, v128, v129
  v_cvt_pk_bf16_f32 v129, v130, v131
  v_cvt_pk_bf16_f32 v130, v132, v133
  v_cvt_pk_bf16_f32 v131, v134, v135
  ds_write_b128 v32, v[128:131] offset:0
  v_cvt_pk_bf16_f32 v168, v168, v169
  v_cvt_pk_bf16_f32 v169, v170, v171
  v_cvt_pk_bf16_f32 v170, v172, v173
  v_cvt_pk_bf16_f32 v171, v174, v175
  ds_write_b128 v32, v[168:171] offset:21760
  v_mul_f32 v208, s92, v136
  v_mul_f32 v209, s92, v137
  v_mul_f32 v210, s92, v138
  v_mul_f32 v211, s92, v139
  v_exp_f32_e64 v208, v208 clamp
  s_add_u32 m0, s81, 2048
  s_xor_b32 s74, s71, 512
  buffer_load_dwordx4 v20, s[16:19], s74 offen lds
  v_exp_f32_e64 v209, v209 clamp
  v_exp_f32_e64 v210, v210 clamp
  v_exp_f32_e64 v211, v211 clamp
  v_max_f32 v136, s94, v136
  v_max_f32 v137, s94, v137
  v_max_f32 v138, s94, v138
  v_max_f32 v139, s94, v139
  v_add_f32 v136, v136, v208
  v_add_f32 v137, v137, v209
  v_add_f32 v138, v138, v210
  v_add_f32 v139, v139, v211
  v_mul_f32 v208, s92, v140
  v_mul_f32 v209, s92, v141
  v_mul_f32 v210, s92, v142
  v_mul_f32 v211, s92, v143
  v_exp_f32_e64 v208, v208 clamp
  buffer_load_dwordx4 v21, s[16:19], s74 offen offset:1024 lds
  v_exp_f32_e64 v209, v209 clamp
  v_exp_f32_e64 v210, v210 clamp
  v_exp_f32_e64 v211, v211 clamp
  v_max_f32 v140, s94, v140
  v_max_f32 v141, s94, v141
  v_max_f32 v142, s94, v142
  v_max_f32 v143, s94, v143
  v_add_f32 v140, v140, v208
  v_add_f32 v141, v141, v209
  v_add_f32 v142, v142, v210
  v_add_f32 v143, v143, v211
  v_cvt_pk_bf16_f32 v136, v136, v137
  v_cvt_pk_bf16_f32 v137, v138, v139
  v_cvt_pk_bf16_f32 v138, v140, v141
  v_cvt_pk_bf16_f32 v139, v142, v143
  ds_write_b128 v32, v[136:139] offset:4352
  s_add_u32 m0, s81, 4096
  s_xor_b32 s74, s72, 512
  buffer_load_dwordx4 v20, s[16:19], s74 offen lds
  v_cvt_pk_bf16_f32 v176, v176, v177
  v_cvt_pk_bf16_f32 v177, v178, v179
  v_cvt_pk_bf16_f32 v178, v180, v181
  v_cvt_pk_bf16_f32 v179, v182, v183
  ds_write_b128 v32, v[176:179] offset:26112
  v_mul_f32 v208, s92, v144
  v_mul_f32 v209, s92, v145
  v_mul_f32 v210, s92, v146
  v_mul_f32 v211, s92, v147
  v_exp_f32_e64 v208, v208 clamp
  v_exp_f32_e64 v209, v209 clamp
  v_exp_f32_e64 v210, v210 clamp
  v_exp_f32_e64 v211, v211 clamp
  v_max_f32 v144, s94, v144
  v_max_f32 v145, s94, v145
  buffer_load_dwordx4 v21, s[16:19], s74 offen offset:1024 lds
  v_max_f32 v146, s94, v146
  v_max_f32 v147, s94, v147
  v_add_f32 v144, v144, v208
  v_add_f32 v145, v145, v209
  v_add_f32 v146, v146, v210
  v_add_f32 v147, v147, v211
  v_mul_f32 v208, s92, v148
  v_mul_f32 v209, s92, v149
  v_mul_f32 v210, s92, v150
  v_mul_f32 v211, s92, v151
  v_exp_f32_e64 v208, v208 clamp
  v_exp_f32_e64 v209, v209 clamp
  v_exp_f32_e64 v210, v210 clamp
  v_exp_f32_e64 v211, v211 clamp
  v_max_f32 v148, s94, v148
  v_max_f32 v149, s94, v149
  s_add_u32 m0, s81, 6144
  s_xor_b32 s74, s73, 512
  buffer_load_dwordx4 v20, s[16:19], s74 offen lds
  v_max_f32 v150, s94, v150
  v_max_f32 v151, s94, v151
  v_add_f32 v148, v148, v208
  v_add_f32 v149, v149, v209
  v_add_f32 v150, v150, v210
  v_add_f32 v151, v151, v211
  v_cvt_pk_bf16_f32 v144, v144, v145
  v_cvt_pk_bf16_f32 v145, v146, v147
  v_cvt_pk_bf16_f32 v146, v148, v149
  v_cvt_pk_bf16_f32 v147, v150, v151
  ds_write_b128 v32, v[144:147] offset:8704
  v_cvt_pk_bf16_f32 v184, v184, v185
  v_cvt_pk_bf16_f32 v185, v186, v187
  v_cvt_pk_bf16_f32 v186, v188, v189
  v_cvt_pk_bf16_f32 v187, v190, v191
  ds_write_b128 v32, v[184:187] offset:30464
  v_mul_f32 v208, s92, v152
  v_mul_f32 v209, s92, v153
  buffer_load_dwordx4 v21, s[16:19], s74 offen offset:1024 lds
  v_mul_f32 v210, s92, v154
  v_mul_f32 v211, s92, v155
  v_exp_f32_e64 v208, v208 clamp
  v_exp_f32_e64 v209, v209 clamp
  v_exp_f32_e64 v210, v210 clamp
  v_exp_f32_e64 v211, v211 clamp
  v_max_f32 v152, s94, v152
  v_max_f32 v153, s94, v153
  v_max_f32 v154, s94, v154
  v_max_f32 v155, s94, v155
  v_add_f32 v152, v152, v208
  v_add_f32 v153, v153, v209
  v_add_f32 v154, v154, v210
  v_add_f32 v155, v155, v211
  v_mul_f32 v208, s92, v156
  v_mul_f32 v209, s92, v157
  s_add_u32 m0, s89, 0
  s_xor_b32 s74, s70, 640
  buffer_load_dwordx4 v20, s[16:19], s74 offen lds
  v_mul_f32 v210, s92, v158
  v_mul_f32 v211, s92, v159
  v_exp_f32_e64 v208, v208 clamp
  v_exp_f32_e64 v209, v209 clamp
  v_exp_f32_e64 v210, v210 clamp
  v_exp_f32_e64 v211, v211 clamp
  v_max_f32 v156, s94, v156
  v_max_f32 v157, s94, v157
  v_max_f32 v158, s94, v158
  v_max_f32 v159, s94, v159
  v_add_f32 v156, v156, v208
  v_add_f32 v157, v157, v209
  v_add_f32 v158, v158, v210
  v_add_f32 v159, v159, v211
  v_cvt_pk_bf16_f32 v152, v152, v153
  v_cvt_pk_bf16_f32 v153, v154, v155
  buffer_load_dwordx4 v21, s[16:19], s74 offen offset:1024 lds
  v_cvt_pk_bf16_f32 v154, v156, v157
  v_cvt_pk_bf16_f32 v155, v158, v159
  ds_write_b128 v32, v[152:155] offset:13056
  v_cvt_pk_bf16_f32 v192, v192, v193
  v_cvt_pk_bf16_f32 v193, v194, v195
  v_cvt_pk_bf16_f32 v194, v196, v197
  v_cvt_pk_bf16_f32 v195, v198, v199
  ds_write_b128 v32, v[192:195] offset:34816
  v_mul_f32 v208, s92, v160
  v_mul_f32 v209, s92, v161
  v_mul_f32 v210, s92, v162
  v_mul_f32 v211, s92, v163
  v_exp_f32_e64 v208, v208 clamp
  v_exp_f32_e64 v209, v209 clamp
  v_exp_f32_e64 v210, v210 clamp
  s_add_u32 m0, s89, 2048
  s_xor_b32 s74, s71, 640
  buffer_load_dwordx4 v20, s[16:19], s74 offen lds
  v_exp_f32_e64 v211, v211 clamp
  v_max_f32 v160, s94, v160
  v_max_f32 v161, s94, v161
  v_max_f32 v162, s94, v162
  v_max_f32 v163, s94, v163
  v_add_f32 v160, v160, v208
  v_add_f32 v161, v161, v209
  v_add_f32 v162, v162, v210
  v_add_f32 v163, v163, v211
  v_mul_f32 v208, s92, v164
  v_mul_f32 v209, s92, v165
  v_mul_f32 v210, s92, v166
  v_mul_f32 v211, s92, v167
  v_exp_f32_e64 v208, v208 clamp
  v_exp_f32_e64 v209, v209 clamp
  v_exp_f32_e64 v210, v210 clamp
  buffer_load_dwordx4 v21, s[16:19], s74 offen offset:1024 lds
  v_exp_f32_e64 v211, v211 clamp
  v_max_f32 v164, s94, v164
  v_max_f32 v165, s94, v165
  v_max_f32 v166, s94, v166
  v_max_f32 v167, s94, v167
  v_add_f32 v164, v164, v208
  v_add_f32 v165, v165, v209
  v_add_f32 v166, v166, v210
  v_add_f32 v167, v167, v211
  v_cvt_pk_bf16_f32 v160, v160, v161
  v_cvt_pk_bf16_f32 v161, v162, v163
  v_cvt_pk_bf16_f32 v162, v164, v165
  v_cvt_pk_bf16_f32 v163, v166, v167
  ds_write_b128 v32, v[160:163] offset:17408
  v_cvt_pk_bf16_f32 v200, v200, v201
  v_cvt_pk_bf16_f32 v201, v202, v203
  v_cvt_pk_bf16_f32 v202, v204, v205
  v_cvt_pk_bf16_f32 v203, v206, v207
  s_add_u32 m0, s89, 4096
  s_xor_b32 s74, s72, 640
  buffer_load_dwordx4 v20, s[16:19], s74 offen lds
  ds_write_b128 v32, v[200:203] offset:39168
  v_mul_f32 v208, s92, v64
  v_mul_f32 v209, s92, v65
  v_mul_f32 v210, s92, v66
  v_mul_f32 v211, s92, v67
  v_exp_f32_e64 v208, v208 clamp
  v_exp_f32_e64 v209, v209 clamp
  v_exp_f32_e64 v210, v210 clamp
  v_exp_f32_e64 v211, v211 clamp
  v_max_f32 v64, s94, v64
  v_max_f32 v65, s94, v65
  v_max_f32 v66, s94, v66
  v_max_f32 v67, s94, v67
  v_add_f32 v64, v64, v208
  v_add_f32 v65, v65, v209
  buffer_load_dwordx4 v21, s[16:19], s74 offen offset:1024 lds
  v_add_f32 v66, v66, v210
  v_add_f32 v67, v67, v211
  v_mul_f32 v208, s92, v68
  v_mul_f32 v209, s92, v69
  v_mul_f32 v210, s92, v70
  v_mul_f32 v211, s92, v71
  v_exp_f32_e64 v208, v208 clamp
  v_exp_f32_e64 v209, v209 clamp
  v_exp_f32_e64 v210, v210 clamp
  v_exp_f32_e64 v211, v211 clamp
  v_max_f32 v68, s94, v68
  v_max_f32 v69, s94, v69
  v_max_f32 v70, s94, v70
  v_max_f32 v71, s94, v71
  v_add_f32 v68, v68, v208
  v_add_f32 v69, v69, v209
  s_add_u32 m0, s89, 6144
  s_xor_b32 s74, s73, 640
  buffer_load_dwordx4 v20, s[16:19], s74 offen lds
  v_add_f32 v70, v70, v210
  v_add_f32 v71, v71, v211
  v_lshrrev_b32 v11, 3, v0
  v_lshlrev_b32 v11, 8, v11
  v_add_u32 v11, s2, v11
  v_lshlrev_b32 v11, 4, v11
  v_and_b32 v11, 0xffffff80, v11
  v_min_u32 v11, L_code_end-L_pc-4, v11
  global_load_dword v11, v11, s[32:33]
  s_waitcnt lgkmcnt(0)
  s_barrier
  ds_read_b128 v[128:131], v34 offset:0
  ds_read_b128 v[132:135], v35 offset:0
  ds_read_b128 v[136:139], v34 offset:32
  ds_read_b128 v[140:143], v35 offset:32
  ds_read_b128 v[144:147], v34 offset:64
  buffer_load_dwordx4 v21, s[16:19], s74 offen offset:1024 lds
  ds_read_b128 v[148:151], v35 offset:64
  ds_read_b128 v[152:155], v34 offset:96
  ds_read_b128 v[156:159], v35 offset:96
  ds_read_b128 v[160:163], v34 offset:128
  ds_read_b128 v[164:167], v35 offset:128
  ds_read_b128 v[168:171], v34 offset:160
  ds_read_b128 v[172:175], v35 offset:160
  ds_read_b128 v[176:179], v34 offset:192
  ds_read_b128 v[180:183], v35 offset:192
  ds_read_b128 v[184:187], v34 offset:224
  s_waitcnt vmcnt(17)
  ds_read_b128 a[0:3], v218 offset:8192
  ds_read_b128 a[16:19], v219 offset:8192
  ds_read_b128 a[4:7], v218 offset:10240
  ds_read_b128 a[20:23], v219 offset:10240
  ds_read_b128 a[8:11], v218 offset:12288
  ds_read_b128 a[24:27], v219 offset:12288
  ds_read_b128 a[12:15], v218 offset:14336
  ds_read_b128 a[28:31], v219 offset:14336
  ds_read_b128 v[188:191], v35 offset:224
  v_cmp_ne_u32 vcc, s63, v216
  s_cbranch_vccnz L_retry6
L_back6:
  s_waitcnt lgkmcnt(15)
  v_mfma_f32_32x32x16_bf16 v[112:127], v[128:131], v[132:135], 0
  v_mul_f32 v208, s92, v72
  v_mul_f32 v209, s92, v73
  v_mul_f32 v210, s92, v74
  v_mul_f32 v211, s92, v75
  v_mfma_f32_32x32x16_bf16 v[112:127], v[136:139], v[140:143], v[112:127]
  v_exp_f32_e64 v208, v208 clamp
  v_exp_f32_e64 v209, v209 clamp
  v_mfma_f32_32x32x16_bf16 v[112:127], v[144:147], v[148:151], v[112:127]
  v_exp_f32_e64 v210, v210 clamp
  s_waitcnt lgkmcnt(1)
  s_add_u32 m0, s81, 8192
  s_xor_b32 s74, s70, 768
  buffer_load_dwordx4 v20, s[16:19], s74 offen lds
  v_exp_f32_e64 v211, v211 clamp
  v_max_f32 v72, s94, v72
  v_mfma_f32_32x32x16_bf16 v[112:127], v[152:155], v[156:159], v[112:127]
  v_max_f32 v73, s94, v73
  v_max_f32 v74, s94, v74
  v_max_f32 v75, s94, v75
  v_add_f32 v72, v72, v208
  v_add_f32 v73, v73, v209
  v_mfma_f32_32x32x16_bf16 v[112:127], v[160:163], v[164:167], v[112:127]
  v_add_f32 v74, v74, v210
  v_add_f32 v75, v75, v211
  v_mul_f32 v208, s92, v76
  v_mul_f32 v209, s92, v77
  v_mul_f32 v210, s92, v78
  v_mfma_f32_32x32x16_bf16 v[112:127], v[168:171], v[172:175], v[112:127]
  v_mul_f32 v211, s92, v79
  buffer_load_dwordx4 v21, s[16:19], s74 offen offset:1024 lds
  v_exp_f32_e64 v208, v208 clamp
  v_exp_f32_e64 v209, v209 clamp
  v_mfma_f32_32x32x16_bf16 v[112:127], v[176:179], v[180:183], v[112:127]
  v_exp_f32_e64 v210, v210 clamp
  v_exp_f32_e64 v211, v211 clamp
  v_max_f32 v76, s94, v76
  s_waitcnt lgkmcnt(0)
  v_mfma_f32_32x32x16_bf16 v[112:127], v[184:187], v[188:191], v[112:127]
  v_max_f32 v77, s94, v77
  v_max_f32 v78, s94, v78
  v_max_f32 v79, s94, v79
  v_add_f32 v76, v76, v208
  v_add_f32 v77, v77, v209
  v_add_f32 v78, v78, v210
  v_add_f32 v79, v79, v211
  s_add_u32 m0, s81, 10240
  s_xor_b32 s74, s71, 768
  buffer_load_dwordx4 v20, s[16:19], s74 offen lds
  v_mul_f32 v208, s92, v80
  v_mul_f32 v209, s92, v81
  v_mul_f32 v210, s92, v82
  v_mul_f32 v211, s92, v83
  v_exp_f32_e64 v208, v208 clamp
  v_exp_f32_e64 v209, v209 clamp
  v_exp_f32_e64 v210, v210 clamp
  v_exp_f32_e64 v211, v211 clamp
  v_max_f32 v80, s94, v80
  v_max_f32 v81, s94, v81
  v_max_f32 v82, s94, v82
  v_max_f32 v83, s94, v83
  v_add_f32 v80, v80, v208
  buffer_atomic_add_f32 v112, v37, s[12:15], s78 offen offset:0
  buffer_load_dwordx4 v21, s[16:19], s74 offen offset:1024 lds
  v_add_f32 v81, v81, v209
  v_add_f32 v82, v82, v210
  v_add_f32 v83, v83, v211
  v_mul_f32 v208, s92, v84
  buffer_atomic_add_f32 v113, v37, s[12:15], s78 offen offset:256
  v_mul_f32 v209, s92, v85
  v_mul_f32 v210, s92, v86
  v_mul_f32 v211, s92, v87
  v_exp_f32_e64 v208, v208 clamp
  buffer_atomic_add_f32 v114, v37, s[12:15], s78 offen offset:512
  v_exp_f32_e64 v209, v209 clamp
  v_exp_f32_e64 v210, v210 clamp
  buffer_atomic_add_f32 v115, v37, s[12:15], s78 offen offset:768
  s_add_u32 m0, s81, 12288
  s_xor_b32 s74, s72, 768
  buffer_load_dwordx4 v20, s[16:19], s74 offen lds
  v_exp_f32_e64 v211, v211 clamp
  v_max_f32 v84, s94, v84
  v_max_f32 v85, s94, v85
  buffer_atomic_add_f32 v116, v37, s[12:15], s78 offen offset:1024
  v_max_f32 v86, s94, v86
  v_max_f32 v87, s94, v87
  v_add_f32 v84, v84, v208
  v_add_f32 v85, v85, v209
  buffer_atomic_add_f32 v117, v37, s[12:15], s78 offen offset:1280
  v_add_f32 v86, v86, v210
  v_add_f32 v87, v87, v211
  v_mul_f32 v208, s92, v88
  v_mul_f32 v209, s92, v89
  buffer_atomic_add_f32 v118, v37, s[12:15], s78 offen offset:1536
  buffer_load_dwordx4 v21, s[16:19], s74 offen offset:1024 lds
  v_mul_f32 v210, s92, v90
  v_mul_f32 v211, s92, v91
  v_exp_f32_e64 v208, v208 clamp
  buffer_atomic_add_f32 v119, v37, s[12:15], s78 offen offset:1792
  v_exp_f32_e64 v209, v209 clamp
  v_exp_f32_e64 v210, v210 clamp
  buffer_atomic_add_f32 v120, v38, s[12:15], s78 offen offset:2048
  v_exp_f32_e64 v211, v211 clamp
  v_max_f32 v88, s94, v88
  v_max_f32 v89, s94, v89
  buffer_atomic_add_f32 v121, v38, s[12:15], s78 offen offset:2304
  s_add_u32 m0, s81, 14336
  s_xor_b32 s74, s73, 768
  buffer_load_dwordx4 v20, s[16:19], s74 offen lds
  v_max_f32 v90, s94, v90
  v_max_f32 v91, s94, v91
  v_add_f32 v88, v88, v208
  v_add_f32 v89, v89, v209
  buffer_atomic_add_f32 v122, v38, s[12:15], s78 offen offset:2560
  v_add_f32 v90, v90, v210
  v_add_f32 v91, v91, v211
  v_mul_f32 v208, s92, v92
  v_mul_f32 v209, s92, v93
  buffer_atomic_add_f32 v123, v38, s[12:15], s78 offen offset:2816
  v_mul_f32 v210, s92, v94
  v_mul_f32 v211, s92, v95
  v_exp_f32_e64 v208, v208 clamp
  v_exp_f32_e64 v209, v209 clamp
  buffer_load_dwordx4 v21, s[16:19], s74 offen offset:1024 lds
  v_exp_f32_e64 v210, v210 clamp
  v_exp_f32_e64 v211, v211 clamp
  v_max_f32 v92, s94, v92
  v_max_f32 v93, s94, v93
  v_max_f32 v94, s94, v94
  v_max_f32 v95, s94, v95
  v_add_f32 v92, v92, v208
  v_add_f32 v93, v93, v209
  v_add_f32 v94, v94, v210
  v_add_f32 v95, v95, v211
  v_mul_f32 v208, s92, v96
  v_mul_f32 v209, s92, v97
  v_mul_f32 v210, s92, v98
  v_mul_f32 v211, s92, v99
  v_exp_f32_e64 v208, v208 clamp
  v_exp_f32_e64 v209, v209 clamp
  s_waitcnt vmcnt(29)
  ds_read_b128 a[32:35], v218 offset:0
  ds_read_b128 a[48:51], v219 offset:0
  ds_read_b128 a[36:39], v218 offset:2048
  ds_read_b128 a[52:55], v219 offset:2048
  ds_read_b128 a[40:43], v218 offset:4096
  ds_read_b128 a[56:59], v219 offset:4096
  ds_read_b128 a[44:47], v218 offset:6144
  ds_read_b128 a[60:63], v219 offset:6144
  v_exp_f32_e64 v210, v210 clamp
  v_exp_f32_e64 v211, v211 clamp
  v_max_f32 v96, s94, v96
  v_max_f32 v97, s94, v97
  v_max_f32 v98, s94, v98
  v_max_f32 v99, s94, v99
  v_add_f32 v96, v96, v208
  v_add_f32 v97, v97, v209
  v_add_f32 v98, v98, v210
  v_add_f32 v99, v99, v211
  v_mul_f32 v208, s92, v100
  v_mul_f32 v209, s92, v101
  v_mul_f32 v210, s92, v102
  v_mul_f32 v211, s92, v103
  v_exp_f32_e64 v208, v208 clamp
  v_exp_f32_e64 v209, v209 clamp
  buffer_load_dwordx2 v[236:237], v239, s[12:15], 0 offen sc1
  buffer_load_dwordx2 v[252:253], v250, s[12:15], 0 offen sc1
  buffer_load_dword v243, v244, s[12:15], 0 offen sc1
  v_exp_f32_e64 v210, v210 clamp
  v_exp_f32_e64 v211, v211 clamp
  v_max_f32 v100, s94, v100
  v_max_f32 v101, s94, v101
  v_max_f32 v102, s94, v102
  v_max_f32 v103, s94, v103
  v_add_f32 v100, v100, v208
  v_add_f32 v101, v101, v209
  v_add_f32 v102, v102, v210
  v_add_f32 v103, v103, v211
  v_cvt_pk_bf16_f32 v176, v64, v65
  v_cvt_pk_bf16_f32 v177, v66, v67
  v_cvt_pk_bf16_f32 v178, v68, v69
  v_cvt_pk_bf16_f32 v179, v70, v71
  v_cvt_pk_bf16_f32 v180, v72, v73
  v_cvt_pk_bf16_f32 v181, v74, v75
  v_cvt_pk_bf16_f32 v182, v76, v77
  v_cvt_pk_bf16_f32 v183, v78, v79
  s_waitcnt lgkmcnt(0)
  s_add_u32 m0, s81, 0
  s_xor_b32 s74, s70, 896
  buffer_load_dwordx4 v20, s[16:19], s74 offen lds
  v_cvt_pk_bf16_f32 v184, v80, v81
  v_cvt_pk_bf16_f32 v185, v82, v83
  v_cvt_pk_bf16_f32 v186, v84, v85
  v_cvt_pk_bf16_f32 v187, v86, v87
  v_cvt_pk_bf16_f32 v188, v88, v89
  v_cvt_pk_bf16_f32 v189, v90, v91
  v_cvt_pk_bf16_f32 v190, v92, v93
  v_cvt_pk_bf16_f32 v191, v94, v95
  v_cvt_pk_bf16_f32 v192, v96, v97
  v_cvt_pk_bf16_f32 v193, v98, v99
  v_cvt_pk_bf16_f32 v194, v100, v101
  v_cvt_pk_bf16_f32 v195, v102, v103
  v_permlane16_swap_b32 v176, v178
  v_permlane16_swap_b32 v177, v179
  v_permlane16_swap_b32 v180, v182
  v_permlane16_swap_b32 v181, v183
  v_permlane16_swap_b32 v184, v186
  v_permlane16_swap_b32 v185, v187
  v_permlane16_swap_b32 v188, v190
  v_permlane16_swap_b32 v189, v191
  buffer_load_dwordx4 v21, s[16:19], s74 offen offset:1024 lds
  v_permlane16_swap_b32 v192, v194
  v_permlane16_swap_b32 v193, v195
  v_permlane32_swap_b32 v176, v178
  v_permlane32_swap_b32 v177, v179
  v_permlane32_swap_b32 v180, v182
  v_permlane32_swap_b32 v181, v183
  v_permlane32_swap_b32 v184, v186
  v_permlane32_swap_b32 v185, v187
  v_permlane32_swap_b32 v188, v190
  v_permlane32_swap_b32 v189, v191
  v_permlane32_swap_b32 v192, v194
  v_permlane32_swap_b32 v193, v195
  v_mov_b32 v16, 0
  v_mov_b32 v17, 0
  v_mov_b32 v18, 0
  v_mov_b32 v19, 0
  ds_write_b128 v234, v[16:19] offset:0
  s_add_u32 m0, s81, 2048
  s_xor_b32 s74, s71, 896
  buffer_load_dwordx4 v20, s[16:19], s74 offen lds
  ds_write_b128 v234, v[16:19] offset:16
  ds_write_b128 v234, v[16:19] offset:32
  buffer_load_dwordx4 v21, s[16:19], s74 offen offset:1024 lds
  ds_write_b128 v234, v[16:19] offset:48
  ds_write_b128 v234, v[16:19] offset:64
  s_add_u32 m0, s81, 4096
  s_xor_b32 s74, s72, 896
  buffer_load_dwordx4 v20, s[16:19], s74 offen lds
  v_lshrrev_b32 v232, 4, v230
  s_lshl_b32 s75, s68, 1
  v_add_u32 v232, s75, v232
  v_mul_u32_u24 v232, 48128, v232
  v_and_b32 v233, 15, v230
  v_lshl_add_u32 v233, v231, 4, v233
  v_lshl_add_u32 v246, v233, 4, v232
  buffer_load_dwordx4 v21, s[16:19], s74 offen offset:1024 lds
  s_add_u32 m0, s81, 6144
  s_xor_b32 s74, s73, 896
  buffer_load_dwordx4 v20, s[16:19], s74 offen lds
  buffer_load_dwordx4 v21, s[16:19], s74 offen offset:1024 lds
  s_waitcnt vmcnt(12)
  buffer_store_dword v2, v3, s[12:15], s90 offen sc1
  s_waitcnt vmcnt(11)
  v_cmp_ne_u32 vcc, s63, v237
  s_cbranch_vccnz L_retry7
L_back7:
  s_waitcnt vmcnt(10)
  v_cmp_ne_u32 vcc, s63, v253
  s_cbranch_vccnz L_retry8
L_back8:
  s_waitcnt vmcnt(9)
  v_cmp_ne_u32 vcc, s63, v243
  s_cbranch_vccnz L_retry9
L_back9:
  s_xor_b32 s74, s85, 0
  buffer_load_dwordx4 v[96:99], v242, s[12:15], s74 offen offset:0 sc1
  ds_read_b128 a[64:67], v220 offset:0
  ds_read_b128 a[80:83], v221 offset:0
  ds_read_b128 a[68:71], v220 offset:2048
  buffer_load_dwordx4 v[100:103], v242, s[12:15], s74 offen offset:1024 sc1
  ds_read_b128 a[84:87], v221 offset:2048
  ds_read_b128 a[72:75], v220 offset:4096
  ds_read_b128 a[88:91], v221 offset:4096
  buffer_load_dwordx4 v[104:107], v242, s[12:15], s74 offen offset:2048 sc1
  ds_read_b128 a[76:79], v220 offset:6144
  ds_read_b128 a[92:95], v221 offset:6144
  ds_read_b128 a[96:99], v218 offset:8192
  buffer_load_dwordx4 v[108:111], v242, s[12:15], s74 offen offset:3072 sc1
  ds_read_b128 a[112:115], v219 offset:8192
  ds_read_b128 a[100:103], v218 offset:10240
  ds_read_b128 a[116:119], v219 offset:10240
  s_xor_b32 s74, s85, 4096
  buffer_load_dwordx4 v[112:115], v242, s[12:15], s74 offen offset:0 sc1
  ds_read_b128 a[104:107], v218 offset:12288
  ds_read_b128 a[120:123], v219 offset:12288
  ds_read_b128 a[108:111], v218 offset:14336
  buffer_load_dwordx4 v[116:119], v242, s[12:15], s74 offen offset:1024 sc1
  ds_read_b128 a[124:127], v219 offset:14336
  s_waitcnt vmcnt(7)
  ds_read_b128 a[128:131], v218 offset:0
  ds_read_b128 a[144:147], v219 offset:0
  buffer_load_dwordx4 v[120:123], v242, s[12:15], s74 offen offset:2048 sc1
  ds_read_b128 a[132:135], v218 offset:2048
  ds_read_b128 a[148:151], v219 offset:2048
  ds_read_b128 a[136:139], v218 offset:4096
  buffer_load_dwordx4 v[124:127], v242, s[12:15], s74 offen offset:3072 sc1
  ds_read_b128 a[152:155], v219 offset:4096
  ds_read_b128 a[140:143], v218 offset:6144
  ds_read_b128 a[156:159], v219 offset:6144
  s_waitcnt lgkmcnt(0)
  s_waitcnt vmcnt(6)
  v_mfma_f32_16x16x32_bf16 v[40:43], v[96:99], a[160:163], 0
  s_xor_b32 s74, s85, 8192
  v_lshlrev_b32 v13, 4, v1
  v_sub_f32 v252, 1.0, v252
  s_lshr_b32 s75, s62, 1
  v_mfma_f32_16x16x32_bf16 v[40:43], v[100:103], a[176:179], v[40:43]
  buffer_load_dwordx4 v[128:131], v242, s[12:15], s74 offen offset:0 sc1
  v_mfma_f32_16x16x32_bf16 v[16:19], v[96:99], a[164:167], 0
  buffer_load_dwordx4 v[132:135], v242, s[12:15], s74 offen offset:1024 sc1
  v_mfma_f32_16x16x32_bf16 v[16:19], v[100:103], a[180:183], v[16:19]
  v_add_u32 v12, s43, v13
  s_add_u32 s80, s60, 1
  v_lshlrev_b32 v251, 16, v251
  s_mul_i32 s75, s75, 5120
  v_mfma_f32_16x16x32_bf16 v[20:23], v[96:99], a[168:171], 0
  s_and_b32 s80, s80, 3
  s_mul_i32 s80, s80, 24576
  v_mul_f32 v251, v251, v252
  s_add_u32 s75, s75, 8388608
  v_mfma_f32_16x16x32_bf16 v[20:23], v[100:103], a[184:187], v[20:23]
  buffer_load_dwordx4 v[136:139], v242, s[12:15], s74 offen offset:2048 sc1
  v_mfma_f32_16x16x32_bf16 v[24:27], v[96:99], a[172:175], 0
  buffer_load_dwordx4 v[140:143], v242, s[12:15], s74 offen offset:3072 sc1
  v_mfma_f32_16x16x32_bf16 v[24:27], v[100:103], a[188:191], v[24:27]
  s_add_u32 s80, s80, 0
  s_and_b32 s76, s62, 1
  s_mul_i32 s34, s76, 3072
  s_waitcnt vmcnt(8)
  v_mfma_f32_16x16x32_bf16 v[40:43], v[104:107], a[192:195], v[40:43]
  s_xor_b32 s74, s85, 12288
  v_add_u32 v4, s80, v13
  s_add_u32 s34, s34, s75
  s_lshl_b32 s76, s76, 3
  v_mfma_f32_16x16x32_bf16 v[40:43], v[108:111], a[208:211], v[40:43]
  buffer_load_dwordx4 v[144:147], v242, s[12:15], s74 offen offset:0 sc1
  v_mfma_f32_16x16x32_bf16 v[16:19], v[104:107], a[196:199], v[16:19]
  buffer_load_dwordx4 v[148:151], v242, s[12:15], s74 offen offset:1024 sc1
  v_mfma_f32_16x16x32_bf16 v[16:19], v[108:111], a[212:215], v[16:19]
  s_add_u32 s80, s60, 2
  s_and_b32 s80, s80, 3
  s_add_u32 s35, s75, s76
  s_add_u32 s35, s35, 2048
  v_mfma_f32_16x16x32_bf16 v[20:23], v[104:107], a[200:203], v[20:23]
  s_mul_i32 s80, s80, 24576
  s_add_u32 s80, s80, 8192
  s_lshl_b32 s75, s61, 10
  s_lshl_b32 s76, s62, 7
  v_mfma_f32_16x16x32_bf16 v[20:23], v[108:111], a[216:219], v[20:23]
  buffer_load_dwordx4 v[96:99], v242, s[12:15], s74 offen offset:2048 sc1
  v_mfma_f32_16x16x32_bf16 v[24:27], v[104:107], a[204:207], v[24:27]
  buffer_load_dwordx4 v[100:103], v242, s[12:15], s74 offen offset:3072 sc1
  v_mfma_f32_16x16x32_bf16 v[24:27], v[108:111], a[220:223], v[24:27]
  v_add_u32 v5, s80, v13
  s_add_u32 s75, s75, s76
  s_lshl_b32 s76, s60, 2
  s_waitcnt vmcnt(10)
  v_mfma_f32_16x16x32_bf16 v[40:43], v[112:115], a[224:227], v[40:43]
  s_xor_b32 s74, s85, 65536
  s_add_u32 s80, s60, 3
  s_add_u32 s75, s75, s76
  s_add_u32 s90, s75, 20185088
  v_mfma_f32_16x16x32_bf16 v[40:43], v[116:119], a[240:243], v[40:43]
  buffer_load_dwordx4 v[104:107], v242, s[12:15], s74 offen offset:0 sc1
  v_mfma_f32_16x16x32_bf16 v[16:19], v[112:115], a[228:231], v[16:19]
  s_and_b32 s80, s80, 3
  s_mul_i32 s80, s80, 24576
  s_mov_b32 s96, 0
  s_mov_b32 s97, -1
  v_mfma_f32_16x16x32_bf16 v[16:19], v[116:119], a[244:247], v[16:19]
  s_add_u32 s80, s80, 16384
  v_add_u32 v6, s80, v13
  v_mfma_f32_16x16x32_bf16 v[20:23], v[112:115], a[232:235], v[20:23]
  s_mul_i32 s80, s60, 24576
  s_add_u32 s80, s80, 0
  v_mfma_f32_16x16x32_bf16 v[20:23], v[116:119], a[248:251], v[20:23]
  buffer_load_dwordx4 v[108:111], v242, s[12:15], s74 offen offset:1024 sc1
  v_mfma_f32_16x16x32_bf16 v[24:27], v[112:115], a[236:239], v[24:27]
  v_add_u32 v7, s80, v13
  v_mov_b32 v8, 0xc0135761
  v_mfma_f32_16x16x32_bf16 v[24:27], v[116:119], a[252:255], v[24:27]
  v_mov_b32 v9, 0xbdd2d3e8
  s_waitcnt vmcnt(10)
  v_mfma_f32_16x16x32_bf16 v[40:43], v[120:123], a[0:3], v[40:43]
  v_mfma_f32_16x16x32_bf16 v[40:43], v[124:127], a[16:19], v[40:43]
  buffer_load_dwordx4 v[112:115], v242, s[12:15], s74 offen offset:2048 sc1
  v_mfma_f32_16x16x32_bf16 v[16:19], v[120:123], a[4:7], v[16:19]
  v_mfma_f32_16x16x32_bf16 v[16:19], v[124:127], a[20:23], v[16:19]
  v_mfma_f32_16x16x32_bf16 v[20:23], v[120:123], a[8:11], v[20:23]
  v_mfma_f32_16x16x32_bf16 v[20:23], v[124:127], a[24:27], v[20:23]
  buffer_load_dwordx4 v[116:119], v242, s[12:15], s74 offen offset:3072 sc1
  v_mfma_f32_16x16x32_bf16 v[24:27], v[120:123], a[12:15], v[24:27]
  v_mfma_f32_16x16x32_bf16 v[24:27], v[124:127], a[28:31], v[24:27]
  s_waitcnt vmcnt(10)
  v_mfma_f32_16x16x32_bf16 v[40:43], v[128:131], a[32:35], v[40:43]
  s_xor_b32 s74, s85, 69632
  v_mfma_f32_16x16x32_bf16 v[40:43], v[132:135], a[48:51], v[40:43]
  buffer_load_dwordx4 v[120:123], v242, s[12:15], s74 offen offset:0 sc1
  v_mfma_f32_16x16x32_bf16 v[16:19], v[128:131], a[36:39], v[16:19]
  v_mfma_f32_16x16x32_bf16 v[16:19], v[132:135], a[52:55], v[16:19]
  v_mfma_f32_16x16x32_bf16 v[20:23], v[128:131], a[40:43], v[20:23]
  v_mfma_f32_16x16x32_bf16 v[20:23], v[132:135], a[56:59], v[20:23]
  buffer_load_dwordx4 v[124:127], v242, s[12:15], s74 offen offset:1024 sc1
  v_mfma_f32_16x16x32_bf16 v[24:27], v[128:131], a[44:47], v[24:27]
  v_mfma_f32_16x16x32_bf16 v[24:27], v[132:135], a[60:63], v[24:27]
  s_waitcnt vmcnt(10)
  v_mfma_f32_16x16x32_bf16 v[40:43], v[136:139], a[64:67], v[40:43]
  v_mfma_f32_16x16x32_bf16 v[40:43], v[140:143], a[80:83], v[40:43]
  buffer_load_dwordx4 v[128:131], v242, s[12:15], s74 offen offset:2048 sc1
  v_mfma_f32_16x16x32_bf16 v[16:19], v[136:139], a[68:71], v[16:19]
  v_mfma_f32_16x16x32_bf16 v[16:19], v[140:143], a[84:87], v[16:19]
  v_mfma_f32_16x16x32_bf16 v[20:23], v[136:139], a[72:75], v[20:23]
  v_mfma_f32_16x16x32_bf16 v[20:23], v[140:143], a[88:91], v[20:23]
  buffer_load_dwordx4 v[132:135], v242, s[12:15], s74 offen offset:3072 sc1
  v_mfma_f32_16x16x32_bf16 v[24:27], v[136:139], a[76:79], v[24:27]
  v_mfma_f32_16x16x32_bf16 v[24:27], v[140:143], a[92:95], v[24:27]
  s_waitcnt vmcnt(10)
  v_mfma_f32_16x16x32_bf16 v[40:43], v[144:147], a[96:99], v[40:43]
  s_xor_b32 s74, s85, 73728
  v_mfma_f32_16x16x32_bf16 v[40:43], v[148:151], a[112:115], v[40:43]
  buffer_load_dwordx4 v[136:139], v242, s[12:15], s74 offen offset:0 sc1
  v_mfma_f32_16x16x32_bf16 v[16:19], v[144:147], a[100:103], v[16:19]
  v_mfma_f32_16x16x32_bf16 v[16:19], v[148:151], a[116:119], v[16:19]
  v_mfma_f32_16x16x32_bf16 v[20:23], v[144:147], a[104:107], v[20:23]
  v_mfma_f32_16x16x32_bf16 v[20:23], v[148:151], a[120:123], v[20:23]
  buffer_load_dwordx4 v[140:143], v242, s[12:15], s74 offen offset:1024 sc1
  v_mfma_f32_16x16x32_bf16 v[24:27], v[144:147], a[108:111], v[24:27]
  v_mfma_f32_16x16x32_bf16 v[24:27], v[148:151], a[124:127], v[24:27]
  s_waitcnt vmcnt(10)
  v_mfma_f32_16x16x32_bf16 v[40:43], v[96:99], a[128:131], v[40:43]
  s_barrier
  v_mfma_f32_16x16x32_bf16 v[40:43], v[100:103], a[144:147], v[40:43]
  buffer_load_dwordx4 v[144:147], v242, s[12:15], s74 offen offset:2048 sc1
  v_mfma_f32_16x16x32_bf16 v[16:19], v[96:99], a[132:135], v[16:19]
  buffer_load_dword v245, v247, s[12:15], 0 offen sc1
  v_mfma_f32_16x16x32_bf16 v[16:19], v[100:103], a[148:151], v[16:19]
  v_mfma_f32_16x16x32_bf16 v[20:23], v[96:99], a[136:139], v[20:23]
  v_mfma_f32_16x16x32_bf16 v[20:23], v[100:103], a[152:155], v[20:23]
  buffer_load_dwordx4 v[148:151], v242, s[12:15], s74 offen offset:3072 sc1
  v_mfma_f32_16x16x32_bf16 v[24:27], v[96:99], a[140:143], v[24:27]
  v_mfma_f32_16x16x32_bf16 v[24:27], v[100:103], a[156:159], v[24:27]
  s_waitcnt vmcnt(11)
  v_mfma_f32_16x16x32_bf16 v[44:47], v[104:107], a[160:163], 0
  s_xor_b32 s74, s85, 77824
  v_mfma_f32_16x16x32_bf16 v[44:47], v[108:111], a[176:179], v[44:47]
  buffer_load_dwordx4 v[96:99], v242, s[12:15], s74 offen offset:0 sc1
  v_mfma_f32_16x16x32_bf16 v[28:31], v[104:107], a[164:167], 0
  v_mfma_f32_16x16x32_bf16 v[28:31], v[108:111], a[180:183], v[28:31]
  ds_write_b128 v4, v[16:19] offset:0
  v_mfma_f32_16x16x32_bf16 v[32:35], v[104:107], a[168:171], 0
  v_mfma_f32_16x16x32_bf16 v[32:35], v[108:111], a[184:187], v[32:35]
  buffer_load_dwordx4 v[100:103], v242, s[12:15], s74 offen offset:1024 sc1
  v_mfma_f32_16x16x32_bf16 v[36:39], v[104:107], a[172:175], 0
  v_mfma_f32_16x16x32_bf16 v[36:39], v[108:111], a[188:191], v[36:39]
  s_waitcnt vmcnt(11)
  v_mfma_f32_16x16x32_bf16 v[44:47], v[112:115], a[192:195], v[44:47]
  ds_write_b128 v5, v[20:23] offset:0
  v_mfma_f32_16x16x32_bf16 v[44:47], v[116:119], a[208:211], v[44:47]
  buffer_load_dwordx4 v[104:107], v242, s[12:15], s74 offen offset:2048 sc1
  v_mfma_f32_16x16x32_bf16 v[28:31], v[112:115], a[196:199], v[28:31]
  v_mfma_f32_16x16x32_bf16 v[28:31], v[116:119], a[212:215], v[28:31]
  v_mfma_f32_16x16x32_bf16 v[32:35], v[112:115], a[200:203], v[32:35]
  ds_write_b128 v6, v[24:27] offset:0
  v_mfma_f32_16x16x32_bf16 v[32:35], v[116:119], a[216:219], v[32:35]
  buffer_load_dwordx4 v[108:111], v242, s[12:15], s74 offen offset:3072 sc1
  v_mfma_f32_16x16x32_bf16 v[36:39], v[112:115], a[204:207], v[36:39]
  v_mfma_f32_16x16x32_bf16 v[36:39], v[116:119], a[220:223], v[36:39]
  s_waitcnt vmcnt(11)
  v_mfma_f32_16x16x32_bf16 v[44:47], v[120:123], a[224:227], v[44:47]
  s_xor_b32 s74, s86, 0
  v_mfma_f32_16x16x32_bf16 v[44:47], v[124:127], a[240:243], v[44:47]
  buffer_load_dwordx4 v[112:115], v242, s[12:15], s74 offen offset:0 sc1
  v_mfma_f32_16x16x32_bf16 v[28:31], v[120:123], a[228:231], v[28:31]
  s_waitcnt lgkmcnt(0)
  s_barrier
  v_mfma_f32_16x16x32_bf16 v[28:31], v[124:127], a[244:247], v[28:31]
  ds_read_b128 v[16:19], v7 offset:0
  v_mfma_f32_16x16x32_bf16 v[32:35], v[120:123], a[232:235], v[32:35]
  ds_read_b128 v[20:23], v7 offset:8192
  v_mfma_f32_16x16x32_bf16 v[32:35], v[124:127], a[248:251], v[32:35]
  buffer_load_dwordx4 v[116:119], v242, s[12:15], s74 offen offset:1024 sc1
  v_mfma_f32_16x16x32_bf16 v[36:39], v[120:123], a[236:239], v[36:39]
  ds_read_b128 v[24:27], v7 offset:16384
  v_mfma_f32_16x16x32_bf16 v[36:39], v[124:127], a[252:255], v[36:39]
  s_waitcnt vmcnt(11)
  v_mfma_f32_16x16x32_bf16 v[44:47], v[128:131], a[0:3], v[44:47]
  s_nop 0
  v_mfma_f32_16x16x32_bf16 v[44:47], v[132:135], a[16:19], v[44:47]
  buffer_load_dwordx4 v[120:123], v242, s[12:15], s74 offen offset:2048 sc1
  v_mfma_f32_16x16x32_bf16 v[28:31], v[128:131], a[4:7], v[28:31]
  v_mfma_f32_16x16x32_bf16 v[28:31], v[132:135], a[20:23], v[28:31]
  v_mfma_f32_16x16x32_bf16 v[32:35], v[128:131], a[8:11], v[32:35]
  s_waitcnt lgkmcnt(2)
  v_add_f32 v40, v40, v16
  v_add_f32 v41, v41, v17
  v_mfma_f32_16x16x32_bf16 v[32:35], v[132:135], a[24:27], v[32:35]
  buffer_load_dwordx4 v[124:127], v242, s[12:15], s74 offen offset:3072 sc1
  v_mfma_f32_16x16x32_bf16 v[36:39], v[128:131], a[12:15], v[36:39]
  v_add_f32 v42, v42, v18
  v_add_f32 v43, v43, v19
  v_mfma_f32_16x16x32_bf16 v[36:39], v[132:135], a[28:31], v[36:39]
  s_waitcnt lgkmcnt(1)
  v_add_f32 v40, v40, v20
  s_waitcnt vmcnt(11)
  v_mfma_f32_16x16x32_bf16 v[44:47], v[136:139], a[32:35], v[44:47]
  s_xor_b32 s74, s86, 4096
  v_add_f32 v41, v41, v21
  v_mfma_f32_16x16x32_bf16 v[44:47], v[140:143], a[48:51], v[44:47]
  buffer_load_dwordx4 v[128:131], v242, s[12:15], s74 offen offset:0 sc1
  v_mfma_f32_16x16x32_bf16 v[28:31], v[136:139], a[36:39], v[28:31]
  v_add_f32 v42, v42, v22
  v_add_f32 v43, v43, v23
  v_mfma_f32_16x16x32_bf16 v[28:31], v[140:143], a[52:55], v[28:31]
  s_waitcnt lgkmcnt(0)
  v_add_f32 v40, v40, v24
  v_add_f32 v41, v41, v25
  v_mfma_f32_16x16x32_bf16 v[32:35], v[136:139], a[40:43], v[32:35]
  v_add_f32 v42, v42, v26
  v_add_f32 v43, v43, v27
  v_mfma_f32_16x16x32_bf16 v[32:35], v[140:143], a[56:59], v[32:35]
  buffer_load_dwordx4 v[132:135], v242, s[12:15], s74 offen offset:1024 sc1
  v_mfma_f32_16x16x32_bf16 v[36:39], v[136:139], a[44:47], v[36:39]
  s_waitcnt vmcnt(11)
  v_cmp_ne_u32 vcc, s63, v245
  s_cbranch_vccnz L_retry10
L_back10:
  v_lshlrev_b32 v247, 2, v1
  buffer_load_dword v212, v247, s[12:15], s78 offen offset:0 sc1
  buffer_load_dword v213, v247, s[12:15], s78 offen offset:256 sc1
  buffer_load_dword v214, v247, s[12:15], s78 offen offset:512 sc1
  buffer_load_dword v215, v247, s[12:15], s78 offen offset:768 sc1
  buffer_load_dword v216, v247, s[12:15], s78 offen offset:1024 sc1
  buffer_load_dword v217, v247, s[12:15], s78 offen offset:1280 sc1
  buffer_load_dword v218, v247, s[12:15], s78 offen offset:1536 sc1
  buffer_load_dword v219, v247, s[12:15], s78 offen offset:1792 sc1
  buffer_load_dword v220, v247, s[12:15], s78 offen offset:2048 sc1
  buffer_load_dword v221, v247, s[12:15], s78 offen offset:2304 sc1
  buffer_load_dword v222, v247, s[12:15], s78 offen offset:2560 sc1
  buffer_load_dword v223, v247, s[12:15], s78 offen offset:2816 sc1
  v_mfma_f32_16x16x32_bf16 v[36:39], v[140:143], a[60:63], v[36:39]
  s_waitcnt vmcnt(22)
  v_mfma_f32_16x16x32_bf16 v[44:47], v[144:147], a[64:67], v[44:47]
  v_mfma_f32_16x16x32_bf16 v[44:47], v[148:151], a[80:83], v[44:47]
  buffer_load_dwordx4 v[136:139], v242, s[12:15], s74 offen offset:2048 sc1
  v_mfma_f32_16x16x32_bf16 v[28:31], v[144:147], a[68:71], v[28:31]
  v_mfma_f32_16x16x32_bf16 v[28:31], v[148:151], a[84:87], v[28:31]
  v_mfma_f32_16x16x32_bf16 v[32:35], v[144:147], a[72:75], v[32:35]
  v_mfma_f32_16x16x32_bf16 v[32:35], v[148:151], a[88:91], v[32:35]
  buffer_load_dwordx4 v[140:143], v242, s[12:15], s74 offen offset:3072 sc1
  v_mfma_f32_16x16x32_bf16 v[36:39], v[144:147], a[76:79], v[36:39]
  v_mfma_f32_16x16x32_bf16 v[36:39], v[148:151], a[92:95], v[36:39]
  s_waitcnt vmcnt(22)
  v_mfma_f32_16x16x32_bf16 v[44:47], v[96:99], a[96:99], v[44:47]
  s_xor_b32 s74, s86, 8192
  v_mfma_f32_16x16x32_bf16 v[44:47], v[100:103], a[112:115], v[44:47]
  buffer_load_dwordx4 v[144:147], v242, s[12:15], s74 offen offset:0 sc1
  v_mfma_f32_16x16x32_bf16 v[28:31], v[96:99], a[100:103], v[28:31]
  v_mfma_f32_16x16x32_bf16 v[28:31], v[100:103], a[116:119], v[28:31]
  v_mfma_f32_16x16x32_bf16 v[32:35], v[96:99], a[104:107], v[32:35]
  v_mfma_f32_16x16x32_bf16 v[32:35], v[100:103], a[120:123], v[32:35]
  buffer_load_dwordx4 v[148:151], v242, s[12:15], s74 offen offset:1024 sc1
  v_mfma_f32_16x16x32_bf16 v[36:39], v[96:99], a[108:111], v[36:39]
  v_mfma_f32_16x16x32_bf16 v[36:39], v[100:103], a[124:127], v[36:39]
  s_waitcnt vmcnt(22)
  v_mfma_f32_16x16x32_bf16 v[44:47], v[104:107], a[128:131], v[44:47]
  v_mfma_f32_16x16x32_bf16 v[44:47], v[108:111], a[144:147], v[44:47]
  buffer_load_dwordx4 v[96:99], v242, s[12:15], s74 offen offset:2048 sc1
  v_mfma_f32_16x16x32_bf16 v[28:31], v[104:107], a[132:135], v[28:31]
  v_mfma_f32_16x16x32_bf16 v[28:31], v[108:111], a[148:151], v[28:31]
  v_mfma_f32_16x16x32_bf16 v[32:35], v[104:107], a[136:139], v[32:35]
  v_mfma_f32_16x16x32_bf16 v[32:35], v[108:111], a[152:155], v[32:35]
  buffer_load_dwordx4 v[100:103], v242, s[12:15], s74 offen offset:3072 sc1
  v_mfma_f32_16x16x32_bf16 v[36:39], v[104:107], a[140:143], v[36:39]
  v_mfma_f32_16x16x32_bf16 v[36:39], v[108:111], a[156:159], v[36:39]
  s_waitcnt vmcnt(22)
  v_mfma_f32_16x16x32_bf16 v[48:51], v[112:115], a[160:163], 0
  s_xor_b32 s74, s86, 12288
  v_mfma_f32_16x16x32_bf16 v[48:51], v[116:119], a[176:179], v[48:51]
  buffer_load_dwordx4 v[104:107], v242, s[12:15], s74 offen offset:0 sc1
  v_mfma_f32_16x16x32_bf16 v[16:19], v[112:115], a[164:167], 0
  v_mfma_f32_16x16x32_bf16 v[16:19], v[116:119], a[180:183], v[16:19]
  ds_write_b128 v4, v[28:31] offset:1024
  v_mfma_f32_16x16x32_bf16 v[20:23], v[112:115], a[168:171], 0
  v_lshrrev_b32 v10, 3, v0
  v_lshlrev_b32 v10, 8, v10
  v_add_u32 v10, s2, v10
  v_mfma_f32_16x16x32_bf16 v[20:23], v[116:119], a[184:187], v[20:23]
  buffer_load_dwordx4 v[108:111], v242, s[12:15], s74 offen offset:1024 sc1
  v_mfma_f32_16x16x32_bf16 v[24:27], v[112:115], a[172:175], 0
  v_lshlrev_b32 v10, 4, v10
  v_and_b32 v10, 0xffffff80, v10
  v_min_u32 v10, L_code_end-L_pc-4, v10
  v_mfma_f32_16x16x32_bf16 v[24:27], v[116:119], a[188:191], v[24:27]
  global_load_dword v10, v10, s[32:33]
  s_waitcnt vmcnt(23)
  v_mfma_f32_16x16x32_bf16 v[48:51], v[120:123], a[192:195], v[48:51]
  ds_write_b128 v5, v[32:35] offset:1024
  v_mfma_f32_16x16x32_bf16 v[48:51], v[124:127], a[208:211], v[48:51]
  buffer_load_dwordx4 v[112:115], v242, s[12:15], s74 offen offset:2048 sc1
  v_mfma_f32_16x16x32_bf16 v[16:19], v[120:123], a[196:199], v[16:19]
  v_mfma_f32_16x16x32_bf16 v[16:19], v[124:127], a[212:215], v[16:19]
  v_mfma_f32_16x16x32_bf16 v[20:23], v[120:123], a[200:203], v[20:23]
  ds_write_b128 v6, v[36:39] offset:1024
  v_mfma_f32_16x16x32_bf16 v[20:23], v[124:127], a[216:219], v[20:23]
  buffer_load_dwordx4 v[116:119], v242, s[12:15], s74 offen offset:3072 sc1
  v_mfma_f32_16x16x32_bf16 v[24:27], v[120:123], a[204:207], v[24:27]
  buffer_load_dword v14, v254, s[12:15], 0 offen sc1
  v_mfma_f32_16x16x32_bf16 v[24:27], v[124:127], a[220:223], v[24:27]
  s_waitcnt vmcnt(24)
  v_mfma_f32_16x16x32_bf16 v[48:51], v[128:131], a[224:227], v[48:51]
  s_xor_b32 s74, s86, 65536
  v_mfma_f32_16x16x32_bf16 v[48:51], v[132:135], a[240:243], v[48:51]
  buffer_load_dwordx4 v[120:123], v242, s[12:15], s74 offen offset:0 sc1
  v_mfma_f32_16x16x32_bf16 v[16:19], v[128:131], a[228:231], v[16:19]
  s_waitcnt lgkmcnt(0)
  s_barrier
  s_waitcnt vmcnt(23)
  v_cvt_pk_bf16_f32 v212, v212, v213
  s_waitcnt vmcnt(21)
  v_cvt_pk_bf16_f32 v213, v214, v215
  v_mfma_f32_16x16x32_bf16 v[16:19], v[132:135], a[244:247], v[16:19]
  ds_read_b128 v[28:31], v7 offset:1024
  s_waitcnt vmcnt(19)
  v_cvt_pk_bf16_f32 v214, v216, v217
  s_waitcnt vmcnt(17)
  v_cvt_pk_bf16_f32 v215, v218, v219
  v_mfma_f32_16x16x32_bf16 v[20:23], v[128:131], a[232:235], v[20:23]
  ds_read_b128 v[32:35], v7 offset:9216
  s_waitcnt vmcnt(15)
  v_cvt_pk_bf16_f32 v216, v220, v221
  s_waitcnt vmcnt(13)
  v_cvt_pk_bf16_f32 v217, v222, v223
  v_mfma_f32_16x16x32_bf16 v[20:23], v[132:135], a[248:251], v[20:23]
  buffer_load_dwordx4 v[124:127], v242, s[12:15], s74 offen offset:1024 sc1
  v_mfma_f32_16x16x32_bf16 v[24:27], v[128:131], a[236:239], v[24:27]
  ds_read_b128 v[36:39], v7 offset:17408
  ds_write_b64 v240, v[212:213] offset:0
  v_mfma_f32_16x16x32_bf16 v[24:27], v[132:135], a[252:255], v[24:27]
  s_waitcnt vmcnt(12)
  v_mfma_f32_16x16x32_bf16 v[48:51], v[136:139], a[0:3], v[48:51]
  s_nop 0
  v_mfma_f32_16x16x32_bf16 v[48:51], v[140:143], a[16:19], v[48:51]
  buffer_load_dwordx4 v[128:131], v242, s[12:15], s74 offen offset:2048 sc1
  v_mfma_f32_16x16x32_bf16 v[16:19], v[136:139], a[4:7], v[16:19]
  ds_write_b64 v240, v[214:215] offset:16
  v_mfma_f32_16x16x32_bf16 v[16:19], v[140:143], a[20:23], v[16:19]
  ds_write_b64 v241, v[216:217] offset:32
  v_mfma_f32_16x16x32_bf16 v[20:23], v[136:139], a[8:11], v[20:23]
  s_waitcnt lgkmcnt(5)
  v_add_f32 v44, v44, v28
  v_add_f32 v45, v45, v29
  v_mfma_f32_16x16x32_bf16 v[20:23], v[140:143], a[24:27], v[20:23]
  buffer_load_dwordx4 v[132:135], v242, s[12:15], s74 offen offset:3072 sc1
  v_mfma_f32_16x16x32_bf16 v[24:27], v[136:139], a[12:15], v[24:27]
  v_add_f32 v46, v46, v30
  v_add_f32 v47, v47, v31
  s_waitcnt lgkmcnt(0)
  s_barrier
  v_mfma_f32_16x16x32_bf16 v[24:27], v[140:143], a[28:31], v[24:27]
  v_add_f32 v44, v44, v32
  v_add_u32 v240, 5632, v238
  v_add_u32 v241, 11264, v238
  s_waitcnt vmcnt(12)
  v_mfma_f32_16x16x32_bf16 v[48:51], v[144:147], a[32:35], v[48:51]
  s_xor_b32 s74, s86, 69632
  v_add_f32 v45, v45, v33
  ds_read2_b64 v[196:199], v241 offset0:0 offset1:2
  v_mfma_f32_16x16x32_bf16 v[48:51], v[148:151], a[48:51], v[48:51]
  buffer_load_dwordx4 v[136:139], v242, s[12:15], s74 offen offset:0 sc1
  v_mfma_f32_16x16x32_bf16 v[16:19], v[144:147], a[36:39], v[16:19]
  v_add_f32 v46, v46, v34
  v_add_f32 v47, v47, v35
  ds_read2_b64 v[200:203], v241 offset0:4 offset1:6
  v_mfma_f32_16x16x32_bf16 v[16:19], v[148:151], a[52:55], v[16:19]
  v_add_f32 v44, v44, v36
  v_add_f32 v45, v45, v37
  ds_read2_b64 v[204:207], v241 offset0:8 offset1:10
  v_mfma_f32_16x16x32_bf16 v[20:23], v[144:147], a[40:43], v[20:23]
  v_add_f32 v46, v46, v38
  v_add_f32 v47, v47, v39
  ds_read2_b64 v[208:211], v241 offset0:12 offset1:14
  v_mfma_f32_16x16x32_bf16 v[20:23], v[148:151], a[56:59], v[20:23]
  buffer_load_dwordx4 v[140:143], v242, s[12:15], s74 offen offset:1024 sc1
  v_mfma_f32_16x16x32_bf16 v[24:27], v[144:147], a[44:47], v[24:27]
  s_nop 0
  v_mfma_f32_16x16x32_bf16 v[24:27], v[148:151], a[60:63], v[24:27]
  s_waitcnt vmcnt(12)
  v_mfma_f32_16x16x32_bf16 v[48:51], v[96:99], a[64:67], v[48:51]
  v_mfma_f32_16x16x32_bf16 v[48:51], v[100:103], a[80:83], v[48:51]
  buffer_load_dwordx4 v[144:147], v242, s[12:15], s74 offen offset:2048 sc1
  v_mfma_f32_16x16x32_bf16 v[16:19], v[96:99], a[68:71], v[16:19]
  s_waitcnt lgkmcnt(3)
  v_mfma_f32_32x32x16_bf16 v[212:227], v[196:199], v[176:179], 0
  ds_read2_b64 v[196:199], v241 offset0:16 offset1:18
  s_waitcnt lgkmcnt(3)
  v_mfma_f32_32x32x16_bf16 v[212:227], v[200:203], v[180:183], v[212:227]
  ds_read2_b64 v[200:203], v238 offset0:0 offset1:2
  s_waitcnt lgkmcnt(3)
  v_mfma_f32_32x32x16_bf16 v[212:227], v[204:207], v[184:187], v[212:227]
  ds_read2_b64 v[204:207], v238 offset0:4 offset1:6
  s_waitcnt lgkmcnt(3)
  v_mfma_f32_32x32x16_bf16 v[212:227], v[208:211], v[188:191], v[212:227]
  ds_read2_b64 v[208:211], v238 offset0:8 offset1:10
  s_waitcnt lgkmcnt(3)
  v_mfma_f32_32x32x16_bf16 v[212:227], v[196:199], v[192:195], v[212:227]
  ds_read2_b64 v[196:199], v240 offset0:4 offset1:6
  s_nop 0
  v_mfma_f32_16x16x32_bf16 v[16:19], v[100:103], a[84:87], v[16:19]
  v_mfma_f32_16x16x32_bf16 v[20:23], v[96:99], a[72:75], v[20:23]
  v_mfma_f32_16x16x32_bf16 v[20:23], v[100:103], a[88:91], v[20:23]
  buffer_load_dwordx4 v[148:151], v242, s[12:15], s74 offen offset:3072 sc1
  v_mfma_f32_16x16x32_bf16 v[24:27], v[96:99], a[76:79], v[24:27]
  v_mfma_f32_16x16x32_bf16 v[24:27], v[100:103], a[92:95], v[24:27]
  s_waitcnt vmcnt(12)
  v_mfma_f32_16x16x32_bf16 v[48:51], v[104:107], a[96:99], v[48:51]
  s_xor_b32 s74, s86, 73728
  v_mfma_f32_16x16x32_bf16 v[48:51], v[108:111], a[112:115], v[48:51]
  buffer_load_dwordx4 v[96:99], v242, s[12:15], s74 offen offset:0 sc1
  v_mfma_f32_16x16x32_bf16 v[16:19], v[104:107], a[100:103], v[16:19]
  v_mfma_f32_16x16x32_bf16 v[16:19], v[108:111], a[116:119], v[16:19]
  v_mfma_f32_16x16x32_bf16 v[20:23], v[104:107], a[104:107], v[20:23]
  v_add_f32 v228, s94, v220
  v_mfma_f32_16x16x32_bf16 v[20:23], v[108:111], a[120:123], v[20:23]
  buffer_load_dwordx4 v[100:103], v242, s[12:15], s74 offen offset:1024 sc1
  v_mfma_f32_16x16x32_bf16 v[24:27], v[104:107], a[108:111], v[24:27]
  v_add_f32 v229, s94, v221
  v_add_f32 v230, s94, v222
  v_add_f32 v231, s94, v223
  v_mfma_f32_16x16x32_bf16 v[24:27], v[108:111], a[124:127], v[24:27]
  v_rcp_f32 v228, v228
  s_waitcnt vmcnt(11)
  v_mfma_f32_16x16x32_bf16 v[48:51], v[112:115], a[128:131], v[48:51]
  s_waitcnt vmcnt(10)
  v_cmp_ne_u32 vcc, s63, v14
  s_cbranch_vccnz L_retry11
L_back11:
  s_lshr_b32 s79, s85, 17
  s_lshl_b32 s79, s79, 10
  s_add_u32 s79, s79, s87
  buffer_load_dwordx4 v[72:75], v248, s[12:15], s79 offen sc1
  s_lshr_b32 s79, s86, 17
  s_lshl_b32 s79, s79, 10
  s_add_u32 s79, s79, s87
  buffer_load_dwordx4 v[76:79], v248, s[12:15], s79 offen sc1
  s_lshr_b32 s79, s91, 17
  s_lshl_b32 s79, s79, 10
  s_add_u32 s79, s79, s87
  buffer_load_dwordx4 v[80:83], v248, s[12:15], s79 offen sc1
  v_mfma_f32_16x16x32_bf16 v[48:51], v[116:119], a[144:147], v[48:51]
  buffer_load_dwordx4 v[104:107], v242, s[12:15], s74 offen offset:2048 sc1
  v_mfma_f32_16x16x32_bf16 v[16:19], v[112:115], a[132:135], v[16:19]
  v_rcp_f32 v229, v229
  v_rcp_f32 v230, v230
  v_mfma_f32_16x16x32_bf16 v[16:19], v[116:119], a[148:151], v[16:19]
  v_rcp_f32 v231, v231
  v_mul_f32 v228, v228, v236
  v_mul_f32 v229, v229, v236
  v_mfma_f32_16x16x32_bf16 v[20:23], v[112:115], a[136:139], v[20:23]
  v_mul_f32 v230, v230, v236
  v_mul_f32 v231, v231, v236
  v_cndmask_b32_e64 v232, v228, v229, s[96:97]
  v_cndmask_b32_e64 v233, v230, v231, s[96:97]
  v_mfma_f32_16x16x32_bf16 v[20:23], v[116:119], a[152:155], v[20:23]
  buffer_load_dwordx4 v[108:111], v242, s[12:15], s74 offen offset:3072 sc1
  v_mfma_f32_16x16x32_bf16 v[24:27], v[112:115], a[140:143], v[24:27]
  v_mul_f32 v212, v212, v231
  v_mul_f32 v213, v213, v231
  v_mul_f32 v214, v214, v231
  v_mul_f32 v215, v215, v231
  v_mfma_f32_16x16x32_bf16 v[24:27], v[116:119], a[156:159], v[24:27]
  v_cvt_pk_bf16_f32 v172, v212, v213
  v_cvt_pk_bf16_f32 v173, v214, v215
  v_mul_f32 v216, v216, v231
  s_waitcnt vmcnt(13)
  v_mfma_f32_16x16x32_bf16 v[52:55], v[120:123], a[160:163], 0
  s_xor_b32 s74, s86, 77824
  v_mul_f32 v217, v217, v231
  v_mul_f32 v218, v218, v231
  v_mul_f32 v219, v219, v231
  v_mfma_f32_16x16x32_bf16 v[52:55], v[124:127], a[176:179], v[52:55]
  buffer_load_dwordx4 v[112:115], v242, s[12:15], s74 offen offset:0 sc1
  v_mfma_f32_16x16x32_bf16 v[28:31], v[120:123], a[164:167], 0
  v_cvt_pk_bf16_f32 v174, v216, v217
  v_cvt_pk_bf16_f32 v175, v218, v219
  s_waitcnt lgkmcnt(3)
  v_mfma_f32_32x32x16_bf16 v[212:227], v[200:203], v[176:179], 0
  ds_read2_b64 v[200:203], v240 offset0:8 offset1:10
  s_waitcnt lgkmcnt(3)
  v_mfma_f32_32x32x16_bf16 v[212:227], v[204:207], v[180:183], v[212:227]
  ds_read2_b64 v[204:207], v240 offset0:12 offset1:14
  s_waitcnt lgkmcnt(3)
  v_mfma_f32_32x32x16_bf16 v[212:227], v[208:211], v[184:187], v[212:227]
  ds_read2_b64 v[208:211], v240 offset0:16 offset1:18
  s_nop 0
  v_mfma_f32_16x16x32_bf16 v[28:31], v[124:127], a[180:183], v[28:31]
  ds_write_b128 v4, v[16:19] offset:2048
  v_mfma_f32_16x16x32_bf16 v[32:35], v[120:123], a[168:171], 0
  v_mfma_f32_16x16x32_bf16 v[32:35], v[124:127], a[184:187], v[32:35]
  buffer_load_dwordx4 v[116:119], v242, s[12:15], s74 offen offset:1024 sc1
  v_mfma_f32_16x16x32_bf16 v[36:39], v[120:123], a[172:175], 0
  v_mfma_f32_16x16x32_bf16 v[36:39], v[124:127], a[188:191], v[36:39]
  s_waitcnt vmcnt(13)
  v_mfma_f32_16x16x32_bf16 v[52:55], v[128:131], a[192:195], v[52:55]
  ds_write_b128 v5, v[20:23] offset:2048
  v_mfma_f32_16x16x32_bf16 v[52:55], v[132:135], a[208:211], v[52:55]
  buffer_load_dwordx4 v[120:123], v242, s[12:15], s74 offen offset:2048 sc1
  v_mfma_f32_16x16x32_bf16 v[28:31], v[128:131], a[196:199], v[28:31]
  v_mfma_f32_16x16x32_bf16 v[28:31], v[132:135], a[212:215], v[28:31]
  v_mfma_f32_16x16x32_bf16 v[32:35], v[128:131], a[200:203], v[32:35]
  ds_write_b128 v6, v[24:27] offset:2048
  v_mfma_f32_16x16x32_bf16 v[32:35], v[132:135], a[216:219], v[32:35]
  buffer_load_dwordx4 v[124:127], v242, s[12:15], s74 offen offset:3072 sc1
  v_mfma_f32_16x16x32_bf16 v[36:39], v[128:131], a[204:207], v[36:39]
  v_mul_f32 v212, v212, v228
  v_mfma_f32_16x16x32_bf16 v[36:39], v[132:135], a[220:223], v[36:39]
  v_mul_f32 v213, v213, v228
  v_mul_f32 v214, v214, v228
  v_mul_f32 v215, v215, v228
  s_waitcnt vmcnt(13)
  v_mfma_f32_16x16x32_bf16 v[52:55], v[136:139], a[224:227], v[52:55]
  s_xor_b32 s74, s91, 0
  v_cvt_pk_bf16_f32 v156, v212, v213
  v_cvt_pk_bf16_f32 v157, v214, v215
  v_mul_f32 v220, v220, v232
  v_mfma_f32_16x16x32_bf16 v[52:55], v[140:143], a[240:243], v[52:55]
  buffer_load_dwordx4 v[128:131], v242, s[12:15], s74 offen offset:0 sc1
  v_mfma_f32_16x16x32_bf16 v[28:31], v[136:139], a[228:231], v[28:31]
  s_waitcnt lgkmcnt(0)
  s_barrier
  v_mul_f32 v221, v221, v232
  v_mul_f32 v222, v222, v232
  v_mfma_f32_16x16x32_bf16 v[28:31], v[140:143], a[244:247], v[28:31]
  ds_read_b128 v[16:19], v7 offset:2048
  v_mul_f32 v223, v223, v232
  v_cvt_pk_bf16_f32 v158, v220, v221
  v_mfma_f32_16x16x32_bf16 v[32:35], v[136:139], a[232:235], v[32:35]
  ds_read_b128 v[20:23], v7 offset:10240
  v_cvt_pk_bf16_f32 v159, v222, v223
  v_mul_f32 v216, v216, v228
  v_mfma_f32_16x16x32_bf16 v[32:35], v[140:143], a[248:251], v[32:35]
  buffer_load_dwordx4 v[132:135], v242, s[12:15], s74 offen offset:1024 sc1
  v_mfma_f32_16x16x32_bf16 v[36:39], v[136:139], a[236:239], v[36:39]
  ds_read_b128 v[24:27], v7 offset:18432
  v_mul_f32 v217, v217, v228
  v_mul_f32 v218, v218, v228
  v_mfma_f32_16x16x32_bf16 v[36:39], v[140:143], a[252:255], v[36:39]
  v_mul_f32 v219, v219, v228
  v_cvt_pk_bf16_f32 v160, v216, v217
  v_cvt_pk_bf16_f32 v161, v218, v219
  s_waitcnt vmcnt(13)
  v_mfma_f32_16x16x32_bf16 v[52:55], v[144:147], a[0:3], v[52:55]
  s_nop 0
  v_mfma_f32_16x16x32_bf16 v[52:55], v[148:151], a[16:19], v[52:55]
  buffer_load_dwordx4 v[136:139], v242, s[12:15], s74 offen offset:2048 sc1
  v_mfma_f32_16x16x32_bf16 v[28:31], v[144:147], a[4:7], v[28:31]
  v_mul_f32 v224, v224, v229
  v_mul_f32 v225, v225, v229
  v_mul_f32 v226, v226, v229
  v_mul_f32 v227, v227, v229
  v_mfma_f32_16x16x32_bf16 v[28:31], v[148:151], a[20:23], v[28:31]
  v_cvt_pk_bf16_f32 v162, v224, v225
  v_cvt_pk_bf16_f32 v163, v226, v227
  v_mfma_f32_32x32x16_bf16 v[212:227], v[196:199], v[180:183], 0
  v_mfma_f32_32x32x16_bf16 v[212:227], v[200:203], v[184:187], v[212:227]
  v_mfma_f32_32x32x16_bf16 v[212:227], v[204:207], v[188:191], v[212:227]
  v_mfma_f32_32x32x16_bf16 v[212:227], v[208:211], v[192:195], v[212:227]
  s_nop 0
  v_mfma_f32_16x16x32_bf16 v[32:35], v[144:147], a[8:11], v[32:35]
  s_waitcnt lgkmcnt(2)
  v_add_f32 v48, v48, v16
  v_add_f32 v49, v49, v17
  v_mfma_f32_16x16x32_bf16 v[32:35], v[148:151], a[24:27], v[32:35]
  buffer_load_dwordx4 v[140:143], v242, s[12:15], s74 offen offset:3072 sc1
  v_mfma_f32_16x16x32_bf16 v[36:39], v[144:147], a[12:15], v[36:39]
  v_add_f32 v50, v50, v18
  v_add_f32 v51, v51, v19
  v_mfma_f32_16x16x32_bf16 v[36:39], v[148:151], a[28:31], v[36:39]
  s_waitcnt lgkmcnt(1)
  v_add_f32 v48, v48, v20
  s_waitcnt vmcnt(13)
  v_mfma_f32_16x16x32_bf16 v[52:55], v[96:99], a[32:35], v[52:55]
  s_xor_b32 s74, s91, 4096
  v_add_f32 v49, v49, v21
  v_mfma_f32_16x16x32_bf16 v[52:55], v[100:103], a[48:51], v[52:55]
  buffer_load_dwordx4 v[144:147], v242, s[12:15], s74 offen offset:0 sc1
  v_mfma_f32_16x16x32_bf16 v[28:31], v[96:99], a[36:39], v[28:31]
  v_add_f32 v50, v50, v22
  v_add_f32 v51, v51, v23
  v_mfma_f32_16x16x32_bf16 v[28:31], v[100:103], a[52:55], v[28:31]
  s_waitcnt lgkmcnt(0)
  v_add_f32 v48, v48, v24
  v_add_f32 v49, v49, v25
  v_mfma_f32_16x16x32_bf16 v[32:35], v[96:99], a[40:43], v[32:35]
  v_add_f32 v50, v50, v26
  v_add_f32 v51, v51, v27
  v_lshrrev_b32 v14, 5, v1
  v_bfe_u32 v15, v1, 4, 1
  v_mfma_f32_16x16x32_bf16 v[32:35], v[100:103], a[56:59], v[32:35]
  buffer_load_dwordx4 v[148:151], v242, s[12:15], s74 offen offset:1024 sc1
  v_mfma_f32_16x16x32_bf16 v[36:39], v[96:99], a[44:47], v[36:39]
  v_lshlrev_b32 v15, 2, v15
  v_lshl_add_u32 v15, v14, 7, v15
  v_add_u32 v15, s48, v15
  v_and_b32 v254, 3, v1
  v_lshl_add_u32 v254, v254, 2, s55
  v_mfma_f32_16x16x32_bf16 v[36:39], v[100:103], a[60:63], v[36:39]
  v_mul_f32 v212, v212, v229
  v_mul_f32 v213, v213, v229
  v_mul_f32 v214, v214, v229
  s_waitcnt vmcnt(10)
  v_mfma_f32_16x16x32_bf16 v[52:55], v[104:107], a[64:67], v[52:55]
  v_mul_f32 v215, v215, v229
  v_cvt_pk_bf16_f32 v164, v212, v213
  v_cvt_pk_bf16_f32 v165, v214, v215
  v_mul_f32 v220, v220, v230
  v_lshl_add_u32 v254, v14, 7, v254
  v_mfma_f32_16x16x32_bf16 v[52:55], v[108:111], a[80:83], v[52:55]
  buffer_load_dwordx4 v[96:99], v242, s[12:15], s74 offen offset:2048 sc1
  v_mfma_f32_16x16x32_bf16 v[28:31], v[104:107], a[68:71], v[28:31]
  v_mul_f32 v221, v221, v230
  v_mul_f32 v222, v222, v230
  v_mul_f32 v223, v223, v230
  v_cvt_pk_bf16_f32 v166, v220, v221
  v_mfma_f32_16x16x32_bf16 v[28:31], v[108:111], a[84:87], v[28:31]
  v_cvt_pk_bf16_f32 v167, v222, v223
  v_mul_f32 v216, v216, v230
  v_mul_f32 v217, v217, v230
  v_mul_f32 v218, v218, v230
  v_lshlrev_b32 v88, 16, v72
  v_mfma_f32_16x16x32_bf16 v[32:35], v[104:107], a[72:75], v[32:35]
  v_mul_f32 v219, v219, v230
  v_cvt_pk_bf16_f32 v168, v216, v217
  v_cvt_pk_bf16_f32 v169, v218, v219
  v_mul_f32 v224, v224, v233
  v_mfma_f32_16x16x32_bf16 v[32:35], v[108:111], a[88:91], v[32:35]
  buffer_load_dwordx4 v[100:103], v242, s[12:15], s74 offen offset:3072 sc1
  v_mfma_f32_16x16x32_bf16 v[36:39], v[104:107], a[76:79], v[36:39]
  v_mul_f32 v225, v225, v233
  v_mul_f32 v226, v226, v233
  v_mul_f32 v227, v227, v233
  v_cvt_pk_bf16_f32 v170, v224, v225
  v_and_b32 v89, 0xffff0000, v72
  v_mfma_f32_16x16x32_bf16 v[36:39], v[108:111], a[92:95], v[36:39]
  v_cvt_pk_bf16_f32 v171, v226, v227
  buffer_store_dwordx2 v[172:173], v246, s[12:15], s35 offen offset:0 sc1
  s_waitcnt vmcnt(11)
  v_mfma_f32_16x16x32_bf16 v[52:55], v[112:115], a[96:99], v[52:55]
  s_xor_b32 s74, s91, 8192
  buffer_store_dwordx2 v[174:175], v246, s[12:15], s35 offen offset:512 sc1
  v_lshlrev_b32 v90, 16, v73
  v_and_b32 v91, 0xffff0000, v73
  v_mfma_f32_16x16x32_bf16 v[52:55], v[116:119], a[112:115], v[52:55]
  buffer_load_dwordx4 v[104:107], v242, s[12:15], s74 offen offset:0 sc1
  v_mfma_f32_16x16x32_bf16 v[28:31], v[112:115], a[100:103], v[28:31]
  buffer_store_dwordx4 v[156:159], v246, s[12:15], s34 offen offset:0 sc1
  v_mul_f32 v92, v88, v88
  v_mul_f32 v93, v89, v89
  v_mfma_f32_16x16x32_bf16 v[28:31], v[116:119], a[116:119], v[28:31]
  buffer_store_dwordx4 v[160:163], v246, s[12:15], s34 offen offset:512 sc1
  v_mul_f32 v94, v90, v90
  v_mul_f32 v95, v91, v91
  v_fma_f32 v92, v92, v9, v8
  v_mfma_f32_16x16x32_bf16 v[32:35], v[112:115], a[104:107], v[32:35]
  buffer_store_dwordx4 v[164:167], v246, s[12:15], s34 offen offset:1024 sc1
  v_fma_f32 v93, v93, v9, v8
  v_fma_f32 v94, v94, v9, v8
  v_mfma_f32_16x16x32_bf16 v[32:35], v[116:119], a[120:123], v[32:35]
  buffer_load_dwordx4 v[108:111], v242, s[12:15], s74 offen offset:1024 sc1
  v_mfma_f32_16x16x32_bf16 v[36:39], v[112:115], a[108:111], v[36:39]
  buffer_store_dwordx4 v[168:171], v246, s[12:15], s34 offen offset:1536 sc1
  v_fma_f32 v95, v95, v9, v8
  v_mul_f32 v92, v92, v88
  v_mul_f32 v93, v93, v89
  v_mfma_f32_16x16x32_bf16 v[36:39], v[116:119], a[124:127], v[36:39]
  v_mul_f32 v94, v94, v90
  v_mul_f32 v95, v95, v91
  s_waitcnt vmcnt(16)
  v_mfma_f32_16x16x32_bf16 v[52:55], v[120:123], a[128:131], v[52:55]
  v_exp_f32 v92, v92
  v_exp_f32 v93, v93
  v_mfma_f32_16x16x32_bf16 v[52:55], v[124:127], a[144:147], v[52:55]
  buffer_load_dwordx4 v[112:115], v242, s[12:15], s74 offen offset:2048 sc1
  v_mfma_f32_16x16x32_bf16 v[28:31], v[120:123], a[132:135], v[28:31]
  v_exp_f32 v94, v94
  v_exp_f32 v95, v95
  v_mfma_f32_16x16x32_bf16 v[28:31], v[124:127], a[148:151], v[28:31]
  v_add_f32 v92, 1.0, v92
  v_add_f32 v93, 1.0, v93
  v_add_f32 v94, 1.0, v94
  v_add_f32 v95, 1.0, v95
  v_mfma_f32_16x16x32_bf16 v[32:35], v[120:123], a[136:139], v[32:35]
  v_rcp_f32 v92, v92
  v_rcp_f32 v93, v93
  v_mfma_f32_16x16x32_bf16 v[32:35], v[124:127], a[152:155], v[32:35]
  buffer_load_dwordx4 v[116:119], v242, s[12:15], s74 offen offset:3072 sc1
  v_mfma_f32_16x16x32_bf16 v[36:39], v[120:123], a[140:143], v[36:39]
  v_rcp_f32 v94, v94
  v_rcp_f32 v95, v95
  v_mul_f32 v88, v88, v92
  v_mfma_f32_16x16x32_bf16 v[36:39], v[124:127], a[156:159], v[36:39]
  v_mul_f32 v89, v89, v93
  v_mul_f32 v90, v90, v94
  v_mul_f32 v91, v91, v95
  s_waitcnt vmcnt(16)
  v_mfma_f32_16x16x32_bf16 v[56:59], v[128:131], a[160:163], 0
  s_xor_b32 s74, s91, 12288
  v_fma_f32 v40, v40, v252, v251
  v_fma_f32 v41, v41, v252, v251
  v_fma_f32 v42, v42, v252, v251
  v_fma_f32 v43, v43, v252, v251
  v_mfma_f32_16x16x32_bf16 v[56:59], v[132:135], a[176:179], v[56:59]
  buffer_load_dwordx4 v[120:123], v242, s[12:15], s74 offen offset:0 sc1
  v_mfma_f32_16x16x32_bf16 v[16:19], v[128:131], a[164:167], 0
  v_mul_f32 v40, v40, v88
  v_mul_f32 v41, v41, v89
  v_mul_f32 v42, v42, v90
  v_mul_f32 v43, v43, v91
  v_mfma_f32_16x16x32_bf16 v[16:19], v[132:135], a[180:183], v[16:19]
  ds_write_b128 v4, v[28:31] offset:3072
  v_mfma_f32_16x16x32_bf16 v[20:23], v[128:131], a[168:171], 0
  v_cvt_pk_bf16_f32 v72, v40, v41
  v_cvt_pk_bf16_f32 v73, v42, v43
  v_lshlrev_b32 v88, 16, v74
  v_and_b32 v89, 0xffff0000, v74
  v_lshlrev_b32 v90, 16, v75
  v_mfma_f32_16x16x32_bf16 v[20:23], v[132:135], a[184:187], v[20:23]
  buffer_load_dwordx4 v[124:127], v242, s[12:15], s74 offen offset:1024 sc1
  v_mfma_f32_16x16x32_bf16 v[24:27], v[128:131], a[172:175], 0
  v_and_b32 v91, 0xffff0000, v75
  v_mul_f32 v92, v88, v88
  v_mul_f32 v93, v89, v89
  v_mul_f32 v94, v90, v90
  v_mfma_f32_16x16x32_bf16 v[24:27], v[132:135], a[188:191], v[24:27]
  v_mul_f32 v95, v91, v91
  v_fma_f32 v92, v92, v9, v8
  v_fma_f32 v93, v93, v9, v8
  v_fma_f32 v94, v94, v9, v8
  s_waitcnt vmcnt(16)
  v_mfma_f32_16x16x32_bf16 v[56:59], v[136:139], a[192:195], v[56:59]
  ds_write_b128 v5, v[32:35] offset:3072
  v_mfma_f32_16x16x32_bf16 v[56:59], v[140:143], a[208:211], v[56:59]
  buffer_load_dwordx4 v[128:131], v242, s[12:15], s74 offen offset:2048 sc1
  v_mfma_f32_16x16x32_bf16 v[16:19], v[136:139], a[196:199], v[16:19]
  v_fma_f32 v95, v95, v9, v8
  v_mul_f32 v92, v92, v88
  v_mul_f32 v93, v93, v89
  v_mul_f32 v94, v94, v90
  v_mfma_f32_16x16x32_bf16 v[16:19], v[140:143], a[212:215], v[16:19]
  v_mul_f32 v95, v95, v91
  v_exp_f32 v92, v92
  v_exp_f32 v93, v93
  v_mfma_f32_16x16x32_bf16 v[20:23], v[136:139], a[200:203], v[20:23]
  ds_write_b128 v6, v[36:39] offset:3072
  v_mfma_f32_16x16x32_bf16 v[20:23], v[140:143], a[216:219], v[20:23]
  buffer_load_dwordx4 v[132:135], v242, s[12:15], s74 offen offset:3072 sc1
  v_mfma_f32_16x16x32_bf16 v[24:27], v[136:139], a[204:207], v[24:27]
  v_exp_f32 v94, v94
  v_exp_f32 v95, v95
  v_mfma_f32_16x16x32_bf16 v[24:27], v[140:143], a[220:223], v[24:27]
  v_add_f32 v92, 1.0, v92
  v_add_f32 v93, 1.0, v93
  v_add_f32 v94, 1.0, v94
  v_add_f32 v95, 1.0, v95
  s_waitcnt vmcnt(16)
  v_mfma_f32_16x16x32_bf16 v[56:59], v[144:147], a[224:227], v[56:59]
  s_xor_b32 s74, s91, 65536
  v_rcp_f32 v92, v92
  v_mfma_f32_16x16x32_bf16 v[56:59], v[148:151], a[240:243], v[56:59]
  buffer_load_dwordx4 v[136:139], v242, s[12:15], s74 offen offset:0 sc1
  v_mfma_f32_16x16x32_bf16 v[16:19], v[144:147], a[228:231], v[16:19]
  s_waitcnt lgkmcnt(0)
  s_barrier
  v_rcp_f32 v93, v93
  v_mfma_f32_16x16x32_bf16 v[16:19], v[148:151], a[244:247], v[16:19]
  ds_read_b128 v[28:31], v7 offset:3072
  v_rcp_f32 v94, v94
  v_mfma_f32_16x16x32_bf16 v[20:23], v[144:147], a[232:235], v[20:23]
  ds_read_b128 v[32:35], v7 offset:11264
  v_rcp_f32 v95, v95
  s_waitcnt vmcnt(7)
  v_mfma_f32_16x16x32_bf16 v[20:23], v[148:151], a[248:251], v[20:23]
  buffer_load_dwordx4 v[140:143], v242, s[12:15], s74 offen offset:1024 sc1
  v_mfma_f32_16x16x32_bf16 v[24:27], v[144:147], a[236:239], v[24:27]
  ds_read_b128 v[36:39], v7 offset:19456
  buffer_store_dword v2, v3, s[12:15], s90 offen sc1
  v_mfma_f32_16x16x32_bf16 v[24:27], v[148:151], a[252:255], v[24:27]
  v_mul_f32 v88, v88, v92
  v_mul_f32 v89, v89, v93
  v_mul_f32 v90, v90, v94
  v_mfma_f32_16x16x32_bf16 v[56:59], v[96:99], a[0:3], v[56:59]
  s_nop 0
  v_mfma_f32_16x16x32_bf16 v[56:59], v[100:103], a[16:19], v[56:59]
  buffer_load_dwordx4 v[144:147], v242, s[12:15], s74 offen offset:2048 sc1
  v_mfma_f32_16x16x32_bf16 v[16:19], v[96:99], a[4:7], v[16:19]
  v_mul_f32 v91, v91, v95
  v_fma_f32 v44, v44, v252, v251
  v_fma_f32 v45, v45, v252, v251
  v_fma_f32 v46, v46, v252, v251
  v_fma_f32 v47, v47, v252, v251
  v_mfma_f32_16x16x32_bf16 v[16:19], v[100:103], a[20:23], v[16:19]
  v_mul_f32 v44, v44, v88
  v_mul_f32 v45, v45, v89
  v_mul_f32 v46, v46, v90
  v_mul_f32 v47, v47, v91
  v_mfma_f32_16x16x32_bf16 v[20:23], v[96:99], a[8:11], v[20:23]
  s_waitcnt lgkmcnt(2)
  v_add_f32 v52, v52, v28
  v_add_f32 v53, v53, v29
  v_cvt_pk_bf16_f32 v74, v44, v45
  v_cvt_pk_bf16_f32 v75, v46, v47
  s_lshr_b32 s79, s85, 17
  v_mfma_f32_16x16x32_bf16 v[20:23], v[100:103], a[24:27], v[20:23]
  buffer_load_dwordx4 v[148:151], v242, s[12:15], s74 offen offset:3072 sc1
  v_mfma_f32_16x16x32_bf16 v[24:27], v[96:99], a[12:15], v[24:27]
  v_add_f32 v54, v54, v30
  v_add_f32 v55, v55, v31
  s_lshl_b32 s79, s79, 10
  s_add_u32 s79, s79, s88
  v_mfma_f32_16x16x32_bf16 v[24:27], v[100:103], a[28:31], v[24:27]
  s_waitcnt lgkmcnt(1)
  v_add_f32 v52, v52, v32
  buffer_store_dwordx4 v[72:75], v248, s[12:15], s79 offen sc1
  v_mfma_f32_16x16x32_bf16 v[56:59], v[104:107], a[32:35], v[56:59]
  s_xor_b32 s74, s91, 69632
  v_add_f32 v53, v53, v33
  v_mfma_f32_16x16x32_bf16 v[56:59], v[108:111], a[48:51], v[56:59]
  buffer_load_dwordx4 v[96:99], v242, s[12:15], s74 offen offset:0 sc1
  v_mfma_f32_16x16x32_bf16 v[16:19], v[104:107], a[36:39], v[16:19]
  v_add_f32 v54, v54, v34
  v_add_f32 v55, v55, v35
  v_lshlrev_b32 v88, 16, v76
  v_and_b32 v89, 0xffff0000, v76
  v_mfma_f32_16x16x32_bf16 v[16:19], v[108:111], a[52:55], v[16:19]
  s_waitcnt lgkmcnt(0)
  v_add_f32 v52, v52, v36
  v_add_f32 v53, v53, v37
  v_lshlrev_b32 v90, 16, v77
  v_and_b32 v91, 0xffff0000, v77
  v_mfma_f32_16x16x32_bf16 v[20:23], v[104:107], a[40:43], v[20:23]
  v_add_f32 v54, v54, v38
  v_add_f32 v55, v55, v39
  v_mul_f32 v92, v88, v88
  v_mul_f32 v93, v89, v89
  v_mul_f32 v94, v90, v90
  v_mfma_f32_16x16x32_bf16 v[20:23], v[108:111], a[56:59], v[20:23]
  buffer_load_dwordx4 v[100:103], v242, s[12:15], s74 offen offset:1024 sc1
  v_mfma_f32_16x16x32_bf16 v[24:27], v[104:107], a[44:47], v[24:27]
  v_mul_f32 v95, v91, v91
  v_fma_f32 v92, v92, v9, v8
  v_fma_f32 v93, v93, v9, v8
  v_fma_f32 v94, v94, v9, v8
  v_mfma_f32_16x16x32_bf16 v[24:27], v[108:111], a[60:63], v[24:27]
  v_fma_f32 v95, v95, v9, v8
  v_mul_f32 v92, v92, v88
  v_mul_f32 v93, v93, v89
  v_mul_f32 v94, v94, v90
  s_waitcnt vmcnt(12)
  v_mfma_f32_16x16x32_bf16 v[56:59], v[112:115], a[64:67], v[56:59]
  v_mul_f32 v95, v95, v91
  v_exp_f32 v92, v92
  v_mfma_f32_16x16x32_bf16 v[56:59], v[116:119], a[80:83], v[56:59]
  buffer_load_dwordx4 v[104:107], v242, s[12:15], s74 offen offset:2048 sc1
  v_mfma_f32_16x16x32_bf16 v[16:19], v[112:115], a[68:71], v[16:19]
  v_exp_f32 v93, v93
  v_exp_f32 v94, v94
  v_mfma_f32_16x16x32_bf16 v[16:19], v[116:119], a[84:87], v[16:19]
  v_exp_f32 v95, v95
  v_add_f32 v92, 1.0, v92
  v_add_f32 v93, 1.0, v93
  v_mfma_f32_16x16x32_bf16 v[20:23], v[112:115], a[72:75], v[20:23]
  v_add_f32 v94, 1.0, v94
  v_add_f32 v95, 1.0, v95
  v_rcp_f32 v92, v92
  v_mfma_f32_16x16x32_bf16 v[20:23], v[116:119], a[88:91], v[20:23]
  buffer_load_dwordx4 v[108:111], v242, s[12:15], s74 offen offset:3072 sc1
  v_mfma_f32_16x16x32_bf16 v[24:27], v[112:115], a[76:79], v[24:27]
  v_rcp_f32 v93, v93
  v_rcp_f32 v94, v94
  v_mfma_f32_16x16x32_bf16 v[24:27], v[116:119], a[92:95], v[24:27]
  v_rcp_f32 v95, v95
  v_mul_f32 v88, v88, v92
  v_mul_f32 v89, v89, v93
  s_waitcnt vmcnt(12)
  v_mfma_f32_16x16x32_bf16 v[56:59], v[120:123], a[96:99], v[56:59]
  s_xor_b32 s74, s91, 73728
  v_mul_f32 v90, v90, v94
  v_mul_f32 v91, v91, v95
  v_fma_f32 v48, v48, v252, v251
  v_mfma_f32_16x16x32_bf16 v[56:59], v[124:127], a[112:115], v[56:59]
  buffer_load_dwordx4 v[112:115], v242, s[12:15], s74 offen offset:0 sc1
  v_mfma_f32_16x16x32_bf16 v[16:19], v[120:123], a[100:103], v[16:19]
  v_fma_f32 v49, v49, v252, v251
  v_fma_f32 v50, v50, v252, v251
  v_fma_f32 v51, v51, v252, v251
  v_mul_f32 v48, v48, v88
  v_mul_f32 v49, v49, v89
  v_mfma_f32_16x16x32_bf16 v[16:19], v[124:127], a[116:119], v[16:19]
  v_mul_f32 v50, v50, v90
  v_mul_f32 v51, v51, v91
  v_cvt_pk_bf16_f32 v76, v48, v49
  v_cvt_pk_bf16_f32 v77, v50, v51
  v_mfma_f32_16x16x32_bf16 v[20:23], v[120:123], a[104:107], v[20:23]
  v_lshlrev_b32 v88, 16, v78
  v_and_b32 v89, 0xffff0000, v78
  v_lshlrev_b32 v90, 16, v79
  v_and_b32 v91, 0xffff0000, v79
  v_mul_f32 v92, v88, v88
  v_mfma_f32_16x16x32_bf16 v[20:23], v[124:127], a[120:123], v[20:23]
  buffer_load_dwordx4 v[116:119], v242, s[12:15], s74 offen offset:1024 sc1
  v_mfma_f32_16x16x32_bf16 v[24:27], v[120:123], a[108:111], v[24:27]
  v_mul_f32 v93, v89, v89
  v_mul_f32 v94, v90, v90
  v_mul_f32 v95, v91, v91
  v_fma_f32 v92, v92, v9, v8
  v_mfma_f32_16x16x32_bf16 v[24:27], v[124:127], a[124:127], v[24:27]
  v_fma_f32 v93, v93, v9, v8
  v_fma_f32 v94, v94, v9, v8
  v_fma_f32 v95, v95, v9, v8
  v_mul_f32 v92, v92, v88
  s_waitcnt vmcnt(12)
  v_mfma_f32_16x16x32_bf16 v[56:59], v[128:131], a[128:131], v[56:59]
  v_mul_f32 v93, v93, v89
  v_mul_f32 v94, v94, v90
  v_mul_f32 v95, v95, v91
  v_mfma_f32_16x16x32_bf16 v[56:59], v[132:135], a[144:147], v[56:59]
  buffer_load_dwordx4 v[120:123], v242, s[12:15], s74 offen offset:2048 sc1
  v_mfma_f32_16x16x32_bf16 v[16:19], v[128:131], a[132:135], v[16:19]
  v_exp_f32 v92, v92
  v_exp_f32 v93, v93
  v_mfma_f32_16x16x32_bf16 v[16:19], v[132:135], a[148:151], v[16:19]
  v_exp_f32 v94, v94
  v_exp_f32 v95, v95
  v_mfma_f32_16x16x32_bf16 v[20:23], v[128:131], a[136:139], v[20:23]
  v_add_f32 v92, 1.0, v92
  v_add_f32 v93, 1.0, v93
  v_add_f32 v94, 1.0, v94
  v_add_f32 v95, 1.0, v95
  v_mfma_f32_16x16x32_bf16 v[20:23], v[132:135], a[152:155], v[20:23]
  buffer_load_dwordx4 v[124:127], v242, s[12:15], s74 offen offset:3072 sc1
  v_mfma_f32_16x16x32_bf16 v[24:27], v[128:131], a[140:143], v[24:27]
  v_rcp_f32 v92, v92
  v_rcp_f32 v93, v93
  v_mfma_f32_16x16x32_bf16 v[24:27], v[132:135], a[156:159], v[24:27]
  v_rcp_f32 v94, v94
  v_rcp_f32 v95, v95
  s_waitcnt vmcnt(12)
  v_mfma_f32_16x16x32_bf16 v[60:63], v[136:139], a[160:163], 0
  s_xor_b32 s74, s91, 77824
  v_mul_f32 v88, v88, v92
  v_mul_f32 v89, v89, v93
  v_mul_f32 v90, v90, v94
  v_mfma_f32_16x16x32_bf16 v[60:63], v[140:143], a[176:179], v[60:63]
  buffer_load_dwordx4 v[128:131], v242, s[12:15], s74 offen offset:0 sc1
  v_mfma_f32_16x16x32_bf16 v[28:31], v[136:139], a[164:167], 0
  v_mul_f32 v91, v91, v95
  v_fma_f32 v52, v52, v252, v251
  v_fma_f32 v53, v53, v252, v251
  v_fma_f32 v54, v54, v252, v251
  v_fma_f32 v55, v55, v252, v251
  v_mfma_f32_16x16x32_bf16 v[28:31], v[140:143], a[180:183], v[28:31]
  ds_write_b128 v4, v[16:19] offset:4096
  v_mfma_f32_16x16x32_bf16 v[32:35], v[136:139], a[168:171], 0
  v_mul_f32 v52, v52, v88
  v_mul_f32 v53, v53, v89
  v_mul_f32 v54, v54, v90
  v_mul_f32 v55, v55, v91
  v_mfma_f32_16x16x32_bf16 v[32:35], v[140:143], a[184:187], v[32:35]
  buffer_load_dwordx4 v[132:135], v242, s[12:15], s74 offen offset:1024 sc1
  v_mfma_f32_16x16x32_bf16 v[36:39], v[136:139], a[172:175], 0
  v_cvt_pk_bf16_f32 v78, v52, v53
  v_cvt_pk_bf16_f32 v79, v54, v55
  s_lshr_b32 s79, s86, 17
  s_lshl_b32 s79, s79, 10
  s_add_u32 s79, s79, s88
  v_mfma_f32_16x16x32_bf16 v[36:39], v[140:143], a[188:191], v[36:39]
  buffer_store_dwordx4 v[76:79], v248, s[12:15], s79 offen sc1
  s_waitcnt vmcnt(12)
  v_mfma_f32_16x16x32_bf16 v[60:63], v[144:147], a[192:195], v[60:63]
  ds_write_b128 v5, v[20:23] offset:4096
  v_mfma_f32_16x16x32_bf16 v[60:63], v[148:151], a[208:211], v[60:63]
  buffer_load_dwordx4 v[136:139], v242, s[12:15], s74 offen offset:2048 sc1
  v_mfma_f32_16x16x32_bf16 v[28:31], v[144:147], a[196:199], v[28:31]
  v_lshlrev_b32 v88, 16, v80
  v_and_b32 v89, 0xffff0000, v80
  v_mfma_f32_16x16x32_bf16 v[28:31], v[148:151], a[212:215], v[28:31]
  v_lshlrev_b32 v90, 16, v81
  v_and_b32 v91, 0xffff0000, v81
  v_mul_f32 v92, v88, v88
  v_mul_f32 v93, v89, v89
  v_mfma_f32_16x16x32_bf16 v[32:35], v[144:147], a[200:203], v[32:35]
  ds_write_b128 v6, v[24:27] offset:4096
  v_mfma_f32_16x16x32_bf16 v[32:35], v[148:151], a[216:219], v[32:35]
  buffer_load_dwordx4 v[140:143], v242, s[12:15], s74 offen offset:3072 sc1
  v_mfma_f32_16x16x32_bf16 v[36:39], v[144:147], a[204:207], v[36:39]
  v_mul_f32 v94, v90, v90
  v_mul_f32 v95, v91, v91
  v_fma_f32 v92, v92, v9, v8
  v_fma_f32 v93, v93, v9, v8
  v_fma_f32 v94, v94, v9, v8
  v_mfma_f32_16x16x32_bf16 v[36:39], v[148:151], a[220:223], v[36:39]
  v_fma_f32 v95, v95, v9, v8
  v_mul_f32 v92, v92, v88
  v_mul_f32 v93, v93, v89
  s_waitcnt vmcnt(11)
  v_mfma_f32_16x16x32_bf16 v[60:63], v[96:99], a[224:227], v[60:63]
  v_mul_f32 v94, v94, v90
  v_mul_f32 v95, v95, v91
  v_exp_f32 v92, v92
  s_waitcnt lgkmcnt(0)
  v_mfma_f32_16x16x32_bf16 v[60:63], v[100:103], a[240:243], v[60:63]
  s_add_u32 s80, s44, 0
  buffer_load_dwordx4 a[160:163], v13, s[12:15], s80 offen offset:0 sc1
  v_mfma_f32_16x16x32_bf16 v[28:31], v[96:99], a[228:231], v[28:31]
  s_barrier
  v_exp_f32 v93, v93
  v_mfma_f32_16x16x32_bf16 v[28:31], v[100:103], a[244:247], v[28:31]
  ds_read_b128 v[16:19], v7 offset:4096
  v_exp_f32 v94, v94
  v_mfma_f32_16x16x32_bf16 v[32:35], v[96:99], a[232:235], v[32:35]
  ds_read_b128 v[20:23], v7 offset:12288
  v_exp_f32 v95, v95
  v_mfma_f32_16x16x32_bf16 v[32:35], v[100:103], a[248:251], v[32:35]
  buffer_load_dwordx4 a[164:167], v13, s[12:15], s80 offen offset:1024 sc1
  v_mfma_f32_16x16x32_bf16 v[36:39], v[96:99], a[236:239], v[36:39]
  ds_read_b128 v[24:27], v7 offset:20480
  v_add_f32 v92, 1.0, v92
  v_add_f32 v93, 1.0, v93
  v_add_f32 v94, 1.0, v94
  v_mfma_f32_16x16x32_bf16 v[36:39], v[100:103], a[252:255], v[36:39]
  v_add_f32 v95, 1.0, v95
  v_rcp_f32 v92, v92
  s_waitcnt vmcnt(11)
  v_mfma_f32_16x16x32_bf16 v[60:63], v[104:107], a[0:3], v[60:63]
  s_nop 0
  v_mfma_f32_16x16x32_bf16 v[60:63], v[108:111], a[16:19], v[60:63]
  buffer_load_dwordx4 a[168:171], v13, s[12:15], s80 offen offset:2048 sc1
  v_mfma_f32_16x16x32_bf16 v[28:31], v[104:107], a[4:7], v[28:31]
  v_rcp_f32 v93, v93
  v_rcp_f32 v94, v94
  v_mfma_f32_16x16x32_bf16 v[28:31], v[108:111], a[20:23], v[28:31]
  v_rcp_f32 v95, v95
  v_mul_f32 v88, v88, v92
  v_mul_f32 v89, v89, v93
  v_mfma_f32_16x16x32_bf16 v[32:35], v[104:107], a[8:11], v[32:35]
  s_waitcnt lgkmcnt(2)
  v_add_f32 v56, v56, v16
  v_add_f32 v57, v57, v17
  v_mul_f32 v90, v90, v94
  v_mul_f32 v91, v91, v95
  buffer_load_dword v14, v15, s[12:15], 0 offen sc1
  v_mfma_f32_16x16x32_bf16 v[32:35], v[108:111], a[24:27], v[32:35]
  buffer_load_dwordx4 a[172:175], v13, s[12:15], s80 offen offset:3072 sc1
  v_mfma_f32_16x16x32_bf16 v[36:39], v[104:107], a[12:15], v[36:39]
  v_add_f32 v58, v58, v18
  v_add_f32 v59, v59, v19
  v_mfma_f32_16x16x32_bf16 v[36:39], v[108:111], a[28:31], v[36:39]
  s_waitcnt lgkmcnt(1)
  v_add_f32 v56, v56, v20
  s_waitcnt vmcnt(12)
  v_mfma_f32_16x16x32_bf16 v[60:63], v[112:115], a[32:35], v[60:63]
  v_add_f32 v57, v57, v21
  v_add_f32 v58, v58, v22
  v_mfma_f32_16x16x32_bf16 v[60:63], v[116:119], a[48:51], v[60:63]
  s_add_u32 s80, s44, 40960
  buffer_load_dwordx4 a[176:179], v13, s[12:15], s80 offen offset:0 sc1
  v_mfma_f32_16x16x32_bf16 v[28:31], v[112:115], a[36:39], v[28:31]
  v_add_f32 v59, v59, v23
  s_waitcnt lgkmcnt(0)
  v_add_f32 v56, v56, v24
  v_mfma_f32_16x16x32_bf16 v[28:31], v[116:119], a[52:55], v[28:31]
  v_add_f32 v57, v57, v25
  v_add_f32 v58, v58, v26
  v_mfma_f32_16x16x32_bf16 v[32:35], v[112:115], a[40:43], v[32:35]
  v_add_f32 v59, v59, v27
  v_mfma_f32_16x16x32_bf16 v[32:35], v[116:119], a[56:59], v[32:35]
  buffer_load_dwordx4 a[180:183], v13, s[12:15], s80 offen offset:1024 sc1
  v_mfma_f32_16x16x32_bf16 v[36:39], v[112:115], a[44:47], v[36:39]
  v_fma_f32 v56, v56, v252, v251
  v_fma_f32 v57, v57, v252, v251
  v_fma_f32 v58, v58, v252, v251
  v_fma_f32 v59, v59, v252, v251
  v_mfma_f32_16x16x32_bf16 v[36:39], v[116:119], a[60:63], v[36:39]
  v_mul_f32 v56, v56, v88
  v_mul_f32 v57, v57, v89
  v_mul_f32 v58, v58, v90
  v_mul_f32 v59, v59, v91
  s_waitcnt vmcnt(12)
  v_mfma_f32_16x16x32_bf16 v[60:63], v[120:123], a[64:67], v[60:63]
  v_cvt_pk_bf16_f32 v80, v56, v57
  v_cvt_pk_bf16_f32 v81, v58, v59
  v_lshlrev_b32 v88, 16, v82
  v_and_b32 v89, 0xffff0000, v82
  v_mfma_f32_16x16x32_bf16 v[60:63], v[124:127], a[80:83], v[60:63]
  buffer_load_dwordx4 a[184:187], v13, s[12:15], s80 offen offset:2048 sc1
  v_mfma_f32_16x16x32_bf16 v[28:31], v[120:123], a[68:71], v[28:31]
  v_lshlrev_b32 v90, 16, v83
  v_and_b32 v91, 0xffff0000, v83
  v_mul_f32 v92, v88, v88
  v_mul_f32 v93, v89, v89
  v_mul_f32 v94, v90, v90
  v_mfma_f32_16x16x32_bf16 v[28:31], v[124:127], a[84:87], v[28:31]
  v_mul_f32 v95, v91, v91
  v_fma_f32 v92, v92, v9, v8
  v_fma_f32 v93, v93, v9, v8
  v_fma_f32 v94, v94, v9, v8
  v_mfma_f32_16x16x32_bf16 v[32:35], v[120:123], a[72:75], v[32:35]
  v_fma_f32 v95, v95, v9, v8
  v_mul_f32 v92, v92, v88
  v_mul_f32 v93, v93, v89
  v_mul_f32 v94, v94, v90
  v_mul_f32 v95, v95, v91
  s_waitcnt vmcnt(10)
  buffer_store_dword v2, v3, s[12:15], s49 offen sc1
  v_mfma_f32_16x16x32_bf16 v[32:35], v[124:127], a[88:91], v[32:35]
  buffer_load_dwordx4 a[188:191], v13, s[12:15], s80 offen offset:3072 sc1
  v_mfma_f32_16x16x32_bf16 v[36:39], v[120:123], a[76:79], v[36:39]
  v_exp_f32 v92, v92
  v_exp_f32 v93, v93
  v_mfma_f32_16x16x32_bf16 v[36:39], v[124:127], a[92:95], v[36:39]
  v_exp_f32 v94, v94
  v_exp_f32 v95, v95
  v_mfma_f32_16x16x32_bf16 v[60:63], v[128:131], a[96:99], v[60:63]
  v_add_f32 v92, 1.0, v92
  v_add_f32 v93, 1.0, v93
  v_add_f32 v94, 1.0, v94
  v_add_f32 v95, 1.0, v95
  v_mfma_f32_16x16x32_bf16 v[60:63], v[132:135], a[112:115], v[60:63]
  s_add_u32 s80, s44, 81920
  buffer_load_dwordx4 a[192:195], v13, s[12:15], s80 offen offset:0 sc1
  v_mfma_f32_16x16x32_bf16 v[28:31], v[128:131], a[100:103], v[28:31]
  v_rcp_f32 v92, v92
  v_rcp_f32 v93, v93
  v_mfma_f32_16x16x32_bf16 v[28:31], v[132:135], a[116:119], v[28:31]
  v_rcp_f32 v94, v94
  v_rcp_f32 v95, v95
  v_mfma_f32_16x16x32_bf16 v[32:35], v[128:131], a[104:107], v[32:35]
  v_mul_f32 v88, v88, v92
  v_mul_f32 v89, v89, v93
  v_mul_f32 v90, v90, v94
  v_mul_f32 v91, v91, v95
  v_mfma_f32_16x16x32_bf16 v[32:35], v[132:135], a[120:123], v[32:35]
  buffer_load_dwordx4 a[196:199], v13, s[12:15], s80 offen offset:1024 sc1
  v_mfma_f32_16x16x32_bf16 v[36:39], v[128:131], a[108:111], v[36:39]
  v_mfma_f32_16x16x32_bf16 v[36:39], v[132:135], a[124:127], v[36:39]
  s_waitcnt vmcnt(12)
  v_mfma_f32_16x16x32_bf16 v[60:63], v[136:139], a[128:131], v[60:63]
  v_mfma_f32_16x16x32_bf16 v[60:63], v[140:143], a[144:147], v[60:63]
  buffer_load_dwordx4 a[200:203], v13, s[12:15], s80 offen offset:2048 sc1
  v_mfma_f32_16x16x32_bf16 v[28:31], v[136:139], a[132:135], v[28:31]
  v_mfma_f32_16x16x32_bf16 v[28:31], v[140:143], a[148:151], v[28:31]
  v_mfma_f32_16x16x32_bf16 v[32:35], v[136:139], a[136:139], v[32:35]
  v_mfma_f32_16x16x32_bf16 v[32:35], v[140:143], a[152:155], v[32:35]
  buffer_load_dwordx4 a[204:207], v13, s[12:15], s80 offen offset:3072 sc1
  v_mfma_f32_16x16x32_bf16 v[36:39], v[136:139], a[140:143], v[36:39]
  v_mfma_f32_16x16x32_bf16 v[36:39], v[140:143], a[156:159], v[36:39]
  s_nop 2
  ds_write_b128 v4, v[28:31] offset:5120
  s_nop 0
  ds_write_b128 v5, v[32:35] offset:5120
  s_nop 1
  ds_write_b128 v6, v[36:39] offset:5120
  s_waitcnt lgkmcnt(0)
  s_barrier
  ds_read_b128 v[28:31], v7 offset:5120
  ds_read_b128 v[32:35], v7 offset:13312
  ds_read_b128 v[36:39], v7 offset:21504
  s_waitcnt lgkmcnt(2)
  v_add_f32 v60, v60, v28
  v_add_f32 v61, v61, v29
  v_add_f32 v62, v62, v30
  v_add_f32 v63, v63, v31
  s_waitcnt lgkmcnt(1)
  v_add_f32 v60, v60, v32
  v_add_f32 v61, v61, v33
  v_add_f32 v62, v62, v34
  v_add_f32 v63, v63, v35
  s_waitcnt lgkmcnt(0)
  v_add_f32 v60, v60, v36
  v_add_f32 v61, v61, v37
  v_add_f32 v62, v62, v38
  v_add_f32 v63, v63, v39
  v_fma_f32 v60, v60, v252, v251
  v_fma_f32 v61, v61, v252, v251
  v_fma_f32 v62, v62, v252, v251
  v_fma_f32 v63, v63, v252, v251
  v_mul_f32 v60, v60, v88
  v_mul_f32 v61, v61, v89
  v_mul_f32 v62, v62, v90
  v_mul_f32 v63, v63, v91
  v_cvt_pk_bf16_f32 v82, v60, v61
  v_cvt_pk_bf16_f32 v83, v62, v63
  s_waitcnt vmcnt(10)
  v_mov_b32 v14, v14
  s_lshr_b32 s79, s91, 17
  s_lshl_b32 s79, s79, 10
  s_add_u32 s79, s79, s88
  buffer_store_dwordx4 v[80:83], v248, s[12:15], s79 offen sc1
  s_add_u32 s80, s44, 122880
  buffer_load_dwordx4 a[208:211], v13, s[12:15], s80 offen offset:0 sc1
  buffer_load_dwordx4 a[212:215], v13, s[12:15], s80 offen offset:1024 sc1
  buffer_load_dwordx4 a[216:219], v13, s[12:15], s80 offen offset:2048 sc1
  buffer_load_dwordx4 a[220:223], v13, s[12:15], s80 offen offset:3072 sc1
  s_add_u32 s80, s44, 163840
  buffer_load_dwordx4 a[224:227], v13, s[12:15], s80 offen offset:0 sc1
  buffer_load_dwordx4 a[228:231], v13, s[12:15], s80 offen offset:1024 sc1
  buffer_load_dwordx4 a[232:235], v13, s[12:15], s80 offen offset:2048 sc1
  buffer_load_dwordx4 a[236:239], v13, s[12:15], s80 offen offset:3072 sc1
  s_add_u32 s80, s45, 0
  buffer_load_dwordx4 a[240:243], v13, s[12:15], s80 offen offset:0 sc1
  buffer_load_dwordx4 a[244:247], v13, s[12:15], s80 offen offset:1024 sc1
  buffer_load_dwordx4 a[248:251], v13, s[12:15], s80 offen offset:2048 sc1
  buffer_load_dwordx4 a[252:255], v13, s[12:15], s80 offen offset:3072 sc1
L_tail:
  v_cmp_ne_u32 vcc, s63, v14
  s_cbranch_vccnz L_retry12
L_back12:
  buffer_load_dwordx4 a[0:3], v13, s[12:15], s51 offen offset:0 sc1
  buffer_load_dwordx4 a[4:7], v13, s[12:15], s50 offen offset:0 sc1
  buffer_load_dwordx4 a[8:11], v13, s[12:15], s41 offen offset:0 sc1
  buffer_load_dwordx4 a[12:15], v13, s[12:15], s40 offen offset:0 sc1
  buffer_load_dwordx4 a[16:19], v13, s[12:15], s51 offen offset:1024 sc1
  buffer_load_dwordx4 a[20:23], v13, s[12:15], s50 offen offset:1024 sc1
  s_add_u32 s49, s49, 131072
  s_waitcnt vmcnt(6)
  buffer_store_dword v2, v3, s[12:15], s49 offen sc1
  buffer_load_dwordx4 a[24:27], v13, s[12:15], s41 offen offset:1024 sc1
  buffer_load_dwordx4 a[28:31], v13, s[12:15], s40 offen offset:1024 sc1
  buffer_load_dwordx4 a[32:35], v13, s[12:15], s51 offen offset:2048 sc1
  buffer_load_dwordx4 a[36:39], v13, s[12:15], s50 offen offset:2048 sc1
  s_add_u32 s76, s60, 1
  s_and_b32 s76, s76, 3
  s_mul_i32 s76, s76, 15360
  s_add_u32 s76, s76, 98304
  v_add_u32 v4, s76, v13
  s_add_u32 s76, s60, 2
  s_and_b32 s76, s76, 3
  s_mul_i32 s76, s76, 15360
  s_add_u32 s76, s76, 103424
  v_add_u32 v5, s76, v13
  s_add_u32 s76, s60, 3
  s_and_b32 s76, s76, 3
  s_mul_i32 s76, s76, 15360
  s_add_u32 s76, s76, 108544
  v_add_u32 v6, s76, v13
  s_mul_i32 s76, s60, 15360
  s_add_u32 s76, s76, 98304
  v_add_u32 v7, s76, v13
  s_add_u32 s70, s40, s47
  s_add_u32 s71, s41, s47
  s_add_u32 s72, s50, s47
  s_add_u32 s73, s51, s47
  v_and_b32 v250, 15, v1
  v_mul_u32_u24 v250, 1280, v250
  v_lshrrev_b32 v252, 4, v1
  v_lshl_add_u32 v253, v252, 4, v250
  v_lshl_add_u32 v250, v252, 3, v250
  s_waitcnt vmcnt(10)
  v_mfma_f32_16x16x32_bf16 v[228:231], a[160:163], a[0:3], 0
  v_mfma_f32_16x16x32_bf16 v[232:235], a[164:167], a[0:3], 0
  v_mfma_f32_16x16x32_bf16 v[236:239], a[168:171], a[0:3], 0
  v_mfma_f32_16x16x32_bf16 v[240:243], a[172:175], a[0:3], 0
  buffer_load_dwordx4 a[40:43], v13, s[12:15], s41 offen offset:2048 sc1
  buffer_load_dwordx4 a[44:47], v13, s[12:15], s40 offen offset:2048 sc1
  s_waitcnt vmcnt(11)
  v_mfma_f32_16x16x32_bf16 v[208:211], a[160:163], a[4:7], 0
  v_mfma_f32_16x16x32_bf16 v[212:215], a[164:167], a[4:7], 0
  v_mfma_f32_16x16x32_bf16 v[216:219], a[168:171], a[4:7], 0
  v_mfma_f32_16x16x32_bf16 v[220:223], a[172:175], a[4:7], 0
  buffer_load_dwordx4 a[48:51], v13, s[12:15], s51 offen offset:3072 sc1
  buffer_load_dwordx4 a[52:55], v13, s[12:15], s50 offen offset:3072 sc1
  s_waitcnt vmcnt(12)
  v_mfma_f32_16x16x32_bf16 v[188:191], a[160:163], a[8:11], 0
  v_mfma_f32_16x16x32_bf16 v[192:195], a[164:167], a[8:11], 0
  v_mfma_f32_16x16x32_bf16 v[196:199], a[168:171], a[8:11], 0
  v_mfma_f32_16x16x32_bf16 v[200:203], a[172:175], a[8:11], 0
  buffer_load_dwordx4 a[56:59], v13, s[12:15], s41 offen offset:3072 sc1
  buffer_load_dwordx4 a[60:63], v13, s[12:15], s40 offen offset:3072 sc1
  s_waitcnt vmcnt(13)
  v_mfma_f32_16x16x32_bf16 v[168:171], a[160:163], a[12:15], 0
  v_mfma_f32_16x16x32_bf16 v[172:175], a[164:167], a[12:15], 0
  v_mfma_f32_16x16x32_bf16 v[176:179], a[168:171], a[12:15], 0
  v_mfma_f32_16x16x32_bf16 v[180:183], a[172:175], a[12:15], 0
  buffer_load_dword v14, v254, s[12:15], 0 offen sc1
  s_add_u32 s75, s51, 4096
  buffer_load_dwordx4 a[64:67], v13, s[12:15], s75 offen offset:0 sc1
  s_waitcnt vmcnt(14)
  v_mfma_f32_16x16x32_bf16 v[228:231], a[176:179], a[16:19], v[228:231]
  v_mfma_f32_16x16x32_bf16 v[232:235], a[180:183], a[16:19], v[232:235]
  v_mfma_f32_16x16x32_bf16 v[236:239], a[184:187], a[16:19], v[236:239]
  v_mfma_f32_16x16x32_bf16 v[240:243], a[188:191], a[16:19], v[240:243]
  s_add_u32 s75, s50, 4096
  buffer_load_dwordx4 a[68:71], v13, s[12:15], s75 offen offset:0 sc1
  s_add_u32 s75, s41, 4096
  buffer_load_dwordx4 a[72:75], v13, s[12:15], s75 offen offset:0 sc1
  s_waitcnt vmcnt(15)
  v_mfma_f32_16x16x32_bf16 v[208:211], a[176:179], a[20:23], v[208:211]
  v_mfma_f32_16x16x32_bf16 v[212:215], a[180:183], a[20:23], v[212:215]
  v_mfma_f32_16x16x32_bf16 v[216:219], a[184:187], a[20:23], v[216:219]
  v_mfma_f32_16x16x32_bf16 v[220:223], a[188:191], a[20:23], v[220:223]
  s_add_u32 s75, s40, 4096
  buffer_load_dwordx4 a[76:79], v13, s[12:15], s75 offen offset:0 sc1
  s_add_u32 s80, s45, 40960
  buffer_load_dwordx4 a[80:83], v13, s[12:15], s80 offen offset:0 sc1
  s_waitcnt vmcnt(15)
  v_mfma_f32_16x16x32_bf16 v[188:191], a[176:179], a[24:27], v[188:191]
  v_mfma_f32_16x16x32_bf16 v[192:195], a[180:183], a[24:27], v[192:195]
  v_mfma_f32_16x16x32_bf16 v[196:199], a[184:187], a[24:27], v[196:199]
  v_mfma_f32_16x16x32_bf16 v[200:203], a[188:191], a[24:27], v[200:203]
  buffer_load_dwordx4 a[84:87], v13, s[12:15], s80 offen offset:1024 sc1
  buffer_load_dwordx4 a[88:91], v13, s[12:15], s80 offen offset:2048 sc1
  s_waitcnt vmcnt(16)
  v_mfma_f32_16x16x32_bf16 v[168:171], a[176:179], a[28:31], v[168:171]
  v_mfma_f32_16x16x32_bf16 v[172:175], a[180:183], a[28:31], v[172:175]
  v_mfma_f32_16x16x32_bf16 v[176:179], a[184:187], a[28:31], v[176:179]
  v_mfma_f32_16x16x32_bf16 v[180:183], a[188:191], a[28:31], v[180:183]
  buffer_load_dwordx4 a[92:95], v13, s[12:15], s80 offen offset:3072 sc1
  s_add_u32 s80, s45, 122880
  buffer_load_dwordx4 a[96:99], v13, s[12:15], s80 offen offset:0 sc1
  s_waitcnt vmcnt(17)
  v_mfma_f32_16x16x32_bf16 v[228:231], a[192:195], a[32:35], v[228:231]
  v_mfma_f32_16x16x32_bf16 v[232:235], a[196:199], a[32:35], v[232:235]
  v_mfma_f32_16x16x32_bf16 v[236:239], a[200:203], a[32:35], v[236:239]
  v_mfma_f32_16x16x32_bf16 v[240:243], a[204:207], a[32:35], v[240:243]
  buffer_load_dwordx4 a[100:103], v13, s[12:15], s80 offen offset:1024 sc1
  buffer_load_dwordx4 a[104:107], v13, s[12:15], s80 offen offset:2048 sc1
  s_waitcnt vmcnt(18)
  v_mfma_f32_16x16x32_bf16 v[208:211], a[192:195], a[36:39], v[208:211]
  v_mfma_f32_16x16x32_bf16 v[212:215], a[196:199], a[36:39], v[212:215]
  v_mfma_f32_16x16x32_bf16 v[216:219], a[200:203], a[36:39], v[216:219]
  v_mfma_f32_16x16x32_bf16 v[220:223], a[204:207], a[36:39], v[220:223]
  buffer_load_dwordx4 a[108:111], v13, s[12:15], s80 offen offset:3072 sc1
  s_waitcnt vmcnt(18)
  v_mfma_f32_16x16x32_bf16 v[188:191], a[192:195], a[40:43], v[188:191]
  v_mfma_f32_16x16x32_bf16 v[192:195], a[196:199], a[40:43], v[192:195]
  v_mfma_f32_16x16x32_bf16 v[196:199], a[200:203], a[40:43], v[196:199]
  v_mfma_f32_16x16x32_bf16 v[200:203], a[204:207], a[40:43], v[200:203]
  s_waitcnt vmcnt(17)
  v_mfma_f32_16x16x32_bf16 v[168:171], a[192:195], a[44:47], v[168:171]
  v_mfma_f32_16x16x32_bf16 v[172:175], a[196:199], a[44:47], v[172:175]
  v_mfma_f32_16x16x32_bf16 v[176:179], a[200:203], a[44:47], v[176:179]
  v_mfma_f32_16x16x32_bf16 v[180:183], a[204:207], a[44:47], v[180:183]
  s_waitcnt vmcnt(12)
  v_cmp_ne_u32 vcc, s63, v14
  s_cbranch_vccnz L_retry13
L_back13:
  v_add_u32 v15, 131072, v254
  buffer_load_dwordx4 a[112:115], v13, s[12:15], s73 offen offset:0 sc1
  buffer_load_dwordx4 a[116:119], v13, s[12:15], s72 offen offset:0 sc1
  buffer_load_dwordx4 a[120:123], v13, s[12:15], s71 offen offset:0 sc1
  buffer_load_dwordx4 a[124:127], v13, s[12:15], s70 offen offset:0 sc1
  v_mfma_f32_16x16x32_bf16 v[228:231], a[208:211], a[48:51], v[228:231]
  v_mfma_f32_16x16x32_bf16 v[232:235], a[212:215], a[48:51], v[232:235]
  v_mfma_f32_16x16x32_bf16 v[236:239], a[216:219], a[48:51], v[236:239]
  v_mfma_f32_16x16x32_bf16 v[240:243], a[220:223], a[48:51], v[240:243]
  s_add_u32 s80, s45, 163840
  buffer_load_dwordx4 a[128:131], v13, s[12:15], s80 offen offset:0 sc1
  buffer_load_dwordx4 a[132:135], v13, s[12:15], s80 offen offset:1024 sc1
  v_mfma_f32_16x16x32_bf16 v[208:211], a[208:211], a[52:55], v[208:211]
  v_mfma_f32_16x16x32_bf16 v[212:215], a[212:215], a[52:55], v[212:215]
  v_mfma_f32_16x16x32_bf16 v[216:219], a[216:219], a[52:55], v[216:219]
  v_mfma_f32_16x16x32_bf16 v[220:223], a[220:223], a[52:55], v[220:223]
  buffer_load_dwordx4 a[136:139], v13, s[12:15], s80 offen offset:2048 sc1
  buffer_load_dwordx4 a[140:143], v13, s[12:15], s80 offen offset:3072 sc1
  v_mfma_f32_16x16x32_bf16 v[188:191], a[208:211], a[56:59], v[188:191]
  v_mfma_f32_16x16x32_bf16 v[192:195], a[212:215], a[56:59], v[192:195]
  v_mfma_f32_16x16x32_bf16 v[196:199], a[216:219], a[56:59], v[196:199]
  v_mfma_f32_16x16x32_bf16 v[200:203], a[220:223], a[56:59], v[200:203]
  buffer_load_dwordx4 a[144:147], v13, s[12:15], s73 offen offset:1024 sc1
  buffer_load_dwordx4 a[148:151], v13, s[12:15], s72 offen offset:1024 sc1
  v_mfma_f32_16x16x32_bf16 v[168:171], a[208:211], a[60:63], v[168:171]
  v_mfma_f32_16x16x32_bf16 v[172:175], a[212:215], a[60:63], v[172:175]
  v_mfma_f32_16x16x32_bf16 v[176:179], a[216:219], a[60:63], v[176:179]
  v_mfma_f32_16x16x32_bf16 v[180:183], a[220:223], a[60:63], v[180:183]
  buffer_load_dwordx4 a[152:155], v13, s[12:15], s71 offen offset:1024 sc1
  buffer_load_dwordx4 a[156:159], v13, s[12:15], s70 offen offset:1024 sc1
  s_waitcnt vmcnt(23)
  v_mfma_f32_16x16x32_bf16 v[228:231], a[224:227], a[64:67], v[228:231]
  v_mfma_f32_16x16x32_bf16 v[232:235], a[228:231], a[64:67], v[232:235]
  v_mfma_f32_16x16x32_bf16 v[236:239], a[232:235], a[64:67], v[236:239]
  v_mfma_f32_16x16x32_bf16 v[240:243], a[236:239], a[64:67], v[240:243]
  s_add_u32 s80, s45, 204800
  buffer_load_dwordx4 v[96:99], v13, s[12:15], s80 offen offset:0 sc1
  buffer_load_dwordx4 v[100:103], v13, s[12:15], s80 offen offset:1024 sc1
  s_waitcnt vmcnt(24)
  v_mfma_f32_16x16x32_bf16 v[208:211], a[224:227], a[68:71], v[208:211]
  v_mfma_f32_16x16x32_bf16 v[212:215], a[228:231], a[68:71], v[212:215]
  v_mfma_f32_16x16x32_bf16 v[216:219], a[232:235], a[68:71], v[216:219]
  v_mfma_f32_16x16x32_bf16 v[220:223], a[236:239], a[68:71], v[220:223]
  buffer_load_dwordx4 v[104:107], v13, s[12:15], s80 offen offset:2048 sc1
  buffer_load_dwordx4 v[108:111], v13, s[12:15], s80 offen offset:3072 sc1
  s_waitcnt vmcnt(25)
  v_mfma_f32_16x16x32_bf16 v[188:191], a[224:227], a[72:75], v[188:191]
  v_mfma_f32_16x16x32_bf16 v[192:195], a[228:231], a[72:75], v[192:195]
  v_mfma_f32_16x16x32_bf16 v[196:199], a[232:235], a[72:75], v[196:199]
  v_mfma_f32_16x16x32_bf16 v[200:203], a[236:239], a[72:75], v[200:203]
  buffer_load_dwordx4 v[112:115], v13, s[12:15], s73 offen offset:3072 sc1
  buffer_load_dwordx4 v[116:119], v13, s[12:15], s72 offen offset:3072 sc1
  s_waitcnt vmcnt(26)
  v_mfma_f32_16x16x32_bf16 v[168:171], a[224:227], a[76:79], v[168:171]
  v_mfma_f32_16x16x32_bf16 v[172:175], a[228:231], a[76:79], v[172:175]
  v_mfma_f32_16x16x32_bf16 v[176:179], a[232:235], a[76:79], v[176:179]
  v_mfma_f32_16x16x32_bf16 v[180:183], a[236:239], a[76:79], v[180:183]
  s_waitcnt vmcnt(17)
  v_mfma_f32_16x16x32_bf16 v[228:231], a[240:243], a[112:115], v[228:231]
  v_mfma_f32_16x16x32_bf16 v[232:235], a[244:247], a[112:115], v[232:235]
  v_mfma_f32_16x16x32_bf16 v[236:239], a[248:251], a[112:115], v[236:239]
  v_mfma_f32_16x16x32_bf16 v[240:243], a[252:255], a[112:115], v[240:243]
  s_waitcnt vmcnt(16)
  v_mfma_f32_16x16x32_bf16 v[208:211], a[240:243], a[116:119], v[208:211]
  v_mfma_f32_16x16x32_bf16 v[212:215], a[244:247], a[116:119], v[212:215]
  v_mfma_f32_16x16x32_bf16 v[216:219], a[248:251], a[116:119], v[216:219]
  v_mfma_f32_16x16x32_bf16 v[220:223], a[252:255], a[116:119], v[220:223]
  s_waitcnt vmcnt(15)
  v_mfma_f32_16x16x32_bf16 v[188:191], a[240:243], a[120:123], v[188:191]
  v_mfma_f32_16x16x32_bf16 v[192:195], a[244:247], a[120:123], v[192:195]
  v_mfma_f32_16x16x32_bf16 v[196:199], a[248:251], a[120:123], v[196:199]
  v_mfma_f32_16x16x32_bf16 v[200:203], a[252:255], a[120:123], v[200:203]
  s_waitcnt vmcnt(14)
  v_mfma_f32_16x16x32_bf16 v[168:171], a[240:243], a[124:127], v[168:171]
  v_mfma_f32_16x16x32_bf16 v[172:175], a[244:247], a[124:127], v[172:175]
  v_mfma_f32_16x16x32_bf16 v[176:179], a[248:251], a[124:127], v[176:179]
  v_mfma_f32_16x16x32_bf16 v[180:183], a[252:255], a[124:127], v[180:183]
  buffer_load_dwordx4 v[120:123], v13, s[12:15], s71 offen offset:3072 sc1
  s_waitcnt vmcnt(10)
  v_mfma_f32_16x16x32_bf16 v[228:231], a[80:83], a[144:147], v[228:231]
  v_mfma_f32_16x16x32_bf16 v[232:235], a[84:87], a[144:147], v[232:235]
  v_mfma_f32_16x16x32_bf16 v[236:239], a[88:91], a[144:147], v[236:239]
  v_mfma_f32_16x16x32_bf16 v[240:243], a[92:95], a[144:147], v[240:243]
  buffer_load_dwordx4 v[124:127], v13, s[12:15], s70 offen offset:3072 sc1
  s_waitcnt vmcnt(10)
  v_mfma_f32_16x16x32_bf16 v[208:211], a[80:83], a[148:151], v[208:211]
  v_mfma_f32_16x16x32_bf16 v[212:215], a[84:87], a[148:151], v[212:215]
  v_mfma_f32_16x16x32_bf16 v[216:219], a[88:91], a[148:151], v[216:219]
  v_mfma_f32_16x16x32_bf16 v[220:223], a[92:95], a[148:151], v[220:223]
  s_add_u32 s80, s45, 81920
  buffer_load_dwordx4 v[128:131], v13, s[12:15], s80 offen offset:0 sc1
  s_waitcnt vmcnt(10)
  v_mfma_f32_16x16x32_bf16 v[188:191], a[80:83], a[152:155], v[188:191]
  v_mfma_f32_16x16x32_bf16 v[192:195], a[84:87], a[152:155], v[192:195]
  v_mfma_f32_16x16x32_bf16 v[196:199], a[88:91], a[152:155], v[196:199]
  v_mfma_f32_16x16x32_bf16 v[200:203], a[92:95], a[152:155], v[200:203]
  buffer_load_dwordx4 v[132:135], v13, s[12:15], s80 offen offset:1024 sc1
  s_waitcnt vmcnt(10)
  v_mfma_f32_16x16x32_bf16 v[168:171], a[80:83], a[156:159], v[168:171]
  v_mfma_f32_16x16x32_bf16 v[172:175], a[84:87], a[156:159], v[172:175]
  v_mfma_f32_16x16x32_bf16 v[176:179], a[88:91], a[156:159], v[176:179]
  v_mfma_f32_16x16x32_bf16 v[180:183], a[92:95], a[156:159], v[180:183]
  buffer_load_dwordx4 v[136:139], v13, s[12:15], s80 offen offset:2048 sc1
  buffer_load_dwordx4 v[140:143], v13, s[12:15], s80 offen offset:3072 sc1
  buffer_load_dword v14, v15, s[12:15], 0 offen sc1
  s_add_u32 s75, s73, 4096
  buffer_load_dwordx4 v[144:147], v13, s[12:15], s75 offen offset:0 sc1
  s_add_u32 s75, s72, 4096
  buffer_load_dwordx4 v[148:151], v13, s[12:15], s75 offen offset:0 sc1
  s_waitcnt vmcnt(10)
  v_mfma_f32_16x16x32_bf16 v[228:231], a[96:99], v[112:115], v[228:231]
  v_mfma_f32_16x16x32_bf16 v[232:235], a[100:103], v[112:115], v[232:235]
  v_mfma_f32_16x16x32_bf16 v[236:239], a[104:107], v[112:115], v[236:239]
  v_mfma_f32_16x16x32_bf16 v[240:243], a[108:111], v[112:115], v[240:243]
  s_add_u32 s75, s71, 4096
  buffer_load_dwordx4 v[152:155], v13, s[12:15], s75 offen offset:0 sc1
  s_waitcnt vmcnt(10)
  v_mfma_f32_16x16x32_bf16 v[208:211], a[96:99], v[116:119], v[208:211]
  v_mfma_f32_16x16x32_bf16 v[212:215], a[100:103], v[116:119], v[212:215]
  v_mfma_f32_16x16x32_bf16 v[216:219], a[104:107], v[116:119], v[216:219]
  v_mfma_f32_16x16x32_bf16 v[220:223], a[108:111], v[116:119], v[220:223]
  s_add_u32 s75, s70, 4096
  buffer_load_dwordx4 v[156:159], v13, s[12:15], s75 offen offset:0 sc1
  s_waitcnt vmcnt(10)
  v_mfma_f32_16x16x32_bf16 v[188:191], a[96:99], v[120:123], v[188:191]
  v_mfma_f32_16x16x32_bf16 v[192:195], a[100:103], v[120:123], v[192:195]
  v_mfma_f32_16x16x32_bf16 v[196:199], a[104:107], v[120:123], v[196:199]
  v_mfma_f32_16x16x32_bf16 v[200:203], a[108:111], v[120:123], v[200:203]
  s_add_u32 s80, s45, 245760
  buffer_load_dwordx4 v[160:163], v12, s[12:15], s80 offen offset:0 sc1
  s_waitcnt vmcnt(10)
  v_mfma_f32_16x16x32_bf16 v[168:171], a[96:99], v[124:127], v[168:171]
  v_mfma_f32_16x16x32_bf16 v[172:175], a[100:103], v[124:127], v[172:175]
  v_mfma_f32_16x16x32_bf16 v[176:179], a[104:107], v[124:127], v[176:179]
  v_mfma_f32_16x16x32_bf16 v[180:183], a[108:111], v[124:127], v[180:183]
  buffer_load_dwordx4 v[164:167], v12, s[12:15], s80 offen offset:1024 sc1
  buffer_load_dwordx4 v[16:19], v12, s[12:15], s80 offen offset:2048 sc1
  buffer_load_dwordx4 v[20:23], v12, s[12:15], s80 offen offset:3072 sc1
  s_add_u32 s75, s73, 4096
  buffer_load_dwordx4 v[24:27], v13, s[12:15], s75 offen offset:1024 sc1
  s_add_u32 s75, s72, 4096
  buffer_load_dwordx4 v[28:31], v13, s[12:15], s75 offen offset:1024 sc1
  s_add_u32 s75, s71, 4096
  buffer_load_dwordx4 v[32:35], v13, s[12:15], s75 offen offset:1024 sc1
  s_waitcnt vmcnt(10)
  v_mfma_f32_16x16x32_bf16 v[228:231], a[128:131], v[144:147], v[228:231]
  v_mfma_f32_16x16x32_bf16 v[232:235], a[132:135], v[144:147], v[232:235]
  v_mfma_f32_16x16x32_bf16 v[236:239], a[136:139], v[144:147], v[236:239]
  v_mfma_f32_16x16x32_bf16 v[240:243], a[140:143], v[144:147], v[240:243]
  s_add_u32 s75, s70, 4096
  buffer_load_dwordx4 v[36:39], v13, s[12:15], s75 offen offset:1024 sc1
  s_waitcnt vmcnt(10)
  v_mfma_f32_16x16x32_bf16 v[208:211], a[128:131], v[148:151], v[208:211]
  v_mfma_f32_16x16x32_bf16 v[212:215], a[132:135], v[148:151], v[212:215]
  v_mfma_f32_16x16x32_bf16 v[216:219], a[136:139], v[148:151], v[216:219]
  v_mfma_f32_16x16x32_bf16 v[220:223], a[140:143], v[148:151], v[220:223]
  v_cmp_ne_u32 vcc, s63, v14
  s_cbranch_vccnz L_retry14
L_back14:
  buffer_load_dwordx4 v[40:43], v13, s[12:15], s73 offen offset:2048 sc1
  buffer_load_dwordx4 v[44:47], v13, s[12:15], s72 offen offset:2048 sc1
  buffer_load_dwordx4 v[48:51], v13, s[12:15], s71 offen offset:2048 sc1
  buffer_load_dwordx4 v[52:55], v13, s[12:15], s70 offen offset:2048 sc1
  s_waitcnt vmcnt(13)
  v_mfma_f32_16x16x32_bf16 v[188:191], a[128:131], v[152:155], v[188:191]
  v_mfma_f32_16x16x32_bf16 v[192:195], a[132:135], v[152:155], v[192:195]
  v_mfma_f32_16x16x32_bf16 v[196:199], a[136:139], v[152:155], v[196:199]
  v_mfma_f32_16x16x32_bf16 v[200:203], a[140:143], v[152:155], v[200:203]
  s_waitcnt vmcnt(12)
  v_mfma_f32_16x16x32_bf16 v[168:171], a[128:131], v[156:159], v[168:171]
  v_mfma_f32_16x16x32_bf16 v[172:175], a[132:135], v[156:159], v[172:175]
  v_mfma_f32_16x16x32_bf16 v[176:179], a[136:139], v[156:159], v[176:179]
  v_mfma_f32_16x16x32_bf16 v[180:183], a[140:143], v[156:159], v[180:183]
  s_add_u32 s75, s73, 4096
  buffer_load_dwordx4 v[56:59], v12, s[12:15], s75 offen offset:2048 sc1
  s_add_u32 s75, s72, 4096
  buffer_load_dwordx4 v[60:63], v12, s[12:15], s75 offen offset:2048 sc1
  s_waitcnt vmcnt(9)
  v_mfma_f32_16x16x32_bf16 v[228:231], v[96:99], v[24:27], v[228:231]
  v_mfma_f32_16x16x32_bf16 v[232:235], v[100:103], v[24:27], v[232:235]
  v_mfma_f32_16x16x32_bf16 v[236:239], v[104:107], v[24:27], v[236:239]
  v_mfma_f32_16x16x32_bf16 v[240:243], v[108:111], v[24:27], v[240:243]
  s_add_u32 s75, s71, 4096
  buffer_load_dwordx4 v[64:67], v12, s[12:15], s75 offen offset:2048 sc1
  s_waitcnt vmcnt(9)
  v_mfma_f32_16x16x32_bf16 v[208:211], v[96:99], v[28:31], v[208:211]
  v_mfma_f32_16x16x32_bf16 v[212:215], v[100:103], v[28:31], v[212:215]
  v_mfma_f32_16x16x32_bf16 v[216:219], v[104:107], v[28:31], v[216:219]
  v_mfma_f32_16x16x32_bf16 v[220:223], v[108:111], v[28:31], v[220:223]
  s_add_u32 s75, s70, 4096
  buffer_load_dwordx4 v[68:71], v12, s[12:15], s75 offen offset:2048 sc1
  s_waitcnt vmcnt(9)
  v_mfma_f32_16x16x32_bf16 v[188:191], v[96:99], v[32:35], v[188:191]
  v_mfma_f32_16x16x32_bf16 v[192:195], v[100:103], v[32:35], v[192:195]
  v_mfma_f32_16x16x32_bf16 v[196:199], v[104:107], v[32:35], v[196:199]
  v_mfma_f32_16x16x32_bf16 v[200:203], v[108:111], v[32:35], v[200:203]
  s_add_u32 s80, s44, 4096
  buffer_load_dwordx4 v[72:75], v13, s[12:15], s80 offen offset:0 sc1
  s_waitcnt vmcnt(9)
  v_mfma_f32_16x16x32_bf16 v[168:171], v[96:99], v[36:39], v[168:171]
  v_mfma_f32_16x16x32_bf16 v[172:175], v[100:103], v[36:39], v[172:175]
  v_mfma_f32_16x16x32_bf16 v[176:179], v[104:107], v[36:39], v[176:179]
  v_mfma_f32_16x16x32_bf16 v[180:183], v[108:111], v[36:39], v[180:183]
  s_add_u32 s80, s44, 45056
  buffer_load_dwordx4 v[76:79], v13, s[12:15], s80 offen offset:0 sc1
  s_add_u32 s80, s44, 86016
  buffer_load_dwordx4 v[80:83], v13, s[12:15], s80 offen offset:0 sc1
  s_waitcnt vmcnt(10)
  v_mfma_f32_16x16x32_bf16 v[228:231], v[128:131], v[40:43], v[228:231]
  v_mfma_f32_16x16x32_bf16 v[232:235], v[132:135], v[40:43], v[232:235]
  v_mfma_f32_16x16x32_bf16 v[236:239], v[136:139], v[40:43], v[236:239]
  v_mfma_f32_16x16x32_bf16 v[240:243], v[140:143], v[40:43], v[240:243]
  s_add_u32 s80, s44, 126976
  buffer_load_dwordx4 v[84:87], v13, s[12:15], s80 offen offset:0 sc1
  s_waitcnt vmcnt(10)
  v_mfma_f32_16x16x32_bf16 v[208:211], v[128:131], v[44:47], v[208:211]
  v_mfma_f32_16x16x32_bf16 v[212:215], v[132:135], v[44:47], v[212:215]
  v_mfma_f32_16x16x32_bf16 v[216:219], v[136:139], v[44:47], v[216:219]
  v_mfma_f32_16x16x32_bf16 v[220:223], v[140:143], v[44:47], v[220:223]
  s_add_u32 s80, s44, 167936
  buffer_load_dwordx4 v[88:91], v13, s[12:15], s80 offen offset:0 sc1
  s_waitcnt vmcnt(10)
  v_mfma_f32_16x16x32_bf16 v[188:191], v[128:131], v[48:51], v[188:191]
  v_mfma_f32_16x16x32_bf16 v[192:195], v[132:135], v[48:51], v[192:195]
  v_mfma_f32_16x16x32_bf16 v[196:199], v[136:139], v[48:51], v[196:199]
  v_mfma_f32_16x16x32_bf16 v[200:203], v[140:143], v[48:51], v[200:203]
  s_add_u32 s80, s45, 4096
  buffer_load_dwordx4 v[92:95], v13, s[12:15], s80 offen offset:0 sc1
  s_waitcnt vmcnt(10)
  v_mfma_f32_16x16x32_bf16 v[168:171], v[128:131], v[52:55], v[168:171]
  v_mfma_f32_16x16x32_bf16 v[172:175], v[132:135], v[52:55], v[172:175]
  v_mfma_f32_16x16x32_bf16 v[176:179], v[136:139], v[52:55], v[176:179]
  v_mfma_f32_16x16x32_bf16 v[180:183], v[140:143], v[52:55], v[180:183]
  s_add_u32 s80, s45, 45056
  buffer_load_dwordx4 a[160:163], v13, s[12:15], s80 offen offset:0 sc1
  s_waitcnt vmcnt(10)
  v_mfma_f32_16x16x32_bf16 v[228:231], v[160:163], v[56:59], v[228:231]
  v_mfma_f32_16x16x32_bf16 v[232:235], v[164:167], v[56:59], v[232:235]
  v_mfma_f32_16x16x32_bf16 v[236:239], v[16:19], v[56:59], v[236:239]
  v_mfma_f32_16x16x32_bf16 v[240:243], v[20:23], v[56:59], v[240:243]
  s_add_u32 s80, s45, 86016
  buffer_load_dwordx4 a[164:167], v13, s[12:15], s80 offen offset:0 sc1
  s_waitcnt vmcnt(10)
  v_mfma_f32_16x16x32_bf16 v[208:211], v[160:163], v[60:63], v[208:211]
  v_mfma_f32_16x16x32_bf16 v[212:215], v[164:167], v[60:63], v[212:215]
  v_mfma_f32_16x16x32_bf16 v[216:219], v[16:19], v[60:63], v[216:219]
  v_mfma_f32_16x16x32_bf16 v[220:223], v[20:23], v[60:63], v[220:223]
  s_add_u32 s80, s45, 126976
  buffer_load_dwordx4 a[168:171], v13, s[12:15], s80 offen offset:0 sc1
  s_waitcnt vmcnt(10)
  v_mfma_f32_16x16x32_bf16 v[188:191], v[160:163], v[64:67], v[188:191]
  ds_write_b128 v6, v[228:231] offset:0
  v_mfma_f32_16x16x32_bf16 v[192:195], v[164:167], v[64:67], v[192:195]
  ds_write_b128 v6, v[232:235] offset:1024
  v_mfma_f32_16x16x32_bf16 v[196:199], v[16:19], v[64:67], v[196:199]
  ds_write_b128 v6, v[236:239] offset:2048
  v_mfma_f32_16x16x32_bf16 v[200:203], v[20:23], v[64:67], v[200:203]
  s_add_u32 s80, s45, 167936
  buffer_load_dwordx4 a[172:175], v13, s[12:15], s80 offen offset:0 sc1
  s_waitcnt vmcnt(10)
  v_mfma_f32_16x16x32_bf16 v[168:171], v[160:163], v[68:71], v[168:171]
  ds_write_b128 v6, v[240:243] offset:3072
  v_mfma_f32_16x16x32_bf16 v[172:175], v[164:167], v[68:71], v[172:175]
  ds_write_b128 v5, v[208:211] offset:0
  v_mfma_f32_16x16x32_bf16 v[176:179], v[16:19], v[68:71], v[176:179]
  ds_write_b128 v5, v[212:215] offset:1024
  v_mfma_f32_16x16x32_bf16 v[180:183], v[20:23], v[68:71], v[180:183]
  ds_write_b128 v5, v[216:219] offset:2048
  s_waitcnt vmcnt(9)
  v_mfma_f32_16x16x32_bf16 v[244:247], v[72:75], a[0:3], 0
  ds_write_b128 v5, v[220:223] offset:3072
  v_mfma_f32_16x16x32_bf16 v[224:227], v[72:75], a[4:7], 0
  ds_write_b128 v4, v[188:191] offset:0
  v_mfma_f32_16x16x32_bf16 v[204:207], v[72:75], a[8:11], 0
  ds_write_b128 v4, v[192:195] offset:1024
  v_mfma_f32_16x16x32_bf16 v[184:187], v[72:75], a[12:15], 0
  ds_write_b128 v4, v[196:199] offset:2048
  s_waitcnt vmcnt(8)
  v_mfma_f32_16x16x32_bf16 v[244:247], v[76:79], a[16:19], v[244:247]
  ds_write_b128 v4, v[200:203] offset:3072
  v_mfma_f32_16x16x32_bf16 v[224:227], v[76:79], a[20:23], v[224:227]
  v_mfma_f32_16x16x32_bf16 v[204:207], v[76:79], a[24:27], v[204:207]
  s_waitcnt lgkmcnt(0)
  s_barrier
  ds_read_b128 v[188:191], v7 offset:0
  ds_read_b128 v[208:211], v7 offset:5120
  v_mfma_f32_16x16x32_bf16 v[184:187], v[76:79], a[28:31], v[184:187]
  s_add_u32 s80, s45, 208896
  buffer_load_dwordx4 a[176:179], v13, s[12:15], s80 offen offset:0 sc1
  ds_read_b128 v[228:231], v7 offset:10240
  s_waitcnt vmcnt(8)
  v_mfma_f32_16x16x32_bf16 v[244:247], v[80:83], a[32:35], v[244:247]
  ds_read_b128 v[192:195], v7 offset:1024
  ds_read_b128 v[212:215], v7 offset:6144
  ds_read_b128 v[232:235], v7 offset:11264
  ds_read_b128 v[196:199], v7 offset:2048
  v_mfma_f32_16x16x32_bf16 v[224:227], v[80:83], a[36:39], v[224:227]
  ds_read_b128 v[216:219], v7 offset:7168
  ds_read_b128 v[236:239], v7 offset:12288
  ds_read_b128 v[200:203], v7 offset:3072
  ds_read_b128 v[220:223], v7 offset:8192
  v_mfma_f32_16x16x32_bf16 v[204:207], v[80:83], a[40:43], v[204:207]
  ds_read_b128 v[240:243], v7 offset:13312
  v_mfma_f32_16x16x32_bf16 v[184:187], v[80:83], a[44:47], v[184:187]
  s_add_u32 s80, s45, 249856
  buffer_load_dwordx4 a[180:183], v12, s[12:15], s80 offen offset:0 sc1
  s_waitcnt vmcnt(8)
  v_mfma_f32_16x16x32_bf16 v[244:247], v[84:87], a[48:51], v[244:247]
  v_mfma_f32_16x16x32_bf16 v[224:227], v[84:87], a[52:55], v[224:227]
  v_mfma_f32_16x16x32_bf16 v[204:207], v[84:87], a[56:59], v[204:207]
  s_waitcnt lgkmcnt(11)
  v_add_f32 v168, v168, v188
  v_add_f32 v169, v169, v189
  v_add_f32 v170, v170, v190
  v_add_f32 v171, v171, v191
  v_mfma_f32_16x16x32_bf16 v[184:187], v[84:87], a[60:63], v[184:187]
  s_waitcnt lgkmcnt(9)
  v_add_f32 v208, v208, v228
  v_add_f32 v209, v209, v229
  v_add_f32 v210, v210, v230
  v_add_f32 v211, v211, v231
  s_waitcnt vmcnt(7)
  v_mfma_f32_16x16x32_bf16 v[244:247], v[88:91], a[64:67], v[244:247]
  v_add_f32 v168, v168, v208
  v_add_f32 v169, v169, v209
  v_add_f32 v170, v170, v210
  v_add_f32 v171, v171, v211
  v_mfma_f32_16x16x32_bf16 v[224:227], v[88:91], a[68:71], v[224:227]
  v_cvt_pk_bf16_f32 v168, v168, v169
  v_cvt_pk_bf16_f32 v169, v170, v171
  buffer_store_dwordx2 v[168:169], v250, s[20:23], s58 offen offset:0
  v_mfma_f32_16x16x32_bf16 v[204:207], v[88:91], a[72:75], v[204:207]
  s_waitcnt lgkmcnt(8)
  v_add_f32 v172, v172, v192
  v_add_f32 v173, v173, v193
  v_add_f32 v174, v174, v194
  v_mfma_f32_16x16x32_bf16 v[184:187], v[88:91], a[76:79], v[184:187]
  v_add_f32 v175, v175, v195
  s_waitcnt lgkmcnt(6)
  v_add_f32 v212, v212, v232
  v_add_f32 v213, v213, v233
  v_add_f32 v214, v214, v234
  s_waitcnt vmcnt(7)
  v_mfma_f32_16x16x32_bf16 v[244:247], v[92:95], a[112:115], v[244:247]
  v_add_f32 v215, v215, v235
  v_add_f32 v172, v172, v212
  v_add_f32 v173, v173, v213
  v_add_f32 v174, v174, v214
  v_mfma_f32_16x16x32_bf16 v[224:227], v[92:95], a[116:119], v[224:227]
  v_add_f32 v175, v175, v215
  v_cvt_pk_bf16_f32 v172, v172, v173
  v_cvt_pk_bf16_f32 v173, v174, v175
  v_mfma_f32_16x16x32_bf16 v[204:207], v[92:95], a[120:123], v[204:207]
  buffer_store_dwordx2 v[172:173], v250, s[20:23], s58 offen offset:32
  s_waitcnt lgkmcnt(5)
  v_add_f32 v176, v176, v196
  v_mfma_f32_16x16x32_bf16 v[184:187], v[92:95], a[124:127], v[184:187]
  v_add_f32 v177, v177, v197
  v_add_f32 v178, v178, v198
  v_add_f32 v179, v179, v199
  s_waitcnt lgkmcnt(3)
  v_add_f32 v216, v216, v236
  s_waitcnt vmcnt(7)
  v_mfma_f32_16x16x32_bf16 v[244:247], a[160:163], a[144:147], v[244:247]
  v_add_f32 v217, v217, v237
  v_add_f32 v218, v218, v238
  v_add_f32 v219, v219, v239
  v_add_f32 v176, v176, v216
  v_mfma_f32_16x16x32_bf16 v[224:227], a[160:163], a[148:151], v[224:227]
  v_add_f32 v177, v177, v217
  v_add_f32 v178, v178, v218
  v_add_f32 v179, v179, v219
  v_cvt_pk_bf16_f32 v176, v176, v177
  v_mfma_f32_16x16x32_bf16 v[204:207], a[160:163], a[152:155], v[204:207]
  v_cvt_pk_bf16_f32 v177, v178, v179
  buffer_store_dwordx2 v[176:177], v250, s[20:23], s58 offen offset:64
  v_mfma_f32_16x16x32_bf16 v[184:187], a[160:163], a[156:159], v[184:187]
  s_waitcnt lgkmcnt(2)
  v_add_f32 v180, v180, v200
  v_add_f32 v181, v181, v201
  v_add_f32 v182, v182, v202
  v_add_f32 v183, v183, v203
  s_waitcnt vmcnt(7)
  v_mfma_f32_16x16x32_bf16 v[244:247], a[164:167], v[40:43], v[244:247]
  s_waitcnt lgkmcnt(0)
  v_add_f32 v220, v220, v240
  v_add_f32 v221, v221, v241
  v_add_f32 v222, v222, v242
  v_add_f32 v223, v223, v243
  v_mfma_f32_16x16x32_bf16 v[224:227], a[164:167], v[44:47], v[224:227]
  v_add_f32 v180, v180, v220
  v_add_f32 v181, v181, v221
  v_add_f32 v182, v182, v222
  v_add_f32 v183, v183, v223
  v_mfma_f32_16x16x32_bf16 v[204:207], a[164:167], v[48:51], v[204:207]
  v_cvt_pk_bf16_f32 v180, v180, v181
  v_cvt_pk_bf16_f32 v181, v182, v183
  buffer_store_dwordx2 v[180:181], v250, s[20:23], s58 offen offset:96
  v_mfma_f32_16x16x32_bf16 v[184:187], a[164:167], v[52:55], v[184:187]
  s_waitcnt vmcnt(7)
  v_mfma_f32_16x16x32_bf16 v[244:247], a[168:171], v[112:115], v[244:247]
  v_mfma_f32_16x16x32_bf16 v[224:227], a[168:171], v[116:119], v[224:227]
  v_mfma_f32_16x16x32_bf16 v[204:207], a[168:171], v[120:123], v[204:207]
  v_mfma_f32_16x16x32_bf16 v[184:187], a[168:171], v[124:127], v[184:187]
  s_waitcnt vmcnt(6)
  v_mfma_f32_16x16x32_bf16 v[244:247], a[172:175], v[144:147], v[244:247]
  v_mfma_f32_16x16x32_bf16 v[224:227], a[172:175], v[148:151], v[224:227]
  v_mfma_f32_16x16x32_bf16 v[204:207], a[172:175], v[152:155], v[204:207]
  v_mfma_f32_16x16x32_bf16 v[184:187], a[172:175], v[156:159], v[184:187]
  s_waitcnt vmcnt(5)
  v_mfma_f32_16x16x32_bf16 v[244:247], a[176:179], v[24:27], v[244:247]
  v_mfma_f32_16x16x32_bf16 v[224:227], a[176:179], v[28:31], v[224:227]
  v_mfma_f32_16x16x32_bf16 v[204:207], a[176:179], v[32:35], v[204:207]
  v_mfma_f32_16x16x32_bf16 v[184:187], a[176:179], v[36:39], v[184:187]
  s_waitcnt vmcnt(4)
  v_mfma_f32_16x16x32_bf16 v[244:247], a[180:183], v[56:59], v[244:247]
  v_mfma_f32_16x16x32_bf16 v[224:227], a[180:183], v[60:63], v[224:227]
  v_mfma_f32_16x16x32_bf16 v[204:207], a[180:183], v[64:67], v[204:207]
  v_mfma_f32_16x16x32_bf16 v[184:187], a[180:183], v[68:71], v[184:187]
  s_nop 4
  ds_write_b128 v6, v[244:247] offset:4096
  ds_write_b128 v5, v[224:227] offset:4096
  ds_write_b128 v4, v[204:207] offset:4096
  s_waitcnt lgkmcnt(0)
  s_barrier
  ds_read_b128 v[204:207], v7 offset:4096
  ds_read_b128 v[224:227], v7 offset:9216
  ds_read_b128 v[244:247], v7 offset:14336
  s_waitcnt lgkmcnt(2)
  v_add_f32 v184, v184, v204
  v_add_f32 v185, v185, v205
  v_add_f32 v186, v186, v206
  v_add_f32 v187, v187, v207
  s_waitcnt lgkmcnt(0)
  v_add_f32 v224, v224, v244
  v_add_f32 v225, v225, v245
  v_add_f32 v226, v226, v246
  v_add_f32 v227, v227, v247
  v_add_f32 v184, v184, v224
  v_add_f32 v185, v185, v225
  v_add_f32 v186, v186, v226
  v_add_f32 v187, v187, v227
  v_cvt_pk_bf16_f32 v184, v184, v185
  v_cvt_pk_bf16_f32 v185, v186, v187
  buffer_store_dwordx2 v[184:185], v250, s[20:23], s58 offen offset:128
  s_or_b32 s75, s2, s60
  s_cmp_eq_u32 s75, 0
  s_cselect_b32 s75, 0, 1073741824
  s_add_u32 s75, s75, 19931136
  v_add_u32 v252, s75, v3
  buffer_store_dword v2, v252, s[12:15], 0 offen sc1
L_end:
  s_endpgm
L_retry0:
  s_mov_b32 s69, 0
L_loop0:
  s_mov_b64 exec, vcc
  buffer_load_dwordx2 v[252:253], v250, s[12:15], 0 offen sc1
  s_mov_b64 exec, -1
  s_waitcnt vmcnt(0)
  v_cmp_ne_u32 vcc, s63, v253
  s_add_u32 s69, s69, 1
  s_cmp_gt_u32 s69, 1048576
  s_cbranch_scc1 L_back0
  s_cbranch_vccz L_back0
  s_sleep 4
  s_branch L_loop0
L_retry1:
  s_mov_b32 s69, 0
L_loop1:
  s_mov_b64 exec, vcc
  buffer_load_dword v243, v244, s[12:15], 0 offen sc1
  s_mov_b64 exec, -1
  s_waitcnt vmcnt(0)
  v_cmp_ne_u32 vcc, s63, v243
  s_add_u32 s69, s69, 1
  s_cmp_gt_u32 s69, 1048576
  s_cbranch_scc1 L_back1
  s_cbranch_vccz L_back1
  s_sleep 4
  s_branch L_loop1
L_retry2:
  s_mov_b32 s69, 0
L_loop2:
  s_mov_b64 exec, vcc
  buffer_load_dwordx4 v[196:199], v34, s[12:15], s78 offen offset:0 sc1
  buffer_load_dwordx4 v[200:203], v34, s[12:15], s78 offen offset:1024 sc1
  buffer_load_dwordx4 v[204:207], v34, s[12:15], s78 offen offset:2048 sc1
  buffer_load_dwordx4 v[208:211], v20, s[12:15], s78 offen offset:3072 sc1
  s_mov_b64 exec, -1
  s_waitcnt vmcnt(0)
  v_mov_b32 v192, 0
  v_xor_b32 v193, s63, v197
  v_xor_b32 v194, s63, v199
  v_or3_b32 v192, v192, v193, v194
  v_xor_b32 v193, s63, v201
  v_xor_b32 v194, s63, v203
  v_or3_b32 v192, v192, v193, v194
  v_xor_b32 v193, s63, v205
  v_xor_b32 v194, s63, v207
  v_or3_b32 v192, v192, v193, v194
  v_xor_b32 v193, s63, v209
  v_xor_b32 v194, s63, v211
  v_or3_b32 v192, v192, v193, v194
  v_cmp_ne_u32 vcc, 0, v192
  s_add_u32 s69, s69, 1
  s_cmp_gt_u32 s69, 1048576
  s_cbranch_scc1 L_back2
  s_cbranch_vccz L_back2
  s_sleep 4
  s_branch L_loop2
L_retry3:
  s_mov_b32 s69, 0
L_loop3:
  s_mov_b64 exec, vcc
  buffer_load_dword v14, v254, s[12:15], 0 offen sc1
  s_mov_b64 exec, -1
  s_waitcnt vmcnt(0)
  v_cmp_ne_u32 vcc, s63, v14
  s_add_u32 s69, s69, 1
  s_cmp_gt_u32 s69, 1048576
  s_cbranch_scc1 L_back3
  s_cbranch_vccz L_back3
  s_sleep 4
  s_branch L_loop3
L_retry4:
  s_mov_b32 s69, 0
L_loop4:
  s_mov_b64 exec, vcc
  buffer_load_dwordx2 v[252:253], v250, s[12:15], 0 offen sc1
  s_mov_b64 exec, -1
  s_waitcnt vmcnt(0)
  v_cmp_ne_u32 vcc, s63, v253
  s_add_u32 s69, s69, 1
  s_cmp_gt_u32 s69, 1048576
  s_cbranch_scc1 L_back4
  s_cbranch_vccz L_back4
  s_sleep 4
  s_branch L_loop4
L_retry5:
  s_mov_b32 s69, 0
L_loop5:
  s_mov_b64 exec, vcc
  buffer_load_dword v243, v244, s[12:15], 0 offen sc1
  s_mov_b64 exec, -1
  s_waitcnt vmcnt(0)
  v_cmp_ne_u32 vcc, s63, v243
  s_add_u32 s69, s69, 1
  s_cmp_gt_u32 s69, 1048576
  s_cbranch_scc1 L_back5
  s_cbranch_vccz L_back5
  s_sleep 4
  s_branch L_loop5
L_retry6:
  s_mov_b32 s69, 0
L_loop6:
  s_mov_b64 exec, vcc
  buffer_load_dword v216, v39, s[12:15], 0 offen sc1
  s_mov_b64 exec, -1
  s_waitcnt vmcnt(0)
  v_cmp_ne_u32 vcc, s63, v216
  s_add_u32 s69, s69, 1
  s_cmp_gt_u32 s69, 1048576
  s_cbranch_scc1 L_back6
  s_cbranch_vccz L_back6
  s_sleep 4
  s_branch L_loop6
L_retry7:
  s_mov_b32 s69, 0
L_loop7:
  s_mov_b64 exec, vcc
  buffer_load_dwordx2 v[236:237], v239, s[12:15], 0 offen sc1
  s_mov_b64 exec, -1
  s_waitcnt vmcnt(0)
  v_cmp_ne_u32 vcc, s63, v237
  s_add_u32 s69, s69, 1
  s_cmp_gt_u32 s69, 1048576
  s_cbranch_scc1 L_back7
  s_cbranch_vccz L_back7
  s_sleep 4
  s_branch L_loop7
L_retry8:
  s_mov_b32 s69, 0
L_loop8:
  s_mov_b64 exec, vcc
  buffer_load_dwordx2 v[252:253], v250, s[12:15], 0 offen sc1
  s_mov_b64 exec, -1
  s_waitcnt vmcnt(0)
  v_cmp_ne_u32 vcc, s63, v253
  s_add_u32 s69, s69, 1
  s_cmp_gt_u32 s69, 1048576
  s_cbranch_scc1 L_back8
  s_cbranch_vccz L_back8
  s_sleep 4
  s_branch L_loop8
L_retry9:
  s_mov_b32 s69, 0
L_loop9:
  s_mov_b64 exec, vcc
  buffer_load_dword v243, v244, s[12:15], 0 offen sc1
  s_mov_b64 exec, -1
  s_waitcnt vmcnt(0)
  v_cmp_ne_u32 vcc, s63, v243
  s_add_u32 s69, s69, 1
  s_cmp_gt_u32 s69, 1048576
  s_cbranch_scc1 L_back9
  s_cbranch_vccz L_back9
  s_sleep 4
  s_branch L_loop9
L_retry10:
  s_mov_b32 s69, 0
L_loop10:
  s_mov_b64 exec, vcc
  buffer_load_dword v245, v247, s[12:15], 0 offen sc1
  s_mov_b64 exec, -1
  s_waitcnt vmcnt(0)
  v_cmp_ne_u32 vcc, s63, v245
  s_add_u32 s69, s69, 1
  s_cmp_gt_u32 s69, 1048576
  s_cbranch_scc1 L_back10
  s_cbranch_vccz L_back10
  s_sleep 4
  s_branch L_loop10
L_retry11:
  s_mov_b32 s69, 0
L_loop11:
  s_mov_b64 exec, vcc
  buffer_load_dword v14, v254, s[12:15], 0 offen sc1
  s_mov_b64 exec, -1
  s_waitcnt vmcnt(0)
  v_cmp_ne_u32 vcc, s63, v14
  s_add_u32 s69, s69, 1
  s_cmp_gt_u32 s69, 1048576
  s_cbranch_scc1 L_back11
  s_cbranch_vccz L_back11
  s_sleep 4
  s_branch L_loop11
L_retry12:
  s_mov_b32 s69, 0
L_loop12:
  s_mov_b64 exec, vcc
  buffer_load_dword v14, v15, s[12:15], 0 offen sc1
  s_mov_b64 exec, -1
  s_waitcnt vmcnt(0)
  v_cmp_ne_u32 vcc, s63, v14
  s_add_u32 s69, s69, 1
  s_cmp_gt_u32 s69, 1048576
  s_cbranch_scc1 L_back12
  s_cbranch_vccz L_back12
  s_sleep 4
  s_branch L_loop12
L_retry13:
  s_mov_b32 s69, 0
L_loop13:
  s_mov_b64 exec, vcc
  buffer_load_dword v14, v254, s[12:15], 0 offen sc1
  s_mov_b64 exec, -1
  s_waitcnt vmcnt(0)
  v_cmp_ne_u32 vcc, s63, v14
  s_add_u32 s69, s69, 1
  s_cmp_gt_u32 s69, 1048576
  s_cbranch_scc1 L_back13
  s_cbranch_vccz L_back13
  s_sleep 4
  s_branch L_loop13
L_retry14:
  s_mov_b32 s69, 0
L_loop14:
  s_mov_b64 exec, vcc
  buffer_load_dword v14, v15, s[12:15], 0 offen sc1
  s_mov_b64 exec, -1
  s_waitcnt vmcnt(0)
  v_cmp_ne_u32 vcc, s63, v14
  s_add_u32 s69, s69, 1
  s_cmp_gt_u32 s69, 1048576
  s_cbranch_scc1 L_back14
  s_cbranch_vccz L_back14
  s_sleep 4
  s_branch L_loop14
L_code_end:
  s_endpgm
.section .rodata,"a"
.p2align 6
.amdhsa_kernel gated_mix__linear_attn_block__mixer_gmlp__prompt_kernel
  .amdhsa_next_free_vgpr 512
  .amdhsa_next_free_sgpr 102
  .amdhsa_accum_offset 256
  .amdhsa_group_segment_fixed_size 0
  .amdhsa_kernarg_size 96
  .amdhsa_user_sgpr_count 2
  .amdhsa_user_sgpr_kernarg_segment_ptr 1
  .amdhsa_system_sgpr_workgroup_id_x 1
  .amdhsa_float_denorm_mode_32 3
.end_amdhsa_kernel
```
